```python
import torch

def _softmax(x, axis=-1):
    return torch.softmax(x, dim=axis)
def _gelu(x):
    return torch.nn.functional.gelu(x, approximate="tanh")
def _silu(x):
    return torch.nn.functional.silu(x)
def _sigmoid(x):
    return torch.sigmoid(x)
def _layernorm(x, axis=-1, eps=1e-5):
    m = x.mean(dim=axis, keepdim=True)
    v = x.var(dim=axis, keepdim=True, unbiased=False)
    return (x - m) / torch.sqrt(v + eps)
def _scatter_add(tgt, idx, src, axis=0):
    return tgt.clone().index_add_(axis, idx, src)
def _segment_sum(src, seg, n):
    out = torch.zeros((n,) + src.shape[1:], dtype=src.dtype)
    return out.index_add_(0, seg, src)
def _pad(x, pw):
    flat = tuple(v for pair in reversed(pw) for v in pair)
    return torch.nn.functional.pad(x, flat)

kernel_name = 'standalone__modern_conv_block_slak__vision'

def setup_inputs():

    _w = (lambda a: (lambda t: t.to(torch.bfloat16) if t.is_floating_point() else t)(torch.as_tensor(a)))
    H = W = 512
    C = 96
    K = 3
    return {
        "x": _w((lambda *s: torch.randn(*s, dtype=torch.bfloat16) * 0.05)(1, H, W, C)),
        "dw": _w((lambda *s: torch.randn(*s, dtype=torch.bfloat16) * 0.05)(K, K, C)),
        "w1": _w((lambda *s: torch.randn(*s, dtype=torch.bfloat16) * 0.05)(C, 4 * C)),
        "w2": _w((lambda *s: torch.randn(*s, dtype=torch.bfloat16) * 0.05)(4 * C, C)),
        "grn_g": _w((lambda *s: torch.randn(*s, dtype=torch.bfloat16) * 0.05)(4 * C)),
        "grn_b": _w((lambda *s: torch.randn(*s, dtype=torch.bfloat16) * 0.05)(4 * C)),
    }

def reference(x, dw, w1, w2, grn_g, grn_b):
    B, H, W, C = x.shape
    K = dw.shape[0]
    pad = K // 2
    xp = _pad(x, ((0,0),(pad,pad),(pad,pad),(0,0)))
    out = torch.zeros_like(x)
    for i in range(K):
        for j in range(K):
            out = out + xp[:, i:i+H, j:j+W, :] * dw[i, j][None, None, None, :]
    h = _layernorm(out, axis=-1)
    h = _gelu(h @ w1)
    gx = torch.sqrt((h * h).sum(axis=(1, 2), keepdims=True) + 1e-6)
    nx = gx / (gx.mean(axis=-1, keepdims=True) + 1e-6)
    h = grn_g[None, None, None, :] * (h * nx) + grn_b[None, None, None, :] + h
    return x + h @ w2
```

```asm
; @launch grid=(256,1,1) block=(256,1,1) lds=163840
.amdgcn_target "amdgcn-amd-amdhsa--gfx950"
.text
.globl standalone__modern_conv_block_slak__vision_kernel
.p2align 8
.type standalone__modern_conv_block_slak__vision_kernel,@function
standalone__modern_conv_block_slak__vision_kernel:
s_cmp_ge_u32 s2, 0x100
s_cbranch_scc1 L_exit
s_load_dwordx16 s[44:59], s[0:1], 0
s_load_dwordx2 s[60:61], s[0:1], 64
s_getpc_b64 s[40:41]
L_pc:
s_sub_u32 s40, s40, 32
s_subb_u32 s41, s41, 0
v_and_b32 v47, 63, v0
v_lshlrev_b32 v158, 5, v0
v_mov_b32 v159, 0
s_mov_b32 s42, 8192
s_mov_b32 s43, 0
v_lshl_add_u64 v[158:159], v[158:159], 0, s[40:41]
global_load_dword a255, v[158:159], off
v_lshl_add_u64 v[158:159], v[158:159], 0, s[42:43]
global_load_dword a255, v[158:159], off
v_lshl_add_u64 v[158:159], v[158:159], 0, s[42:43]
v_lshrrev_b32 v46, 6, v0
v_lshlrev_b32 v1, 4, v47
v_readfirstlane_b32 s62, v46
s_and_b32 s91, s2, 7
s_lshr_b32 s65, s2, 3
s_lshr_b32 s66, s65, 4
s_lshl_b32 s63, s91, 1
s_add_u32 s63, s63, s66
s_lshl_b32 s63, s63, 5
s_and_b32 s64, s65, 15
s_lshl_b32 s64, s64, 5
v_and_b32 v48, 31, v47
v_lshrrev_b32 v49, 5, v47
s_lshl_b32 s67, s63, 9
s_add_u32 s67, s67, s64
s_sub_u32 s67, s67, 513
s_mul_i32 s67, s67, 0xc0
s_sub_u32 s66, s64, 1
v_mov_b32 v55, 0x80000000
s_lshl_b32 s68, s62, 6
s_add_u32 s65, s68, 0
v_add_u32 v50, s65, v47
s_lshl_b32 s70, s65, 4
v_mul_u32_u24 v51, 482, v50
v_lshrrev_b32 v51, 16, v51
v_mul_u32_u24 v52, 136, v51
v_sub_u32 v52, v50, v52
v_lshrrev_b32 v53, 2, v52
v_lshrrev_b32 v54, 4, v52
v_xor_b32 v52, v52, v54
v_and_b32 v52, 3, v52
v_lshl_add_u32 v51, v51, 9, v53
v_add_u32 v53, s66, v53
v_mul_u32_u24 v51, 0xc0, v51
v_cmp_gt_u32 vcc, 0x200, v53
v_lshl_add_u32 v51, v52, 4, v51
v_add_u32 v51, s67, v51
v_cndmask_b32 v12, v55, v51, vcc
s_add_u32 s65, s68, 256
v_add_u32 v50, s65, v47
s_lshl_b32 s71, s65, 4
v_mul_u32_u24 v51, 482, v50
v_lshrrev_b32 v51, 16, v51
v_mul_u32_u24 v52, 136, v51
v_sub_u32 v52, v50, v52
v_lshrrev_b32 v53, 2, v52
v_lshrrev_b32 v54, 4, v52
v_xor_b32 v52, v52, v54
v_and_b32 v52, 3, v52
v_lshl_add_u32 v51, v51, 9, v53
v_add_u32 v53, s66, v53
v_mul_u32_u24 v51, 0xc0, v51
v_cmp_gt_u32 vcc, 0x200, v53
v_lshl_add_u32 v51, v52, 4, v51
v_add_u32 v51, s67, v51
v_cndmask_b32 v13, v55, v51, vcc
s_add_u32 s65, s68, 512
v_add_u32 v50, s65, v47
s_lshl_b32 s72, s65, 4
v_mul_u32_u24 v51, 482, v50
v_lshrrev_b32 v51, 16, v51
v_mul_u32_u24 v52, 136, v51
v_sub_u32 v52, v50, v52
v_lshrrev_b32 v53, 2, v52
v_lshrrev_b32 v54, 4, v52
v_xor_b32 v52, v52, v54
v_and_b32 v52, 3, v52
v_lshl_add_u32 v51, v51, 9, v53
v_add_u32 v53, s66, v53
v_mul_u32_u24 v51, 0xc0, v51
v_cmp_gt_u32 vcc, 0x200, v53
v_lshl_add_u32 v51, v52, 4, v51
v_add_u32 v51, s67, v51
v_cndmask_b32 v14, v55, v51, vcc
s_add_u32 s65, s68, 768
v_add_u32 v50, s65, v47
s_lshl_b32 s73, s65, 4
v_mul_u32_u24 v51, 482, v50
v_lshrrev_b32 v51, 16, v51
v_mul_u32_u24 v52, 136, v51
v_sub_u32 v52, v50, v52
v_lshrrev_b32 v53, 2, v52
v_lshrrev_b32 v54, 4, v52
v_xor_b32 v52, v52, v54
v_and_b32 v52, 3, v52
v_lshl_add_u32 v51, v51, 9, v53
v_add_u32 v53, s66, v53
v_mul_u32_u24 v51, 0xc0, v51
v_cmp_gt_u32 vcc, 0x200, v53
v_lshl_add_u32 v51, v52, 4, v51
v_add_u32 v51, s67, v51
v_cndmask_b32 v15, v55, v51, vcc
s_add_u32 s65, s68, 1024
v_add_u32 v50, s65, v47
s_lshl_b32 s74, s65, 4
v_mul_u32_u24 v51, 482, v50
v_lshrrev_b32 v51, 16, v51
v_mul_u32_u24 v52, 136, v51
v_sub_u32 v52, v50, v52
v_lshrrev_b32 v53, 2, v52
v_lshrrev_b32 v54, 4, v52
v_xor_b32 v52, v52, v54
v_and_b32 v52, 3, v52
v_lshl_add_u32 v51, v51, 9, v53
v_add_u32 v53, s66, v53
v_mul_u32_u24 v51, 0xc0, v51
v_cmp_gt_u32 vcc, 0x200, v53
v_lshl_add_u32 v51, v52, 4, v51
v_add_u32 v51, s67, v51
v_cndmask_b32 v16, v55, v51, vcc
s_add_u32 s65, s68, 1280
s_min_u32 s65, s65, 1296
v_add_u32 v50, s65, v47
s_lshl_b32 s75, s65, 4
v_mul_u32_u24 v51, 482, v50
v_lshrrev_b32 v51, 16, v51
v_mul_u32_u24 v52, 136, v51
v_sub_u32 v52, v50, v52
v_lshrrev_b32 v53, 2, v52
v_lshrrev_b32 v54, 4, v52
v_xor_b32 v52, v52, v54
v_and_b32 v52, 3, v52
v_lshl_add_u32 v51, v51, 9, v53
v_add_u32 v53, s66, v53
v_mul_u32_u24 v51, 0xc0, v51
v_cmp_gt_u32 vcc, 0x200, v53
v_lshl_add_u32 v51, v52, 4, v51
v_add_u32 v51, s67, v51
v_cndmask_b32 v17, v55, v51, vcc
s_cmp_ge_u32 s62, 2
s_cselect_b32 s75, 0x18000, s75
s_cselect_b64 vcc, -1, 0
v_cndmask_b32 v17, v17, v55, vcc
v_mul_u32_u24 v50, 12, v48
v_mul_u32_u24 v51, 3072, v49
v_add_u32 v31, v50, v51
s_mov_b32 s89, 64
s_movk_i32 s90, 0x80
s_waitcnt lgkmcnt(0)
s_mov_b32 s4, s44
s_and_b32 s5, s45, 0xffff
s_mov_b32 s6, 50331648
s_mov_b32 s7, 0x20000
s_mov_b32 s16, s48
s_and_b32 s17, s49, 0xffff
s_mov_b32 s18, 73728
s_mov_b32 s19, 0x20000
s_add_u32 m0, s70, 71680
s_nop 0
buffer_load_dwordx4 v12, s[4:7], 0 offen  lds
s_add_u32 m0, s71, 71680
s_nop 0
buffer_load_dwordx4 v13, s[4:7], 0 offen  lds
s_add_u32 m0, s72, 71680
s_nop 0
buffer_load_dwordx4 v14, s[4:7], 0 offen  lds
s_add_u32 m0, s73, 71680
s_nop 0
buffer_load_dwordx4 v15, s[4:7], 0 offen  lds
s_add_u32 m0, s74, 71680
s_nop 0
buffer_load_dwordx4 v16, s[4:7], 0 offen  lds
s_add_u32 m0, s75, 71680
s_nop 0
buffer_load_dwordx4 v17, s[4:7], 0 offen  lds
v_lshrrev_b32 v51, 5, v0
v_add_u32 v51, 0, v51
v_mul_u32_u24 v52, 57, v51
v_lshrrev_b32 v52, 9, v52
v_mul_u32_u24 v53, 9, v52
v_sub_u32 v53, v51, v53
v_mul_u32_u24 v53, 96, v53
v_lshl_add_u32 v53, v52, 5, v53
v_add_lshl_u32 v22, v53, v48, 1
v_lshrrev_b32 v51, 5, v0
v_add_u32 v51, 8, v51
v_mul_u32_u24 v52, 57, v51
v_lshrrev_b32 v52, 9, v52
v_mul_u32_u24 v53, 9, v52
v_sub_u32 v53, v51, v53
v_mul_u32_u24 v53, 96, v53
v_lshl_add_u32 v53, v52, 5, v53
v_add_lshl_u32 v23, v53, v48, 1
v_lshrrev_b32 v51, 5, v0
v_add_u32 v51, 16, v51
v_mul_u32_u24 v52, 57, v51
v_lshrrev_b32 v52, 9, v52
v_mul_u32_u24 v53, 9, v52
v_sub_u32 v53, v51, v53
v_mul_u32_u24 v53, 96, v53
v_lshl_add_u32 v53, v52, 5, v53
v_add_lshl_u32 v24, v53, v48, 1
v_lshrrev_b32 v51, 5, v0
v_add_u32 v51, 24, v51
v_mul_u32_u24 v52, 57, v51
v_lshrrev_b32 v52, 9, v52
v_mul_u32_u24 v53, 9, v52
v_sub_u32 v53, v51, v53
v_mul_u32_u24 v53, 96, v53
v_lshl_add_u32 v53, v52, 5, v53
v_add_lshl_u32 v25, v53, v48, 1
s_mul_i32 s65, s62, 3
s_add_u32 s65, s65, 0
s_lshr_b32 s66, s65, 1
s_and_b32 s65, s65, 1
s_mul_i32 s67, s65, 36
s_add_u32 s67, s67, s66
s_mul_i32 s66, s66, 12288
s_mul_i32 s65, s65, 384
s_add_u32 s76, s65, s66
s_add_u32 s77, s76, 6144
s_cmp_ge_u32 s67, 40
s_cselect_b32 s68, 85760, 0
s_lshl_b32 s67, s67, 10
v_add_u32 v32, s67, v1
v_add_u32 v33, s68, v32
s_mul_i32 s65, s62, 3
s_add_u32 s65, s65, 1
s_lshr_b32 s66, s65, 1
s_and_b32 s65, s65, 1
s_mul_i32 s67, s65, 36
s_add_u32 s67, s67, s66
s_mul_i32 s66, s66, 12288
s_mul_i32 s65, s65, 384
s_add_u32 s78, s65, s66
s_add_u32 s79, s78, 6144
s_cmp_ge_u32 s67, 40
s_cselect_b32 s68, 85760, 0
s_lshl_b32 s67, s67, 10
v_add_u32 v34, s67, v1
v_add_u32 v35, s68, v34
s_mul_i32 s65, s62, 3
s_add_u32 s65, s65, 2
s_lshr_b32 s66, s65, 1
s_and_b32 s65, s65, 1
s_mul_i32 s67, s65, 36
s_add_u32 s67, s67, s66
s_mul_i32 s66, s66, 12288
s_mul_i32 s65, s65, 384
s_add_u32 s80, s65, s66
s_add_u32 s81, s80, 6144
s_cmp_ge_u32 s67, 40
s_cselect_b32 s68, 85760, 0
s_lshl_b32 s67, s67, 10
v_add_u32 v36, s67, v1
v_add_u32 v37, s68, v36
s_mov_b32 s24, s46
s_and_b32 s25, s47, 0xffff
s_mov_b32 s26, 1728
s_mov_b32 s27, 0x20000
buffer_load_ushort v22, v22, s[24:27], 0 offen
buffer_load_ushort v23, v23, s[24:27], 0 offen
buffer_load_ushort v24, v24, s[24:27], 0 offen
buffer_load_ushort v25, v25, s[24:27], 0 offen
s_mov_b32 s20, s50
s_and_b32 s21, s51, 0xffff
s_mov_b32 s22, 73728
s_mov_b32 s23, 0x20000
s_mov_b32 s28, s52
s_and_b32 s29, s53, 0xffff
s_mov_b32 s30, 768
s_mov_b32 s31, 0x20000
s_mov_b32 s32, s54
s_and_b32 s33, s55, 0xffff
s_mov_b32 s34, 768
s_mov_b32 s35, 0x20000
s_mov_b32 s8, s56
s_and_b32 s9, s57, 0xffff
s_mov_b32 s10, 50331648
s_mov_b32 s11, 0x20000
s_mov_b32 s36, s58
s_and_b32 s37, s59, 0xffff
s_mov_b32 s38, 256
s_mov_b32 s39, 0x20000
s_mov_b32 s12, s60
s_and_b32 s13, s61, 0xffff
s_mov_b32 s14, 77594624
s_mov_b32 s15, 0x20000
s_mov_b32 s44, s76
s_mov_b32 s45, s77
s_mov_b32 s46, s78
s_mov_b32 s47, s79
s_mov_b32 s48, s80
s_mov_b32 s49, s81
v_min_u32 v50, 47, v47
s_mul_i32 s65, s62, 96
v_lshl_add_u32 v50, v50, 1, s65
v_and_b32 v52, 31, v50
v_lshrrev_b32 v51, 5, v50
v_mad_u32_u24 v52, v52, 6, v51
s_cmp_ge_u32 s62, 2
s_cselect_b32 s65, 186, 0
v_add_lshl_u32 v21, v52, s65, 1
s_sub_u32 s65, 3, s62
s_lshl_b32 s65, s65, 3
s_add_u32 s65, s65, s2
s_cmp_ge_u32 s65, 8
s_cselect_b32 s61, 0x7ff00000, 0
s_lshl_b32 s50, s91, 11
s_lshl_b32 s66, s91, 8
s_add_u32 s51, s66, 0x10000
v_and_b32 v26, 7, v47
v_lshl_add_u32 v26, v26, 11, s61
v_add_u32 v27, s61, v1
v_accvgpr_write_b32 a248, 0
v_accvgpr_write_b32 a249, 0
v_accvgpr_write_b32 a250, 0
v_accvgpr_write_b32 a251, 0
v_add_u32 v2, 0x10000, v1
v_add_u32 v3, 0x20000, v1
s_mov_b32 s84, 0x44ea44ea
s_mov_b32 s85, 93952
s_mov_b32 s87, 0x77800000
s_mov_b32 s86, 0x06eff558
v_and_b32 v50, 3, v48
v_xor_b32 v51, 1, v50
v_lshl_or_b32 v50, v51, 2, v50
v_mul_u32_u24 v4, 0x1111, v50
v_bfe_u32 v50, v48, 3, 1
v_lshlrev_b32 v51, 4, v48
v_add_u32 v51, 143616, v51
v_cmp_eq_u32 vcc, v50, v49
v_mov_b32 v52, 0x40000000
s_nop 0
v_cndmask_b32 v5, v52, v51, vcc
s_mul_i32 s65, s62, 4352
s_add_u32 s65, s65, 71680
v_add_u32 v50, 0, v48
v_bfe_u32 v51, v50, 2, 2
v_lshlrev_b32 v52, 1, v49
v_xor_b32 v51, v51, v52
v_lshl_add_u32 v51, v50, 2, v51
v_lshl_add_u32 v6, v51, 4, s65
v_xor_b32 v51, 1, v51
v_lshl_add_u32 v7, v51, 4, s65
v_add_u32 v50, 1, v48
v_bfe_u32 v51, v50, 2, 2
v_lshlrev_b32 v52, 1, v49
v_xor_b32 v51, v51, v52
v_lshl_add_u32 v51, v50, 2, v51
v_lshl_add_u32 v8, v51, 4, s65
v_xor_b32 v51, 1, v51
v_lshl_add_u32 v9, v51, 4, s65
v_add_u32 v50, 2, v48
v_bfe_u32 v51, v50, 2, 2
v_lshlrev_b32 v52, 1, v49
v_xor_b32 v51, v51, v52
v_lshl_add_u32 v51, v50, 2, v51
v_lshl_add_u32 v10, v51, 4, s65
v_xor_b32 v51, 1, v51
v_lshl_add_u32 v11, v51, 4, s65
s_lshl_b32 s65, s62, 1
s_add_u32 s65, s65, s63
s_lshl_b32 s65, s65, 9
s_add_u32 s65, s65, s64
s_mul_i32 s76, s65, 0xc0
s_cmp_ge_u32 s62, 1
s_cselect_b32 s69, 6912, 0
s_lshl_b32 s65, s62, 10
s_add_u32 s65, s65, 92160
s_add_u32 s69, s69, s65
s_mul_i32 s65, s2, 294912
s_mul_i32 s3, s62, 73728
s_add_u32 s65, s65, s3
s_add_u32 s3, s65, 2097152
s_add_u32 s77, s76, 98304
s_add_u32 s78, s76, 786432
s_add_u32 s79, s76, 884736
s_add_u32 s80, s76, 1572864
s_add_u32 s81, s76, 1671168
s_add_u32 s82, s76, 2359296
s_add_u32 s83, s76, 2457600
v_bfe_u32 v50, v48, 2, 1
v_cmp_eq_u32 vcc, v50, v49
v_lshrrev_b32 v50, 3, v48
v_bfe_u32 v51, v48, 1, 1
v_lshl_or_b32 v50, v50, 1, v51
v_mov_b32 v51, 15
v_cndmask_b32 v50, v51, v50, vcc
v_and_b32 v51, 1, v48
v_lshlrev_b32 v51, 4, v51
v_mov_b32 v52, 0x3c00
v_lshlrev_b32 v52, v51, v52
v_cmp_eq_u32 vcc, 0, v50
s_nop 1
v_cndmask_b32 v53, 0, v52, vcc
v_accvgpr_write_b32 a240, v53
v_cmp_eq_u32 vcc, 1, v50
s_nop 1
v_cndmask_b32 v54, 0, v52, vcc
v_accvgpr_write_b32 a241, v54
v_cmp_eq_u32 vcc, 2, v50
s_nop 1
v_cndmask_b32 v53, 0, v52, vcc
v_accvgpr_write_b32 a242, v53
v_cmp_eq_u32 vcc, 3, v50
s_nop 1
v_cndmask_b32 v54, 0, v52, vcc
v_accvgpr_write_b32 a243, v54
v_cmp_eq_u32 vcc, 4, v50
s_nop 1
v_cndmask_b32 v53, 0, v52, vcc
v_accvgpr_write_b32 a244, v53
v_cmp_eq_u32 vcc, 5, v50
s_nop 1
v_cndmask_b32 v54, 0, v52, vcc
v_accvgpr_write_b32 a245, v54
v_cmp_eq_u32 vcc, 6, v50
s_nop 1
v_cndmask_b32 v53, 0, v52, vcc
v_accvgpr_write_b32 a246, v53
v_cmp_eq_u32 vcc, 7, v50
s_nop 1
v_cndmask_b32 v54, 0, v52, vcc
v_accvgpr_write_b32 a247, v54
v_lshrrev_b32 v42, 4, v48
v_bfe_u32 v51, v48, 2, 1
v_lshl_or_b32 v42, v42, 1, v51
v_lshlrev_b32 v43, 4, v0
v_add_u32 v43, 143616, v43
s_lshl_b32 s65, s62, 2
s_add_u32 s65, s65, 93440
v_mov_b32 v30, s65
v_mov_b32 v57, 0
ds_write_b32 v30, v57
ds_write_b32 v30, v57 offset:16
v_and_b32 v51, 3, v48
v_lshlrev_b32 v51, 2, v51
v_add_u32 v45, 93456, v51
v_add_u32 v44, 16, v30
v_lshlrev_b32 v46, 17, v0
v_or_b32 v46, 0x8000, v46
v_mov_b32 v48, 0x409d30fc
v_lshlrev_b32 v60, 2, v0
v_add_u32 v61, 159488, v60
v_add_u32 v60, 93952, v60
v_add_u32 v50, 0, v46
v_add_u32 v51, 0x10000, v46
v_pk_mul_f32 v[50:51], v[50:51], s[86:87] op_sel:[0,1] op_sel_hi:[1,1] neg_lo:[1,0] neg_hi:[1,0]
v_pk_fma_f32 v[52:53], v[50:51], v[50:51], v[48:49] op_sel_hi:[1,1,0]
v_add_u32 v54, 0x2000000, v46
v_pk_mul_f32 v[52:53], v[50:51], v[52:53]
v_add_u32 v55, 0x2010000, v46
v_exp_f32 v52, v52
v_pk_mul_f32 v[54:55], v[54:55], s[86:87] op_sel:[0,1] op_sel_hi:[1,1] neg_lo:[1,0] neg_hi:[1,0]
v_exp_f32 v53, v53
v_pk_fma_f32 v[56:57], v[54:55], v[54:55], v[48:49] op_sel_hi:[1,1,0]
v_pk_add_f32 v[52:53], v[52:53], 1.0 op_sel_hi:[1,0]
v_pk_mul_f32 v[56:57], v[54:55], v[56:57]
v_rcp_f32 v52, v52
v_exp_f32 v56, v56
v_rcp_f32 v53, v53
v_exp_f32 v57, v57
v_pk_mul_f32 v[50:51], v[50:51], v[52:53]
v_pk_add_f32 v[56:57], v[56:57], 1.0 op_sel_hi:[1,0]
v_pk_mul_f32 v[50:51], v[50:51], v[50:51]
v_rcp_f32 v56, v56
v_cvt_pk_bf16_f32 v58, v50, v51
v_rcp_f32 v57, v57
s_nop 0
v_pk_mul_f32 v[54:55], v[54:55], v[56:57]
v_pk_mul_f32 v[54:55], v[54:55], v[54:55]
v_cvt_pk_bf16_f32 v59, v54, v55
ds_write_b32 v60, v58 offset:0
ds_write_b32 v60, v59 offset:1024
v_add_u32 v50, 0x4000000, v46
v_add_u32 v51, 0x4010000, v46
v_pk_mul_f32 v[50:51], v[50:51], s[86:87] op_sel:[0,1] op_sel_hi:[1,1] neg_lo:[1,0] neg_hi:[1,0]
v_pk_fma_f32 v[52:53], v[50:51], v[50:51], v[48:49] op_sel_hi:[1,1,0]
v_add_u32 v54, 0x6000000, v46
v_pk_mul_f32 v[52:53], v[50:51], v[52:53]
v_add_u32 v55, 0x6010000, v46
v_exp_f32 v52, v52
v_pk_mul_f32 v[54:55], v[54:55], s[86:87] op_sel:[0,1] op_sel_hi:[1,1] neg_lo:[1,0] neg_hi:[1,0]
v_exp_f32 v53, v53
v_pk_fma_f32 v[56:57], v[54:55], v[54:55], v[48:49] op_sel_hi:[1,1,0]
v_pk_add_f32 v[52:53], v[52:53], 1.0 op_sel_hi:[1,0]
v_pk_mul_f32 v[56:57], v[54:55], v[56:57]
v_rcp_f32 v52, v52
v_exp_f32 v56, v56
v_rcp_f32 v53, v53
v_exp_f32 v57, v57
v_pk_mul_f32 v[50:51], v[50:51], v[52:53]
v_pk_add_f32 v[56:57], v[56:57], 1.0 op_sel_hi:[1,0]
v_pk_mul_f32 v[50:51], v[50:51], v[50:51]
v_rcp_f32 v56, v56
v_cvt_pk_bf16_f32 v58, v50, v51
v_rcp_f32 v57, v57
s_nop 0
v_pk_mul_f32 v[54:55], v[54:55], v[56:57]
v_pk_mul_f32 v[54:55], v[54:55], v[54:55]
v_cvt_pk_bf16_f32 v59, v54, v55
ds_write_b32 v60, v58 offset:2048
ds_write_b32 v60, v59 offset:3072
v_add_u32 v50, 0x8000000, v46
v_add_u32 v51, 0x8010000, v46
v_pk_mul_f32 v[50:51], v[50:51], s[86:87] op_sel:[0,1] op_sel_hi:[1,1] neg_lo:[1,0] neg_hi:[1,0]
v_pk_fma_f32 v[52:53], v[50:51], v[50:51], v[48:49] op_sel_hi:[1,1,0]
v_add_u32 v54, 0xa000000, v46
v_pk_mul_f32 v[52:53], v[50:51], v[52:53]
v_add_u32 v55, 0xa010000, v46
v_exp_f32 v52, v52
v_pk_mul_f32 v[54:55], v[54:55], s[86:87] op_sel:[0,1] op_sel_hi:[1,1] neg_lo:[1,0] neg_hi:[1,0]
v_exp_f32 v53, v53
v_pk_fma_f32 v[56:57], v[54:55], v[54:55], v[48:49] op_sel_hi:[1,1,0]
v_pk_add_f32 v[52:53], v[52:53], 1.0 op_sel_hi:[1,0]
v_pk_mul_f32 v[56:57], v[54:55], v[56:57]
v_rcp_f32 v52, v52
v_exp_f32 v56, v56
v_rcp_f32 v53, v53
v_exp_f32 v57, v57
v_pk_mul_f32 v[50:51], v[50:51], v[52:53]
v_pk_add_f32 v[56:57], v[56:57], 1.0 op_sel_hi:[1,0]
v_pk_mul_f32 v[50:51], v[50:51], v[50:51]
v_rcp_f32 v56, v56
v_cvt_pk_bf16_f32 v58, v50, v51
v_rcp_f32 v57, v57
s_nop 0
v_pk_mul_f32 v[54:55], v[54:55], v[56:57]
v_pk_mul_f32 v[54:55], v[54:55], v[54:55]
v_cvt_pk_bf16_f32 v59, v54, v55
ds_write_b32 v60, v58 offset:4096
ds_write_b32 v60, v59 offset:5120
v_add_u32 v50, 0, v46
v_add_u32 v51, 0x10000, v46
v_pk_mul_f32 v[50:51], v[50:51], s[86:87] op_sel:[0,1] op_sel_hi:[1,1]
v_pk_fma_f32 v[52:53], v[50:51], v[50:51], v[48:49] op_sel_hi:[1,1,0]
v_add_u32 v54, 0x2000000, v46
v_pk_mul_f32 v[52:53], v[50:51], v[52:53]
v_add_u32 v55, 0x2010000, v46
v_exp_f32 v52, v52
v_pk_mul_f32 v[54:55], v[54:55], s[86:87] op_sel:[0,1] op_sel_hi:[1,1]
v_exp_f32 v53, v53
v_pk_fma_f32 v[56:57], v[54:55], v[54:55], v[48:49] op_sel_hi:[1,1,0]
v_pk_add_f32 v[52:53], v[52:53], 1.0 op_sel_hi:[1,0]
v_pk_mul_f32 v[56:57], v[54:55], v[56:57]
v_rcp_f32 v52, v52
v_exp_f32 v56, v56
v_rcp_f32 v53, v53
v_exp_f32 v57, v57
v_pk_mul_f32 v[50:51], v[50:51], v[52:53]
v_pk_add_f32 v[56:57], v[56:57], 1.0 op_sel_hi:[1,0]
v_pk_mul_f32 v[50:51], v[50:51], v[50:51]
v_rcp_f32 v56, v56
v_cvt_pk_bf16_f32 v58, v50, v51
v_rcp_f32 v57, v57
s_nop 0
v_pk_mul_f32 v[54:55], v[54:55], v[56:57]
v_pk_mul_f32 v[54:55], v[54:55], v[54:55]
v_cvt_pk_bf16_f32 v59, v54, v55
ds_write_b32 v61, v58 offset:0
ds_write_b32 v61, v59 offset:1024
v_add_u32 v50, 0x4000000, v46
v_add_u32 v51, 0x4010000, v46
v_pk_mul_f32 v[50:51], v[50:51], s[86:87] op_sel:[0,1] op_sel_hi:[1,1]
v_pk_fma_f32 v[52:53], v[50:51], v[50:51], v[48:49] op_sel_hi:[1,1,0]
v_add_u32 v54, 0x6000000, v46
v_pk_mul_f32 v[52:53], v[50:51], v[52:53]
v_add_u32 v55, 0x6010000, v46
v_exp_f32 v52, v52
v_pk_mul_f32 v[54:55], v[54:55], s[86:87] op_sel:[0,1] op_sel_hi:[1,1]
v_exp_f32 v53, v53
v_pk_fma_f32 v[56:57], v[54:55], v[54:55], v[48:49] op_sel_hi:[1,1,0]
v_pk_add_f32 v[52:53], v[52:53], 1.0 op_sel_hi:[1,0]
v_pk_mul_f32 v[56:57], v[54:55], v[56:57]
v_rcp_f32 v52, v52
v_exp_f32 v56, v56
v_rcp_f32 v53, v53
v_exp_f32 v57, v57
v_pk_mul_f32 v[50:51], v[50:51], v[52:53]
v_pk_add_f32 v[56:57], v[56:57], 1.0 op_sel_hi:[1,0]
v_pk_mul_f32 v[50:51], v[50:51], v[50:51]
v_rcp_f32 v56, v56
v_cvt_pk_bf16_f32 v58, v50, v51
v_rcp_f32 v57, v57
s_nop 0
v_pk_mul_f32 v[54:55], v[54:55], v[56:57]
v_pk_mul_f32 v[54:55], v[54:55], v[54:55]
v_cvt_pk_bf16_f32 v59, v54, v55
ds_write_b32 v61, v58 offset:2048
ds_write_b32 v61, v59 offset:3072
v_add_u32 v50, 0x8000000, v46
v_add_u32 v51, 0x8010000, v46
v_pk_mul_f32 v[50:51], v[50:51], s[86:87] op_sel:[0,1] op_sel_hi:[1,1]
v_pk_fma_f32 v[52:53], v[50:51], v[50:51], v[48:49] op_sel_hi:[1,1,0]
v_pk_mul_f32 v[52:53], v[50:51], v[52:53]
v_exp_f32 v52, v52
v_exp_f32 v53, v53
s_nop 0
v_pk_add_f32 v[52:53], v[52:53], 1.0 op_sel_hi:[1,0]
v_rcp_f32 v52, v52
v_rcp_f32 v53, v53
s_nop 0
v_pk_mul_f32 v[50:51], v[50:51], v[52:53]
v_pk_mul_f32 v[50:51], v[50:51], v[50:51]
v_cvt_pk_bf16_f32 v58, v50, v51
ds_write_b32 v61, v58 offset:4096
s_add_u32 m0, s70, 100096
s_nop 0
buffer_load_dwordx4 v12, s[4:7], s89 offen  lds
s_add_u32 m0, s71, 100096
s_nop 0
buffer_load_dwordx4 v13, s[4:7], s89 offen  lds
s_add_u32 m0, s72, 100096
s_nop 0
buffer_load_dwordx4 v14, s[4:7], s89 offen  lds
s_add_u32 m0, s73, 100096
s_nop 0
buffer_load_dwordx4 v15, s[4:7], s89 offen  lds
s_add_u32 m0, s74, 100096
s_nop 0
buffer_load_dwordx4 v16, s[4:7], s89 offen  lds
s_add_u32 m0, s75, 100096
s_nop 0
buffer_load_dwordx4 v17, s[4:7], s89 offen  lds
v_cmp_eq_u32 vcc, 0, v42
s_waitcnt vmcnt(9)
s_nop 0
v_cndmask_b32 v50, 0, v22, vcc
v_cmp_eq_u32 vcc, 1, v42
s_nop 1
v_cndmask_b32 v51, 0, v22, vcc
v_cmp_eq_u32 vcc, 2, v42
s_nop 1
v_cndmask_b32 v52, 0, v22, vcc
v_cmp_eq_u32 vcc, 3, v42
s_nop 1
v_cndmask_b32 v53, 0, v22, vcc
ds_write_b128 v43, v[50:53] offset:0
v_cmp_eq_u32 vcc, 0, v42
s_waitcnt vmcnt(8)
s_nop 0
v_cndmask_b32 v54, 0, v23, vcc
v_cmp_eq_u32 vcc, 1, v42
s_nop 1
v_cndmask_b32 v55, 0, v23, vcc
v_cmp_eq_u32 vcc, 2, v42
s_nop 1
v_cndmask_b32 v56, 0, v23, vcc
v_cmp_eq_u32 vcc, 3, v42
s_nop 1
v_cndmask_b32 v57, 0, v23, vcc
ds_write_b128 v43, v[54:57] offset:4096
v_cmp_eq_u32 vcc, 0, v42
s_waitcnt vmcnt(7)
s_nop 0
v_cndmask_b32 v50, 0, v24, vcc
v_cmp_eq_u32 vcc, 1, v42
s_nop 1
v_cndmask_b32 v51, 0, v24, vcc
v_cmp_eq_u32 vcc, 2, v42
s_nop 1
v_cndmask_b32 v52, 0, v24, vcc
v_cmp_eq_u32 vcc, 3, v42
s_nop 1
v_cndmask_b32 v53, 0, v24, vcc
ds_write_b128 v43, v[50:53] offset:8192
v_cmp_eq_u32 vcc, 0, v42
s_waitcnt vmcnt(6)
s_nop 0
v_cndmask_b32 v54, 0, v25, vcc
v_cmp_eq_u32 vcc, 1, v42
s_nop 1
v_cndmask_b32 v55, 0, v25, vcc
v_cmp_eq_u32 vcc, 2, v42
s_nop 1
v_cndmask_b32 v56, 0, v25, vcc
v_cmp_eq_u32 vcc, 3, v42
s_nop 1
v_cndmask_b32 v57, 0, v25, vcc
v_cmp_gt_u32 vcc, 96, v0
v_mov_b32 v60, 0x40000000
s_nop 0
v_cndmask_b32 v43, v60, v43, vcc
ds_write_b128 v43, v[54:57] offset:12288
v_mov_b32 v24, v44
v_mov_b32 v25, v45
s_waitcnt lgkmcnt(0)
s_barrier
s_nop 0
s_add_u32 m0, s70, 121856
v_mfma_f32_32x32x16_bf16 v[160:175], a[248:251], a[248:251], 0
ds_read_b128 a[156:159], v6 offset:0
ds_read_b128 a[160:163], v7 offset:0
ds_read_b128 a[144:147], v5 offset:0
ds_read_b128 a[164:167], v6 offset:2176
buffer_load_dwordx4 v12, s[4:7], s90 offen  lds
v_mov_b32 v28, 0
v_mfma_f32_32x32x16_bf16 v[208:223], a[248:251], a[248:251], 0
ds_read_b128 a[168:171], v7 offset:2176
ds_read_b128 a[148:151], v5 offset:1536
ds_read_b128 a[172:175], v6 offset:4352
ds_read_b128 a[176:179], v7 offset:4352
v_mov_b32 v29, 0
v_mov_b32 v22, 0x05040100
v_mov_b32 v23, 0x07060302
ds_read_b128 a[152:155], v5 offset:3072
s_add_u32 s101, s3, 4096
s_add_u32 m0, s71, 121856
s_nop 0
buffer_load_dwordx4 v13, s[4:7], s90 offen  lds
s_waitcnt lgkmcnt(3)
v_smfmac_f32_32x32x32_bf16 v[160:175], a[144:147], a[156:163], v4
ds_read_b128 a[156:159], v6 offset:6528
ds_read_b128 a[160:163], v7 offset:6528
s_add_u32 m0, s72, 121856
s_nop 0
buffer_load_dwordx4 v14, s[4:7], s90 offen  lds
v_smfmac_f32_32x32x32_bf16 v[160:175], a[148:151], a[164:171], v4
v_smfmac_f32_32x32x32_bf16 v[208:223], a[144:147], a[164:171], v4
ds_read_b128 a[164:167], v8 offset:0
ds_read_b128 a[168:171], v9 offset:0
ds_read_b128 a[144:147], v5 offset:512
s_waitcnt lgkmcnt(3)
v_smfmac_f32_32x32x32_bf16 v[160:175], a[152:155], a[172:179], v4
s_add_u32 m0, s73, 121856
s_nop 0
buffer_load_dwordx4 v15, s[4:7], s90 offen  lds
v_smfmac_f32_32x32x32_bf16 v[208:223], a[148:151], a[172:179], v4
ds_read_b128 a[172:175], v8 offset:2176
ds_read_b128 a[176:179], v9 offset:2176
ds_read_b128 a[148:151], v5 offset:2048
v_smfmac_f32_32x32x32_bf16 v[208:223], a[152:155], a[156:163], v4
ds_read_b128 a[156:159], v8 offset:4352
ds_read_b128 a[160:163], v9 offset:4352
ds_read_b128 a[152:155], v5 offset:3584
s_add_u32 m0, s74, 121856
s_nop 0
buffer_load_dwordx4 v16, s[4:7], s90 offen  lds
s_waitcnt lgkmcnt(4)
v_smfmac_f32_32x32x32_bf16 v[160:175], a[144:147], a[164:171], v4
ds_read_b128 a[164:167], v8 offset:6528
ds_read_b128 a[168:171], v9 offset:6528
s_waitcnt lgkmcnt(2)
v_smfmac_f32_32x32x32_bf16 v[160:175], a[148:151], a[172:179], v4
s_add_u32 m0, s75, 121856
s_nop 0
buffer_load_dwordx4 v17, s[4:7], s90 offen  lds
v_smfmac_f32_32x32x32_bf16 v[208:223], a[144:147], a[172:179], v4
ds_read_b128 a[172:175], v10 offset:0
ds_read_b128 a[176:179], v11 offset:0
ds_read_b128 a[144:147], v5 offset:1024
v_smfmac_f32_32x32x32_bf16 v[160:175], a[152:155], a[156:163], v4
v_smfmac_f32_32x32x32_bf16 v[208:223], a[148:151], a[156:163], v4
ds_read_b128 a[156:159], v10 offset:2176
buffer_load_dwordx3 v[62:64], v31, s[16:19], s44 offen offset:0
ds_read_b128 a[160:163], v11 offset:2176
ds_read_b128 a[148:151], v5 offset:2560
s_waitcnt lgkmcnt(4)
v_smfmac_f32_32x32x32_bf16 v[208:223], a[152:155], a[164:171], v4
ds_read_b128 a[164:167], v10 offset:4352
ds_read_b128 a[168:171], v11 offset:4352
ds_read_b128 a[152:155], v5 offset:4096
s_waitcnt lgkmcnt(4)
v_smfmac_f32_32x32x32_bf16 v[160:175], a[144:147], a[172:179], v4
ds_read_b128 a[172:175], v10 offset:6528
buffer_load_dwordx3 v[66:68], v31, s[16:19], s44 offen offset:768
ds_read_b128 a[176:179], v11 offset:6528
s_waitcnt lgkmcnt(2)
v_smfmac_f32_32x32x32_bf16 v[160:175], a[148:151], a[156:163], v4
v_smfmac_f32_32x32x32_bf16 v[208:223], a[144:147], a[156:163], v4
buffer_load_dwordx3 v[70:72], v31, s[16:19], s44 offen offset:1536
v_smfmac_f32_32x32x32_bf16 v[160:175], a[152:155], a[164:171], v4
s_nop 4
v_smfmac_f32_32x32x32_bf16 v[208:223], a[148:151], a[164:171], v4
s_nop 4
s_waitcnt lgkmcnt(0)
v_smfmac_f32_32x32x32_bf16 v[208:223], a[152:155], a[172:179], v4
buffer_load_dwordx3 v[74:76], v31, s[16:19], s44 offen offset:2304
v_mfma_f32_32x32x16_bf16 v[176:191], a[248:251], a[248:251], 0
v_mfma_f32_32x32x16_bf16 v[224:239], a[248:251], a[248:251], 0
v_pk_mul_f32 v[48:49], v[160:161], v[160:161]
buffer_load_dwordx3 v[78:80], v31, s[16:19], s45 offen offset:0
v_pk_fma_f32 v[48:49], v[162:163], v[162:163], v[48:49]
v_pk_add_f32 v[46:47], v[160:161], v[162:163]
v_pk_fma_f32 v[48:49], v[164:165], v[164:165], v[48:49]
v_pk_add_f32 v[46:47], v[46:47], v[164:165]
v_pk_fma_f32 v[48:49], v[166:167], v[166:167], v[48:49]
v_pk_add_f32 v[46:47], v[46:47], v[166:167]
v_pk_fma_f32 v[48:49], v[168:169], v[168:169], v[48:49]
v_pk_add_f32 v[46:47], v[46:47], v[168:169]
v_pk_fma_f32 v[48:49], v[170:171], v[170:171], v[48:49]
v_pk_add_f32 v[46:47], v[46:47], v[170:171]
v_pk_fma_f32 v[48:49], v[172:173], v[172:173], v[48:49]
v_pk_add_f32 v[46:47], v[46:47], v[172:173]
v_pk_fma_f32 v[48:49], v[174:175], v[174:175], v[48:49]
v_pk_add_f32 v[46:47], v[46:47], v[174:175]
v_pk_mul_f32 v[52:53], v[208:209], v[208:209]
v_pk_fma_f32 v[52:53], v[210:211], v[210:211], v[52:53]
v_pk_add_f32 v[50:51], v[208:209], v[210:211]
buffer_load_dwordx3 v[82:84], v31, s[16:19], s45 offen offset:768
v_pk_fma_f32 v[52:53], v[212:213], v[212:213], v[52:53]
v_pk_add_f32 v[50:51], v[50:51], v[212:213]
v_pk_fma_f32 v[52:53], v[214:215], v[214:215], v[52:53]
v_pk_add_f32 v[50:51], v[50:51], v[214:215]
v_pk_fma_f32 v[52:53], v[216:217], v[216:217], v[52:53]
v_pk_add_f32 v[50:51], v[50:51], v[216:217]
v_pk_fma_f32 v[52:53], v[218:219], v[218:219], v[52:53]
v_pk_add_f32 v[50:51], v[50:51], v[218:219]
v_pk_fma_f32 v[52:53], v[220:221], v[220:221], v[52:53]
v_pk_add_f32 v[50:51], v[50:51], v[220:221]
v_pk_fma_f32 v[52:53], v[222:223], v[222:223], v[52:53]
v_pk_add_f32 v[50:51], v[50:51], v[222:223]
buffer_load_dwordx3 v[86:88], v31, s[16:19], s45 offen offset:1536
buffer_load_dwordx3 v[90:92], v31, s[16:19], s45 offen offset:2304
buffer_load_dwordx3 v[94:96], v31, s[16:19], s46 offen offset:0
buffer_load_dwordx3 v[98:100], v31, s[16:19], s46 offen offset:768
buffer_load_dwordx3 v[102:104], v31, s[16:19], s46 offen offset:1536
buffer_load_dwordx3 v[106:108], v31, s[16:19], s46 offen offset:2304
s_waitcnt vmcnt(12)
s_barrier
ds_read_b128 a[156:159], v6 offset:28416
ds_read_b128 a[160:163], v7 offset:28416
ds_read_b128 a[144:147], v5 offset:4608
ds_read_b128 a[164:167], v6 offset:30592
ds_read_b128 a[168:171], v7 offset:30592
ds_read_b128 a[148:151], v5 offset:6144
ds_read_b128 a[172:175], v6 offset:32768
ds_read_b128 a[176:179], v7 offset:32768
ds_read_b128 a[152:155], v5 offset:7680
buffer_load_dwordx3 v[110:112], v31, s[16:19], s47 offen offset:0
s_waitcnt vmcnt(12)
v_pk_maximum3_f16 v28, v28, v62, v63
v_pk_minimum3_f16 v29, v29, v62, v63
s_waitcnt lgkmcnt(3)
v_smfmac_f32_32x32x32_bf16 v[176:191], a[144:147], a[156:163], v4
ds_read_b128 a[156:159], v6 offset:34944
ds_read_b128 a[160:163], v7 offset:34944
buffer_load_dwordx3 v[114:116], v31, s[16:19], s47 offen offset:768
s_waitcnt vmcnt(12)
v_pk_maximum3_f16 v28, v28, v64, v66
v_pk_minimum3_f16 v29, v29, v64, v66
v_smfmac_f32_32x32x32_bf16 v[176:191], a[148:151], a[164:171], v4
v_pk_maximum3_f16 v28, v28, v67, v68
v_pk_minimum3_f16 v29, v29, v67, v68
v_smfmac_f32_32x32x32_bf16 v[224:239], a[144:147], a[164:171], v4
ds_read_b128 a[164:167], v8 offset:28416
ds_read_b128 a[168:171], v9 offset:28416
ds_read_b128 a[144:147], v5 offset:5120
s_waitcnt lgkmcnt(3)
v_smfmac_f32_32x32x32_bf16 v[176:191], a[152:155], a[172:179], v4
buffer_load_dwordx3 v[118:120], v31, s[16:19], s47 offen offset:1536
s_waitcnt vmcnt(12)
v_pk_maximum3_f16 v28, v28, v70, v71
v_pk_minimum3_f16 v29, v29, v70, v71
v_smfmac_f32_32x32x32_bf16 v[224:239], a[148:151], a[172:179], v4
ds_read_b128 a[172:175], v8 offset:30592
ds_read_b128 a[176:179], v9 offset:30592
ds_read_b128 a[148:151], v5 offset:6656
v_smfmac_f32_32x32x32_bf16 v[224:239], a[152:155], a[156:163], v4
ds_read_b128 a[156:159], v8 offset:32768
ds_read_b128 a[160:163], v9 offset:32768
ds_read_b128 a[152:155], v5 offset:8192
buffer_load_dwordx3 v[122:124], v31, s[16:19], s47 offen offset:2304
s_waitcnt vmcnt(12)
v_pk_maximum3_f16 v28, v28, v72, v74
v_pk_minimum3_f16 v29, v29, v72, v74
s_waitcnt lgkmcnt(4)
v_smfmac_f32_32x32x32_bf16 v[176:191], a[144:147], a[164:171], v4
ds_read_b128 a[164:167], v8 offset:34944
v_pk_maximum3_f16 v28, v28, v75, v76
v_pk_minimum3_f16 v29, v29, v75, v76
ds_read_b128 a[168:171], v9 offset:34944
s_waitcnt lgkmcnt(2)
v_smfmac_f32_32x32x32_bf16 v[176:191], a[148:151], a[172:179], v4
buffer_load_dwordx3 v[126:128], v31, s[16:19], s48 offen offset:0
s_waitcnt vmcnt(12)
v_pk_maximum3_f16 v28, v28, v78, v79
v_pk_minimum3_f16 v29, v29, v78, v79
v_smfmac_f32_32x32x32_bf16 v[224:239], a[144:147], a[172:179], v4
ds_read_b128 a[172:175], v10 offset:28416
ds_read_b128 a[176:179], v11 offset:28416
ds_read_b128 a[144:147], v5 offset:5632
v_smfmac_f32_32x32x32_bf16 v[176:191], a[152:155], a[156:163], v4
v_smfmac_f32_32x32x32_bf16 v[224:239], a[148:151], a[156:163], v4
ds_read_b128 a[156:159], v10 offset:30592
buffer_load_dwordx3 v[130:132], v31, s[16:19], s48 offen offset:768
s_waitcnt vmcnt(12)
v_pk_maximum3_f16 v28, v28, v80, v82
v_pk_minimum3_f16 v29, v29, v80, v82
s_waitcnt lgkmcnt(2)
v_smfmac_f32_32x32x32_bf16 v[224:239], a[152:155], a[164:171], v4
ds_read_b128 a[160:163], v11 offset:30592
v_pk_maximum3_f16 v28, v28, v83, v84
v_pk_minimum3_f16 v29, v29, v83, v84
ds_read_b128 a[148:151], v5 offset:7168
ds_read_b128 a[164:167], v10 offset:32768
ds_read_b128 a[168:171], v11 offset:32768
ds_read_b128 a[152:155], v5 offset:8704
buffer_load_dwordx3 v[134:136], v31, s[16:19], s48 offen offset:1536
s_waitcnt lgkmcnt(5)
v_smfmac_f32_32x32x32_bf16 v[176:191], a[144:147], a[172:179], v4
ds_read_b128 a[172:175], v10 offset:34944
s_waitcnt vmcnt(12)
v_pk_maximum3_f16 v28, v28, v86, v87
v_pk_minimum3_f16 v29, v29, v86, v87
ds_read_b128 a[176:179], v11 offset:34944
s_waitcnt lgkmcnt(2)
v_smfmac_f32_32x32x32_bf16 v[176:191], a[148:151], a[156:163], v4
buffer_load_dwordx3 v[138:140], v31, s[16:19], s48 offen offset:2304
s_waitcnt vmcnt(12)
v_pk_maximum3_f16 v28, v28, v88, v90
v_pk_minimum3_f16 v29, v29, v88, v90
v_pk_maximum3_f16 v28, v28, v91, v92
v_smfmac_f32_32x32x32_bf16 v[224:239], a[144:147], a[156:163], v4
ds_read_b128 a[156:159], v6 offset:50176
v_pk_minimum3_f16 v29, v29, v91, v92
v_perm_b32 v38, v66, v62, v22
v_perm_b32 v39, v74, v70, v22
v_perm_b32 v40, v82, v78, v22
v_perm_b32 v41, v90, v86, v22
v_perm_b32 v42, v66, v62, v23
v_smfmac_f32_32x32x32_bf16 v[176:191], a[152:155], a[164:171], v4
ds_read_b128 a[160:163], v7 offset:50176
buffer_load_dwordx3 v[142:144], v31, s[16:19], s49 offen offset:0
v_perm_b32 v43, v74, v70, v23
v_perm_b32 v44, v82, v78, v23
v_perm_b32 v45, v90, v86, v23
v_smfmac_f32_32x32x32_bf16 v[224:239], a[148:151], a[164:171], v4
ds_read_b128 a[144:147], v5 offset:9216
ds_read_b128 a[164:167], v6 offset:52352
ds_read_b128 a[168:171], v7 offset:52352
ds_read_b128 a[148:151], v5 offset:10752
ds_write_b128 v32, v[38:41] offset:0
s_waitcnt lgkmcnt(5)
v_smfmac_f32_32x32x32_bf16 v[224:239], a[152:155], a[172:179], v4
ds_read_b128 a[172:175], v6 offset:54528
v_perm_b32 v38, v67, v63, v22
v_perm_b32 v39, v75, v71, v22
buffer_load_dwordx3 v[146:148], v31, s[16:19], s49 offen offset:768
v_pk_fma_f32 v[48:49], v[176:177], v[176:177], v[48:49]
v_pk_add_f32 v[46:47], v[46:47], v[176:177]
v_pk_fma_f32 v[48:49], v[178:179], v[178:179], v[48:49]
v_pk_add_f32 v[46:47], v[46:47], v[178:179]
v_pk_fma_f32 v[48:49], v[180:181], v[180:181], v[48:49]
v_pk_add_f32 v[46:47], v[46:47], v[180:181]
v_pk_fma_f32 v[48:49], v[182:183], v[182:183], v[48:49]
v_pk_add_f32 v[46:47], v[46:47], v[182:183]
v_pk_fma_f32 v[48:49], v[184:185], v[184:185], v[48:49]
v_pk_add_f32 v[46:47], v[46:47], v[184:185]
v_pk_fma_f32 v[48:49], v[186:187], v[186:187], v[48:49]
v_pk_add_f32 v[46:47], v[46:47], v[186:187]
v_pk_fma_f32 v[48:49], v[188:189], v[188:189], v[48:49]
v_pk_add_f32 v[46:47], v[46:47], v[188:189]
v_pk_fma_f32 v[48:49], v[190:191], v[190:191], v[48:49]
v_pk_add_f32 v[46:47], v[46:47], v[190:191]
v_pk_fma_f32 v[52:53], v[224:225], v[224:225], v[52:53]
buffer_load_dwordx3 v[150:152], v31, s[16:19], s49 offen offset:1536
v_pk_add_f32 v[50:51], v[50:51], v[224:225]
v_pk_fma_f32 v[52:53], v[226:227], v[226:227], v[52:53]
v_pk_add_f32 v[50:51], v[50:51], v[226:227]
v_pk_fma_f32 v[52:53], v[228:229], v[228:229], v[52:53]
v_pk_add_f32 v[50:51], v[50:51], v[228:229]
v_pk_fma_f32 v[52:53], v[230:231], v[230:231], v[52:53]
v_pk_add_f32 v[50:51], v[50:51], v[230:231]
v_pk_fma_f32 v[52:53], v[232:233], v[232:233], v[52:53]
v_pk_add_f32 v[50:51], v[50:51], v[232:233]
v_pk_fma_f32 v[52:53], v[234:235], v[234:235], v[52:53]
v_pk_add_f32 v[50:51], v[50:51], v[234:235]
v_pk_fma_f32 v[52:53], v[236:237], v[236:237], v[52:53]
v_pk_add_f32 v[50:51], v[50:51], v[236:237]
v_pk_fma_f32 v[52:53], v[238:239], v[238:239], v[52:53]
v_pk_add_f32 v[50:51], v[50:51], v[238:239]
v_mfma_f32_32x32x16_bf16 v[192:207], a[248:251], a[248:251], 0
ds_read_b128 a[176:179], v7 offset:54528
ds_read_b128 a[152:155], v5 offset:12288
ds_write_b128 v32, v[42:45] offset:6144
buffer_load_dwordx3 v[154:156], v31, s[16:19], s49 offen offset:2304
v_mfma_f32_32x32x16_bf16 v[240:255], a[248:251], a[248:251], 0
v_perm_b32 v40, v83, v79, v22
v_perm_b32 v41, v91, v87, v22
v_perm_b32 v42, v67, v63, v23
v_perm_b32 v43, v75, v71, v23
v_perm_b32 v44, v83, v79, v23
v_perm_b32 v45, v91, v87, v23
ds_write_b128 v32, v[38:41] offset:12288
buffer_store_dwordx4 a[248:251], v27, s[12:15], s50 offen sc1
s_waitcnt lgkmcnt(1)
v_smfmac_f32_32x32x32_bf16 v[192:207], a[144:147], a[156:163], v4
ds_read_b128 a[156:159], v6 offset:56704
v_perm_b32 v38, v68, v64, v22
v_perm_b32 v39, v76, v72, v22
v_perm_b32 v40, v84, v80, v22
v_perm_b32 v41, v92, v88, v22
ds_read_b128 a[160:163], v7 offset:56704
v_smfmac_f32_32x32x32_bf16 v[192:207], a[148:151], a[164:171], v4
ds_write_b128 v32, v[42:45] offset:18432
buffer_store_dwordx4 a[248:251], v27, s[12:15], s50 offen offset:1024 sc1
v_smfmac_f32_32x32x32_bf16 v[240:255], a[144:147], a[164:171], v4
ds_read_b128 a[164:167], v8 offset:50176
v_perm_b32 v42, v68, v64, v23
v_perm_b32 v43, v76, v72, v23
v_perm_b32 v44, v84, v80, v23
v_perm_b32 v45, v92, v88, v23
s_waitcnt vmcnt(17)
v_pk_maximum3_f16 v28, v28, v94, v95
v_smfmac_f32_32x32x32_bf16 v[192:207], a[152:155], a[172:179], v4
ds_read_b128 a[168:171], v9 offset:50176
v_pk_minimum3_f16 v29, v29, v94, v95
s_waitcnt vmcnt(16)
v_pk_maximum3_f16 v28, v28, v96, v98
buffer_store_dword a248, v26, s[12:15], s51 offen sc1
v_smfmac_f32_32x32x32_bf16 v[240:255], a[148:151], a[172:179], v4
ds_read_b128 a[144:147], v5 offset:9728
v_pk_minimum3_f16 v29, v29, v96, v98
v_pk_maximum3_f16 v28, v28, v99, v100
v_pk_minimum3_f16 v29, v29, v99, v100
s_waitcnt vmcnt(16)
v_pk_maximum3_f16 v28, v28, v102, v103
v_pk_minimum3_f16 v29, v29, v102, v103
s_waitcnt lgkmcnt(1)
v_smfmac_f32_32x32x32_bf16 v[240:255], a[152:155], a[156:163], v4
ds_read_b128 a[172:175], v8 offset:52352
s_waitcnt vmcnt(15)
v_pk_maximum3_f16 v28, v28, v104, v106
buffer_load_ushort v18, v21, s[28:31], 0 offen
v_pk_minimum3_f16 v29, v29, v104, v106
v_pk_maximum3_f16 v28, v28, v107, v108
v_pk_minimum3_f16 v29, v29, v107, v108
s_waitcnt vmcnt(15)
v_pk_maximum3_f16 v28, v28, v110, v111
v_pk_minimum3_f16 v29, v29, v110, v111
s_waitcnt vmcnt(14)
v_pk_maximum3_f16 v28, v28, v112, v114
v_pk_minimum3_f16 v29, v29, v112, v114
v_pk_maximum3_f16 v28, v28, v115, v116
v_pk_minimum3_f16 v29, v29, v115, v116
s_waitcnt lgkmcnt(0)
v_smfmac_f32_32x32x32_bf16 v[192:207], a[144:147], a[164:171], v4
ds_read_b128 a[176:179], v9 offset:52352
s_waitcnt vmcnt(13)
v_pk_maximum3_f16 v28, v28, v118, v119
buffer_load_ushort v19, v21, s[28:31], 0 offen offset:12
v_pk_minimum3_f16 v29, v29, v118, v119
s_waitcnt vmcnt(13)
v_pk_maximum3_f16 v28, v28, v120, v122
v_pk_minimum3_f16 v29, v29, v120, v122
v_pk_maximum3_f16 v28, v28, v123, v124
v_pk_minimum3_f16 v29, v29, v123, v124
ds_read_b128 a[148:151], v5 offset:11264
ds_read_b128 a[156:159], v8 offset:54528
ds_read_b128 a[160:163], v9 offset:54528
ds_read_b128 a[152:155], v5 offset:12800
ds_read_b128 a[164:167], v8 offset:56704
ds_read_b128 a[168:171], v9 offset:56704
ds_write_b128 v32, v[38:41] offset:24576
buffer_load_ushort v20, v21, s[32:35], 0 offen
ds_write_b128 v33, v[42:45] offset:30720
v_perm_b32 v38, v98, v94, v22
v_perm_b32 v39, v106, v102, v22
v_perm_b32 v40, v114, v110, v22
v_perm_b32 v41, v122, v118, v22
v_perm_b32 v42, v98, v94, v23
v_perm_b32 v43, v106, v102, v23
v_perm_b32 v44, v114, v110, v23
v_perm_b32 v45, v122, v118, v23
ds_write_b128 v34, v[38:41] offset:0
s_waitcnt lgkmcnt(4)
v_smfmac_f32_32x32x32_bf16 v[192:207], a[148:151], a[172:179], v4
ds_write_b128 v34, v[42:45] offset:6144
buffer_load_ushort v21, v21, s[32:35], 0 offen offset:12
v_smfmac_f32_32x32x32_bf16 v[240:255], a[144:147], a[172:179], v4
ds_read_b128 a[172:175], v10 offset:50176
v_perm_b32 v38, v99, v95, v22
v_perm_b32 v39, v107, v103, v22
v_perm_b32 v40, v115, v111, v22
v_perm_b32 v41, v123, v119, v22
v_perm_b32 v42, v99, v95, v23
v_smfmac_f32_32x32x32_bf16 v[192:207], a[152:155], a[156:163], v4
ds_read_b128 a[176:179], v11 offset:50176
v_perm_b32 v43, v107, v103, v23
v_perm_b32 v44, v115, v111, v23
v_perm_b32 v45, v123, v119, v23
ds_read_b128 a[144:147], v5 offset:10240
v_smfmac_f32_32x32x32_bf16 v[240:255], a[148:151], a[156:163], v4
ds_read_b128 a[156:159], v10 offset:52352
ds_read_b128 a[160:163], v11 offset:52352
ds_read_b128 a[148:151], v5 offset:11776
ds_write_b128 v34, v[38:41] offset:12288
s_waitcnt lgkmcnt(5)
v_smfmac_f32_32x32x32_bf16 v[240:255], a[152:155], a[164:171], v4
ds_read_b128 a[164:167], v10 offset:54528
v_perm_b32 v38, v100, v96, v22
v_perm_b32 v39, v108, v104, v22
v_perm_b32 v40, v116, v112, v22
v_perm_b32 v41, v124, v120, v22
ds_read_b128 a[168:171], v11 offset:54528
ds_read_b128 a[152:155], v5 offset:13312
ds_write_b128 v34, v[42:45] offset:18432
ds_write_b128 v34, v[38:41] offset:24576
s_waitcnt lgkmcnt(6)
v_smfmac_f32_32x32x32_bf16 v[192:207], a[144:147], a[172:179], v4
ds_read_b128 a[172:175], v10 offset:56704
v_perm_b32 v42, v100, v96, v23
v_perm_b32 v43, v108, v104, v23
v_perm_b32 v44, v116, v112, v23
v_perm_b32 v45, v124, v120, v23
s_waitcnt vmcnt(14)
v_pk_maximum3_f16 v28, v28, v126, v127
v_smfmac_f32_32x32x32_bf16 v[192:207], a[148:151], a[156:163], v4
ds_read_b128 a[176:179], v11 offset:56704
v_pk_minimum3_f16 v29, v29, v126, v127
s_waitcnt vmcnt(13)
v_pk_maximum3_f16 v28, v28, v128, v130
v_pk_minimum3_f16 v29, v29, v128, v130
v_pk_maximum3_f16 v28, v28, v131, v132
v_pk_minimum3_f16 v29, v29, v131, v132
v_smfmac_f32_32x32x32_bf16 v[240:255], a[144:147], a[156:163], v4
ds_write_b128 v35, v[42:45] offset:30720
s_waitcnt vmcnt(12)
v_pk_maximum3_f16 v28, v28, v134, v135
s_waitcnt lgkmcnt(3)
v_smfmac_f32_32x32x32_bf16 v[192:207], a[152:155], a[164:171], v4
v_pk_minimum3_f16 v29, v29, v134, v135
s_waitcnt vmcnt(11)
v_pk_maximum3_f16 v28, v28, v136, v138
v_pk_minimum3_f16 v29, v29, v136, v138
v_pk_maximum3_f16 v28, v28, v139, v140
v_pk_minimum3_f16 v29, v29, v139, v140
v_smfmac_f32_32x32x32_bf16 v[240:255], a[148:151], a[164:171], v4
s_waitcnt vmcnt(10)
v_pk_maximum3_f16 v28, v28, v142, v143
v_pk_minimum3_f16 v29, v29, v142, v143
s_waitcnt vmcnt(9)
v_pk_maximum3_f16 v28, v28, v144, v146
v_pk_minimum3_f16 v29, v29, v144, v146
v_pk_maximum3_f16 v28, v28, v147, v148
s_waitcnt lgkmcnt(0)
s_barrier
v_pk_fma_f32 v[48:49], v[192:193], v[192:193], v[48:49]
v_pk_add_f32 v[46:47], v[46:47], v[192:193]
v_pk_fma_f32 v[48:49], v[194:195], v[194:195], v[48:49]
v_pk_add_f32 v[46:47], v[46:47], v[194:195]
v_pk_fma_f32 v[48:49], v[196:197], v[196:197], v[48:49]
v_pk_add_f32 v[46:47], v[46:47], v[196:197]
v_pk_fma_f32 v[48:49], v[198:199], v[198:199], v[48:49]
v_pk_add_f32 v[46:47], v[46:47], v[198:199]
v_pk_fma_f32 v[48:49], v[200:201], v[200:201], v[48:49]
v_pk_add_f32 v[46:47], v[46:47], v[200:201]
v_pk_fma_f32 v[48:49], v[202:203], v[202:203], v[48:49]
v_pk_add_f32 v[46:47], v[46:47], v[202:203]
v_pk_fma_f32 v[48:49], v[204:205], v[204:205], v[48:49]
v_pk_add_f32 v[46:47], v[46:47], v[204:205]
v_pk_fma_f32 v[48:49], v[206:207], v[206:207], v[48:49]
v_pk_add_f32 v[46:47], v[46:47], v[206:207]
v_smfmac_f32_32x32x32_bf16 v[240:255], a[152:155], a[172:179], v4
v_pk_minimum3_f16 v29, v29, v147, v148
s_waitcnt vmcnt(8)
v_pk_maximum3_f16 v28, v28, v150, v151
v_pk_minimum3_f16 v29, v29, v150, v151
s_waitcnt vmcnt(7)
v_pk_maximum3_f16 v28, v28, v152, v154
v_pk_minimum3_f16 v29, v29, v152, v154
v_pk_maximum3_f16 v28, v28, v155, v156
v_pk_minimum3_f16 v29, v29, v155, v156
v_and_b32 v29, 0x7fff7fff, v29
v_pk_max_u16 v28, v28, v29
v_lshrrev_b32 v29, 16, v28
v_pk_fma_f32 v[52:53], v[240:241], v[240:241], v[52:53]
v_pk_add_f32 v[50:51], v[50:51], v[240:241]
v_pk_fma_f32 v[52:53], v[242:243], v[242:243], v[52:53]
v_pk_add_f32 v[50:51], v[50:51], v[242:243]
v_pk_fma_f32 v[52:53], v[244:245], v[244:245], v[52:53]
v_pk_add_f32 v[50:51], v[50:51], v[244:245]
v_pk_fma_f32 v[52:53], v[246:247], v[246:247], v[52:53]
v_pk_add_f32 v[50:51], v[50:51], v[246:247]
v_pk_fma_f32 v[52:53], v[248:249], v[248:249], v[52:53]
v_pk_add_f32 v[50:51], v[50:51], v[248:249]
v_pk_fma_f32 v[52:53], v[250:251], v[250:251], v[52:53]
v_pk_add_f32 v[50:51], v[50:51], v[250:251]
v_pk_fma_f32 v[52:53], v[252:253], v[252:253], v[52:53]
v_pk_add_f32 v[50:51], v[50:51], v[252:253]
v_pk_fma_f32 v[52:53], v[254:255], v[254:255], v[52:53]
v_pk_add_f32 v[50:51], v[50:51], v[254:255]
v_and_b32 v28, 0xffff, v28
v_add_u32 v12, 786432, v12
v_max_u32 v28, v28, v29
v_add_u32 v13, 786432, v13
v_perm_b32 v38, v130, v126, v22
v_add_u32 v14, 786432, v14
v_perm_b32 v39, v138, v134, v22
v_add_u32 v15, 786432, v15
v_perm_b32 v40, v146, v142, v22
v_add_u32 v16, 786432, v16
v_perm_b32 v41, v154, v150, v22
v_add_u32 v17, 786432, v17
v_add_f32 v46, v46, v47
v_perm_b32 v42, v130, v126, v23
v_add_f32 v48, v48, v49
v_perm_b32 v43, v138, v134, v23
v_add_f32 v50, v50, v51
v_perm_b32 v44, v146, v142, v23
v_add_f32 v52, v52, v53
v_perm_b32 v45, v154, v150, v23
v_permlane32_swap_b32 v46, v48
v_permlane32_swap_b32 v50, v52
v_add_f32 v46, v46, v48
v_add_f32 v50, v50, v52
v_mov_b32 v48, v46
v_mov_b32 v52, v50
ds_max_u32 v30, v28
v_permlane32_swap_b32 v46, v48
v_permlane32_swap_b32 v50, v52
v_mul_f32 v46, 0x3c2aaaab, v46
v_mul_f32 v50, 0x3c2aaaab, v50
v_mul_f32 v48, 0x3c2aaaab, v48
v_mul_f32 v52, 0x3c2aaaab, v52
v_fma_f32 v48, -v46, v46, v48
v_fma_f32 v52, -v50, v50, v52
v_max_f32 v48, 0, v48
v_max_f32 v52, 0, v52
v_add_f32 v48, 0x3727c5ac, v48
v_add_f32 v52, 0x3727c5ac, v52
v_rsq_f32 v48, v48
v_rsq_f32 v52, v52
v_mul_f32 v48, s86, v48
v_mul_f32_e64 v46, -v46, v48
v_pk_fma_f32 v[160:161], v[160:161], v[48:49], v[46:47] op_sel_hi:[1,0,0]
v_pk_fma_f32 v[162:163], v[162:163], v[48:49], v[46:47] op_sel_hi:[1,0,0]
v_pk_fma_f32 v[164:165], v[164:165], v[48:49], v[46:47] op_sel_hi:[1,0,0]
v_pk_fma_f32 v[166:167], v[166:167], v[48:49], v[46:47] op_sel_hi:[1,0,0]
v_pk_fma_f32 v[168:169], v[168:169], v[48:49], v[46:47] op_sel_hi:[1,0,0]
v_pk_fma_f32 v[170:171], v[170:171], v[48:49], v[46:47] op_sel_hi:[1,0,0]
v_pk_fma_f32 v[172:173], v[172:173], v[48:49], v[46:47] op_sel_hi:[1,0,0]
v_pk_fma_f32 v[174:175], v[174:175], v[48:49], v[46:47] op_sel_hi:[1,0,0]
v_pk_fma_f32 v[176:177], v[176:177], v[48:49], v[46:47] op_sel_hi:[1,0,0]
v_pk_fma_f32 v[178:179], v[178:179], v[48:49], v[46:47] op_sel_hi:[1,0,0]
v_pk_fma_f32 v[180:181], v[180:181], v[48:49], v[46:47] op_sel_hi:[1,0,0]
v_pk_fma_f32 v[182:183], v[182:183], v[48:49], v[46:47] op_sel_hi:[1,0,0]
v_pk_fma_f32 v[184:185], v[184:185], v[48:49], v[46:47] op_sel_hi:[1,0,0]
v_pk_fma_f32 v[186:187], v[186:187], v[48:49], v[46:47] op_sel_hi:[1,0,0]
v_pk_fma_f32 v[188:189], v[188:189], v[48:49], v[46:47] op_sel_hi:[1,0,0]
v_pk_fma_f32 v[190:191], v[190:191], v[48:49], v[46:47] op_sel_hi:[1,0,0]
v_pk_fma_f32 v[192:193], v[192:193], v[48:49], v[46:47] op_sel_hi:[1,0,0]
v_pk_fma_f32 v[194:195], v[194:195], v[48:49], v[46:47] op_sel_hi:[1,0,0]
v_pk_fma_f32 v[196:197], v[196:197], v[48:49], v[46:47] op_sel_hi:[1,0,0]
v_pk_fma_f32 v[198:199], v[198:199], v[48:49], v[46:47] op_sel_hi:[1,0,0]
v_pk_fma_f32 v[200:201], v[200:201], v[48:49], v[46:47] op_sel_hi:[1,0,0]
v_pk_fma_f32 v[202:203], v[202:203], v[48:49], v[46:47] op_sel_hi:[1,0,0]
v_pk_fma_f32 v[204:205], v[204:205], v[48:49], v[46:47] op_sel_hi:[1,0,0]
v_pk_fma_f32 v[206:207], v[206:207], v[48:49], v[46:47] op_sel_hi:[1,0,0]
v_mul_f32 v52, 0xbeeff558, v52
v_mul_f32_e64 v50, -v50, v52
v_pk_fma_f32 v[208:209], v[208:209], v[52:53], v[50:51] op_sel_hi:[1,0,0]
v_pk_fma_f32 v[210:211], v[210:211], v[52:53], v[50:51] op_sel_hi:[1,0,0]
v_pk_fma_f32 v[212:213], v[212:213], v[52:53], v[50:51] op_sel_hi:[1,0,0]
v_pk_fma_f32 v[214:215], v[214:215], v[52:53], v[50:51] op_sel_hi:[1,0,0]
v_pk_fma_f32 v[216:217], v[216:217], v[52:53], v[50:51] op_sel_hi:[1,0,0]
v_pk_fma_f32 v[218:219], v[218:219], v[52:53], v[50:51] op_sel_hi:[1,0,0]
v_pk_fma_f32 v[220:221], v[220:221], v[52:53], v[50:51] op_sel_hi:[1,0,0]
v_pk_fma_f32 v[222:223], v[222:223], v[52:53], v[50:51] op_sel_hi:[1,0,0]
v_pk_fma_f32 v[224:225], v[224:225], v[52:53], v[50:51] op_sel_hi:[1,0,0]
v_pk_fma_f32 v[226:227], v[226:227], v[52:53], v[50:51] op_sel_hi:[1,0,0]
v_pk_fma_f32 v[228:229], v[228:229], v[52:53], v[50:51] op_sel_hi:[1,0,0]
v_pk_fma_f32 v[230:231], v[230:231], v[52:53], v[50:51] op_sel_hi:[1,0,0]
v_pk_fma_f32 v[232:233], v[232:233], v[52:53], v[50:51] op_sel_hi:[1,0,0]
v_pk_fma_f32 v[234:235], v[234:235], v[52:53], v[50:51] op_sel_hi:[1,0,0]
v_pk_fma_f32 v[236:237], v[236:237], v[52:53], v[50:51] op_sel_hi:[1,0,0]
v_pk_fma_f32 v[238:239], v[238:239], v[52:53], v[50:51] op_sel_hi:[1,0,0]
v_pk_fma_f32 v[240:241], v[240:241], v[52:53], v[50:51] op_sel_hi:[1,0,0]
v_pk_fma_f32 v[242:243], v[242:243], v[52:53], v[50:51] op_sel_hi:[1,0,0]
v_pk_fma_f32 v[244:245], v[244:245], v[52:53], v[50:51] op_sel_hi:[1,0,0]
v_pk_fma_f32 v[246:247], v[246:247], v[52:53], v[50:51] op_sel_hi:[1,0,0]
v_pk_fma_f32 v[248:249], v[248:249], v[52:53], v[50:51] op_sel_hi:[1,0,0]
v_pk_fma_f32 v[250:251], v[250:251], v[52:53], v[50:51] op_sel_hi:[1,0,0]
v_pk_fma_f32 v[252:253], v[252:253], v[52:53], v[50:51] op_sel_hi:[1,0,0]
v_pk_fma_f32 v[254:255], v[254:255], v[52:53], v[50:51] op_sel_hi:[1,0,0]
v_cvt_pk_bf16_f32 v54, v160, v161
v_cvt_pk_bf16_f32 v55, v162, v163
v_cvt_pk_bf16_f32 v56, v164, v165
v_accvgpr_write_b32 a0, v54
v_cvt_pk_bf16_f32 v57, v166, v167
v_accvgpr_write_b32 a1, v55
v_cvt_pk_bf16_f32 v58, v168, v169
v_accvgpr_write_b32 a2, v56
v_cvt_pk_bf16_f32 v59, v170, v171
v_accvgpr_write_b32 a3, v57
v_cvt_pk_bf16_f32 v60, v172, v173
v_accvgpr_write_b32 a4, v58
v_cvt_pk_bf16_f32 v61, v174, v175
v_mfma_f32_32x32x16_bf16 v[160:175], a[248:251], a[248:251], 0
global_load_dword a255, v[158:159], off
ds_write_b128 v36, v[38:41] offset:0
ds_write_b128 v36, v[42:45] offset:6144
v_accvgpr_write_b32 a5, v59
v_perm_b32 v38, v131, v127, v22
v_cvt_pk_bf16_f32 v54, v176, v177
v_perm_b32 v39, v139, v135, v22
v_accvgpr_write_b32 a6, v60
v_perm_b32 v40, v147, v143, v22
v_cvt_pk_bf16_f32 v55, v178, v179
v_perm_b32 v41, v155, v151, v22
v_accvgpr_write_b32 a7, v61
v_perm_b32 v42, v131, v127, v23
v_cvt_pk_bf16_f32 v56, v180, v181
v_perm_b32 v43, v139, v135, v23
v_accvgpr_write_b32 a8, v54
v_perm_b32 v44, v147, v143, v23
v_cvt_pk_bf16_f32 v57, v182, v183
v_perm_b32 v45, v155, v151, v23
v_accvgpr_write_b32 a9, v55
v_cvt_pk_bf16_f32 v58, v184, v185
v_accvgpr_write_b32 a10, v56
v_cvt_pk_bf16_f32 v59, v186, v187
v_accvgpr_write_b32 a11, v57
v_cvt_pk_bf16_f32 v60, v188, v189
v_accvgpr_write_b32 a12, v58
v_cvt_pk_bf16_f32 v61, v190, v191
v_accvgpr_write_b32 a13, v59
v_cvt_pk_bf16_f32 v54, v192, v193
v_accvgpr_write_b32 a14, v60
v_cvt_pk_bf16_f32 v55, v194, v195
v_accvgpr_write_b32 a15, v61
v_cvt_pk_bf16_f32 v56, v196, v197
v_accvgpr_write_b32 a16, v54
v_cvt_pk_bf16_f32 v57, v198, v199
v_accvgpr_write_b32 a17, v55
v_cvt_pk_bf16_f32 v58, v200, v201
v_accvgpr_write_b32 a18, v56
v_cvt_pk_bf16_f32 v59, v202, v203
v_accvgpr_write_b32 a19, v57
v_cvt_pk_bf16_f32 v60, v204, v205
v_accvgpr_write_b32 a20, v58
v_cvt_pk_bf16_f32 v61, v206, v207
v_accvgpr_write_b32 a21, v59
v_cvt_pk_bf16_f32 v54, v208, v209
v_accvgpr_write_b32 a22, v60
v_cvt_pk_bf16_f32 v55, v210, v211
v_accvgpr_write_b32 a23, v61
v_cvt_pk_bf16_f32 v56, v212, v213
v_accvgpr_write_b32 a24, v54
v_cvt_pk_bf16_f32 v57, v214, v215
v_accvgpr_write_b32 a25, v55
v_cvt_pk_bf16_f32 v58, v216, v217
v_accvgpr_write_b32 a26, v56
v_cvt_pk_bf16_f32 v59, v218, v219
v_accvgpr_write_b32 a27, v57
v_cvt_pk_bf16_f32 v60, v220, v221
v_accvgpr_write_b32 a28, v58
v_cvt_pk_bf16_f32 v61, v222, v223
v_mfma_f32_32x32x16_bf16 v[208:223], a[248:251], a[248:251], 0
ds_write_b128 v36, v[38:41] offset:12288
ds_write_b128 v36, v[42:45] offset:18432
v_accvgpr_write_b32 a29, v59
v_perm_b32 v38, v132, v128, v22
v_cvt_pk_bf16_f32 v54, v224, v225
v_perm_b32 v39, v140, v136, v22
v_accvgpr_write_b32 a30, v60
v_perm_b32 v40, v148, v144, v22
v_cvt_pk_bf16_f32 v55, v226, v227
v_perm_b32 v41, v156, v152, v22
v_accvgpr_write_b32 a31, v61
v_perm_b32 v42, v132, v128, v23
v_cvt_pk_bf16_f32 v56, v228, v229
v_perm_b32 v43, v140, v136, v23
v_accvgpr_write_b32 a32, v54
v_perm_b32 v44, v148, v144, v23
v_cvt_pk_bf16_f32 v57, v230, v231
v_perm_b32 v45, v156, v152, v23
v_accvgpr_write_b32 a33, v55
v_mov_b32 v30, 93440
v_cvt_pk_bf16_f32 v58, v232, v233
v_mov_b32 v154, v24
v_mov_b32 v155, v25
v_accvgpr_write_b32 a34, v56
v_cvt_pk_bf16_f32 v59, v234, v235
v_accvgpr_write_b32 a35, v57
v_cvt_pk_bf16_f32 v60, v236, v237
v_accvgpr_write_b32 a36, v58
v_cvt_pk_bf16_f32 v61, v238, v239
v_accvgpr_write_b32 a37, v59
v_cvt_pk_bf16_f32 v54, v240, v241
v_accvgpr_write_b32 a38, v60
v_cvt_pk_bf16_f32 v55, v242, v243
v_accvgpr_write_b32 a39, v61
v_cvt_pk_bf16_f32 v56, v244, v245
v_accvgpr_write_b32 a40, v54
v_cvt_pk_bf16_f32 v57, v246, v247
v_accvgpr_write_b32 a41, v55
v_cvt_pk_bf16_f32 v58, v248, v249
v_accvgpr_write_b32 a42, v56
v_cvt_pk_bf16_f32 v59, v250, v251
v_accvgpr_write_b32 a43, v57
v_cvt_pk_bf16_f32 v60, v252, v253
v_accvgpr_write_b32 a44, v58
v_cvt_pk_bf16_f32 v61, v254, v255
v_accvgpr_write_b32 a45, v59
v_accvgpr_write_b32 a46, v60
v_accvgpr_write_b32 a47, v61
s_add_u32 m0, s70, 71680
ds_write_b128 v36, v[38:41] offset:24576
buffer_load_dwordx4 v12, s[4:7], 0 offen  lds
ds_write_b128 v37, v[42:45] offset:30720
s_add_u32 m0, s71, 71680
s_nop 0
buffer_load_dwordx4 v13, s[4:7], 0 offen  lds
s_add_u32 m0, s72, 71680
s_nop 0
buffer_load_dwordx4 v14, s[4:7], 0 offen  lds
s_add_u32 m0, s73, 71680
s_nop 0
buffer_load_dwordx4 v15, s[4:7], 0 offen  lds
s_add_u32 m0, s74, 71680
s_nop 0
buffer_load_dwordx4 v16, s[4:7], 0 offen  lds
s_add_u32 m0, s75, 71680
s_nop 0
buffer_load_dwordx4 v17, s[4:7], 0 offen  lds
s_waitcnt lgkmcnt(0)
s_barrier
ds_read_b128 a[192:195], v1 offset:0
ds_read_b128 a[196:199], v1 offset:1024
ds_read_b128 a[200:203], v1 offset:2048
ds_read_b128 a[204:207], v1 offset:3072
ds_read_b128 a[208:211], v1 offset:4096
ds_read_b128 a[212:215], v1 offset:5120
ds_read_b128 a[216:219], v1 offset:6144
ds_read_b128 a[220:223], v1 offset:7168
ds_read_b128 a[224:227], v1 offset:8192
ds_read_b128 a[228:231], v1 offset:9216
ds_read_b128 a[232:235], v1 offset:10240
ds_read_b128 a[236:239], v1 offset:11264
ds_read_b128 v[40:43], v30
s_waitcnt lgkmcnt(0)
v_max3_u32 v28, v40, v41, v42
v_max_u32 v28, v28, v43
s_nop 0
v_readfirstlane_b32 s88, v28
s_nop 1
s_lshr_b32 s88, s88, 7
s_sub_i32 s88, s88, 129
s_max_i32 s88, s88, 0
s_min_i32 s88, s88, 12
s_cmp_lg_u32 s88, 0
s_cbranch_scc1 L_redo
L_back:
v_mov_b32 v156, 3
v_mfma_f32_32x32x16_bf16 v[102:117], a[0:3], a[192:195], 0
s_add_u32 s96, s88, 112
s_lshl_b32 s96, s96, 23
s_sub_u32 s86, 0x3eeff558, s96
s_add_u32 s87, 0x3f800000, s96
s_sub_u32 s60, 0xbf800000, s96
v_mfma_f32_32x32x16_bf16 v[102:117], a[4:7], a[196:199], v[102:117]
v_mfma_f32_32x32x16_bf16 v[102:117], a[8:11], a[200:203], v[102:117]
v_mfma_f32_32x32x16_bf16 v[102:117], a[12:15], a[204:207], v[102:117]
v_mfma_f32_32x32x16_bf16 v[102:117], a[16:19], a[208:211], v[102:117]
v_mfma_f32_32x32x16_bf16 v[102:117], a[20:23], a[212:215], v[102:117]
s_nop 5
v_mfma_f32_32x32x16_bf16 v[134:149], a[24:27], a[192:195], 0
ds_read_b128 a[192:195], v1 offset:12288
s_nop 3
v_mad_u32_u16 v102, v102, 2, s85 op_sel:[1,0,0,0]
v_mad_u32_u16 v103, v103, 2, s85 op_sel:[1,0,0,0]
v_mad_u32_u16 v104, v104, 2, s85 op_sel:[1,0,0,0]
v_mfma_f32_32x32x16_bf16 v[134:149], a[28:31], a[196:199], v[134:149]
ds_read_b128 a[196:199], v1 offset:13312
ds_read_u16_d16_hi v102, v102
ds_read_u16_d16_hi v103, v103
ds_read_u16_d16_hi v104, v104
v_mad_u32_u16 v105, v105, 2, s85 op_sel:[1,0,0,0]
v_mad_u32_u16 v106, v106, 2, s85 op_sel:[1,0,0,0]
v_mad_u32_u16 v107, v107, 2, s85 op_sel:[1,0,0,0]
v_mfma_f32_32x32x16_bf16 v[134:149], a[32:35], a[200:203], v[134:149]
ds_read_b128 a[200:203], v1 offset:14336
ds_read_u16_d16_hi v105, v105
ds_read_u16_d16_hi v106, v106
ds_read_u16_d16_hi v107, v107
v_mad_u32_u16 v108, v108, 2, s85 op_sel:[1,0,0,0]
v_mad_u32_u16 v109, v109, 2, s85 op_sel:[1,0,0,0]
v_mad_u32_u16 v110, v110, 2, s85 op_sel:[1,0,0,0]
v_mfma_f32_32x32x16_bf16 v[134:149], a[36:39], a[204:207], v[134:149]
ds_read_b128 a[204:207], v1 offset:15360
ds_read_u16_d16_hi v108, v108
ds_read_u16_d16_hi v109, v109
ds_read_u16_d16_hi v110, v110
v_mad_u32_u16 v111, v111, 2, s85 op_sel:[1,0,0,0]
v_mad_u32_u16 v112, v112, 2, s85 op_sel:[1,0,0,0]
v_mad_u32_u16 v113, v113, 2, s85 op_sel:[1,0,0,0]
v_mfma_f32_32x32x16_bf16 v[134:149], a[40:43], a[208:211], v[134:149]
v_mad_u32_u16 v114, v114, 2, s85 op_sel:[1,0,0,0]
v_mad_u32_u16 v115, v115, 2, s85 op_sel:[1,0,0,0]
v_mad_u32_u16 v116, v116, 2, s85 op_sel:[1,0,0,0]
v_mad_u32_u16 v117, v117, 2, s85 op_sel:[1,0,0,0]
ds_read_b128 a[208:211], v1 offset:16384
v_mfma_f32_32x32x16_bf16 v[134:149], a[44:47], a[212:215], v[134:149]
ds_read_b128 a[212:215], v1 offset:17408
ds_read_u16_d16_hi v111, v111
ds_read_u16_d16_hi v112, v112
ds_read_u16_d16_hi v113, v113
s_nop 1
v_mfma_f32_32x32x16_bf16 v[118:133], a[0:3], a[216:219], 0
ds_read_u16_d16_hi v114, v114
s_nop 3
v_mul_f32 v150, s60, v146
v_mul_f32 v151, s60, v147
v_mul_f32 v152, s60, v148
v_mfma_f32_32x32x16_bf16 v[118:133], a[4:7], a[220:223], v[118:133]
v_mul_f32 v153, s60, v149
v_mad_u32_u16 v150, v150, 2, s85 op_sel:[1,0,0,0]
v_mad_u32_u16 v151, v151, 2, s85 op_sel:[1,0,0,0]
v_mad_u32_u16 v152, v152, 2, s85 op_sel:[1,0,0,0]
v_mad_u32_u16 v153, v153, 2, s85 op_sel:[1,0,0,0]
v_cvt_pk_f16_f32 v86, v134, v135
v_cvt_pk_f16_f32 v87, v136, v137
v_mfma_f32_32x32x16_bf16 v[118:133], a[8:11], a[224:227], v[118:133]
v_pk_fma_f16 v70, v86, v86, s84
v_cvt_pk_f16_f32 v88, v138, v139
v_pk_fma_f16 v71, v87, v87, s84
v_pk_mul_f16 v70, v86, v70
v_cvt_pk_f16_f32 v89, v140, v141
v_exp_f16 v62, v70
v_lshl_add_u64 v[158:159], v[158:159], 0, s[42:43]
v_pk_fma_f16 v72, v88, v88, s84
v_mfma_f32_32x32x16_bf16 v[118:133], a[12:15], a[228:231], v[118:133]
ds_read_u16_d16_hi v115, v115
v_pk_mul_f16 v71, v87, v71
v_cvt_pk_f16_f32 v90, v142, v143
v_pk_fma_f16 v73, v89, v89, s84
v_exp_f16 v63, v71
v_pk_mul_f16 v72, v88, v72
v_cvt_pk_f16_f32 v91, v144, v145
v_mfma_f32_32x32x16_bf16 v[118:133], a[16:19], a[232:235], v[118:133]
ds_read_u16_d16_hi v116, v116
ds_read_u16_d16_hi v117, v117
v_pk_fma_f16 v74, v90, v90, s84
v_pk_mul_f16 v73, v89, v73
v_pk_fma_f16 v75, v91, v91, s84
v_exp_f16 v64, v72
v_pk_mul_f16 v74, v90, v74
v_mfma_f32_32x32x16_bf16 v[118:133], a[20:23], a[236:239], v[118:133]
ds_read_u16_d16_hi v150, v150
v_pk_mul_f16 v75, v91, v75
v_exp_f16_sdwa v62, v70 dst_sel:WORD_1 dst_unused:UNUSED_PRESERVE src0_sel:WORD_1
v_exp_f16 v65, v73
v_exp_f16_sdwa v63, v71 dst_sel:WORD_1 dst_unused:UNUSED_PRESERVE src0_sel:WORD_1
v_mfma_f32_32x32x16_bf16 v[134:149], a[24:27], a[216:219], 0
ds_read_b128 a[216:219], v1 offset:18432
ds_read_u16_d16_hi v151, v151
v_exp_f16 v66, v74
v_exp_f16_sdwa v64, v72 dst_sel:WORD_1 dst_unused:UNUSED_PRESERVE src0_sel:WORD_1
v_exp_f16 v67, v75
v_mfma_f32_32x32x16_bf16 v[134:149], a[28:31], a[220:223], v[134:149]
ds_read_b128 a[220:223], v1 offset:19456
ds_read_u16_d16_hi v152, v152
v_mad_u32_u16 v118, v118, 2, s85 op_sel:[1,0,0,0]
v_mad_u32_u16 v119, v119, 2, s85 op_sel:[1,0,0,0]
v_mad_u32_u16 v120, v120, 2, s85 op_sel:[1,0,0,0]
v_mad_u32_u16 v121, v121, 2, s85 op_sel:[1,0,0,0]
v_mad_u32_u16 v122, v122, 2, s85 op_sel:[1,0,0,0]
v_mad_u32_u16 v123, v123, 2, s85 op_sel:[1,0,0,0]
v_mfma_f32_32x32x16_bf16 v[134:149], a[32:35], a[224:227], v[134:149]
ds_read_b128 a[224:227], v1 offset:20480
ds_read_u16_d16_hi v153, v153
v_mad_u32_u16 v124, v124, 2, s85 op_sel:[1,0,0,0]
v_mad_u32_u16 v125, v125, 2, s85 op_sel:[1,0,0,0]
v_mad_u32_u16 v126, v126, 2, s85 op_sel:[1,0,0,0]
v_mad_u32_u16 v127, v127, 2, s85 op_sel:[1,0,0,0]
v_mad_u32_u16 v128, v128, 2, s85 op_sel:[1,0,0,0]
v_mfma_f32_32x32x16_bf16 v[134:149], a[36:39], a[228:231], v[134:149]
ds_read_b128 a[228:231], v1 offset:21504
v_pk_add_f16 v70, v62, 1.0 op_sel_hi:[1,0]
v_mad_u32_u16 v129, v129, 2, s85 op_sel:[1,0,0,0]
v_pk_add_f16 v71, v63, 1.0 op_sel_hi:[1,0]
v_mad_u32_u16 v130, v130, 2, s85 op_sel:[1,0,0,0]
v_pk_add_f16 v72, v64, 1.0 op_sel_hi:[1,0]
v_mad_u32_u16 v131, v131, 2, s85 op_sel:[1,0,0,0]
v_mfma_f32_32x32x16_bf16 v[134:149], a[40:43], a[232:235], v[134:149]
ds_read_b128 a[232:235], v1 offset:22528
v_exp_f16_sdwa v65, v73 dst_sel:WORD_1 dst_unused:UNUSED_PRESERVE src0_sel:WORD_1
v_exp_f16_sdwa v66, v74 dst_sel:WORD_1 dst_unused:UNUSED_PRESERVE src0_sel:WORD_1
v_pk_add_f16 v73, v65, 1.0 op_sel_hi:[1,0]
v_mad_u32_u16 v132, v132, 2, s85 op_sel:[1,0,0,0]
v_pk_add_f16 v74, v66, 1.0 op_sel_hi:[1,0]
v_mfma_f32_32x32x16_bf16 v[134:149], a[44:47], a[236:239], v[134:149]
ds_read_b128 a[236:239], v1 offset:23552
ds_read_u16_d16_hi v118, v118
v_mad_u32_u16 v133, v133, 2, s85 op_sel:[1,0,0,0]
v_exp_f16_sdwa v67, v75 dst_sel:WORD_1 dst_unused:UNUSED_PRESERVE src0_sel:WORD_1
v_rcp_f16 v62, v70
v_pk_add_f16 v75, v67, 1.0 op_sel_hi:[1,0]
s_waitcnt lgkmcnt(9)
v_pk_add_f32 v[22:23], v[116:117], v[114:115]
v_pk_add_f32 v[22:23], v[22:23], v[112:113]
v_pk_add_f32 v[22:23], v[22:23], v[110:111]
v_pk_add_f32 v[22:23], v[22:23], v[108:109]
v_pk_add_f32 v[22:23], v[22:23], v[106:107]
v_rcp_f16 v63, v71
v_pk_add_f32 v[22:23], v[22:23], v[104:105]
v_pk_add_f32 v[22:23], v[22:23], v[102:103]
v_mfma_f32_32x32x16_bf16 v[102:117], a[0:3], a[192:195], 0
s_add_u32 m0, s70, 100096
ds_read_u16_d16_hi v119, v119
buffer_load_dwordx4 v12, s[4:7], s89 offen  lds
ds_read_u16_d16_hi v120, v120
ds_read_u16_d16_hi v121, v121
v_add_f32 v22, v22, v150
v_mfma_f32_32x32x16_bf16 v[102:117], a[4:7], a[196:199], v[102:117]
ds_read_u16_d16_hi v122, v122
s_waitcnt lgkmcnt(9)
v_add_f32 v23, v23, v151
v_rcp_f16 v64, v72
v_rcp_f16_sdwa v62, v70 dst_sel:WORD_1 dst_unused:UNUSED_PRESERVE src0_sel:WORD_1
v_rcp_f16 v65, v73
v_mfma_f32_32x32x16_bf16 v[102:117], a[8:11], a[200:203], v[102:117]
ds_read_u16_d16_hi v123, v123
ds_read_u16_d16_hi v124, v124
ds_read_u16_d16_hi v125, v125
v_add_f32 v22, v22, v152
v_rcp_f16_sdwa v63, v71 dst_sel:WORD_1 dst_unused:UNUSED_PRESERVE src0_sel:WORD_1
v_rcp_f16 v66, v74
v_mfma_f32_32x32x16_bf16 v[102:117], a[12:15], a[204:207], v[102:117]
ds_read_u16_d16_hi v126, v126
s_waitcnt lgkmcnt(9)
v_add_f32 v23, v23, v153
v_mul_f32 v150, s60, v146
v_mul_f32 v151, s60, v147
v_mul_f32 v152, s60, v148
v_mul_f32 v153, s60, v149
v_mad_u32_u16 v150, v150, 2, s85 op_sel:[1,0,0,0]
v_mfma_f32_32x32x16_bf16 v[102:117], a[16:19], a[208:211], v[102:117]
ds_read_u16_d16_hi v127, v127
ds_read_u16_d16_hi v128, v128
s_add_u32 m0, s71, 100096
v_mad_u32_u16 v151, v151, 2, s85 op_sel:[1,0,0,0]
v_mad_u32_u16 v152, v152, 2, s85 op_sel:[1,0,0,0]
v_mad_u32_u16 v153, v153, 2, s85 op_sel:[1,0,0,0]
v_cvt_pk_f16_f32 v94, v134, v135
v_mfma_f32_32x32x16_bf16 v[102:117], a[20:23], a[212:215], v[102:117]
buffer_load_dwordx4 v13, s[4:7], s89 offen  lds
ds_read_u16_d16_hi v129, v129
ds_read_u16_d16_hi v130, v130
v_cvt_pk_f16_f32 v95, v136, v137
v_pk_fma_f16 v78, v94, v94, s84
v_pk_mul_f16 v86, v86, v62
v_cvt_pk_f16_f32 v96, v138, v139
v_pk_fma_f16 v79, v95, v95, s84
v_pk_mul_f16 v78, v94, v78
v_pk_mul_f16 v87, v87, v63
v_cvt_pk_f16_f32 v97, v140, v141
v_pk_fma_f16 v80, v96, v96, s84
v_pk_mul_f16 v79, v95, v79
v_rcp_f16_sdwa v64, v72 dst_sel:WORD_1 dst_unused:UNUSED_PRESERVE src0_sel:WORD_1
v_rcp_f16 v67, v75
v_pk_mul_f16 v88, v88, v64
v_cvt_pk_f16_f32 v98, v142, v143
v_pk_fma_f16 v81, v97, v97, s84
v_pk_mul_f16 v80, v96, v80
v_rcp_f16_sdwa v65, v73 dst_sel:WORD_1 dst_unused:UNUSED_PRESERVE src0_sel:WORD_1
v_rcp_f16_sdwa v66, v74 dst_sel:WORD_1 dst_unused:UNUSED_PRESERVE src0_sel:WORD_1
v_pk_mul_f16 v89, v89, v65
v_cvt_pk_f16_f32 v99, v144, v145
v_mfma_f32_32x32x16_bf16 v[134:149], a[192:195], a[24:27], 0
ds_read_b128 a[192:195], v1 offset:24576
ds_read_u16_d16_hi v131, v131
ds_read_u16_d16_hi v132, v132
ds_read_u16_d16_hi v133, v133
v_pk_fma_f16 v82, v98, v98, s84
v_rcp_f16_sdwa v67, v75 dst_sel:WORD_1 dst_unused:UNUSED_PRESERVE src0_sel:WORD_1
v_pk_mul_f16 v81, v97, v81
v_mfma_f32_32x32x16_bf16 v[134:149], a[196:199], a[28:31], v[134:149]
ds_read_b128 a[196:199], v1 offset:25600
s_add_u32 m0, s72, 100096
ds_read_u16_d16_hi v150, v150
buffer_load_dwordx4 v14, s[4:7], s89 offen  lds
v_pk_mul_f16 v90, v90, v66
v_pk_fma_f16 v83, v99, v99, s84
v_mfma_f32_32x32x16_bf16 v[134:149], a[200:203], a[32:35], v[134:149]
ds_read_b128 a[200:203], v1 offset:26624
v_pk_mul_f16 v82, v98, v82
v_pk_mul_f16 v83, v99, v83
v_pk_mul_f16 v91, v91, v67
v_mad_u32_u16 v102, v102, 2, s85 op_sel:[1,0,0,0]
v_mad_u32_u16 v103, v103, 2, s85 op_sel:[1,0,0,0]
v_exp_f16 v62, v78
v_mfma_f32_32x32x16_bf16 v[134:149], a[204:207], a[36:39], v[134:149]
ds_read_b128 a[204:207], v1 offset:27648
v_mad_u32_u16 v104, v104, 2, s85 op_sel:[1,0,0,0]
v_mad_u32_u16 v105, v105, 2, s85 op_sel:[1,0,0,0]
v_mad_u32_u16 v106, v106, 2, s85 op_sel:[1,0,0,0]
v_mad_u32_u16 v107, v107, 2, s85 op_sel:[1,0,0,0]
v_mad_u32_u16 v108, v108, 2, s85 op_sel:[1,0,0,0]
v_mad_u32_u16 v109, v109, 2, s85 op_sel:[1,0,0,0]
v_exp_f16 v63, v79
v_mfma_f32_32x32x16_bf16 v[134:149], a[208:211], a[40:43], v[134:149]
ds_read_b128 a[208:211], v1 offset:28672
ds_read_u16_d16_hi v151, v151
v_mad_u32_u16 v110, v110, 2, s85 op_sel:[1,0,0,0]
v_mad_u32_u16 v111, v111, 2, s85 op_sel:[1,0,0,0]
v_mad_u32_u16 v112, v112, 2, s85 op_sel:[1,0,0,0]
v_exp_f16 v64, v80
v_exp_f16_sdwa v62, v78 dst_sel:WORD_1 dst_unused:UNUSED_PRESERVE src0_sel:WORD_1
v_mfma_f32_32x32x16_bf16 v[134:149], a[212:215], a[44:47], v[134:149]
ds_read_b128 a[212:215], v1 offset:29696
v_pk_add_f16 v78, v62, 1.0 op_sel_hi:[1,0]
v_mad_u32_u16 v113, v113, 2, s85 op_sel:[1,0,0,0]
v_exp_f16 v65, v81
v_exp_f16_sdwa v63, v79 dst_sel:WORD_1 dst_unused:UNUSED_PRESERVE src0_sel:WORD_1
v_exp_f16 v66, v82
v_pk_add_f16 v79, v63, 1.0 op_sel_hi:[1,0]
v_mad_u32_u16 v114, v114, 2, s85 op_sel:[1,0,0,0]
v_exp_f16_sdwa v64, v80 dst_sel:WORD_1 dst_unused:UNUSED_PRESERVE src0_sel:WORD_1
v_exp_f16 v67, v83
v_pk_add_f16 v80, v64, 1.0 op_sel_hi:[1,0]
v_mad_u32_u16 v115, v115, 2, s85 op_sel:[1,0,0,0]
v_exp_f16_sdwa v65, v81 dst_sel:WORD_1 dst_unused:UNUSED_PRESERVE src0_sel:WORD_1
v_exp_f16_sdwa v66, v82 dst_sel:WORD_1 dst_unused:UNUSED_PRESERVE src0_sel:WORD_1
v_pk_add_f16 v81, v65, 1.0 op_sel_hi:[1,0]
v_mad_u32_u16 v116, v116, 2, s85 op_sel:[1,0,0,0]
v_pk_add_f16 v82, v66, 1.0 op_sel_hi:[1,0]
v_mad_u32_u16 v117, v117, 2, s85 op_sel:[1,0,0,0]
v_exp_f16_sdwa v67, v83 dst_sel:WORD_1 dst_unused:UNUSED_PRESERVE src0_sel:WORD_1
v_rcp_f16 v62, v78
s_waitcnt lgkmcnt(5)
v_pk_add_f32 v[24:25], v[132:133], v[130:131]
v_pk_add_f32 v[24:25], v[24:25], v[128:129]
v_pk_add_f32 v[24:25], v[24:25], v[126:127]
v_pk_add_f32 v[24:25], v[24:25], v[124:125]
v_rcp_f16 v63, v79
v_pk_add_f32 v[24:25], v[24:25], v[122:123]
v_pk_add_f32 v[24:25], v[24:25], v[120:121]
v_pk_add_f32 v[24:25], v[24:25], v[118:119]
v_dot2c_f32_f16 v23, v91, v91
v_dot2c_f32_f16 v22, v90, v90
v_dot2c_f32_f16 v23, v89, v89
v_dot2c_f32_f16 v22, v88, v88
v_dot2c_f32_f16 v23, v87, v87
v_dot2c_f32_f16 v22, v86, v86
v_mfma_f32_32x32x16_bf16 v[118:133], a[0:3], a[216:219], 0
s_add_u32 m0, s73, 100096
ds_read_u16_d16_hi v152, v152
buffer_load_dwordx4 v15, s[4:7], s89 offen  lds
ds_read_u16_d16_hi v153, v153
ds_read_u16_d16_hi v102, v102
v_pk_add_f16 v83, v67, 1.0 op_sel_hi:[1,0]
v_mfma_f32_32x32x16_bf16 v[118:133], a[4:7], a[220:223], v[118:133]
ds_read_u16_d16_hi v103, v103
ds_read_u16_d16_hi v104, v104
ds_read_u16_d16_hi v105, v105
ds_read_u16_d16_hi v106, v106
v_add_f32 v24, v24, v150
s_waitcnt lgkmcnt(7)
v_add_f32 v25, v25, v151
v_rcp_f16 v64, v80
v_mfma_f32_32x32x16_bf16 v[118:133], a[8:11], a[224:227], v[118:133]
ds_read_u16_d16_hi v107, v107
ds_read_u16_d16_hi v108, v108
ds_read_u16_d16_hi v109, v109
v_rcp_f16_sdwa v62, v78 dst_sel:WORD_1 dst_unused:UNUSED_PRESERVE src0_sel:WORD_1
v_rcp_f16 v65, v81
v_rcp_f16_sdwa v63, v79 dst_sel:WORD_1 dst_unused:UNUSED_PRESERVE src0_sel:WORD_1
v_mfma_f32_32x32x16_bf16 v[118:133], a[12:15], a[228:231], v[118:133]
ds_read_u16_d16_hi v110, v110
v_rcp_f16 v66, v82
s_waitcnt lgkmcnt(8)
v_add_f32 v24, v24, v152
v_rcp_f16_sdwa v64, v80 dst_sel:WORD_1 dst_unused:UNUSED_PRESERVE src0_sel:WORD_1
v_rcp_f16 v67, v83
v_mfma_f32_32x32x16_bf16 v[118:133], a[16:19], a[232:235], v[118:133]
s_add_u32 m0, s74, 100096
ds_read_u16_d16_hi v111, v111
buffer_load_dwordx4 v16, s[4:7], s89 offen  lds
ds_read_u16_d16_hi v112, v112
ds_read_u16_d16_hi v113, v113
v_add_f32 v25, v25, v153
v_mfma_f32_32x32x16_bf16 v[118:133], a[20:23], a[236:239], v[118:133]
v_cvt_pk_f16_f32 v86, v134, v135
v_cvt_pk_f16_f32 v87, v136, v137
v_pk_fma_f16 v70, v86, v86, s84
v_cvt_pk_f16_f32 v88, v138, v139
v_pk_fma_f16 v71, v87, v87, s84
v_pk_mul_f16 v70, v86, v70
v_cvt_pk_f16_f32 v89, v140, v141
v_pk_fma_f16 v72, v88, v88, s84
v_pk_mul_f16 v71, v87, v71
v_cvt_pk_f16_f32 v90, v142, v143
v_pk_mul_f16 v94, v94, v62
v_pk_fma_f16 v73, v89, v89, s84
v_pk_mul_f16 v72, v88, v72
v_cvt_pk_f16_f32 v91, v144, v145
v_pk_mul_f16 v95, v95, v63
v_pk_fma_f16 v74, v90, v90, s84
v_pk_mul_f16 v73, v89, v73
v_cvt_pk_f16_f32 v92, v146, v147
v_pk_mul_f16 v96, v96, v64
v_pk_fma_f16 v75, v91, v91, s84
v_pk_mul_f16 v74, v90, v74
v_rcp_f16_sdwa v65, v81 dst_sel:WORD_1 dst_unused:UNUSED_PRESERVE src0_sel:WORD_1
v_rcp_f16_sdwa v66, v82 dst_sel:WORD_1 dst_unused:UNUSED_PRESERVE src0_sel:WORD_1
v_pk_mul_f16 v97, v97, v65
v_cvt_pk_f16_f32 v93, v148, v149
v_mfma_f32_32x32x16_bf16 v[134:149], a[24:27], a[216:219], 0
ds_read_b128 a[216:219], v1 offset:30720
s_add_u32 m0, s75, 100096
ds_read_u16_d16_hi v114, v114
buffer_load_dwordx4 v17, s[4:7], s89 offen  lds
ds_read_u16_d16_hi v115, v115
v_pk_fma_f16 v76, v92, v92, s84
v_mfma_f32_32x32x16_bf16 v[134:149], a[28:31], a[220:223], v[134:149]
ds_read_b128 a[220:223], v1 offset:31744
ds_read_u16_d16_hi v116, v116
ds_read_u16_d16_hi v117, v117
v_pk_mul_f16 v75, v91, v75
v_pk_mul_f16 v98, v98, v66
v_pk_fma_f16 v77, v93, v93, s84
v_pk_mul_f16 v76, v92, v76
v_mfma_f32_32x32x16_bf16 v[134:149], a[32:35], a[224:227], v[134:149]
ds_read_b128 a[224:227], v1 offset:32768
v_pk_mul_f16 v77, v93, v77
v_rcp_f16_sdwa v67, v83 dst_sel:WORD_1 dst_unused:UNUSED_PRESERVE src0_sel:WORD_1
v_exp_f16 v62, v70
v_pk_mul_f16 v99, v99, v67
v_mad_u32_u16 v118, v118, 2, s85 op_sel:[1,0,0,0]
v_mfma_f32_32x32x16_bf16 v[134:149], a[36:39], a[228:231], v[134:149]
ds_read_b128 a[228:231], v1 offset:33792
ds_read_u16_d16_hi v118, v118
v_mad_u32_u16 v119, v119, 2, s85 op_sel:[1,0,0,0]
v_mad_u32_u16 v120, v120, 2, s85 op_sel:[1,0,0,0]
v_mad_u32_u16 v121, v121, 2, s85 op_sel:[1,0,0,0]
v_exp_f16 v63, v71
v_mad_u32_u16 v122, v122, 2, s85 op_sel:[1,0,0,0]
v_mfma_f32_32x32x16_bf16 v[134:149], a[40:43], a[232:235], v[134:149]
ds_read_b128 a[232:235], v1 offset:34816
ds_read_u16_d16_hi v119, v119
v_mad_u32_u16 v123, v123, 2, s85 op_sel:[1,0,0,0]
v_mad_u32_u16 v124, v124, 2, s85 op_sel:[1,0,0,0]
v_mad_u32_u16 v125, v125, 2, s85 op_sel:[1,0,0,0]
v_mad_u32_u16 v126, v126, 2, s85 op_sel:[1,0,0,0]
v_exp_f16 v64, v72
v_mfma_f32_32x32x16_bf16 v[134:149], a[44:47], a[236:239], v[134:149]
ds_read_b128 a[236:239], v1 offset:35840
ds_read_u16_d16_hi v120, v120
v_mad_u32_u16 v127, v127, 2, s85 op_sel:[1,0,0,0]
v_exp_f16_sdwa v62, v70 dst_sel:WORD_1 dst_unused:UNUSED_PRESERVE src0_sel:WORD_1
v_exp_f16 v65, v73
v_pk_add_f16 v70, v62, 1.0 op_sel_hi:[1,0]
v_mad_u32_u16 v128, v128, 2, s85 op_sel:[1,0,0,0]
v_exp_f16_sdwa v63, v71 dst_sel:WORD_1 dst_unused:UNUSED_PRESERVE src0_sel:WORD_1
v_lshlrev_b32 v157, 12, v1
v_add_u32 v157, s61, v157
v_mov_b32 v61, 1
s_waitcnt vmcnt(13)
v_lshl_or_b32 v20, v21, 16, v20
v_lshlrev_b32 v18, 16, v18
v_lshlrev_b32 v19, 16, v19
v_pk_add_f16 v71, v63, 1.0 op_sel_hi:[1,0]
v_mad_u32_u16 v129, v129, 2, s85 op_sel:[1,0,0,0]
v_exp_f16 v66, v74
v_exp_f16_sdwa v64, v72 dst_sel:WORD_1 dst_unused:UNUSED_PRESERVE src0_sel:WORD_1
v_exp_f16 v67, v75
v_pk_add_f16 v72, v64, 1.0 op_sel_hi:[1,0]
v_mad_u32_u16 v130, v130, 2, s85 op_sel:[1,0,0,0]
v_exp_f16_sdwa v65, v73 dst_sel:WORD_1 dst_unused:UNUSED_PRESERVE src0_sel:WORD_1
v_exp_f16 v68, v76
v_pk_add_f16 v73, v65, 1.0 op_sel_hi:[1,0]
v_exp_f16_sdwa v66, v74 dst_sel:WORD_1 dst_unused:UNUSED_PRESERVE src0_sel:WORD_1
s_waitcnt lgkmcnt(4)
v_pk_add_f32 v[26:27], v[116:117], v[114:115]
v_pk_add_f32 v[26:27], v[26:27], v[112:113]
v_pk_add_f32 v[26:27], v[26:27], v[110:111]
v_pk_add_f32 v[26:27], v[26:27], v[108:109]
v_pk_add_f32 v[26:27], v[26:27], v[106:107]
v_exp_f16 v69, v77
v_pk_add_f32 v[26:27], v[26:27], v[104:105]
v_pk_add_f32 v[26:27], v[26:27], v[102:103]
v_dot2c_f32_f16 v25, v99, v99
v_dot2c_f32_f16 v24, v98, v98
v_dot2c_f32_f16 v25, v97, v97
v_dot2c_f32_f16 v24, v96, v96
v_dot2c_f32_f16 v25, v95, v95
v_dot2c_f32_f16 v24, v94, v94
v_mfma_f32_32x32x16_bf16 v[102:117], a[0:3], a[192:195], 0
s_add_u32 m0, s70, 121856
ds_read_u16_d16_hi v121, v121
buffer_load_dwordx4 v12, s[4:7], s90 offen  lds
ds_read_u16_d16_hi v122, v122
ds_read_u16_d16_hi v123, v123
v_pk_add_f16 v74, v66, 1.0 op_sel_hi:[1,0]
v_mfma_f32_32x32x16_bf16 v[102:117], a[4:7], a[196:199], v[102:117]
ds_read_u16_d16_hi v124, v124
ds_read_u16_d16_hi v125, v125
ds_read_u16_d16_hi v126, v126
ds_read_u16_d16_hi v127, v127
v_mad_u32_u16 v131, v131, 2, s85 op_sel:[1,0,0,0]
v_exp_f16_sdwa v67, v75 dst_sel:WORD_1 dst_unused:UNUSED_PRESERVE src0_sel:WORD_1
v_exp_f16_sdwa v68, v76 dst_sel:WORD_1 dst_unused:UNUSED_PRESERVE src0_sel:WORD_1
v_mfma_f32_32x32x16_bf16 v[102:117], a[8:11], a[200:203], v[102:117]
ds_read_u16_d16_hi v128, v128
ds_read_u16_d16_hi v129, v129
ds_read_u16_d16_hi v130, v130
v_pk_add_f16 v75, v67, 1.0 op_sel_hi:[1,0]
v_mad_u32_u16 v132, v132, 2, s85 op_sel:[1,0,0,0]
v_pk_add_f16 v76, v68, 1.0 op_sel_hi:[1,0]
v_exp_f16_sdwa v69, v77 dst_sel:WORD_1 dst_unused:UNUSED_PRESERVE src0_sel:WORD_1
v_mfma_f32_32x32x16_bf16 v[102:117], a[12:15], a[204:207], v[102:117]
ds_read_u16_d16_hi v131, v131
v_mad_u32_u16 v133, v133, 2, s85 op_sel:[1,0,0,0]
v_pk_add_f16 v77, v69, 1.0 op_sel_hi:[1,0]
v_mul_f32 v150, s60, v146
s_waitcnt vmcnt(7)
ds_write_b32 v154, v156
v_mul_f32 v151, s60, v147
v_mfma_f32_32x32x16_bf16 v[102:117], a[16:19], a[208:211], v[102:117]
ds_read_b32 v156, v155
v_mul_f32 v152, s60, v148
v_mul_f32 v153, s60, v149
v_mad_u32_u16 v150, v150, 2, s85 op_sel:[1,0,0,0]
v_mad_u32_u16 v151, v151, 2, s85 op_sel:[1,0,0,0]
v_mad_u32_u16 v152, v152, 2, s85 op_sel:[1,0,0,0]
v_mad_u32_u16 v153, v153, 2, s85 op_sel:[1,0,0,0]
v_cvt_pk_f16_f32 v94, v134, v135
v_mfma_f32_32x32x16_bf16 v[102:117], a[20:23], a[212:215], v[102:117]
s_add_u32 m0, s71, 121856
ds_read_u16_d16_hi v132, v132
buffer_load_dwordx4 v13, s[4:7], s90 offen  lds
ds_read_u16_d16_hi v133, v133
v_cvt_pk_f16_f32 v95, v136, v137
v_rcp_f16 v62, v70
v_rcp_f16 v63, v71
v_rcp_f16 v64, v72
v_rcp_f16_sdwa v62, v70 dst_sel:WORD_1 dst_unused:UNUSED_PRESERVE src0_sel:WORD_1
v_rcp_f16 v65, v73
v_pk_mul_f16 v86, v86, v62
v_pk_fma_f16 v78, v94, v94, s84
v_cvt_pk_f16_f32 v96, v138, v139
v_rcp_f16_sdwa v63, v71 dst_sel:WORD_1 dst_unused:UNUSED_PRESERVE src0_sel:WORD_1
v_rcp_f16 v66, v74
v_pk_mul_f16 v87, v87, v63
v_pk_fma_f16 v79, v95, v95, s84
v_pk_mul_f16 v78, v94, v78
v_rcp_f16_sdwa v64, v72 dst_sel:WORD_1 dst_unused:UNUSED_PRESERVE src0_sel:WORD_1
v_rcp_f16 v67, v75
v_pk_mul_f16 v88, v88, v64
v_cvt_pk_f16_f32 v97, v140, v141
v_pk_fma_f16 v80, v96, v96, s84
v_pk_mul_f16 v79, v95, v79
v_rcp_f16_sdwa v65, v73 dst_sel:WORD_1 dst_unused:UNUSED_PRESERVE src0_sel:WORD_1
v_rcp_f16 v68, v76
v_pk_mul_f16 v89, v89, v65
v_cvt_pk_f16_f32 v98, v142, v143
v_pk_fma_f16 v81, v97, v97, s84
v_rcp_f16_sdwa v66, v74 dst_sel:WORD_1 dst_unused:UNUSED_PRESERVE src0_sel:WORD_1
v_rcp_f16 v69, v77
v_pk_mul_f16 v90, v90, v66
v_pk_mul_f16 v80, v96, v80
v_cvt_pk_f16_f32 v99, v144, v145
v_mfma_f32_32x32x16_bf16 v[134:149], a[24:27], a[192:195], 0
ds_read_b128 a[192:195], v1 offset:36864
s_add_u32 m0, s72, 121856
ds_read_u16_d16_hi v150, v150
buffer_load_dwordx4 v14, s[4:7], s90 offen  lds
ds_read_u16_d16_hi v151, v151
v_rcp_f16_sdwa v67, v75 dst_sel:WORD_1 dst_unused:UNUSED_PRESERVE src0_sel:WORD_1
v_mfma_f32_32x32x16_bf16 v[134:149], a[28:31], a[196:199], v[134:149]
ds_read_b128 a[196:199], v1 offset:37888
ds_read_u16_d16_hi v152, v152
ds_read_u16_d16_hi v153, v153
v_pk_mul_f16 v91, v91, v67
v_pk_fma_f16 v82, v98, v98, s84
v_pk_mul_f16 v81, v97, v81
v_rcp_f16_sdwa v68, v76 dst_sel:WORD_1 dst_unused:UNUSED_PRESERVE src0_sel:WORD_1
v_mfma_f32_32x32x16_bf16 v[134:149], a[32:35], a[200:203], v[134:149]
ds_read_b128 a[200:203], v1 offset:38912
s_waitcnt lgkmcnt(7)
v_cmp_gt_u32 vcc, 3, v156
v_pk_mul_f16 v92, v92, v68
v_pk_fma_f16 v83, v99, v99, s84
s_cbranch_vccnz L_spin3
L_ok3:
v_mov_b32 v156, 4
v_pk_mul_f16 v82, v98, v82
v_mfma_f32_32x32x16_bf16 v[134:149], a[36:39], a[204:207], v[134:149]
ds_read_b128 a[204:207], v1 offset:39936
ds_read_b128 a[156:159], v6 offset:0
ds_read_b128 a[160:163], v7 offset:0
ds_read_b128 a[144:147], v5 offset:0
v_pk_mul_f16 v83, v99, v83
v_rcp_f16_sdwa v69, v77 dst_sel:WORD_1 dst_unused:UNUSED_PRESERVE src0_sel:WORD_1
v_exp_f16 v62, v78
v_pk_add_f32 v[28:29], v[132:133], v[130:131]
v_pk_add_f32 v[28:29], v[28:29], v[128:129]
v_pk_add_f32 v[28:29], v[28:29], v[126:127]
v_pk_add_f32 v[28:29], v[28:29], v[124:125]
v_exp_f16 v63, v79
v_pk_add_f32 v[28:29], v[28:29], v[122:123]
v_pk_add_f32 v[28:29], v[28:29], v[120:121]
v_pk_add_f32 v[28:29], v[28:29], v[118:119]
v_mfma_f32_32x32x16_f16 v[118:133], v[86:89], a[240:243], 0
ds_read_b128 a[164:167], v6 offset:2176
ds_read_b128 a[168:171], v7 offset:2176
ds_read_b128 a[148:151], v5 offset:1536
ds_read_b128 a[172:175], v6 offset:4352
v_exp_f16 v64, v80
v_pk_mul_f16 v93, v93, v69
v_mad_u32_u16 v102, v102, 2, s85 op_sel:[1,0,0,0]
v_mfma_f32_32x32x16_bf16 v[134:149], a[40:43], a[208:211], v[134:149]
ds_read_b128 a[208:211], v1 offset:40960
s_add_u32 m0, s73, 121856
buffer_store_dwordx4 v[86:89], v1, s[12:15], s101 offen offset:0 sc1
ds_read_b128 a[176:179], v7 offset:4352
v_mfma_f32_32x32x16_f16 v[118:133], v[90:93], a[244:247], v[118:133]
v_mad_u32_u16 v103, v103, 2, s85 op_sel:[1,0,0,0]
v_mad_u32_u16 v104, v104, 2, s85 op_sel:[1,0,0,0]
v_mad_u32_u16 v105, v105, 2, s85 op_sel:[1,0,0,0]
v_exp_f16_sdwa v62, v78 dst_sel:WORD_1 dst_unused:UNUSED_PRESERVE src0_sel:WORD_1
v_mad_u32_u16 v106, v106, 2, s85 op_sel:[1,0,0,0]
v_mad_u32_u16 v107, v107, 2, s85 op_sel:[1,0,0,0]
v_mad_u32_u16 v108, v108, 2, s85 op_sel:[1,0,0,0]
v_mfma_f32_32x32x16_bf16 v[134:149], a[44:47], a[212:215], v[134:149]
ds_read_b128 a[212:215], v1 offset:41984
ds_read_b128 a[152:155], v5 offset:3072
ds_read_u16_d16_hi v102, v102
v_exp_f16 v65, v81
v_mad_u32_u16 v109, v109, 2, s85 op_sel:[1,0,0,0]
v_mad_u32_u16 v110, v110, 2, s85 op_sel:[1,0,0,0]
v_mad_u32_u16 v111, v111, 2, s85 op_sel:[1,0,0,0]
v_pk_fma_f32 v[26:27], v[118:119], v[118:119], v[26:27]
v_pk_fma_f32 v[26:27], v[120:121], v[120:121], v[26:27]
v_pk_fma_f32 v[26:27], v[122:123], v[122:123], v[26:27]
v_pk_fma_f32 v[26:27], v[124:125], v[124:125], v[26:27]
v_pk_fma_f32 v[26:27], v[126:127], v[126:127], v[26:27]
v_pk_fma_f32 v[26:27], v[128:129], v[128:129], v[26:27]
v_pk_fma_f32 v[26:27], v[130:131], v[130:131], v[26:27]
v_pk_fma_f32 v[26:27], v[132:133], v[132:133], v[26:27]
s_waitcnt lgkmcnt(4)
v_smfmac_f32_32x32x32_bf16 v[160:175], a[144:147], a[156:163], v4
ds_read_b128 a[156:159], v6 offset:6528
v_mad_u32_u16 v112, v112, 2, s85 op_sel:[1,0,0,0]
v_pk_add_f16 v78, v62, 1.0 op_sel_hi:[1,0]
v_exp_f16_sdwa v63, v79 dst_sel:WORD_1 dst_unused:UNUSED_PRESERVE src0_sel:WORD_1
v_mad_u32_u16 v113, v113, 2, s85 op_sel:[1,0,0,0]
v_pk_add_f16 v79, v63, 1.0 op_sel_hi:[1,0]
v_mfma_f32_32x32x16_bf16 v[118:133], a[0:3], a[216:219], 0
ds_read_b128 a[160:163], v7 offset:6528
buffer_load_dwordx4 v15, s[4:7], s90 offen  lds
ds_read_u16_d16_hi v103, v103
ds_read_u16_d16_hi v104, v104
v_mad_u32_u16 v114, v114, 2, s85 op_sel:[1,0,0,0]
v_exp_f16 v66, v82
v_smfmac_f32_32x32x32_bf16 v[160:175], a[148:151], a[164:171], v4
ds_read_u16_d16_hi v105, v105
v_exp_f16_sdwa v64, v80 dst_sel:WORD_1 dst_unused:UNUSED_PRESERVE src0_sel:WORD_1
v_exp_f16 v67, v83
v_pk_add_f16 v80, v64, 1.0 op_sel_hi:[1,0]
v_mad_u32_u16 v115, v115, 2, s85 op_sel:[1,0,0,0]
v_mfma_f32_32x32x16_bf16 v[118:133], a[4:7], a[220:223], v[118:133]
ds_read_u16_d16_hi v106, v106
ds_read_u16_d16_hi v107, v107
ds_read_u16_d16_hi v108, v108
ds_read_u16_d16_hi v109, v109
v_exp_f16_sdwa v65, v81 dst_sel:WORD_1 dst_unused:UNUSED_PRESERVE src0_sel:WORD_1
v_exp_f16_sdwa v66, v82 dst_sel:WORD_1 dst_unused:UNUSED_PRESERVE src0_sel:WORD_1
v_smfmac_f32_32x32x32_bf16 v[208:223], a[144:147], a[164:171], v4
ds_read_b128 a[164:167], v8 offset:0
v_pk_add_f16 v81, v65, 1.0 op_sel_hi:[1,0]
v_mad_u32_u16 v116, v116, 2, s85 op_sel:[1,0,0,0]
v_pk_add_f16 v82, v66, 1.0 op_sel_hi:[1,0]
v_mad_u32_u16 v117, v117, 2, s85 op_sel:[1,0,0,0]
v_exp_f16_sdwa v67, v83 dst_sel:WORD_1 dst_unused:UNUSED_PRESERVE src0_sel:WORD_1
v_mfma_f32_32x32x16_bf16 v[118:133], a[8:11], a[224:227], v[118:133]
ds_read_b128 a[168:171], v9 offset:0
ds_read_b128 a[144:147], v5 offset:512
s_add_u32 m0, s74, 121856
ds_read_u16_d16_hi v110, v110
buffer_load_dwordx4 v16, s[4:7], s90 offen  lds
v_pk_add_f16 v83, v67, 1.0 op_sel_hi:[1,0]
s_waitcnt lgkmcnt(7)
v_smfmac_f32_32x32x32_bf16 v[160:175], a[152:155], a[172:179], v4
ds_read_u16_d16_hi v111, v111
v_add_f32 v28, v28, v150
v_add_f32 v29, v29, v151
v_add_f32 v28, v28, v152
v_add_f32 v29, v29, v153
v_mul_f32 v150, s60, v146
v_mul_f32 v151, s60, v147
v_mfma_f32_32x32x16_bf16 v[118:133], a[12:15], a[228:231], v[118:133]
ds_read_u16_d16_hi v112, v112
ds_read_u16_d16_hi v113, v113
ds_read_u16_d16_hi v114, v114
ds_read_u16_d16_hi v115, v115
v_mul_f32 v152, s60, v148
v_mul_f32 v153, s60, v149
v_mad_u32_u16 v150, v150, 2, s85 op_sel:[1,0,0,0]
v_mad_u32_u16 v151, v151, 2, s85 op_sel:[1,0,0,0]
v_smfmac_f32_32x32x32_bf16 v[208:223], a[148:151], a[172:179], v4
ds_read_b128 a[172:175], v8 offset:2176
v_mad_u32_u16 v152, v152, 2, s85 op_sel:[1,0,0,0]
v_mad_u32_u16 v153, v153, 2, s85 op_sel:[1,0,0,0]
v_cvt_pk_f16_f32 v86, v134, v135
v_cvt_pk_f16_f32 v87, v136, v137
v_pk_fma_f16 v70, v86, v86, s84
v_rcp_f16 v62, v78
v_mfma_f32_32x32x16_bf16 v[118:133], a[16:19], a[232:235], v[118:133]
ds_read_b128 a[176:179], v9 offset:2176
ds_read_b128 a[148:151], v5 offset:2048
v_rcp_f16 v63, v79
v_rcp_f16 v64, v80
v_rcp_f16_sdwa v62, v78 dst_sel:WORD_1 dst_unused:UNUSED_PRESERVE src0_sel:WORD_1
v_smfmac_f32_32x32x32_bf16 v[208:223], a[152:155], a[156:163], v4
ds_read_b128 a[156:159], v8 offset:4352
v_pk_mul_f16 v94, v94, v62
v_cvt_pk_f16_f32 v88, v138, v139
v_pk_fma_f16 v71, v87, v87, s84
v_pk_mul_f16 v70, v86, v70
v_rcp_f16 v65, v81
v_mfma_f32_32x32x16_bf16 v[118:133], a[20:23], a[236:239], v[118:133]
ds_read_b128 a[160:163], v9 offset:4352
ds_read_b128 a[152:155], v5 offset:3584
s_add_u32 m0, s75, 121856
ds_read_u16_d16_hi v116, v116
buffer_load_dwordx4 v17, s[4:7], s90 offen  lds
v_rcp_f16_sdwa v63, v79 dst_sel:WORD_1 dst_unused:UNUSED_PRESERVE src0_sel:WORD_1
s_waitcnt lgkmcnt(9)
v_smfmac_f32_32x32x32_bf16 v[160:175], a[144:147], a[164:171], v4
ds_read_b128 a[164:167], v8 offset:6528
v_pk_mul_f16 v95, v95, v63
v_cvt_pk_f16_f32 v89, v140, v141
v_rcp_f16 v66, v82
v_pk_fma_f16 v72, v88, v88, s84
v_pk_mul_f16 v71, v87, v71
v_rcp_f16_sdwa v64, v80 dst_sel:WORD_1 dst_unused:UNUSED_PRESERVE src0_sel:WORD_1
v_rcp_f16 v67, v83
v_pk_mul_f16 v96, v96, v64
v_rcp_f16_sdwa v65, v81 dst_sel:WORD_1 dst_unused:UNUSED_PRESERVE src0_sel:WORD_1
v_rcp_f16_sdwa v66, v82 dst_sel:WORD_1 dst_unused:UNUSED_PRESERVE src0_sel:WORD_1
v_rcp_f16_sdwa v67, v83 dst_sel:WORD_1 dst_unused:UNUSED_PRESERVE src0_sel:WORD_1
v_exp_f16 v62, v70
v_exp_f16 v63, v71
ds_read_b128 a[168:171], v9 offset:6528
ds_read_u16_d16_hi v117, v117
ds_read_u16_d16_hi v150, v150
ds_read_u16_d16_hi v151, v151
buffer_store_dwordx4 v[90:93], v1, s[12:15], s101 offen offset:1024 sc1
ds_read_u16_d16_hi v152, v152
s_waitcnt lgkmcnt(7)
v_smfmac_f32_32x32x32_bf16 v[160:175], a[148:151], a[172:179], v4
ds_read_u16_d16_hi v153, v153
v_cvt_pk_f16_f32 v90, v142, v143
v_pk_fma_f16 v73, v89, v89, s84
v_pk_mul_f16 v72, v88, v72
v_exp_f16 v64, v72
v_pk_mul_f16 v97, v97, v65
v_smfmac_f32_32x32x32_bf16 v[208:223], a[144:147], a[172:179], v4
ds_read_b128 a[172:175], v10 offset:0
v_cvt_pk_f16_f32 v91, v144, v145
v_pk_fma_f16 v74, v90, v90, s84
v_pk_mul_f16 v73, v89, v73
v_pk_mul_f16 v98, v98, v66
v_exp_f16_sdwa v62, v70 dst_sel:WORD_1 dst_unused:UNUSED_PRESERVE src0_sel:WORD_1
v_mfma_f32_32x32x16_bf16 v[134:149], a[216:219], a[24:27], 0
ds_read_b128 a[216:219], v1 offset:43008
ds_read_b128 a[176:179], v11 offset:0
ds_read_b128 a[144:147], v5 offset:1024
v_pk_fma_f16 v75, v91, v91, s84
v_pk_mul_f16 v74, v90, v74
v_pk_mul_f16 v75, v91, v75
v_exp_f16 v65, v73
v_smfmac_f32_32x32x32_bf16 v[160:175], a[152:155], a[156:163], v4
v_pk_mul_f16 v99, v99, v67
v_mad_u32_u16 v118, v118, 2, s85 op_sel:[1,0,0,0]
v_mad_u32_u16 v119, v119, 2, s85 op_sel:[1,0,0,0]
v_mad_u32_u16 v120, v120, 2, s85 op_sel:[1,0,0,0]
v_mad_u32_u16 v121, v121, 2, s85 op_sel:[1,0,0,0]
v_mad_u32_u16 v122, v122, 2, s85 op_sel:[1,0,0,0]
v_mad_u32_u16 v123, v123, 2, s85 op_sel:[1,0,0,0]
s_waitcnt lgkmcnt(6)
v_pk_add_f32 v[30:31], v[116:117], v[114:115]
v_pk_add_f32 v[30:31], v[30:31], v[112:113]
v_pk_add_f32 v[30:31], v[30:31], v[110:111]
v_exp_f16_sdwa v63, v71 dst_sel:WORD_1 dst_unused:UNUSED_PRESERVE src0_sel:WORD_1
v_pk_add_f32 v[30:31], v[30:31], v[108:109]
v_pk_add_f32 v[30:31], v[30:31], v[106:107]
v_pk_add_f32 v[30:31], v[30:31], v[104:105]
v_exp_f16 v66, v74
v_pk_add_f32 v[30:31], v[30:31], v[102:103]
v_dot2c_f32_f16 v29, v99, v99
v_dot2c_f32_f16 v28, v98, v98
v_dot2c_f32_f16 v29, v97, v97
v_dot2c_f32_f16 v28, v96, v96
v_dot2c_f32_f16 v29, v95, v95
v_dot2c_f32_f16 v28, v94, v94
v_mfma_f32_32x32x16_bf16 v[134:149], a[220:223], a[28:31], v[134:149]
ds_read_b128 a[220:223], v1 offset:44032
ds_read_u16_d16_hi v118, v118
ds_read_u16_d16_hi v119, v119
ds_read_u16_d16_hi v120, v120
v_mad_u32_u16 v124, v124, 2, s85 op_sel:[1,0,0,0]
v_mad_u32_u16 v125, v125, 2, s85 op_sel:[1,0,0,0]
v_mad_u32_u16 v126, v126, 2, s85 op_sel:[1,0,0,0]
v_mad_u32_u16 v127, v127, 2, s85 op_sel:[1,0,0,0]
v_smfmac_f32_32x32x32_bf16 v[208:223], a[148:151], a[156:163], v4
ds_read_b128 a[156:159], v10 offset:2176
v_mad_u32_u16 v128, v128, 2, s85 op_sel:[1,0,0,0]
v_pk_add_f16 v70, v62, 1.0 op_sel_hi:[1,0]
v_mad_u32_u16 v129, v129, 2, s85 op_sel:[1,0,0,0]
v_pk_add_f16 v71, v63, 1.0 op_sel_hi:[1,0]
v_mad_u32_u16 v130, v130, 2, s85 op_sel:[1,0,0,0]
v_exp_f16_sdwa v64, v72 dst_sel:WORD_1 dst_unused:UNUSED_PRESERVE src0_sel:WORD_1
v_mfma_f32_32x32x16_bf16 v[134:149], a[224:227], a[32:35], v[134:149]
ds_read_b128 a[224:227], v1 offset:45056
ds_read_b128 a[160:163], v11 offset:2176
ds_read_b128 a[148:151], v5 offset:2560
ds_read_u16_d16_hi v121, v121
v_pk_add_f16 v72, v64, 1.0 op_sel_hi:[1,0]
v_mad_u32_u16 v131, v131, 2, s85 op_sel:[1,0,0,0]
v_exp_f16 v67, v75
v_smfmac_f32_32x32x32_bf16 v[208:223], a[152:155], a[164:171], v4
ds_read_b128 a[164:167], v10 offset:4352
v_exp_f16_sdwa v65, v73 dst_sel:WORD_1 dst_unused:UNUSED_PRESERVE src0_sel:WORD_1
v_exp_f16_sdwa v66, v74 dst_sel:WORD_1 dst_unused:UNUSED_PRESERVE src0_sel:WORD_1
v_pk_add_f16 v73, v65, 1.0 op_sel_hi:[1,0]
v_mad_u32_u16 v132, v132, 2, s85 op_sel:[1,0,0,0]
v_mfma_f32_32x32x16_bf16 v[134:149], a[228:231], a[36:39], v[134:149]
ds_read_b128 a[228:231], v1 offset:46080
ds_read_b128 a[168:171], v11 offset:4352
ds_read_b128 a[152:155], v5 offset:4096
ds_read_u16_d16_hi v122, v122
v_exp_f16_sdwa v67, v75 dst_sel:WORD_1 dst_unused:UNUSED_PRESERVE src0_sel:WORD_1
v_pk_add_f16 v74, v66, 1.0 op_sel_hi:[1,0]
v_mad_u32_u16 v133, v133, 2, s85 op_sel:[1,0,0,0]
s_waitcnt lgkmcnt(7)
v_smfmac_f32_32x32x32_bf16 v[160:175], a[144:147], a[172:179], v4
ds_read_b128 a[172:175], v10 offset:6528
v_pk_add_f16 v75, v67, 1.0 op_sel_hi:[1,0]
v_add_f32 v30, v30, v150
v_add_f32 v31, v31, v151
v_add_f32 v30, v30, v152
v_add_f32 v31, v31, v153
v_rcp_f16 v62, v70
v_mfma_f32_32x32x16_bf16 v[134:149], a[232:235], a[40:43], v[134:149]
ds_read_b128 a[232:235], v1 offset:47104
ds_read_b128 a[176:179], v11 offset:6528
ds_read_u16_d16_hi v123, v123
ds_read_u16_d16_hi v124, v124
v_rcp_f16 v63, v71
v_rcp_f16 v64, v72
s_waitcnt lgkmcnt(8)
v_smfmac_f32_32x32x32_bf16 v[160:175], a[148:151], a[156:163], v4
ds_read_u16_d16_hi v125, v125
v_rcp_f16_sdwa v62, v70 dst_sel:WORD_1 dst_unused:UNUSED_PRESERVE src0_sel:WORD_1
v_rcp_f16 v65, v73
v_rcp_f16_sdwa v63, v71 dst_sel:WORD_1 dst_unused:UNUSED_PRESERVE src0_sel:WORD_1
v_mfma_f32_32x32x16_bf16 v[134:149], a[236:239], a[44:47], v[134:149]
ds_read_b128 a[236:239], v1 offset:48128
ds_read_u16_d16_hi v126, v126
ds_read_u16_d16_hi v127, v127
buffer_atomic_add v61, v157, s[36:39], 0 offen
v_rcp_f16 v66, v74
v_smfmac_f32_32x32x32_bf16 v[208:223], a[144:147], a[156:163], v4
ds_read_u16_d16_hi v128, v128
v_rcp_f16_sdwa v64, v72 dst_sel:WORD_1 dst_unused:UNUSED_PRESERVE src0_sel:WORD_1
v_rcp_f16 v67, v75
v_rcp_f16_sdwa v65, v73 dst_sel:WORD_1 dst_unused:UNUSED_PRESERVE src0_sel:WORD_1
v_mfma_f32_32x32x16_bf16 v[102:117], a[0:3], a[192:195], 0
ds_read_u16_d16_hi v129, v129
ds_read_u16_d16_hi v130, v130
ds_read_u16_d16_hi v131, v131
ds_read_u16_d16_hi v132, v132
v_cvt_pk_f16_f32 v94, v134, v135
v_rcp_f16_sdwa v66, v74 dst_sel:WORD_1 dst_unused:UNUSED_PRESERVE src0_sel:WORD_1
v_cvt_pk_f16_f32 v95, v136, v137
s_waitcnt lgkmcnt(9)
v_smfmac_f32_32x32x32_bf16 v[160:175], a[152:155], a[164:171], v4
ds_read_u16_d16_hi v133, v133
v_pk_fma_f16 v78, v94, v94, s84
v_cvt_pk_f16_f32 v96, v138, v139
v_pk_fma_f16 v79, v95, v95, s84
v_pk_mul_f16 v78, v94, v78
v_cvt_pk_f16_f32 v97, v140, v141
v_mfma_f32_32x32x16_bf16 v[102:117], a[4:7], a[196:199], v[102:117]
v_pk_fma_f16 v80, v96, v96, s84
v_pk_mul_f16 v79, v95, v79
v_cvt_pk_f16_f32 v98, v142, v143
v_pk_mul_f16 v86, v86, v62
v_pk_fma_f16 v81, v97, v97, s84
v_pk_mul_f16 v80, v96, v80
v_cvt_pk_f16_f32 v99, v144, v145
v_pk_mul_f32 v[48:49], v[160:161], v[160:161]
v_pk_fma_f32 v[48:49], v[162:163], v[162:163], v[48:49]
v_pk_add_f32 v[46:47], v[160:161], v[162:163]
v_pk_fma_f32 v[48:49], v[164:165], v[164:165], v[48:49]
v_pk_add_f32 v[46:47], v[46:47], v[164:165]
v_pk_fma_f32 v[48:49], v[166:167], v[166:167], v[48:49]
v_pk_add_f32 v[46:47], v[46:47], v[166:167]
v_pk_fma_f32 v[48:49], v[168:169], v[168:169], v[48:49]
v_pk_add_f32 v[46:47], v[46:47], v[168:169]
v_pk_fma_f32 v[48:49], v[170:171], v[170:171], v[48:49]
v_pk_add_f32 v[46:47], v[46:47], v[170:171]
v_pk_fma_f32 v[48:49], v[172:173], v[172:173], v[48:49]
v_pk_add_f32 v[46:47], v[46:47], v[172:173]
v_pk_fma_f32 v[48:49], v[174:175], v[174:175], v[48:49]
v_pk_add_f32 v[46:47], v[46:47], v[174:175]
v_smfmac_f32_32x32x32_bf16 v[208:223], a[148:151], a[164:171], v4
s_add_u32 s101, s3, 10240
v_pk_mul_f16 v87, v87, v63
v_pk_fma_f16 v82, v98, v98, s84
v_pk_mul_f16 v81, v97, v81
v_cvt_pk_f16_f32 v100, v146, v147
v_pk_mul_f16 v88, v88, v64
v_pk_fma_f16 v83, v99, v99, s84
v_mfma_f32_32x32x16_bf16 v[102:117], a[8:11], a[200:203], v[102:117]
v_pk_mul_f16 v82, v98, v82
v_pk_mul_f16 v89, v89, v65
v_cvt_pk_f16_f32 v101, v148, v149
v_pk_fma_f16 v84, v100, v100, s84
v_pk_mul_f16 v83, v99, v83
v_pk_mul_f16 v90, v90, v66
v_pk_fma_f16 v85, v101, v101, s84
v_pk_mul_f16 v84, v100, v84
v_smfmac_f32_32x32x32_bf16 v[208:223], a[152:155], a[172:179], v4
v_pk_mul_f16 v85, v101, v85
v_rcp_f16_sdwa v67, v75 dst_sel:WORD_1 dst_unused:UNUSED_PRESERVE src0_sel:WORD_1
v_exp_f16 v62, v78
v_pk_mul_f16 v91, v91, v67
v_exp_f16 v63, v79
v_mfma_f32_32x32x16_bf16 v[102:117], a[12:15], a[204:207], v[102:117]
v_exp_f16 v64, v80
v_exp_f16_sdwa v62, v78 dst_sel:WORD_1 dst_unused:UNUSED_PRESERVE src0_sel:WORD_1
v_exp_f16 v65, v81
v_exp_f16_sdwa v63, v79 dst_sel:WORD_1 dst_unused:UNUSED_PRESERVE src0_sel:WORD_1
v_mfma_f32_32x32x16_bf16 v[176:191], a[248:251], a[248:251], 0
v_exp_f16 v66, v82
v_exp_f16_sdwa v64, v80 dst_sel:WORD_1 dst_unused:UNUSED_PRESERVE src0_sel:WORD_1
v_exp_f16 v67, v83
v_exp_f16_sdwa v65, v81 dst_sel:WORD_1 dst_unused:UNUSED_PRESERVE src0_sel:WORD_1
s_waitcnt lgkmcnt(0)
v_pk_add_f32 v[32:33], v[132:133], v[130:131]
v_pk_add_f32 v[32:33], v[32:33], v[128:129]
v_pk_add_f32 v[32:33], v[32:33], v[126:127]
v_pk_add_f32 v[32:33], v[32:33], v[124:125]
v_pk_add_f32 v[32:33], v[32:33], v[122:123]
v_exp_f16 v68, v84
v_pk_add_f32 v[32:33], v[32:33], v[120:121]
v_pk_add_f32 v[32:33], v[32:33], v[118:119]
v_dot2c_f32_f16 v31, v91, v91
v_dot2c_f32_f16 v30, v90, v90
v_dot2c_f32_f16 v31, v89, v89
v_dot2c_f32_f16 v30, v88, v88
s_waitcnt vmcnt(9)
ds_write_b32 v154, v156
v_dot2c_f32_f16 v31, v87, v87
v_dot2c_f32_f16 v30, v86, v86
v_pk_mul_f32 v[52:53], v[208:209], v[208:209]
v_pk_fma_f32 v[52:53], v[210:211], v[210:211], v[52:53]
v_pk_add_f32 v[50:51], v[208:209], v[210:211]
v_pk_fma_f32 v[52:53], v[212:213], v[212:213], v[52:53]
v_pk_add_f32 v[50:51], v[50:51], v[212:213]
v_exp_f16_sdwa v66, v82 dst_sel:WORD_1 dst_unused:UNUSED_PRESERVE src0_sel:WORD_1
v_pk_fma_f32 v[52:53], v[214:215], v[214:215], v[52:53]
v_pk_add_f32 v[50:51], v[50:51], v[214:215]
v_pk_fma_f32 v[52:53], v[216:217], v[216:217], v[52:53]
v_exp_f16 v69, v85
v_pk_add_f32 v[50:51], v[50:51], v[216:217]
v_pk_fma_f32 v[52:53], v[218:219], v[218:219], v[52:53]
v_pk_add_f32 v[50:51], v[50:51], v[218:219]
v_pk_fma_f32 v[52:53], v[220:221], v[220:221], v[52:53]
v_pk_add_f32 v[50:51], v[50:51], v[220:221]
v_pk_fma_f32 v[52:53], v[222:223], v[222:223], v[52:53]
v_pk_add_f32 v[50:51], v[50:51], v[222:223]
v_mfma_f32_32x32x16_bf16 v[102:117], a[16:19], a[208:211], v[102:117]
global_load_dword a255, v[158:159], off
v_add_u32 v12, 786432, v12
v_exp_f16_sdwa v67, v83 dst_sel:WORD_1 dst_unused:UNUSED_PRESERVE src0_sel:WORD_1
v_lshl_add_u64 v[158:159], v[158:159], 0, s[42:43]
v_add_u32 v13, 786432, v13
v_mfma_f32_32x32x16_bf16 v[224:239], a[248:251], a[248:251], 0
v_add_u32 v14, 786432, v14
v_exp_f16_sdwa v68, v84 dst_sel:WORD_1 dst_unused:UNUSED_PRESERVE src0_sel:WORD_1
v_add_u32 v15, 786432, v15
v_exp_f16_sdwa v69, v85 dst_sel:WORD_1 dst_unused:UNUSED_PRESERVE src0_sel:WORD_1
v_add_u32 v16, 786432, v16
v_add_u32 v17, 786432, v17
v_mfma_f32_32x32x16_bf16 v[102:117], a[20:23], a[212:215], v[102:117]
s_nop 5
v_mfma_f32_32x32x16_bf16 v[134:149], a[24:27], a[192:195], 0
ds_read_b128 a[192:195], v1 offset:49152
s_nop 3
v_mad_u32_u16 v102, v102, 2, s85 op_sel:[1,0,0,0]
v_mad_u32_u16 v103, v103, 2, s85 op_sel:[1,0,0,0]
v_mad_u32_u16 v104, v104, 2, s85 op_sel:[1,0,0,0]
v_mfma_f32_32x32x16_bf16 v[134:149], a[28:31], a[196:199], v[134:149]
ds_read_b128 a[196:199], v1 offset:50176
ds_read_u16_d16_hi v102, v102
ds_read_u16_d16_hi v103, v103
ds_read_u16_d16_hi v104, v104
v_mad_u32_u16 v105, v105, 2, s85 op_sel:[1,0,0,0]
v_mad_u32_u16 v106, v106, 2, s85 op_sel:[1,0,0,0]
v_mad_u32_u16 v107, v107, 2, s85 op_sel:[1,0,0,0]
v_mfma_f32_32x32x16_bf16 v[134:149], a[32:35], a[200:203], v[134:149]
ds_read_b128 a[200:203], v1 offset:51200
ds_read_u16_d16_hi v105, v105
ds_read_u16_d16_hi v106, v106
ds_read_u16_d16_hi v107, v107
v_mad_u32_u16 v108, v108, 2, s85 op_sel:[1,0,0,0]
v_mad_u32_u16 v109, v109, 2, s85 op_sel:[1,0,0,0]
v_mad_u32_u16 v110, v110, 2, s85 op_sel:[1,0,0,0]
v_mfma_f32_32x32x16_bf16 v[134:149], a[36:39], a[204:207], v[134:149]
ds_read_b128 a[204:207], v1 offset:52224
ds_read_u16_d16_hi v108, v108
ds_read_u16_d16_hi v109, v109
ds_read_u16_d16_hi v110, v110
v_mad_u32_u16 v111, v111, 2, s85 op_sel:[1,0,0,0]
v_pk_add_f16 v78, v62, 1.0 op_sel_hi:[1,0]
v_mad_u32_u16 v112, v112, 2, s85 op_sel:[1,0,0,0]
v_mfma_f32_32x32x16_bf16 v[134:149], a[40:43], a[208:211], v[134:149]
v_pk_add_f16 v79, v63, 1.0 op_sel_hi:[1,0]
v_mad_u32_u16 v113, v113, 2, s85 op_sel:[1,0,0,0]
v_pk_add_f16 v80, v64, 1.0 op_sel_hi:[1,0]
v_mad_u32_u16 v114, v114, 2, s85 op_sel:[1,0,0,0]
v_rcp_f16 v62, v78
v_pk_add_f16 v81, v65, 1.0 op_sel_hi:[1,0]
v_pk_add_f16 v82, v66, 1.0 op_sel_hi:[1,0]
v_mfma_f32_32x32x16_bf16 v[134:149], a[44:47], a[212:215], v[134:149]
ds_read_b128 a[208:211], v1 offset:53248
ds_read_b128 a[212:215], v1 offset:54272
v_mad_u32_u16 v115, v115, 2, s85 op_sel:[1,0,0,0]
v_pk_add_f16 v83, v67, 1.0 op_sel_hi:[1,0]
v_rcp_f16 v63, v79
v_mad_u32_u16 v116, v116, 2, s85 op_sel:[1,0,0,0]
v_pk_add_f16 v84, v68, 1.0 op_sel_hi:[1,0]
v_mfma_f32_32x32x16_bf16 v[118:133], a[0:3], a[216:219], 0
ds_read_u16_d16_hi v111, v111
v_mad_u32_u16 v117, v117, 2, s85 op_sel:[1,0,0,0]
ds_read_b32 v156, v155
v_pk_add_f16 v85, v69, 1.0 op_sel_hi:[1,0]
v_mul_f32 v150, s60, v146
v_mul_f32 v151, s60, v147
v_mfma_f32_32x32x16_bf16 v[118:133], a[4:7], a[220:223], v[118:133]
ds_read_u16_d16_hi v112, v112
v_mul_f32 v152, s60, v148
v_mul_f32 v153, s60, v149
v_mad_u32_u16 v150, v150, 2, s85 op_sel:[1,0,0,0]
v_mad_u32_u16 v151, v151, 2, s85 op_sel:[1,0,0,0]
v_mad_u32_u16 v152, v152, 2, s85 op_sel:[1,0,0,0]
v_mad_u32_u16 v153, v153, 2, s85 op_sel:[1,0,0,0]
v_cvt_pk_f16_f32 v86, v134, v135
v_mfma_f32_32x32x16_bf16 v[118:133], a[8:11], a[224:227], v[118:133]
ds_read_u16_d16_hi v113, v113
v_cvt_pk_f16_f32 v87, v136, v137
v_rcp_f16 v64, v80
v_rcp_f16_sdwa v62, v78 dst_sel:WORD_1 dst_unused:UNUSED_PRESERVE src0_sel:WORD_1
v_rcp_f16 v65, v81
v_mfma_f32_32x32x16_bf16 v[118:133], a[12:15], a[228:231], v[118:133]
ds_read_u16_d16_hi v114, v114
ds_read_u16_d16_hi v115, v115
v_pk_mul_f16 v94, v94, v62
v_pk_fma_f16 v70, v86, v86, s84
v_cvt_pk_f16_f32 v88, v138, v139
v_rcp_f16_sdwa v63, v79 dst_sel:WORD_1 dst_unused:UNUSED_PRESERVE src0_sel:WORD_1
v_rcp_f16 v66, v82
v_mfma_f32_32x32x16_bf16 v[118:133], a[16:19], a[232:235], v[118:133]
ds_read_u16_d16_hi v116, v116
ds_read_u16_d16_hi v117, v117
v_pk_mul_f16 v95, v95, v63
v_pk_fma_f16 v71, v87, v87, s84
v_pk_mul_f16 v70, v86, v70
v_rcp_f16_sdwa v64, v80 dst_sel:WORD_1 dst_unused:UNUSED_PRESERVE src0_sel:WORD_1
v_rcp_f16 v67, v83
v_mfma_f32_32x32x16_bf16 v[118:133], a[20:23], a[236:239], v[118:133]
ds_read_u16_d16_hi v150, v150
v_pk_mul_f16 v96, v96, v64
v_cvt_pk_f16_f32 v89, v140, v141
v_pk_fma_f16 v72, v88, v88, s84
v_pk_mul_f16 v71, v87, v71
v_rcp_f16_sdwa v65, v81 dst_sel:WORD_1 dst_unused:UNUSED_PRESERVE src0_sel:WORD_1
v_rcp_f16 v68, v84
v_pk_mul_f16 v97, v97, v65
v_cvt_pk_f16_f32 v90, v142, v143
v_pk_fma_f16 v73, v89, v89, s84
v_rcp_f16_sdwa v66, v82 dst_sel:WORD_1 dst_unused:UNUSED_PRESERVE src0_sel:WORD_1
v_rcp_f16 v69, v85
v_pk_mul_f16 v98, v98, v66
v_pk_mul_f16 v72, v88, v72
v_cvt_pk_f16_f32 v91, v144, v145
v_mfma_f32_32x32x16_bf16 v[134:149], a[24:27], a[216:219], 0
ds_read_b128 a[216:219], v1 offset:55296
ds_read_u16_d16_hi v151, v151
ds_read_u16_d16_hi v152, v152
ds_read_u16_d16_hi v153, v153
s_waitcnt lgkmcnt(9)
v_cmp_gt_u32 vcc, 4, v156
v_rcp_f16_sdwa v67, v83 dst_sel:WORD_1 dst_unused:UNUSED_PRESERVE src0_sel:WORD_1
v_mfma_f32_32x32x16_bf16 v[134:149], a[28:31], a[220:223], v[134:149]
ds_read_b128 a[220:223], v1 offset:56320
buffer_store_dwordx4 v[94:97], v1, s[12:15], s101 offen offset:0 sc1
s_cbranch_vccnz L_spin4
L_ok4:
v_mov_b32 v156, 5
v_mfma_f32_32x32x16_bf16 v[134:149], a[32:35], a[224:227], v[134:149]
ds_read_b128 a[224:227], v1 offset:57344
ds_read_b128 a[156:159], v6 offset:28416
v_pk_mul_f16 v99, v99, v67
v_pk_fma_f16 v74, v90, v90, s84
v_pk_mul_f16 v73, v89, v73
v_rcp_f16_sdwa v68, v84 dst_sel:WORD_1 dst_unused:UNUSED_PRESERVE src0_sel:WORD_1
v_mfma_f32_32x32x16_bf16 v[134:149], a[36:39], a[228:231], v[134:149]
ds_read_b128 a[228:231], v1 offset:58368
v_pk_mul_f16 v100, v100, v68
v_pk_fma_f16 v75, v91, v91, s84
v_pk_mul_f16 v74, v90, v74
v_pk_mul_f16 v75, v91, v75
v_rcp_f16_sdwa v69, v85 dst_sel:WORD_1 dst_unused:UNUSED_PRESERVE src0_sel:WORD_1
v_exp_f16 v62, v70
v_mfma_f32_32x32x16_bf16 v[134:149], a[40:43], a[232:235], v[134:149]
ds_read_b128 a[232:235], v1 offset:59392
ds_read_b128 a[160:163], v7 offset:28416
v_pk_mul_f16 v101, v101, v69
v_mad_u32_u16 v118, v118, 2, s85 op_sel:[1,0,0,0]
v_mad_u32_u16 v119, v119, 2, s85 op_sel:[1,0,0,0]
v_mad_u32_u16 v120, v120, 2, s85 op_sel:[1,0,0,0]
v_exp_f16 v63, v71
s_waitcnt lgkmcnt(9)
v_pk_add_f32 v[34:35], v[116:117], v[114:115]
v_pk_add_f32 v[34:35], v[34:35], v[112:113]
v_pk_add_f32 v[34:35], v[34:35], v[110:111]
v_exp_f16 v64, v72
v_pk_add_f32 v[34:35], v[34:35], v[108:109]
v_pk_add_f32 v[34:35], v[34:35], v[106:107]
v_pk_add_f32 v[34:35], v[34:35], v[104:105]
v_pk_add_f32 v[34:35], v[34:35], v[102:103]
v_mfma_f32_32x32x16_f16 v[102:117], v[94:97], a[240:243], 0
ds_read_b128 a[144:147], v5 offset:4608
ds_read_b128 a[164:167], v6 offset:30592
ds_read_b128 a[168:171], v7 offset:30592
s_add_u32 m0, s70, 71680
ds_read_b128 a[148:151], v5 offset:6144
v_mad_u32_u16 v121, v121, 2, s85 op_sel:[1,0,0,0]
v_mad_u32_u16 v122, v122, 2, s85 op_sel:[1,0,0,0]
v_mad_u32_u16 v123, v123, 2, s85 op_sel:[1,0,0,0]
v_mfma_f32_32x32x16_bf16 v[134:149], a[44:47], a[236:239], v[134:149]
ds_read_b128 a[236:239], v1 offset:60416
buffer_load_dwordx4 v12, s[4:7], 0 offen  lds
v_mad_u32_u16 v124, v124, 2, s85 op_sel:[1,0,0,0]
v_mad_u32_u16 v125, v125, 2, s85 op_sel:[1,0,0,0]
v_mad_u32_u16 v126, v126, 2, s85 op_sel:[1,0,0,0]
v_mad_u32_u16 v127, v127, 2, s85 op_sel:[1,0,0,0]
v_mfma_f32_32x32x16_f16 v[102:117], v[98:101], a[244:247], v[102:117]
ds_read_b128 a[172:175], v6 offset:32768
ds_read_b128 a[176:179], v7 offset:32768
v_mad_u32_u16 v128, v128, 2, s85 op_sel:[1,0,0,0]
v_exp_f16_sdwa v62, v70 dst_sel:WORD_1 dst_unused:UNUSED_PRESERVE src0_sel:WORD_1
v_exp_f16 v65, v73
v_pk_add_f16 v70, v62, 1.0 op_sel_hi:[1,0]
v_mad_u32_u16 v129, v129, 2, s85 op_sel:[1,0,0,0]
v_exp_f16_sdwa v63, v71 dst_sel:WORD_1 dst_unused:UNUSED_PRESERVE src0_sel:WORD_1
v_exp_f16 v66, v74
v_pk_add_f16 v71, v63, 1.0 op_sel_hi:[1,0]
v_mad_u32_u16 v130, v130, 2, s85 op_sel:[1,0,0,0]
v_exp_f16_sdwa v64, v72 dst_sel:WORD_1 dst_unused:UNUSED_PRESERVE src0_sel:WORD_1
v_pk_fma_f32 v[32:33], v[102:103], v[102:103], v[32:33]
v_pk_fma_f32 v[32:33], v[104:105], v[104:105], v[32:33]
v_pk_fma_f32 v[32:33], v[106:107], v[106:107], v[32:33]
v_pk_fma_f32 v[32:33], v[108:109], v[108:109], v[32:33]
v_exp_f16 v67, v75
v_pk_fma_f32 v[32:33], v[110:111], v[110:111], v[32:33]
v_pk_fma_f32 v[32:33], v[112:113], v[112:113], v[32:33]
v_pk_fma_f32 v[32:33], v[114:115], v[114:115], v[32:33]
v_exp_f16_sdwa v65, v73 dst_sel:WORD_1 dst_unused:UNUSED_PRESERVE src0_sel:WORD_1
v_pk_fma_f32 v[32:33], v[116:117], v[116:117], v[32:33]
v_mfma_f32_32x32x16_bf16 v[102:117], a[0:3], a[192:195], 0
ds_read_b128 a[152:155], v5 offset:7680
s_add_u32 m0, s71, 71680
ds_read_u16_d16_hi v118, v118
buffer_load_dwordx4 v13, s[4:7], 0 offen  lds
ds_read_u16_d16_hi v119, v119
v_pk_add_f16 v72, v64, 1.0 op_sel_hi:[1,0]
s_waitcnt lgkmcnt(3)
v_smfmac_f32_32x32x32_bf16 v[176:191], a[144:147], a[156:163], v4
ds_read_b128 a[156:159], v6 offset:34944
v_mad_u32_u16 v131, v131, 2, s85 op_sel:[1,0,0,0]
v_pk_add_f16 v73, v65, 1.0 op_sel_hi:[1,0]
v_mad_u32_u16 v132, v132, 2, s85 op_sel:[1,0,0,0]
v_exp_f16_sdwa v66, v74 dst_sel:WORD_1 dst_unused:UNUSED_PRESERVE src0_sel:WORD_1
v_exp_f16_sdwa v67, v75 dst_sel:WORD_1 dst_unused:UNUSED_PRESERVE src0_sel:WORD_1
v_mfma_f32_32x32x16_bf16 v[102:117], a[4:7], a[196:199], v[102:117]
ds_read_b128 a[160:163], v7 offset:34944
ds_read_u16_d16_hi v120, v120
ds_read_u16_d16_hi v121, v121
ds_read_u16_d16_hi v122, v122
v_pk_add_f16 v74, v66, 1.0 op_sel_hi:[1,0]
v_mad_u32_u16 v133, v133, 2, s85 op_sel:[1,0,0,0]
v_pk_add_f16 v75, v67, 1.0 op_sel_hi:[1,0]
v_add_f32 v34, v34, v150
v_smfmac_f32_32x32x32_bf16 v[176:191], a[148:151], a[164:171], v4
ds_read_u16_d16_hi v123, v123
v_add_f32 v35, v35, v151
v_add_f32 v34, v34, v152
v_add_f32 v35, v35, v153
v_mul_f32 v150, s60, v146
v_mul_f32 v151, s60, v147
v_mul_f32 v152, s60, v148
v_mfma_f32_32x32x16_bf16 v[102:117], a[8:11], a[200:203], v[102:117]
ds_read_u16_d16_hi v124, v124
ds_read_u16_d16_hi v125, v125
s_add_u32 m0, s72, 71680
ds_read_u16_d16_hi v126, v126
buffer_load_dwordx4 v14, s[4:7], 0 offen  lds
v_mul_f32 v153, s60, v149
v_smfmac_f32_32x32x32_bf16 v[224:239], a[144:147], a[164:171], v4
ds_read_b128 a[164:167], v8 offset:28416
v_mad_u32_u16 v150, v150, 2, s85 op_sel:[1,0,0,0]
v_mad_u32_u16 v151, v151, 2, s85 op_sel:[1,0,0,0]
v_mad_u32_u16 v152, v152, 2, s85 op_sel:[1,0,0,0]
v_mad_u32_u16 v153, v153, 2, s85 op_sel:[1,0,0,0]
v_cvt_pk_f16_f32 v94, v134, v135
v_cvt_pk_f16_f32 v95, v136, v137
v_mfma_f32_32x32x16_bf16 v[102:117], a[12:15], a[204:207], v[102:117]
ds_read_b128 a[168:171], v9 offset:28416
ds_read_b128 a[144:147], v5 offset:5120
ds_read_u16_d16_hi v127, v127
ds_read_u16_d16_hi v128, v128
v_pk_fma_f16 v78, v94, v94, s84
v_rcp_f16 v62, v70
v_rcp_f16 v63, v71
s_waitcnt lgkmcnt(8)
v_smfmac_f32_32x32x32_bf16 v[176:191], a[152:155], a[172:179], v4
ds_read_u16_d16_hi v129, v129
v_rcp_f16 v64, v72
v_rcp_f16_sdwa v62, v70 dst_sel:WORD_1 dst_unused:UNUSED_PRESERVE src0_sel:WORD_1
v_rcp_f16 v65, v73
v_mfma_f32_32x32x16_bf16 v[102:117], a[16:19], a[208:211], v[102:117]
ds_read_u16_d16_hi v130, v130
ds_read_u16_d16_hi v131, v131
s_add_u32 m0, s73, 71680
ds_read_u16_d16_hi v132, v132
v_pk_mul_f16 v86, v86, v62
v_cvt_pk_f16_f32 v96, v138, v139
v_pk_fma_f16 v79, v95, v95, s84
v_smfmac_f32_32x32x32_bf16 v[224:239], a[148:151], a[172:179], v4
ds_read_b128 a[172:175], v8 offset:30592
v_pk_mul_f16 v78, v94, v78
v_rcp_f16_sdwa v63, v71 dst_sel:WORD_1 dst_unused:UNUSED_PRESERVE src0_sel:WORD_1
v_rcp_f16 v66, v74
v_pk_mul_f16 v87, v87, v63
v_mfma_f32_32x32x16_bf16 v[102:117], a[20:23], a[212:215], v[102:117]
ds_read_b128 a[176:179], v9 offset:30592
buffer_load_dwordx4 v15, s[4:7], 0 offen  lds
ds_read_b128 a[148:151], v5 offset:6656
v_cvt_pk_f16_f32 v97, v140, v141
v_pk_fma_f16 v80, v96, v96, s84
v_pk_mul_f16 v79, v95, v79
v_smfmac_f32_32x32x32_bf16 v[224:239], a[152:155], a[156:163], v4
ds_read_b128 a[156:159], v8 offset:32768
v_rcp_f16_sdwa v64, v72 dst_sel:WORD_1 dst_unused:UNUSED_PRESERVE src0_sel:WORD_1
v_rcp_f16 v67, v75
v_pk_mul_f16 v88, v88, v64
v_rcp_f16_sdwa v65, v73 dst_sel:WORD_1 dst_unused:UNUSED_PRESERVE src0_sel:WORD_1
s_waitcnt lgkmcnt(8)
v_smfmac_f32_32x32x32_bf16 v[176:191], a[144:147], a[164:171], v4
ds_read_b128 a[160:163], v9 offset:32768
v_rcp_f16_sdwa v66, v74 dst_sel:WORD_1 dst_unused:UNUSED_PRESERVE src0_sel:WORD_1
v_rcp_f16_sdwa v67, v75 dst_sel:WORD_1 dst_unused:UNUSED_PRESERVE src0_sel:WORD_1
v_exp_f16 v62, v78
v_exp_f16 v63, v79
ds_read_b128 a[152:155], v5 offset:8192
ds_read_b128 a[164:167], v8 offset:34944
ds_read_b128 a[168:171], v9 offset:34944
ds_read_u16_d16_hi v133, v133
buffer_store_dwordx4 v[98:101], v1, s[12:15], s101 offen offset:1024 sc1
ds_read_u16_d16_hi v150, v150
ds_read_u16_d16_hi v151, v151
v_cvt_pk_f16_f32 v98, v142, v143
v_pk_fma_f16 v81, v97, v97, s84
v_pk_mul_f16 v80, v96, v80
v_pk_mul_f16 v89, v89, v65
v_cvt_pk_f16_f32 v99, v144, v145
v_mfma_f32_32x32x16_bf16 v[134:149], a[192:195], a[24:27], 0
v_pk_fma_f16 v82, v98, v98, s84
v_pk_mul_f16 v81, v97, v81
v_pk_mul_f16 v90, v90, v66
v_pk_fma_f16 v83, v99, v99, s84
v_exp_f16 v64, v80
v_pk_mul_f16 v82, v98, v82
v_pk_mul_f16 v83, v99, v83
v_mfma_f32_32x32x16_bf16 v[134:149], a[196:199], a[28:31], v[134:149]
ds_read_b128 a[192:195], v1 offset:61440
ds_read_b128 a[196:199], v1 offset:62464
ds_read_u16_d16_hi v152, v152
v_pk_mul_f16 v91, v91, v67
v_exp_f16_sdwa v62, v78 dst_sel:WORD_1 dst_unused:UNUSED_PRESERVE src0_sel:WORD_1
v_mad_u32_u16 v102, v102, 2, s85 op_sel:[1,0,0,0]
v_mad_u32_u16 v103, v103, 2, s85 op_sel:[1,0,0,0]
s_waitcnt lgkmcnt(7)
v_smfmac_f32_32x32x32_bf16 v[176:191], a[148:151], a[172:179], v4
ds_read_u16_d16_hi v153, v153
v_mad_u32_u16 v104, v104, 2, s85 op_sel:[1,0,0,0]
v_mad_u32_u16 v105, v105, 2, s85 op_sel:[1,0,0,0]
v_mad_u32_u16 v106, v106, 2, s85 op_sel:[1,0,0,0]
v_exp_f16 v65, v81
v_mad_u32_u16 v107, v107, 2, s85 op_sel:[1,0,0,0]
v_mfma_f32_32x32x16_bf16 v[134:149], a[200:203], a[32:35], v[134:149]
ds_read_b128 a[200:203], v1 offset:63488
s_add_u32 m0, s74, 71680
ds_read_u16_d16_hi v102, v102
buffer_load_dwordx4 v16, s[4:7], 0 offen  lds
ds_read_u16_d16_hi v103, v103
v_mad_u32_u16 v108, v108, 2, s85 op_sel:[1,0,0,0]
v_smfmac_f32_32x32x32_bf16 v[224:239], a[144:147], a[172:179], v4
ds_read_b128 a[172:175], v10 offset:28416
v_mad_u32_u16 v109, v109, 2, s85 op_sel:[1,0,0,0]
v_mad_u32_u16 v110, v110, 2, s85 op_sel:[1,0,0,0]
v_mad_u32_u16 v111, v111, 2, s85 op_sel:[1,0,0,0]
v_mad_u32_u16 v112, v112, 2, s85 op_sel:[1,0,0,0]
v_pk_add_f16 v78, v62, 1.0 op_sel_hi:[1,0]
v_exp_f16_sdwa v63, v79 dst_sel:WORD_1 dst_unused:UNUSED_PRESERVE src0_sel:WORD_1
s_waitcnt lgkmcnt(7)
v_pk_add_f32 v[36:37], v[132:133], v[130:131]
v_pk_add_f32 v[36:37], v[36:37], v[128:129]
v_pk_add_f32 v[36:37], v[36:37], v[126:127]
v_exp_f16 v66, v82
v_pk_add_f32 v[36:37], v[36:37], v[124:125]
v_pk_add_f32 v[36:37], v[36:37], v[122:123]
v_pk_add_f32 v[36:37], v[36:37], v[120:121]
v_exp_f16_sdwa v64, v80 dst_sel:WORD_1 dst_unused:UNUSED_PRESERVE src0_sel:WORD_1
v_pk_add_f32 v[36:37], v[36:37], v[118:119]
v_dot2c_f32_f16 v35, v91, v91
v_dot2c_f32_f16 v34, v90, v90
v_dot2c_f32_f16 v35, v89, v89
v_dot2c_f32_f16 v34, v88, v88
v_dot2c_f32_f16 v35, v87, v87
v_dot2c_f32_f16 v34, v86, v86
v_mfma_f32_32x32x16_bf16 v[134:149], a[204:207], a[36:39], v[134:149]
ds_read_b128 a[204:207], v1 offset:64512
ds_read_b128 a[176:179], v11 offset:28416
ds_read_b128 a[144:147], v5 offset:5632
ds_read_u16_d16_hi v104, v104
v_mad_u32_u16 v113, v113, 2, s85 op_sel:[1,0,0,0]
v_pk_add_f16 v79, v63, 1.0 op_sel_hi:[1,0]
v_exp_f16 v67, v83
v_smfmac_f32_32x32x32_bf16 v[176:191], a[152:155], a[156:163], v4
s_add_u32 m0, s75, 71680
ds_read_u16_d16_hi v105, v105
v_mad_u32_u16 v114, v114, 2, s85 op_sel:[1,0,0,0]
v_pk_add_f16 v80, v64, 1.0 op_sel_hi:[1,0]
v_mad_u32_u16 v115, v115, 2, s85 op_sel:[1,0,0,0]
v_exp_f16_sdwa v65, v81 dst_sel:WORD_1 dst_unused:UNUSED_PRESERVE src0_sel:WORD_1
v_mfma_f32_32x32x16_bf16 v[134:149], a[208:211], a[40:43], v[134:149]
ds_read_b128 a[208:211], v2 offset:0
buffer_load_dwordx4 v17, s[4:7], 0 offen  lds
ds_read_u16_d16_hi v106, v106
ds_read_u16_d16_hi v107, v107
v_pk_add_f16 v81, v65, 1.0 op_sel_hi:[1,0]
v_mad_u32_u16 v116, v116, 2, s85 op_sel:[1,0,0,0]
v_smfmac_f32_32x32x32_bf16 v[224:239], a[148:151], a[156:163], v4
ds_read_b128 a[156:159], v10 offset:30592
v_exp_f16_sdwa v66, v82 dst_sel:WORD_1 dst_unused:UNUSED_PRESERVE src0_sel:WORD_1
v_exp_f16_sdwa v67, v83 dst_sel:WORD_1 dst_unused:UNUSED_PRESERVE src0_sel:WORD_1
v_pk_add_f16 v82, v66, 1.0 op_sel_hi:[1,0]
v_mad_u32_u16 v117, v117, 2, s85 op_sel:[1,0,0,0]
v_mfma_f32_32x32x16_bf16 v[134:149], a[212:215], a[44:47], v[134:149]
ds_read_b128 a[212:215], v2 offset:1024
ds_read_b128 a[160:163], v11 offset:30592
ds_read_b128 a[148:151], v5 offset:7168
ds_read_u16_d16_hi v108, v108
v_pk_add_f16 v83, v67, 1.0 op_sel_hi:[1,0]
v_add_f32 v36, v36, v150
v_add_f32 v37, v37, v151
s_waitcnt lgkmcnt(8)
v_add_f32 v36, v36, v152
v_smfmac_f32_32x32x32_bf16 v[224:239], a[152:155], a[164:171], v4
ds_read_b128 a[164:167], v10 offset:32768
v_add_f32 v37, v37, v153
v_cvt_pk_f16_f32 v86, v134, v135
v_cvt_pk_f16_f32 v87, v136, v137
v_pk_fma_f16 v70, v86, v86, s84
v_cvt_pk_f16_f32 v88, v138, v139
v_pk_fma_f16 v71, v87, v87, s84
v_mfma_f32_32x32x16_bf16 v[118:133], a[0:3], a[216:219], 0
ds_read_b128 a[168:171], v11 offset:32768
ds_read_b128 a[152:155], v5 offset:8704
ds_read_u16_d16_hi v109, v109
v_rcp_f16 v62, v78
v_pk_mul_f16 v70, v86, v70
v_cvt_pk_f16_f32 v89, v140, v141
v_pk_fma_f16 v72, v88, v88, s84
v_smfmac_f32_32x32x32_bf16 v[176:191], a[144:147], a[172:179], v4
ds_read_b128 a[172:175], v10 offset:34944
v_pk_mul_f16 v71, v87, v71
v_cvt_pk_f16_f32 v90, v142, v143
v_rcp_f16 v63, v79
v_rcp_f16 v64, v80
v_mfma_f32_32x32x16_bf16 v[118:133], a[4:7], a[220:223], v[118:133]
ds_read_b128 a[176:179], v11 offset:34944
ds_read_u16_d16_hi v110, v110
s_add_u32 s101, s3, 16384
v_rcp_f16_sdwa v62, v78 dst_sel:WORD_1 dst_unused:UNUSED_PRESERVE src0_sel:WORD_1
v_rcp_f16 v65, v81
v_pk_mul_f16 v94, v94, v62
v_mfma_f32_32x32x16_bf16 v[118:133], a[8:11], a[224:227], v[118:133]
ds_read_u16_d16_hi v111, v111
ds_read_u16_d16_hi v112, v112
ds_read_u16_d16_hi v113, v113
v_pk_fma_f16 v73, v89, v89, s84
v_rcp_f16_sdwa v63, v79 dst_sel:WORD_1 dst_unused:UNUSED_PRESERVE src0_sel:WORD_1
v_pk_mul_f16 v72, v88, v72
v_cvt_pk_f16_f32 v91, v144, v145
s_waitcnt lgkmcnt(8)
v_smfmac_f32_32x32x32_bf16 v[176:191], a[148:151], a[156:163], v4
ds_read_u16_d16_hi v114, v114
v_pk_mul_f16 v95, v95, v63
v_pk_fma_f16 v74, v90, v90, s84
v_pk_mul_f16 v73, v89, v73
v_rcp_f16 v66, v82
v_cvt_pk_f16_f32 v92, v146, v147
v_mfma_f32_32x32x16_bf16 v[118:133], a[12:15], a[228:231], v[118:133]
ds_read_u16_d16_hi v115, v115
ds_read_u16_d16_hi v116, v116
ds_read_u16_d16_hi v117, v117
v_rcp_f16_sdwa v64, v80 dst_sel:WORD_1 dst_unused:UNUSED_PRESERVE src0_sel:WORD_1
v_rcp_f16 v67, v83
v_pk_mul_f16 v96, v96, v64
v_smfmac_f32_32x32x32_bf16 v[224:239], a[144:147], a[156:163], v4
v_pk_fma_f16 v75, v91, v91, s84
v_pk_mul_f16 v74, v90, v74
v_rcp_f16_sdwa v65, v81 dst_sel:WORD_1 dst_unused:UNUSED_PRESERVE src0_sel:WORD_1
v_rcp_f16_sdwa v66, v82 dst_sel:WORD_1 dst_unused:UNUSED_PRESERVE src0_sel:WORD_1
v_pk_mul_f16 v97, v97, v65
v_mfma_f32_32x32x16_bf16 v[118:133], a[16:19], a[232:235], v[118:133]
s_waitcnt vmcnt(11) lgkmcnt(6)
ds_write_b32 v154, v156
v_cvt_pk_f16_f32 v93, v148, v149
v_pk_fma_f16 v76, v92, v92, s84
ds_read_b32 v156, v155
v_pk_mul_f16 v75, v91, v75
v_smfmac_f32_32x32x32_bf16 v[176:191], a[152:155], a[164:171], v4
v_pk_mul_f16 v98, v98, v66
v_pk_fma_f16 v77, v93, v93, s84
v_pk_mul_f16 v76, v92, v76
v_pk_mul_f16 v77, v93, v77
v_rcp_f16_sdwa v67, v83 dst_sel:WORD_1 dst_unused:UNUSED_PRESERVE src0_sel:WORD_1
v_exp_f16 v62, v70
v_mfma_f32_32x32x16_bf16 v[118:133], a[20:23], a[236:239], v[118:133]
v_pk_mul_f16 v99, v99, v67
v_exp_f16 v63, v71
v_exp_f16 v64, v72
v_exp_f16_sdwa v62, v70 dst_sel:WORD_1 dst_unused:UNUSED_PRESERVE src0_sel:WORD_1
v_exp_f16 v65, v73
v_pk_fma_f32 v[48:49], v[176:177], v[176:177], v[48:49]
v_pk_add_f32 v[46:47], v[46:47], v[176:177]
v_pk_fma_f32 v[48:49], v[178:179], v[178:179], v[48:49]
v_pk_add_f32 v[46:47], v[46:47], v[178:179]
v_exp_f16_sdwa v63, v71 dst_sel:WORD_1 dst_unused:UNUSED_PRESERVE src0_sel:WORD_1
v_pk_fma_f32 v[48:49], v[180:181], v[180:181], v[48:49]
v_pk_add_f32 v[46:47], v[46:47], v[180:181]
v_pk_fma_f32 v[48:49], v[182:183], v[182:183], v[48:49]
v_exp_f16 v66, v74
v_pk_add_f32 v[46:47], v[46:47], v[182:183]
v_pk_fma_f32 v[48:49], v[184:185], v[184:185], v[48:49]
v_pk_add_f32 v[46:47], v[46:47], v[184:185]
v_pk_fma_f32 v[48:49], v[186:187], v[186:187], v[48:49]
v_pk_add_f32 v[46:47], v[46:47], v[186:187]
v_pk_fma_f32 v[48:49], v[188:189], v[188:189], v[48:49]
v_pk_add_f32 v[46:47], v[46:47], v[188:189]
v_pk_fma_f32 v[48:49], v[190:191], v[190:191], v[48:49]
v_pk_add_f32 v[46:47], v[46:47], v[190:191]
v_smfmac_f32_32x32x32_bf16 v[224:239], a[148:151], a[164:171], v4
v_mad_u32_u16 v118, v118, 2, s85 op_sel:[1,0,0,0]
v_mad_u32_u16 v119, v119, 2, s85 op_sel:[1,0,0,0]
v_mad_u32_u16 v120, v120, 2, s85 op_sel:[1,0,0,0]
v_mad_u32_u16 v121, v121, 2, s85 op_sel:[1,0,0,0]
v_mad_u32_u16 v122, v122, 2, s85 op_sel:[1,0,0,0]
v_mad_u32_u16 v123, v123, 2, s85 op_sel:[1,0,0,0]
v_mad_u32_u16 v124, v124, 2, s85 op_sel:[1,0,0,0]
s_waitcnt lgkmcnt(0)
v_pk_add_f32 v[38:39], v[116:117], v[114:115]
v_pk_add_f32 v[38:39], v[38:39], v[112:113]
v_pk_add_f32 v[38:39], v[38:39], v[110:111]
v_pk_add_f32 v[38:39], v[38:39], v[108:109]
v_pk_add_f32 v[38:39], v[38:39], v[106:107]
v_pk_add_f32 v[38:39], v[38:39], v[104:105]
v_exp_f16_sdwa v64, v72 dst_sel:WORD_1 dst_unused:UNUSED_PRESERVE src0_sel:WORD_1
v_cmp_gt_u32 vcc, 5, v156
v_pk_add_f32 v[38:39], v[38:39], v[102:103]
v_dot2c_f32_f16 v37, v99, v99
s_cbranch_vccnz L_spin5
L_ok5:
v_mov_b32 v156, 6
v_dot2c_f32_f16 v36, v98, v98
v_dot2c_f32_f16 v37, v97, v97
v_dot2c_f32_f16 v36, v96, v96
v_dot2c_f32_f16 v37, v95, v95
v_dot2c_f32_f16 v36, v94, v94
v_mfma_f32_32x32x16_bf16 v[134:149], a[24:27], a[216:219], 0
ds_read_b128 a[216:219], v2 offset:2048
ds_read_b128 a[156:159], v6 offset:50176
ds_read_b128 a[160:163], v7 offset:50176
ds_read_b128 a[144:147], v5 offset:9216
v_mad_u32_u16 v125, v125, 2, s85 op_sel:[1,0,0,0]
v_exp_f16 v67, v75
v_mad_u32_u16 v126, v126, 2, s85 op_sel:[1,0,0,0]
v_smfmac_f32_32x32x32_bf16 v[224:239], a[152:155], a[172:179], v4
ds_read_b128 a[164:167], v6 offset:52352
v_mad_u32_u16 v127, v127, 2, s85 op_sel:[1,0,0,0]
v_pk_add_f16 v70, v62, 1.0 op_sel_hi:[1,0]
v_mad_u32_u16 v128, v128, 2, s85 op_sel:[1,0,0,0]
v_pk_add_f16 v71, v63, 1.0 op_sel_hi:[1,0]
v_exp_f16_sdwa v65, v73 dst_sel:WORD_1 dst_unused:UNUSED_PRESERVE src0_sel:WORD_1
v_mfma_f32_32x32x16_bf16 v[134:149], a[28:31], a[220:223], v[134:149]
ds_read_b128 a[220:223], v2 offset:3072
ds_read_b128 a[168:171], v7 offset:52352
ds_read_b128 a[148:151], v5 offset:10752
ds_read_b128 a[172:175], v6 offset:54528
v_mad_u32_u16 v129, v129, 2, s85 op_sel:[1,0,0,0]
v_pk_add_f16 v72, v64, 1.0 op_sel_hi:[1,0]
v_exp_f16 v68, v76
v_pk_fma_f32 v[52:53], v[224:225], v[224:225], v[52:53]
v_pk_add_f32 v[50:51], v[50:51], v[224:225]
v_pk_fma_f32 v[52:53], v[226:227], v[226:227], v[52:53]
v_pk_add_f32 v[50:51], v[50:51], v[226:227]
v_pk_fma_f32 v[52:53], v[228:229], v[228:229], v[52:53]
v_pk_add_f32 v[50:51], v[50:51], v[228:229]
v_pk_fma_f32 v[52:53], v[230:231], v[230:231], v[52:53]
v_pk_add_f32 v[50:51], v[50:51], v[230:231]
v_pk_fma_f32 v[52:53], v[232:233], v[232:233], v[52:53]
v_pk_add_f32 v[50:51], v[50:51], v[232:233]
v_pk_fma_f32 v[52:53], v[234:235], v[234:235], v[52:53]
v_pk_add_f32 v[50:51], v[50:51], v[234:235]
v_pk_fma_f32 v[52:53], v[236:237], v[236:237], v[52:53]
v_pk_add_f32 v[50:51], v[50:51], v[236:237]
v_pk_fma_f32 v[52:53], v[238:239], v[238:239], v[52:53]
v_pk_add_f32 v[50:51], v[50:51], v[238:239]
v_mfma_f32_32x32x16_bf16 v[192:207], a[248:251], a[248:251], 0
ds_read_b128 a[176:179], v7 offset:54528
ds_read_b128 a[152:155], v5 offset:12288
s_add_u32 m0, s70, 100096
ds_read_u16_d16_hi v118, v118
buffer_load_dwordx4 v12, s[4:7], s89 offen  lds
v_mad_u32_u16 v130, v130, 2, s85 op_sel:[1,0,0,0]
v_mfma_f32_32x32x16_bf16 v[134:149], a[32:35], a[224:227], v[134:149]
ds_read_b128 a[224:227], v2 offset:4096
ds_read_u16_d16_hi v119, v119
ds_read_u16_d16_hi v120, v120
ds_read_u16_d16_hi v121, v121
v_pk_add_f16 v73, v65, 1.0 op_sel_hi:[1,0]
v_exp_f16_sdwa v66, v74 dst_sel:WORD_1 dst_unused:UNUSED_PRESERVE src0_sel:WORD_1
v_mfma_f32_32x32x16_bf16 v[240:255], a[248:251], a[248:251], 0
ds_read_u16_d16_hi v122, v122
ds_read_u16_d16_hi v123, v123
ds_read_u16_d16_hi v124, v124
ds_read_u16_d16_hi v125, v125
v_pk_add_f16 v74, v66, 1.0 op_sel_hi:[1,0]
v_exp_f16 v69, v77
v_mad_u32_u16 v131, v131, 2, s85 op_sel:[1,0,0,0]
v_mfma_f32_32x32x16_bf16 v[134:149], a[36:39], a[228:231], v[134:149]
ds_read_b128 a[228:231], v2 offset:5120
v_exp_f16_sdwa v67, v75 dst_sel:WORD_1 dst_unused:UNUSED_PRESERVE src0_sel:WORD_1
v_exp_f16_sdwa v68, v76 dst_sel:WORD_1 dst_unused:UNUSED_PRESERVE src0_sel:WORD_1
v_pk_add_f16 v75, v67, 1.0 op_sel_hi:[1,0]
v_mad_u32_u16 v132, v132, 2, s85 op_sel:[1,0,0,0]
v_pk_add_f16 v76, v68, 1.0 op_sel_hi:[1,0]
s_waitcnt lgkmcnt(8)
v_smfmac_f32_32x32x32_bf16 v[192:207], a[144:147], a[156:163], v4
ds_read_b128 a[156:159], v6 offset:56704
v_mad_u32_u16 v133, v133, 2, s85 op_sel:[1,0,0,0]
v_exp_f16_sdwa v69, v77 dst_sel:WORD_1 dst_unused:UNUSED_PRESERVE src0_sel:WORD_1
v_rcp_f16 v62, v70
v_pk_add_f16 v77, v69, 1.0 op_sel_hi:[1,0]
v_mfma_f32_32x32x16_bf16 v[134:149], a[40:43], a[232:235], v[134:149]
ds_read_b128 a[232:235], v3 offset:26368
ds_read_b128 a[160:163], v7 offset:56704
s_add_u32 m0, s71, 100096
ds_read_u16_d16_hi v126, v126
buffer_load_dwordx4 v13, s[4:7], s89 offen  lds
v_rcp_f16 v63, v71
v_smfmac_f32_32x32x32_bf16 v[192:207], a[148:151], a[164:171], v4
ds_read_u16_d16_hi v127, v127
v_rcp_f16 v64, v72
v_rcp_f16_sdwa v62, v70 dst_sel:WORD_1 dst_unused:UNUSED_PRESERVE src0_sel:WORD_1
v_rcp_f16 v65, v73
v_mfma_f32_32x32x16_bf16 v[134:149], a[44:47], a[236:239], v[134:149]
ds_read_b128 a[236:239], v3 offset:27392
ds_read_u16_d16_hi v128, v128
v_rcp_f16_sdwa v63, v71 dst_sel:WORD_1 dst_unused:UNUSED_PRESERVE src0_sel:WORD_1
v_rcp_f16 v66, v74
v_rcp_f16_sdwa v64, v72 dst_sel:WORD_1 dst_unused:UNUSED_PRESERVE src0_sel:WORD_1
v_smfmac_f32_32x32x32_bf16 v[240:255], a[144:147], a[164:171], v4
ds_read_b128 a[164:167], v8 offset:50176
v_rcp_f16 v67, v75
v_rcp_f16_sdwa v65, v73 dst_sel:WORD_1 dst_unused:UNUSED_PRESERVE src0_sel:WORD_1
v_rcp_f16 v68, v76
v_mfma_f32_32x32x16_bf16 v[102:117], a[0:3], a[192:195], 0
ds_read_b128 a[168:171], v9 offset:50176
ds_read_b128 a[144:147], v5 offset:9728
v_mul_f32 v150, s60, v146
v_mul_f32 v151, s60, v147
v_mul_f32 v152, s60, v148
v_mul_f32 v153, s60, v149
v_mad_u32_u16 v150, v150, 2, s85 op_sel:[1,0,0,0]
v_mad_u32_u16 v151, v151, 2, s85 op_sel:[1,0,0,0]
v_smfmac_f32_32x32x32_bf16 v[192:207], a[152:155], a[172:179], v4
s_add_u32 m0, s72, 100096
ds_read_u16_d16_hi v129, v129
v_mad_u32_u16 v152, v152, 2, s85 op_sel:[1,0,0,0]
v_mad_u32_u16 v153, v153, 2, s85 op_sel:[1,0,0,0]
v_cvt_pk_f16_f32 v94, v134, v135
v_rcp_f16_sdwa v66, v74 dst_sel:WORD_1 dst_unused:UNUSED_PRESERVE src0_sel:WORD_1
v_mfma_f32_32x32x16_bf16 v[102:117], a[4:7], a[196:199], v[102:117]
buffer_load_dwordx4 v14, s[4:7], s89 offen  lds
ds_read_u16_d16_hi v130, v130
ds_read_u16_d16_hi v131, v131
ds_read_u16_d16_hi v132, v132
v_cvt_pk_f16_f32 v95, v136, v137
v_pk_mul_f16 v86, v86, v62
v_smfmac_f32_32x32x32_bf16 v[240:255], a[148:151], a[172:179], v4
ds_read_b128 a[172:175], v8 offset:52352
v_pk_fma_f16 v78, v94, v94, s84
v_cvt_pk_f16_f32 v96, v138, v139
v_rcp_f16 v69, v77
v_pk_mul_f16 v87, v87, v63
v_pk_fma_f16 v79, v95, v95, s84
v_mfma_f32_32x32x16_bf16 v[102:117], a[8:11], a[200:203], v[102:117]
ds_read_b128 a[176:179], v9 offset:52352
ds_read_b128 a[148:151], v5 offset:11264
v_pk_mul_f16 v78, v94, v78
v_pk_mul_f16 v88, v88, v64
v_cvt_pk_f16_f32 v97, v140, v141
v_pk_fma_f16 v80, v96, v96, s84
v_pk_mul_f16 v79, v95, v79
s_waitcnt lgkmcnt(7)
v_smfmac_f32_32x32x32_bf16 v[240:255], a[152:155], a[156:163], v4
ds_read_b128 a[156:159], v8 offset:54528
v_pk_mul_f16 v89, v89, v65
v_cvt_pk_f16_f32 v98, v142, v143
v_pk_fma_f16 v81, v97, v97, s84
v_rcp_f16_sdwa v67, v75 dst_sel:WORD_1 dst_unused:UNUSED_PRESERVE src0_sel:WORD_1
v_pk_mul_f16 v90, v90, v66
v_mfma_f32_32x32x16_bf16 v[102:117], a[12:15], a[204:207], v[102:117]
ds_read_b128 a[160:163], v9 offset:54528
ds_read_b128 a[152:155], v5 offset:12800
s_add_u32 m0, s73, 100096
ds_read_u16_d16_hi v133, v133
buffer_load_dwordx4 v15, s[4:7], s89 offen  lds
v_pk_mul_f16 v80, v96, v80
v_smfmac_f32_32x32x32_bf16 v[192:207], a[144:147], a[164:171], v4
ds_read_b128 a[164:167], v8 offset:56704
v_cvt_pk_f16_f32 v99, v144, v145
v_pk_mul_f16 v91, v91, v67
v_pk_fma_f16 v82, v98, v98, s84
v_pk_mul_f16 v81, v97, v81
v_rcp_f16_sdwa v68, v76 dst_sel:WORD_1 dst_unused:UNUSED_PRESERVE src0_sel:WORD_1
v_mfma_f32_32x32x16_bf16 v[102:117], a[16:19], a[208:211], v[102:117]
ds_read_b128 a[168:171], v9 offset:56704
ds_read_u16_d16_hi v150, v150
v_pk_mul_f16 v92, v92, v68
v_rcp_f16_sdwa v69, v77 dst_sel:WORD_1 dst_unused:UNUSED_PRESERVE src0_sel:WORD_1
v_pk_fma_f16 v83, v99, v99, s84
v_pk_mul_f16 v82, v98, v82
v_pk_mul_f16 v83, v99, v83
v_mfma_f32_32x32x16_bf16 v[102:117], a[20:23], a[212:215], v[102:117]
ds_read_u16_d16_hi v151, v151
ds_read_u16_d16_hi v152, v152
v_pk_mul_f16 v93, v93, v69
v_exp_f16 v62, v78
v_exp_f16 v63, v79
v_exp_f16 v64, v80
v_mfma_f32_32x32x16_bf16 v[134:149], a[24:27], a[192:195], 0
ds_read_b128 a[192:195], v1 offset:0
ds_read_u16_d16_hi v153, v153
v_exp_f16_sdwa v62, v78 dst_sel:WORD_1 dst_unused:UNUSED_PRESERVE src0_sel:WORD_1
v_exp_f16 v65, v81
v_exp_f16_sdwa v63, v79 dst_sel:WORD_1 dst_unused:UNUSED_PRESERVE src0_sel:WORD_1
s_waitcnt lgkmcnt(7)
v_smfmac_f32_32x32x32_bf16 v[192:207], a[148:151], a[172:179], v4
s_add_u32 m0, s74, 100096
buffer_store_dwordx4 v[86:89], v1, s[12:15], s101 offen offset:0 sc1
v_mfma_f32_32x32x16_bf16 v[134:149], a[28:31], a[196:199], v[134:149]
ds_read_b128 a[196:199], v1 offset:1024
v_mad_u32_u16 v102, v102, 2, s85 op_sel:[1,0,0,0]
v_mad_u32_u16 v103, v103, 2, s85 op_sel:[1,0,0,0]
v_mad_u32_u16 v104, v104, 2, s85 op_sel:[1,0,0,0]
v_mad_u32_u16 v105, v105, 2, s85 op_sel:[1,0,0,0]
v_exp_f16 v66, v82
v_mad_u32_u16 v106, v106, 2, s85 op_sel:[1,0,0,0]
v_pk_add_f32 v[40:41], v[132:133], v[130:131]
v_pk_add_f32 v[40:41], v[40:41], v[128:129]
v_pk_add_f32 v[40:41], v[40:41], v[126:127]
v_pk_add_f32 v[40:41], v[40:41], v[124:125]
v_pk_add_f32 v[40:41], v[40:41], v[122:123]
v_pk_add_f32 v[40:41], v[40:41], v[120:121]
v_exp_f16_sdwa v64, v80 dst_sel:WORD_1 dst_unused:UNUSED_PRESERVE src0_sel:WORD_1
v_pk_add_f32 v[40:41], v[40:41], v[118:119]
v_smfmac_f32_32x32x32_bf16 v[240:255], a[144:147], a[172:179], v4
ds_read_b128 a[172:175], v10 offset:50176
v_mad_u32_u16 v107, v107, 2, s85 op_sel:[1,0,0,0]
v_mad_u32_u16 v108, v108, 2, s85 op_sel:[1,0,0,0]
v_mad_u32_u16 v109, v109, 2, s85 op_sel:[1,0,0,0]
v_mad_u32_u16 v110, v110, 2, s85 op_sel:[1,0,0,0]
v_exp_f16 v67, v83
v_mfma_f32_32x32x16_f16 v[118:133], v[86:89], a[240:243], 0
ds_read_b128 a[176:179], v11 offset:50176
ds_read_b128 a[144:147], v5 offset:10240
ds_read_u16_d16_hi v102, v102
ds_read_u16_d16_hi v103, v103
v_mad_u32_u16 v111, v111, 2, s85 op_sel:[1,0,0,0]
v_mad_u32_u16 v112, v112, 2, s85 op_sel:[1,0,0,0]
v_pk_add_f16 v78, v62, 1.0 op_sel_hi:[1,0]
v_mad_u32_u16 v113, v113, 2, s85 op_sel:[1,0,0,0]
v_mfma_f32_32x32x16_bf16 v[134:149], a[32:35], a[200:203], v[134:149]
ds_read_b128 a[200:203], v1 offset:2048
buffer_load_dwordx4 v16, s[4:7], s89 offen  lds
ds_read_u16_d16_hi v104, v104
ds_read_u16_d16_hi v105, v105
v_pk_add_f16 v79, v63, 1.0 op_sel_hi:[1,0]
v_mad_u32_u16 v114, v114, 2, s85 op_sel:[1,0,0,0]
v_smfmac_f32_32x32x32_bf16 v[192:207], a[152:155], a[156:163], v4
ds_read_u16_d16_hi v106, v106
v_pk_add_f16 v80, v64, 1.0 op_sel_hi:[1,0]
v_mad_u32_u16 v115, v115, 2, s85 op_sel:[1,0,0,0]
v_exp_f16_sdwa v65, v81 dst_sel:WORD_1 dst_unused:UNUSED_PRESERVE src0_sel:WORD_1
v_exp_f16_sdwa v66, v82 dst_sel:WORD_1 dst_unused:UNUSED_PRESERVE src0_sel:WORD_1
v_mfma_f32_32x32x16_f16 v[118:133], v[90:93], a[244:247], v[118:133]
ds_read_u16_d16_hi v107, v107
ds_read_u16_d16_hi v108, v108
ds_read_u16_d16_hi v109, v109
ds_read_u16_d16_hi v110, v110
v_pk_add_f16 v81, v65, 1.0 op_sel_hi:[1,0]
v_mad_u32_u16 v116, v116, 2, s85 op_sel:[1,0,0,0]
v_pk_add_f16 v82, v66, 1.0 op_sel_hi:[1,0]
v_mfma_f32_32x32x16_bf16 v[134:149], a[36:39], a[204:207], v[134:149]
ds_read_b128 a[204:207], v1 offset:3072
ds_read_u16_d16_hi v111, v111
ds_read_u16_d16_hi v112, v112
v_mad_u32_u16 v117, v117, 2, s85 op_sel:[1,0,0,0]
v_exp_f16_sdwa v67, v83 dst_sel:WORD_1 dst_unused:UNUSED_PRESERVE src0_sel:WORD_1
v_rcp_f16 v62, v78
v_pk_fma_f32 v[38:39], v[118:119], v[118:119], v[38:39]
v_pk_fma_f32 v[38:39], v[120:121], v[120:121], v[38:39]
v_pk_fma_f32 v[38:39], v[122:123], v[122:123], v[38:39]
v_rcp_f16 v63, v79
v_pk_fma_f32 v[38:39], v[124:125], v[124:125], v[38:39]
v_pk_fma_f32 v[38:39], v[126:127], v[126:127], v[38:39]
v_pk_fma_f32 v[38:39], v[128:129], v[128:129], v[38:39]
v_pk_fma_f32 v[38:39], v[130:131], v[130:131], v[38:39]
v_rcp_f16 v64, v80
v_pk_fma_f32 v[38:39], v[132:133], v[132:133], v[38:39]
v_smfmac_f32_32x32x32_bf16 v[240:255], a[148:151], a[156:163], v4
ds_read_b128 a[156:159], v10 offset:52352
v_pk_add_f16 v83, v67, 1.0 op_sel_hi:[1,0]
s_waitcnt lgkmcnt(8)
v_add_f32 v40, v40, v150
v_add_f32 v41, v41, v151
v_add_f32 v40, v40, v152
v_add_f32 v41, v41, v153
v_mfma_f32_32x32x16_bf16 v[134:149], a[40:43], a[208:211], v[134:149]
ds_read_b128 a[208:211], v1 offset:4096
ds_read_b128 a[160:163], v11 offset:52352
ds_read_b128 a[148:151], v5 offset:11776
s_add_u32 m0, s75, 100096
v_rcp_f16_sdwa v62, v78 dst_sel:WORD_1 dst_unused:UNUSED_PRESERVE src0_sel:WORD_1
v_rcp_f16 v65, v81
v_smfmac_f32_32x32x32_bf16 v[240:255], a[152:155], a[164:171], v4
ds_read_b128 a[164:167], v10 offset:54528
v_rcp_f16_sdwa v63, v79 dst_sel:WORD_1 dst_unused:UNUSED_PRESERVE src0_sel:WORD_1
v_rcp_f16 v66, v82
v_rcp_f16_sdwa v64, v80 dst_sel:WORD_1 dst_unused:UNUSED_PRESERVE src0_sel:WORD_1
v_mfma_f32_32x32x16_bf16 v[134:149], a[44:47], a[212:215], v[134:149]
ds_read_b128 a[212:215], v1 offset:5120
ds_read_b128 a[168:171], v11 offset:54528
buffer_load_dwordx4 v17, s[4:7], s89 offen  lds
ds_read_b128 a[152:155], v5 offset:13312
v_rcp_f16 v67, v83
v_smfmac_f32_32x32x32_bf16 v[192:207], a[144:147], a[172:179], v4
ds_read_b128 a[172:175], v10 offset:56704
v_rcp_f16_sdwa v65, v81 dst_sel:WORD_1 dst_unused:UNUSED_PRESERVE src0_sel:WORD_1
v_rcp_f16_sdwa v66, v82 dst_sel:WORD_1 dst_unused:UNUSED_PRESERVE src0_sel:WORD_1
v_rcp_f16_sdwa v67, v83 dst_sel:WORD_1 dst_unused:UNUSED_PRESERVE src0_sel:WORD_1
v_mfma_f32_32x32x16_bf16 v[118:133], a[0:3], a[216:219], 0
ds_read_b128 a[176:179], v11 offset:56704
v_mul_f32 v150, s60, v146
v_mul_f32 v151, s60, v147
v_mul_f32 v152, s60, v148
v_mul_f32 v153, s60, v149
v_mad_u32_u16 v150, v150, 2, s85 op_sel:[1,0,0,0]
v_mad_u32_u16 v151, v151, 2, s85 op_sel:[1,0,0,0]
v_mad_u32_u16 v152, v152, 2, s85 op_sel:[1,0,0,0]
v_mfma_f32_32x32x16_bf16 v[118:133], a[4:7], a[220:223], v[118:133]
ds_read_u16_d16_hi v113, v113
ds_read_u16_d16_hi v114, v114
v_mad_u32_u16 v153, v153, 2, s85 op_sel:[1,0,0,0]
v_cvt_pk_f16_f32 v86, v134, v135
v_cvt_pk_f16_f32 v87, v136, v137
v_pk_fma_f16 v70, v86, v86, s84
v_pk_mul_f16 v94, v94, v62
v_mfma_f32_32x32x16_bf16 v[118:133], a[8:11], a[224:227], v[118:133]
ds_read_u16_d16_hi v115, v115
ds_read_u16_d16_hi v116, v116
ds_read_u16_d16_hi v117, v117
buffer_store_dwordx4 v[90:93], v1, s[12:15], s101 offen offset:1024 sc1
s_waitcnt lgkmcnt(7)
v_smfmac_f32_32x32x32_bf16 v[192:207], a[148:151], a[156:163], v4
ds_read_u16_d16_hi v150, v150
v_cvt_pk_f16_f32 v88, v138, v139
v_pk_fma_f16 v71, v87, v87, s84
v_pk_mul_f16 v70, v86, v70
v_pk_mul_f16 v95, v95, v63
v_cvt_pk_f16_f32 v89, v140, v141
v_exp_f16 v62, v70
v_mfma_f32_32x32x16_bf16 v[118:133], a[12:15], a[228:231], v[118:133]
ds_read_u16_d16_hi v151, v151
ds_read_u16_d16_hi v152, v152
ds_read_u16_d16_hi v153, v153
v_pk_fma_f16 v72, v88, v88, s84
v_pk_mul_f16 v71, v87, v71
v_pk_mul_f16 v96, v96, v64
v_exp_f16 v63, v71
v_smfmac_f32_32x32x32_bf16 v[240:255], a[144:147], a[156:163], v4
v_cvt_pk_f16_f32 v90, v142, v143
v_pk_fma_f16 v73, v89, v89, s84
v_pk_mul_f16 v72, v88, v72
v_pk_mul_f16 v97, v97, v65
v_cvt_pk_f16_f32 v91, v144, v145
v_pk_fma_f16 v74, v90, v90, s84
v_pk_mul_f16 v73, v89, v73
v_mfma_f32_32x32x16_bf16 v[118:133], a[16:19], a[232:235], v[118:133]
v_pk_mul_f16 v98, v98, v66
v_pk_fma_f16 v75, v91, v91, s84
v_pk_mul_f16 v74, v90, v74
v_pk_mul_f16 v75, v91, v75
v_pk_mul_f16 v99, v99, v67
v_exp_f16 v64, v72
v_exp_f16_sdwa v62, v70 dst_sel:WORD_1 dst_unused:UNUSED_PRESERVE src0_sel:WORD_1
v_smfmac_f32_32x32x32_bf16 v[192:207], a[152:155], a[164:171], v4
s_add_u32 s101, s3, 22528
v_exp_f16 v65, v73
v_exp_f16_sdwa v63, v71 dst_sel:WORD_1 dst_unused:UNUSED_PRESERVE src0_sel:WORD_1
v_exp_f16 v66, v74
v_mfma_f32_32x32x16_bf16 v[118:133], a[20:23], a[236:239], v[118:133]
v_exp_f16_sdwa v64, v72 dst_sel:WORD_1 dst_unused:UNUSED_PRESERVE src0_sel:WORD_1
v_exp_f16 v67, v75
v_exp_f16_sdwa v65, v73 dst_sel:WORD_1 dst_unused:UNUSED_PRESERVE src0_sel:WORD_1
v_exp_f16_sdwa v66, v74 dst_sel:WORD_1 dst_unused:UNUSED_PRESERVE src0_sel:WORD_1
s_waitcnt lgkmcnt(2)
v_pk_add_f32 v[42:43], v[116:117], v[114:115]
v_pk_add_f32 v[42:43], v[42:43], v[112:113]
v_pk_add_f32 v[42:43], v[42:43], v[110:111]
v_exp_f16_sdwa v67, v75 dst_sel:WORD_1 dst_unused:UNUSED_PRESERVE src0_sel:WORD_1
v_pk_add_f32 v[42:43], v[42:43], v[108:109]
v_pk_add_f32 v[42:43], v[42:43], v[106:107]
v_pk_add_f32 v[42:43], v[42:43], v[104:105]
v_pk_add_f32 v[42:43], v[42:43], v[102:103]
v_dot2c_f32_f16 v41, v99, v99
v_dot2c_f32_f16 v40, v98, v98
v_dot2c_f32_f16 v41, v97, v97
v_dot2c_f32_f16 v40, v96, v96
v_dot2c_f32_f16 v41, v95, v95
v_dot2c_f32_f16 v40, v94, v94
v_pk_fma_f32 v[48:49], v[192:193], v[192:193], v[48:49]
v_pk_add_f32 v[46:47], v[46:47], v[192:193]
v_pk_fma_f32 v[48:49], v[194:195], v[194:195], v[48:49]
v_pk_add_f32 v[46:47], v[46:47], v[194:195]
v_pk_fma_f32 v[48:49], v[196:197], v[196:197], v[48:49]
v_pk_add_f32 v[46:47], v[46:47], v[196:197]
v_pk_fma_f32 v[48:49], v[198:199], v[198:199], v[48:49]
v_pk_add_f32 v[46:47], v[46:47], v[198:199]
v_pk_fma_f32 v[48:49], v[200:201], v[200:201], v[48:49]
v_pk_add_f32 v[46:47], v[46:47], v[200:201]
v_pk_fma_f32 v[48:49], v[202:203], v[202:203], v[48:49]
v_pk_add_f32 v[46:47], v[46:47], v[202:203]
v_pk_fma_f32 v[48:49], v[204:205], v[204:205], v[48:49]
v_pk_add_f32 v[46:47], v[46:47], v[204:205]
v_pk_fma_f32 v[48:49], v[206:207], v[206:207], v[48:49]
v_pk_add_f32 v[46:47], v[46:47], v[206:207]
v_smfmac_f32_32x32x32_bf16 v[240:255], a[148:151], a[164:171], v4
v_mad_u32_u16 v118, v118, 2, s85 op_sel:[1,0,0,0]
v_mad_u32_u16 v119, v119, 2, s85 op_sel:[1,0,0,0]
v_mad_u32_u16 v120, v120, 2, s85 op_sel:[1,0,0,0]
v_mad_u32_u16 v121, v121, 2, s85 op_sel:[1,0,0,0]
v_mad_u32_u16 v122, v122, 2, s85 op_sel:[1,0,0,0]
v_mad_u32_u16 v123, v123, 2, s85 op_sel:[1,0,0,0]
v_mfma_f32_32x32x16_bf16 v[134:149], a[216:219], a[24:27], 0
ds_read_b128 a[216:219], v1 offset:6144
ds_read_u16_d16_hi v118, v118
ds_read_u16_d16_hi v119, v119
ds_read_u16_d16_hi v120, v120
s_waitcnt vmcnt(8)
ds_write_b32 v154, v156
v_mad_u32_u16 v124, v124, 2, s85 op_sel:[1,0,0,0]
v_smfmac_f32_32x32x32_bf16 v[240:255], a[152:155], a[172:179], v4
ds_read_u16_d16_hi v121, v121
v_mad_u32_u16 v125, v125, 2, s85 op_sel:[1,0,0,0]
v_mad_u32_u16 v126, v126, 2, s85 op_sel:[1,0,0,0]
v_mad_u32_u16 v127, v127, 2, s85 op_sel:[1,0,0,0]
v_mad_u32_u16 v128, v128, 2, s85 op_sel:[1,0,0,0]
v_pk_add_f16 v70, v62, 1.0 op_sel_hi:[1,0]
v_mfma_f32_32x32x16_bf16 v[134:149], a[220:223], a[28:31], v[134:149]
ds_read_b128 a[220:223], v1 offset:7168
ds_read_u16_d16_hi v122, v122
ds_read_u16_d16_hi v123, v123
ds_read_u16_d16_hi v124, v124
v_mad_u32_u16 v129, v129, 2, s85 op_sel:[1,0,0,0]
v_pk_add_f16 v71, v63, 1.0 op_sel_hi:[1,0]
v_rcp_f16 v62, v70
v_pk_fma_f32 v[52:53], v[240:241], v[240:241], v[52:53]
v_pk_add_f32 v[50:51], v[50:51], v[240:241]
v_pk_fma_f32 v[52:53], v[242:243], v[242:243], v[52:53]
v_rcp_f16 v63, v71
v_pk_add_f32 v[50:51], v[50:51], v[242:243]
v_pk_fma_f32 v[52:53], v[244:245], v[244:245], v[52:53]
v_pk_add_f32 v[50:51], v[50:51], v[244:245]
v_pk_fma_f32 v[52:53], v[246:247], v[246:247], v[52:53]
v_pk_add_f32 v[50:51], v[50:51], v[246:247]
v_pk_fma_f32 v[52:53], v[248:249], v[248:249], v[52:53]
v_pk_add_f32 v[50:51], v[50:51], v[248:249]
v_pk_fma_f32 v[52:53], v[250:251], v[250:251], v[52:53]
v_pk_add_f32 v[50:51], v[50:51], v[250:251]
v_pk_fma_f32 v[52:53], v[252:253], v[252:253], v[52:53]
v_pk_add_f32 v[50:51], v[50:51], v[252:253]
v_pk_fma_f32 v[52:53], v[254:255], v[254:255], v[52:53]
v_pk_add_f32 v[50:51], v[50:51], v[254:255]
v_mfma_f32_32x32x16_bf16 v[134:149], a[224:227], a[32:35], v[134:149]
ds_read_b128 a[224:227], v1 offset:8192
ds_read_u16_d16_hi v125, v125
ds_read_u16_d16_hi v126, v126
ds_read_u16_d16_hi v127, v127
v_add_f32 v46, v46, v47
v_mad_u32_u16 v130, v130, 2, s85 op_sel:[1,0,0,0]
v_add_f32 v48, v48, v49
v_pk_add_f16 v72, v64, 1.0 op_sel_hi:[1,0]
v_mfma_f32_32x32x16_bf16 v[134:149], a[228:231], a[36:39], v[134:149]
ds_read_b128 a[228:231], v1 offset:9216
ds_read_u16_d16_hi v128, v128
ds_read_u16_d16_hi v129, v129
v_add_f32 v50, v50, v51
v_mad_u32_u16 v131, v131, 2, s85 op_sel:[1,0,0,0]
v_add_f32 v52, v52, v53
v_pk_add_f16 v73, v65, 1.0 op_sel_hi:[1,0]
v_permlane32_swap_b32 v46, v48
v_mfma_f32_32x32x16_bf16 v[134:149], a[232:235], a[40:43], v[134:149]
ds_read_b128 a[232:235], v1 offset:10240
ds_read_u16_d16_hi v130, v130
v_permlane32_swap_b32 v50, v52
v_mad_u32_u16 v132, v132, 2, s85 op_sel:[1,0,0,0]
v_add_f32 v46, v46, v48
v_pk_add_f16 v74, v66, 1.0 op_sel_hi:[1,0]
v_add_f32 v50, v50, v52
v_mfma_f32_32x32x16_bf16 v[134:149], a[236:239], a[44:47], v[134:149]
ds_read_b128 a[236:239], v1 offset:11264
v_mov_b32 v48, v46
v_mad_u32_u16 v133, v133, 2, s85 op_sel:[1,0,0,0]
v_mov_b32 v52, v50
v_pk_add_f16 v75, v67, 1.0 op_sel_hi:[1,0]
v_permlane32_swap_b32 v46, v48
v_add_f32 v42, v42, v150
v_permlane32_swap_b32 v50, v52
v_add_f32 v43, v43, v151
v_mul_f32 v46, 0x3c2aaaab, v46
s_waitcnt lgkmcnt(8)
v_add_f32 v42, v42, v152
v_mul_f32 v50, 0x3c2aaaab, v50
v_add_f32 v43, v43, v153
v_mul_f32 v48, 0x3c2aaaab, v48
v_cvt_pk_f16_f32 v94, v134, v135
v_mul_f32 v52, 0x3c2aaaab, v52
v_cvt_pk_f16_f32 v95, v136, v137
v_fma_f32 v48, -v46, v46, v48
v_pk_fma_f16 v78, v94, v94, s84
v_rcp_f16 v64, v72
v_fma_f32 v52, -v50, v50, v52
v_cvt_pk_f16_f32 v96, v138, v139
v_max_f32 v48, 0, v48
v_pk_fma_f16 v79, v95, v95, s84
v_max_f32 v52, 0, v52
v_pk_mul_f16 v78, v94, v78
v_add_f32 v48, 0x3727c5ac, v48
v_cvt_pk_f16_f32 v97, v140, v141
v_add_f32 v52, 0x3727c5ac, v52
v_rsq_f32 v48, v48
v_pk_fma_f16 v80, v96, v96, s84
v_rsq_f32 v52, v52
v_pk_mul_f16 v79, v95, v79
v_mul_f32 v48, s86, v48
v_cvt_pk_f16_f32 v98, v142, v143
v_mul_f32_e64 v46, -v46, v48
v_pk_fma_f32 v[160:161], v[160:161], v[48:49], v[46:47] op_sel_hi:[1,0,0]
v_pk_fma_f32 v[162:163], v[162:163], v[48:49], v[46:47] op_sel_hi:[1,0,0]
v_rcp_f16_sdwa v62, v70 dst_sel:WORD_1 dst_unused:UNUSED_PRESERVE src0_sel:WORD_1
v_pk_fma_f32 v[164:165], v[164:165], v[48:49], v[46:47] op_sel_hi:[1,0,0]
v_pk_fma_f32 v[166:167], v[166:167], v[48:49], v[46:47] op_sel_hi:[1,0,0]
v_pk_fma_f32 v[168:169], v[168:169], v[48:49], v[46:47] op_sel_hi:[1,0,0]
v_rcp_f16 v65, v73
v_pk_fma_f32 v[170:171], v[170:171], v[48:49], v[46:47] op_sel_hi:[1,0,0]
v_pk_fma_f32 v[172:173], v[172:173], v[48:49], v[46:47] op_sel_hi:[1,0,0]
v_pk_fma_f32 v[174:175], v[174:175], v[48:49], v[46:47] op_sel_hi:[1,0,0]
v_pk_fma_f32 v[176:177], v[176:177], v[48:49], v[46:47] op_sel_hi:[1,0,0]
v_pk_fma_f32 v[178:179], v[178:179], v[48:49], v[46:47] op_sel_hi:[1,0,0]
v_pk_fma_f32 v[180:181], v[180:181], v[48:49], v[46:47] op_sel_hi:[1,0,0]
v_pk_fma_f32 v[182:183], v[182:183], v[48:49], v[46:47] op_sel_hi:[1,0,0]
v_pk_fma_f32 v[184:185], v[184:185], v[48:49], v[46:47] op_sel_hi:[1,0,0]
v_pk_fma_f32 v[186:187], v[186:187], v[48:49], v[46:47] op_sel_hi:[1,0,0]
v_pk_fma_f32 v[188:189], v[188:189], v[48:49], v[46:47] op_sel_hi:[1,0,0]
v_pk_fma_f32 v[190:191], v[190:191], v[48:49], v[46:47] op_sel_hi:[1,0,0]
v_pk_fma_f32 v[192:193], v[192:193], v[48:49], v[46:47] op_sel_hi:[1,0,0]
v_pk_fma_f32 v[194:195], v[194:195], v[48:49], v[46:47] op_sel_hi:[1,0,0]
v_pk_fma_f32 v[196:197], v[196:197], v[48:49], v[46:47] op_sel_hi:[1,0,0]
v_pk_fma_f32 v[198:199], v[198:199], v[48:49], v[46:47] op_sel_hi:[1,0,0]
v_pk_fma_f32 v[200:201], v[200:201], v[48:49], v[46:47] op_sel_hi:[1,0,0]
v_pk_fma_f32 v[202:203], v[202:203], v[48:49], v[46:47] op_sel_hi:[1,0,0]
v_pk_fma_f32 v[204:205], v[204:205], v[48:49], v[46:47] op_sel_hi:[1,0,0]
v_pk_fma_f32 v[206:207], v[206:207], v[48:49], v[46:47] op_sel_hi:[1,0,0]
v_pk_mul_f16 v86, v86, v62
v_mul_f32 v52, 0xbeeff558, v52
v_pk_fma_f16 v81, v97, v97, s84
v_mul_f32_e64 v50, -v50, v52
v_pk_fma_f32 v[208:209], v[208:209], v[52:53], v[50:51] op_sel_hi:[1,0,0]
v_pk_fma_f32 v[210:211], v[210:211], v[52:53], v[50:51] op_sel_hi:[1,0,0]
v_pk_fma_f32 v[212:213], v[212:213], v[52:53], v[50:51] op_sel_hi:[1,0,0]
v_pk_fma_f32 v[214:215], v[214:215], v[52:53], v[50:51] op_sel_hi:[1,0,0]
v_pk_fma_f32 v[216:217], v[216:217], v[52:53], v[50:51] op_sel_hi:[1,0,0]
v_pk_fma_f32 v[218:219], v[218:219], v[52:53], v[50:51] op_sel_hi:[1,0,0]
v_pk_fma_f32 v[220:221], v[220:221], v[52:53], v[50:51] op_sel_hi:[1,0,0]
v_pk_fma_f32 v[222:223], v[222:223], v[52:53], v[50:51] op_sel_hi:[1,0,0]
v_pk_fma_f32 v[224:225], v[224:225], v[52:53], v[50:51] op_sel_hi:[1,0,0]
v_pk_fma_f32 v[226:227], v[226:227], v[52:53], v[50:51] op_sel_hi:[1,0,0]
v_pk_fma_f32 v[228:229], v[228:229], v[52:53], v[50:51] op_sel_hi:[1,0,0]
v_pk_fma_f32 v[230:231], v[230:231], v[52:53], v[50:51] op_sel_hi:[1,0,0]
v_pk_fma_f32 v[232:233], v[232:233], v[52:53], v[50:51] op_sel_hi:[1,0,0]
v_pk_fma_f32 v[234:235], v[234:235], v[52:53], v[50:51] op_sel_hi:[1,0,0]
v_pk_fma_f32 v[236:237], v[236:237], v[52:53], v[50:51] op_sel_hi:[1,0,0]
v_pk_fma_f32 v[238:239], v[238:239], v[52:53], v[50:51] op_sel_hi:[1,0,0]
v_pk_fma_f32 v[240:241], v[240:241], v[52:53], v[50:51] op_sel_hi:[1,0,0]
v_pk_fma_f32 v[242:243], v[242:243], v[52:53], v[50:51] op_sel_hi:[1,0,0]
v_pk_fma_f32 v[244:245], v[244:245], v[52:53], v[50:51] op_sel_hi:[1,0,0]
v_pk_fma_f32 v[246:247], v[246:247], v[52:53], v[50:51] op_sel_hi:[1,0,0]
v_pk_fma_f32 v[248:249], v[248:249], v[52:53], v[50:51] op_sel_hi:[1,0,0]
v_pk_fma_f32 v[250:251], v[250:251], v[52:53], v[50:51] op_sel_hi:[1,0,0]
v_pk_fma_f32 v[252:253], v[252:253], v[52:53], v[50:51] op_sel_hi:[1,0,0]
v_pk_fma_f32 v[254:255], v[254:255], v[52:53], v[50:51] op_sel_hi:[1,0,0]
v_pk_mul_f16 v80, v96, v80
v_cvt_pk_bf16_f32 v54, v160, v161
v_cvt_pk_f16_f32 v99, v144, v145
v_cvt_pk_bf16_f32 v55, v162, v163
v_rcp_f16_sdwa v63, v71 dst_sel:WORD_1 dst_unused:UNUSED_PRESERVE src0_sel:WORD_1
v_cvt_pk_bf16_f32 v56, v164, v165
v_pk_mul_f16 v87, v87, v63
v_accvgpr_write_b32 a48, v54
v_pk_fma_f16 v82, v98, v98, s84
v_rcp_f16 v66, v74
v_cvt_pk_bf16_f32 v57, v166, v167
v_pk_mul_f16 v81, v97, v81
v_accvgpr_write_b32 a49, v55
v_rcp_f16_sdwa v64, v72 dst_sel:WORD_1 dst_unused:UNUSED_PRESERVE src0_sel:WORD_1
v_cvt_pk_bf16_f32 v58, v168, v169
v_cvt_pk_f16_f32 v100, v146, v147
v_accvgpr_write_b32 a50, v56
v_rcp_f16 v67, v75
v_cvt_pk_bf16_f32 v59, v170, v171
v_pk_mul_f16 v88, v88, v64
v_accvgpr_write_b32 a51, v57
v_pk_fma_f16 v83, v99, v99, s84
v_cvt_pk_bf16_f32 v60, v172, v173
v_mfma_f32_32x32x16_bf16 v[102:117], a[48:51], a[192:195], 0
ds_read_u16_d16_hi v131, v131
ds_read_u16_d16_hi v132, v132
ds_read_u16_d16_hi v133, v133
v_accvgpr_write_b32 a52, v58
v_pk_mul_f16 v82, v98, v82
v_cvt_pk_bf16_f32 v61, v174, v175
v_rcp_f16_sdwa v65, v73 dst_sel:WORD_1 dst_unused:UNUSED_PRESERVE src0_sel:WORD_1
v_mfma_f32_32x32x16_bf16 v[160:175], a[248:251], a[248:251], 0
v_accvgpr_write_b32 a53, v59
v_pk_mul_f16 v89, v89, v65
v_cvt_pk_bf16_f32 v54, v176, v177
v_cvt_pk_f16_f32 v101, v148, v149
v_accvgpr_write_b32 a54, v60
v_pk_fma_f16 v84, v100, v100, s84
v_cvt_pk_bf16_f32 v55, v178, v179
v_pk_mul_f16 v83, v99, v83
v_accvgpr_write_b32 a55, v61
v_rcp_f16_sdwa v66, v74 dst_sel:WORD_1 dst_unused:UNUSED_PRESERVE src0_sel:WORD_1
v_cvt_pk_bf16_f32 v56, v180, v181
v_mfma_f32_32x32x16_bf16 v[102:117], a[52:55], a[196:199], v[102:117]
global_load_dword a255, v[158:159], off
v_accvgpr_write_b32 a56, v54
v_pk_mul_f16 v90, v90, v66
v_cvt_pk_bf16_f32 v57, v182, v183
v_pk_fma_f16 v85, v101, v101, s84
v_accvgpr_write_b32 a57, v55
v_pk_mul_f16 v84, v100, v84
v_cvt_pk_bf16_f32 v58, v184, v185
v_pk_mul_f16 v85, v101, v85
v_accvgpr_write_b32 a58, v56
v_rcp_f16_sdwa v67, v75 dst_sel:WORD_1 dst_unused:UNUSED_PRESERVE src0_sel:WORD_1
v_lshl_add_u64 v[158:159], v[158:159], 0, s[42:43]
v_cvt_pk_bf16_f32 v59, v186, v187
v_pk_mul_f16 v91, v91, v67
v_accvgpr_write_b32 a59, v57
v_exp_f16 v62, v78
v_cvt_pk_bf16_f32 v60, v188, v189
s_waitcnt lgkmcnt(0)
v_pk_add_f32 v[44:45], v[132:133], v[130:131]
v_pk_add_f32 v[44:45], v[44:45], v[128:129]
v_pk_add_f32 v[44:45], v[44:45], v[126:127]
v_pk_add_f32 v[44:45], v[44:45], v[124:125]
v_pk_add_f32 v[44:45], v[44:45], v[122:123]
v_exp_f16 v63, v79
v_pk_add_f32 v[44:45], v[44:45], v[120:121]
v_pk_add_f32 v[44:45], v[44:45], v[118:119]
v_dot2c_f32_f16 v43, v91, v91
v_dot2c_f32_f16 v42, v90, v90
v_dot2c_f32_f16 v43, v89, v89
v_dot2c_f32_f16 v42, v88, v88
v_dot2c_f32_f16 v43, v87, v87
v_dot2c_f32_f16 v42, v86, v86
v_mfma_f32_32x32x16_bf16 v[102:117], a[56:59], a[200:203], v[102:117]
v_accvgpr_write_b32 a60, v58
v_exp_f16 v64, v80
v_cvt_pk_bf16_f32 v61, v190, v191
v_exp_f16_sdwa v62, v78 dst_sel:WORD_1 dst_unused:UNUSED_PRESERVE src0_sel:WORD_1
v_accvgpr_write_b32 a61, v59
v_exp_f16 v65, v81
v_cvt_pk_bf16_f32 v54, v192, v193
v_exp_f16_sdwa v63, v79 dst_sel:WORD_1 dst_unused:UNUSED_PRESERVE src0_sel:WORD_1
v_accvgpr_write_b32 a62, v60
v_exp_f16 v66, v82
v_cvt_pk_bf16_f32 v55, v194, v195
v_exp_f16_sdwa v64, v80 dst_sel:WORD_1 dst_unused:UNUSED_PRESERVE src0_sel:WORD_1
v_accvgpr_write_b32 a63, v61
v_exp_f16 v67, v83
v_cvt_pk_bf16_f32 v56, v196, v197
v_mfma_f32_32x32x16_bf16 v[102:117], a[60:63], a[204:207], v[102:117]
v_accvgpr_write_b32 a64, v54
v_exp_f16_sdwa v65, v81 dst_sel:WORD_1 dst_unused:UNUSED_PRESERVE src0_sel:WORD_1
v_cvt_pk_bf16_f32 v57, v198, v199
v_exp_f16 v68, v84
v_accvgpr_write_b32 a65, v55
v_exp_f16_sdwa v66, v82 dst_sel:WORD_1 dst_unused:UNUSED_PRESERVE src0_sel:WORD_1
v_cvt_pk_bf16_f32 v58, v200, v201
v_exp_f16 v69, v85
v_accvgpr_write_b32 a66, v56
v_exp_f16_sdwa v67, v83 dst_sel:WORD_1 dst_unused:UNUSED_PRESERVE src0_sel:WORD_1
v_cvt_pk_bf16_f32 v59, v202, v203
v_exp_f16_sdwa v68, v84 dst_sel:WORD_1 dst_unused:UNUSED_PRESERVE src0_sel:WORD_1
v_accvgpr_write_b32 a67, v57
v_exp_f16_sdwa v69, v85 dst_sel:WORD_1 dst_unused:UNUSED_PRESERVE src0_sel:WORD_1
v_cvt_pk_bf16_f32 v60, v204, v205
v_mfma_f32_32x32x16_bf16 v[102:117], a[64:67], a[208:211], v[102:117]
v_accvgpr_write_b32 a68, v58
v_cvt_pk_bf16_f32 v61, v206, v207
v_accvgpr_write_b32 a69, v59
v_cvt_pk_bf16_f32 v54, v208, v209
v_accvgpr_write_b32 a70, v60
v_cvt_pk_bf16_f32 v55, v210, v211
v_accvgpr_write_b32 a71, v61
v_cvt_pk_bf16_f32 v56, v212, v213
v_accvgpr_write_b32 a72, v54
v_mfma_f32_32x32x16_bf16 v[102:117], a[68:71], a[212:215], v[102:117]
v_cvt_pk_bf16_f32 v57, v214, v215
v_accvgpr_write_b32 a73, v55
v_cvt_pk_bf16_f32 v58, v216, v217
v_accvgpr_write_b32 a74, v56
v_cvt_pk_bf16_f32 v59, v218, v219
v_accvgpr_write_b32 a75, v57
v_cvt_pk_bf16_f32 v60, v220, v221
v_accvgpr_write_b32 a76, v58
v_mfma_f32_32x32x16_bf16 v[134:149], a[72:75], a[192:195], 0
ds_read_b128 a[192:195], v1 offset:12288
v_cvt_pk_bf16_f32 v61, v222, v223
v_accvgpr_write_b32 a77, v59
v_mad_u32_u16 v102, v102, 2, s85 op_sel:[1,0,0,0]
v_cvt_pk_bf16_f32 v54, v224, v225
v_mad_u32_u16 v103, v103, 2, s85 op_sel:[1,0,0,0]
v_accvgpr_write_b32 a78, v60
v_mfma_f32_32x32x16_bf16 v[208:223], a[248:251], a[248:251], 0
ds_read_u16_d16_hi v102, v102
ds_read_u16_d16_hi v103, v103
v_cvt_pk_bf16_f32 v55, v226, v227
v_mad_u32_u16 v104, v104, 2, s85 op_sel:[1,0,0,0]
v_accvgpr_write_b32 a79, v61
v_mad_u32_u16 v105, v105, 2, s85 op_sel:[1,0,0,0]
v_cvt_pk_bf16_f32 v56, v228, v229
v_mfma_f32_32x32x16_bf16 v[134:149], a[76:79], a[196:199], v[134:149]
ds_read_b128 a[196:199], v1 offset:13312
ds_read_u16_d16_hi v104, v104
ds_read_u16_d16_hi v105, v105
v_accvgpr_write_b32 a80, v54
v_mad_u32_u16 v106, v106, 2, s85 op_sel:[1,0,0,0]
v_cvt_pk_bf16_f32 v57, v230, v231
v_mad_u32_u16 v107, v107, 2, s85 op_sel:[1,0,0,0]
v_accvgpr_write_b32 a81, v55
v_mad_u32_u16 v108, v108, 2, s85 op_sel:[1,0,0,0]
v_cvt_pk_bf16_f32 v58, v232, v233
v_mad_u32_u16 v109, v109, 2, s85 op_sel:[1,0,0,0]
v_accvgpr_write_b32 a82, v56
v_mad_u32_u16 v110, v110, 2, s85 op_sel:[1,0,0,0]
v_cvt_pk_bf16_f32 v59, v234, v235
v_mad_u32_u16 v111, v111, 2, s85 op_sel:[1,0,0,0]
v_accvgpr_write_b32 a83, v57
v_pk_add_f16 v78, v62, 1.0 op_sel_hi:[1,0]
v_rcp_f16 v62, v78
v_mfma_f32_32x32x16_bf16 v[134:149], a[80:83], a[200:203], v[134:149]
ds_read_b128 a[200:203], v1 offset:14336
ds_read_u16_d16_hi v106, v106
ds_read_u16_d16_hi v107, v107
ds_read_u16_d16_hi v108, v108
v_cvt_pk_bf16_f32 v60, v236, v237
v_mad_u32_u16 v112, v112, 2, s85 op_sel:[1,0,0,0]
v_accvgpr_write_b32 a84, v58
v_pk_add_f16 v79, v63, 1.0 op_sel_hi:[1,0]
v_cvt_pk_bf16_f32 v61, v238, v239
v_mad_u32_u16 v113, v113, 2, s85 op_sel:[1,0,0,0]
v_accvgpr_write_b32 a85, v59
v_rcp_f16 v63, v79
v_cvt_pk_bf16_f32 v54, v240, v241
v_pk_add_f16 v80, v64, 1.0 op_sel_hi:[1,0]
v_accvgpr_write_b32 a86, v60
v_rcp_f16 v64, v80
v_cvt_pk_bf16_f32 v55, v242, v243
v_mad_u32_u16 v114, v114, 2, s85 op_sel:[1,0,0,0]
v_accvgpr_write_b32 a87, v61
v_pk_add_f16 v81, v65, 1.0 op_sel_hi:[1,0]
v_cvt_pk_bf16_f32 v56, v244, v245
v_mfma_f32_32x32x16_bf16 v[134:149], a[84:87], a[204:207], v[134:149]
ds_read_b128 a[204:207], v1 offset:15360
ds_read_u16_d16_hi v109, v109
ds_read_u16_d16_hi v110, v110
ds_read_u16_d16_hi v111, v111
v_accvgpr_write_b32 a88, v54
v_pk_add_f16 v82, v66, 1.0 op_sel_hi:[1,0]
v_cvt_pk_bf16_f32 v57, v246, v247
v_mad_u32_u16 v115, v115, 2, s85 op_sel:[1,0,0,0]
v_accvgpr_write_b32 a89, v55
v_pk_add_f16 v83, v67, 1.0 op_sel_hi:[1,0]
v_cvt_pk_bf16_f32 v58, v248, v249
v_mad_u32_u16 v116, v116, 2, s85 op_sel:[1,0,0,0]
v_accvgpr_write_b32 a90, v56
v_pk_add_f16 v84, v68, 1.0 op_sel_hi:[1,0]
v_cvt_pk_bf16_f32 v59, v250, v251
v_mad_u32_u16 v117, v117, 2, s85 op_sel:[1,0,0,0]
v_accvgpr_write_b32 a91, v57
v_pk_add_f16 v85, v69, 1.0 op_sel_hi:[1,0]
v_cvt_pk_bf16_f32 v60, v252, v253
v_mfma_f32_32x32x16_bf16 v[134:149], a[88:91], a[208:211], v[134:149]
ds_read_b128 a[208:211], v1 offset:16384
ds_read_u16_d16_hi v112, v112
ds_read_u16_d16_hi v113, v113
ds_read_u16_d16_hi v114, v114
v_accvgpr_write_b32 a92, v58
v_rcp_f16_sdwa v62, v78 dst_sel:WORD_1 dst_unused:UNUSED_PRESERVE src0_sel:WORD_1
v_cvt_pk_bf16_f32 v61, v254, v255
v_rcp_f16 v65, v81
v_accvgpr_write_b32 a93, v59
v_rcp_f16_sdwa v63, v79 dst_sel:WORD_1 dst_unused:UNUSED_PRESERVE src0_sel:WORD_1
v_accvgpr_write_b32 a94, v60
v_rcp_f16 v66, v82
v_accvgpr_write_b32 a95, v61
v_rcp_f16_sdwa v64, v80 dst_sel:WORD_1 dst_unused:UNUSED_PRESERVE src0_sel:WORD_1
v_rcp_f16 v67, v83
v_mfma_f32_32x32x16_bf16 v[134:149], a[92:95], a[212:215], v[134:149]
ds_read_b128 a[212:215], v1 offset:17408
ds_read_u16_d16_hi v115, v115
ds_read_u16_d16_hi v116, v116
v_rcp_f16_sdwa v65, v81 dst_sel:WORD_1 dst_unused:UNUSED_PRESERVE src0_sel:WORD_1
v_rcp_f16 v68, v84
v_rcp_f16_sdwa v66, v82 dst_sel:WORD_1 dst_unused:UNUSED_PRESERVE src0_sel:WORD_1
v_mfma_f32_32x32x16_bf16 v[118:133], a[48:51], a[216:219], 0
ds_read_u16_d16_hi v117, v117
v_rcp_f16 v69, v85
v_rcp_f16_sdwa v67, v83 dst_sel:WORD_1 dst_unused:UNUSED_PRESERVE src0_sel:WORD_1
v_rcp_f16_sdwa v68, v84 dst_sel:WORD_1 dst_unused:UNUSED_PRESERVE src0_sel:WORD_1
v_rcp_f16_sdwa v69, v85 dst_sel:WORD_1 dst_unused:UNUSED_PRESERVE src0_sel:WORD_1
v_mfma_f32_32x32x16_bf16 v[118:133], a[52:55], a[220:223], v[118:133]
v_mul_f32 v150, s60, v146
v_mul_f32 v151, s60, v147
v_mul_f32 v152, s60, v148
v_mul_f32 v153, s60, v149
v_mad_u32_u16 v150, v150, 2, s85 op_sel:[1,0,0,0]
v_mad_u32_u16 v151, v151, 2, s85 op_sel:[1,0,0,0]
v_mad_u32_u16 v152, v152, 2, s85 op_sel:[1,0,0,0]
v_mad_u32_u16 v153, v153, 2, s85 op_sel:[1,0,0,0]
v_mfma_f32_32x32x16_bf16 v[118:133], a[56:59], a[224:227], v[118:133]
ds_read_u16_d16_hi v150, v150
ds_read_u16_d16_hi v151, v151
ds_read_u16_d16_hi v152, v152
ds_read_u16_d16_hi v153, v153
v_cvt_pk_f16_f32 v86, v134, v135
v_cvt_pk_f16_f32 v87, v136, v137
v_pk_mul_f16 v94, v94, v62
v_mfma_f32_32x32x16_bf16 v[118:133], a[60:63], a[228:231], v[118:133]
v_pk_fma_f16 v70, v86, v86, s84
v_cvt_pk_f16_f32 v88, v138, v139
v_pk_mul_f16 v95, v95, v63
v_pk_fma_f16 v71, v87, v87, s84
v_pk_mul_f16 v70, v86, v70
v_pk_mul_f16 v96, v96, v64
v_cvt_pk_f16_f32 v89, v140, v141
v_mfma_f32_32x32x16_bf16 v[118:133], a[64:67], a[232:235], v[118:133]
v_pk_fma_f16 v72, v88, v88, s84
v_pk_mul_f16 v71, v87, v71
v_pk_mul_f16 v97, v97, v65
v_cvt_pk_f16_f32 v90, v142, v143
v_exp_f16 v62, v70
v_pk_fma_f16 v73, v89, v89, s84
v_pk_mul_f16 v98, v98, v66
s_waitcnt lgkmcnt(2)
v_pk_add_f32 v[22:23], v[22:23], v[116:117]
v_pk_add_f32 v[22:23], v[22:23], v[114:115]
v_pk_add_f32 v[22:23], v[22:23], v[112:113]
v_pk_add_f32 v[22:23], v[22:23], v[110:111]
v_pk_add_f32 v[22:23], v[22:23], v[108:109]
v_exp_f16 v63, v71
v_pk_add_f32 v[22:23], v[22:23], v[106:107]
v_pk_add_f32 v[22:23], v[22:23], v[104:105]
v_pk_add_f32 v[22:23], v[22:23], v[102:103]
v_mfma_f32_32x32x16_f16 v[102:117], v[94:97], a[240:243], 0
buffer_store_dwordx4 v[94:97], v1, s[12:15], s101 offen offset:0 sc1
v_pk_mul_f16 v72, v88, v72
v_cvt_pk_f16_f32 v91, v144, v145
v_mfma_f32_32x32x16_bf16 v[118:133], a[68:71], a[236:239], v[118:133]
v_pk_mul_f16 v99, v99, v67
v_pk_fma_f16 v74, v90, v90, s84
v_pk_mul_f16 v73, v89, v73
v_pk_mul_f16 v100, v100, v68
v_exp_f16 v64, v72
v_pk_fma_f16 v75, v91, v91, s84
v_pk_mul_f16 v74, v90, v74
v_mfma_f32_32x32x16_bf16 v[134:149], a[72:75], a[216:219], 0
ds_read_b128 a[216:219], v1 offset:18432
v_pk_mul_f16 v75, v91, v75
v_pk_mul_f16 v101, v101, v69
v_exp_f16_sdwa v62, v70 dst_sel:WORD_1 dst_unused:UNUSED_PRESERVE src0_sel:WORD_1
v_mad_u32_u16 v118, v118, 2, s85 op_sel:[1,0,0,0]
v_mad_u32_u16 v119, v119, 2, s85 op_sel:[1,0,0,0]
v_mad_u32_u16 v120, v120, 2, s85 op_sel:[1,0,0,0]
v_mfma_f32_32x32x16_f16 v[102:117], v[98:101], a[244:247], v[102:117]
ds_read_u16_d16_hi v118, v118
ds_read_u16_d16_hi v119, v119
ds_read_u16_d16_hi v120, v120
v_mad_u32_u16 v121, v121, 2, s85 op_sel:[1,0,0,0]
v_exp_f16 v65, v73
v_mad_u32_u16 v122, v122, 2, s85 op_sel:[1,0,0,0]
v_mad_u32_u16 v123, v123, 2, s85 op_sel:[1,0,0,0]
v_mfma_f32_32x32x16_bf16 v[134:149], a[76:79], a[220:223], v[134:149]
ds_read_b128 a[220:223], v1 offset:19456
ds_read_u16_d16_hi v121, v121
ds_read_u16_d16_hi v122, v122
ds_read_u16_d16_hi v123, v123
v_mad_u32_u16 v124, v124, 2, s85 op_sel:[1,0,0,0]
v_mad_u32_u16 v125, v125, 2, s85 op_sel:[1,0,0,0]
v_mad_u32_u16 v126, v126, 2, s85 op_sel:[1,0,0,0]
v_pk_fma_f32 v[44:45], v[102:103], v[102:103], v[44:45]
v_pk_fma_f32 v[44:45], v[104:105], v[104:105], v[44:45]
v_pk_fma_f32 v[44:45], v[106:107], v[106:107], v[44:45]
v_pk_fma_f32 v[44:45], v[108:109], v[108:109], v[44:45]
v_pk_fma_f32 v[44:45], v[110:111], v[110:111], v[44:45]
v_pk_fma_f32 v[44:45], v[112:113], v[112:113], v[44:45]
v_pk_fma_f32 v[44:45], v[114:115], v[114:115], v[44:45]
v_pk_fma_f32 v[44:45], v[116:117], v[116:117], v[44:45]
v_mfma_f32_32x32x16_bf16 v[134:149], a[80:83], a[224:227], v[134:149]
ds_read_b128 a[224:227], v1 offset:20480
ds_read_u16_d16_hi v124, v124
ds_read_u16_d16_hi v125, v125
ds_read_u16_d16_hi v126, v126
v_mad_u32_u16 v127, v127, 2, s85 op_sel:[1,0,0,0]
v_mad_u32_u16 v128, v128, 2, s85 op_sel:[1,0,0,0]
v_pk_add_f16 v70, v62, 1.0 op_sel_hi:[1,0]
v_mfma_f32_32x32x16_bf16 v[134:149], a[84:87], a[228:231], v[134:149]
ds_read_b128 a[228:231], v1 offset:21504
ds_read_u16_d16_hi v127, v127
buffer_store_dwordx4 v[98:101], v1, s[12:15], s101 offen offset:1024 sc1
ds_read_u16_d16_hi v128, v128
v_mfma_f32_32x32x16_bf16 v[134:149], a[88:91], a[232:235], v[134:149]
ds_read_b128 a[232:235], v1 offset:22528
v_mad_u32_u16 v129, v129, 2, s85 op_sel:[1,0,0,0]
v_exp_f16_sdwa v63, v71 dst_sel:WORD_1 dst_unused:UNUSED_PRESERVE src0_sel:WORD_1
v_exp_f16 v66, v74
v_pk_add_f16 v71, v63, 1.0 op_sel_hi:[1,0]
v_mad_u32_u16 v130, v130, 2, s85 op_sel:[1,0,0,0]
v_mfma_f32_32x32x16_bf16 v[134:149], a[92:95], a[236:239], v[134:149]
ds_read_b128 a[236:239], v1 offset:23552
ds_read_u16_d16_hi v129, v129
v_exp_f16_sdwa v64, v72 dst_sel:WORD_1 dst_unused:UNUSED_PRESERVE src0_sel:WORD_1
v_exp_f16 v67, v75
v_pk_add_f16 v72, v64, 1.0 op_sel_hi:[1,0]
v_mad_u32_u16 v131, v131, 2, s85 op_sel:[1,0,0,0]
v_mfma_f32_32x32x16_bf16 v[102:117], a[48:51], a[192:195], 0
ds_read_u16_d16_hi v130, v130
v_exp_f16_sdwa v65, v73 dst_sel:WORD_1 dst_unused:UNUSED_PRESERVE src0_sel:WORD_1
v_exp_f16_sdwa v66, v74 dst_sel:WORD_1 dst_unused:UNUSED_PRESERVE src0_sel:WORD_1
v_pk_add_f16 v73, v65, 1.0 op_sel_hi:[1,0]
v_mad_u32_u16 v132, v132, 2, s85 op_sel:[1,0,0,0]
v_pk_add_f16 v74, v66, 1.0 op_sel_hi:[1,0]
v_mfma_f32_32x32x16_bf16 v[102:117], a[52:55], a[196:199], v[102:117]
ds_read_u16_d16_hi v131, v131
ds_read_u16_d16_hi v132, v132
v_mad_u32_u16 v133, v133, 2, s85 op_sel:[1,0,0,0]
v_exp_f16_sdwa v67, v75 dst_sel:WORD_1 dst_unused:UNUSED_PRESERVE src0_sel:WORD_1
v_rcp_f16 v62, v70
v_pk_add_f16 v75, v67, 1.0 op_sel_hi:[1,0]
v_mfma_f32_32x32x16_bf16 v[102:117], a[56:59], a[200:203], v[102:117]
ds_read_u16_d16_hi v133, v133
s_add_u32 s101, s3, 28672
v_add_f32 v22, v22, v150
v_add_f32 v23, v23, v151
s_waitcnt lgkmcnt(9)
v_add_f32 v22, v22, v152
v_add_f32 v23, v23, v153
v_mul_f32 v150, s60, v146
v_mfma_f32_32x32x16_bf16 v[102:117], a[60:63], a[204:207], v[102:117]
v_mul_f32 v151, s60, v147
v_mul_f32 v152, s60, v148
v_mul_f32 v153, s60, v149
v_mad_u32_u16 v150, v150, 2, s85 op_sel:[1,0,0,0]
v_mad_u32_u16 v151, v151, 2, s85 op_sel:[1,0,0,0]
v_mad_u32_u16 v152, v152, 2, s85 op_sel:[1,0,0,0]
v_mad_u32_u16 v153, v153, 2, s85 op_sel:[1,0,0,0]
v_cvt_pk_f16_f32 v94, v134, v135
v_mfma_f32_32x32x16_bf16 v[102:117], a[64:67], a[208:211], v[102:117]
ds_read_u16_d16_hi v150, v150
ds_read_u16_d16_hi v151, v151
ds_read_u16_d16_hi v152, v152
v_cvt_pk_f16_f32 v95, v136, v137
v_rcp_f16 v63, v71
v_pk_fma_f16 v78, v94, v94, s84
v_rcp_f16 v64, v72
v_mfma_f32_32x32x16_bf16 v[102:117], a[68:71], a[212:215], v[102:117]
ds_read_u16_d16_hi v153, v153
v_rcp_f16_sdwa v62, v70 dst_sel:WORD_1 dst_unused:UNUSED_PRESERVE src0_sel:WORD_1
v_rcp_f16 v65, v73
v_pk_mul_f16 v86, v86, v62
v_cvt_pk_f16_f32 v96, v138, v139
v_pk_fma_f16 v79, v95, v95, s84
v_pk_mul_f16 v78, v94, v78
v_rcp_f16_sdwa v63, v71 dst_sel:WORD_1 dst_unused:UNUSED_PRESERVE src0_sel:WORD_1
v_rcp_f16 v66, v74
v_pk_mul_f16 v87, v87, v63
v_cvt_pk_f16_f32 v97, v140, v141
v_pk_fma_f16 v80, v96, v96, s84
v_pk_mul_f16 v79, v95, v79
v_rcp_f16_sdwa v64, v72 dst_sel:WORD_1 dst_unused:UNUSED_PRESERVE src0_sel:WORD_1
v_rcp_f16 v67, v75
v_pk_mul_f16 v88, v88, v64
v_cvt_pk_f16_f32 v98, v142, v143
v_pk_fma_f16 v81, v97, v97, s84
v_rcp_f16_sdwa v65, v73 dst_sel:WORD_1 dst_unused:UNUSED_PRESERVE src0_sel:WORD_1
v_pk_mul_f16 v80, v96, v80
v_pk_mul_f16 v89, v89, v65
v_cvt_pk_f16_f32 v99, v144, v145
v_mfma_f32_32x32x16_bf16 v[134:149], a[192:195], a[72:75], 0
ds_read_b128 a[192:195], v1 offset:24576
v_pk_fma_f16 v82, v98, v98, s84
v_pk_mul_f16 v81, v97, v81
v_rcp_f16_sdwa v66, v74 dst_sel:WORD_1 dst_unused:UNUSED_PRESERVE src0_sel:WORD_1
v_rcp_f16_sdwa v67, v75 dst_sel:WORD_1 dst_unused:UNUSED_PRESERVE src0_sel:WORD_1
v_pk_mul_f16 v90, v90, v66
v_mfma_f32_32x32x16_bf16 v[134:149], a[196:199], a[76:79], v[134:149]
ds_read_b128 a[196:199], v1 offset:25600
v_pk_fma_f16 v83, v99, v99, s84
v_pk_mul_f16 v82, v98, v82
v_pk_mul_f16 v83, v99, v83
v_exp_f16 v62, v78
v_pk_mul_f16 v91, v91, v67
v_mad_u32_u16 v102, v102, 2, s85 op_sel:[1,0,0,0]
s_waitcnt lgkmcnt(4)
v_pk_add_f32 v[24:25], v[24:25], v[132:133]
v_pk_add_f32 v[24:25], v[24:25], v[130:131]
v_pk_add_f32 v[24:25], v[24:25], v[128:129]
v_pk_add_f32 v[24:25], v[24:25], v[126:127]
v_pk_add_f32 v[24:25], v[24:25], v[124:125]
v_exp_f16 v63, v79
v_pk_add_f32 v[24:25], v[24:25], v[122:123]
v_pk_add_f32 v[24:25], v[24:25], v[120:121]
v_pk_add_f32 v[24:25], v[24:25], v[118:119]
v_dot2c_f32_f16 v23, v91, v91
v_dot2c_f32_f16 v22, v90, v90
v_dot2c_f32_f16 v23, v89, v89
v_dot2c_f32_f16 v22, v88, v88
v_dot2c_f32_f16 v23, v87, v87
v_dot2c_f32_f16 v22, v86, v86
v_mfma_f32_32x32x16_bf16 v[134:149], a[200:203], a[80:83], v[134:149]
ds_read_b128 a[200:203], v1 offset:26624
ds_read_u16_d16_hi v102, v102
v_mad_u32_u16 v103, v103, 2, s85 op_sel:[1,0,0,0]
v_mad_u32_u16 v104, v104, 2, s85 op_sel:[1,0,0,0]
v_mad_u32_u16 v105, v105, 2, s85 op_sel:[1,0,0,0]
v_exp_f16 v64, v80
v_mad_u32_u16 v106, v106, 2, s85 op_sel:[1,0,0,0]
v_mfma_f32_32x32x16_bf16 v[134:149], a[204:207], a[84:87], v[134:149]
ds_read_b128 a[204:207], v1 offset:27648
ds_read_u16_d16_hi v103, v103
ds_read_u16_d16_hi v104, v104
ds_read_u16_d16_hi v105, v105
v_mad_u32_u16 v107, v107, 2, s85 op_sel:[1,0,0,0]
v_exp_f16_sdwa v62, v78 dst_sel:WORD_1 dst_unused:UNUSED_PRESERVE src0_sel:WORD_1
v_mad_u32_u16 v108, v108, 2, s85 op_sel:[1,0,0,0]
v_mfma_f32_32x32x16_bf16 v[134:149], a[208:211], a[88:91], v[134:149]
ds_read_b128 a[208:211], v1 offset:28672
ds_read_u16_d16_hi v106, v106
ds_read_u16_d16_hi v107, v107
ds_read_u16_d16_hi v108, v108
v_mad_u32_u16 v109, v109, 2, s85 op_sel:[1,0,0,0]
v_exp_f16 v65, v81
v_mad_u32_u16 v110, v110, 2, s85 op_sel:[1,0,0,0]
v_mfma_f32_32x32x16_bf16 v[134:149], a[212:215], a[92:95], v[134:149]
ds_read_b128 a[212:215], v1 offset:29696
ds_read_u16_d16_hi v109, v109
ds_read_u16_d16_hi v110, v110
v_mad_u32_u16 v111, v111, 2, s85 op_sel:[1,0,0,0]
v_mad_u32_u16 v112, v112, 2, s85 op_sel:[1,0,0,0]
v_pk_add_f16 v78, v62, 1.0 op_sel_hi:[1,0]
v_mad_u32_u16 v113, v113, 2, s85 op_sel:[1,0,0,0]
v_mfma_f32_32x32x16_bf16 v[118:133], a[48:51], a[216:219], 0
ds_read_u16_d16_hi v111, v111
v_exp_f16_sdwa v63, v79 dst_sel:WORD_1 dst_unused:UNUSED_PRESERVE src0_sel:WORD_1
ds_read_b32 v156, v155
v_pk_add_f16 v79, v63, 1.0 op_sel_hi:[1,0]
v_mad_u32_u16 v114, v114, 2, s85 op_sel:[1,0,0,0]
v_mfma_f32_32x32x16_bf16 v[118:133], a[52:55], a[220:223], v[118:133]
v_exp_f16 v66, v82
v_exp_f16_sdwa v64, v80 dst_sel:WORD_1 dst_unused:UNUSED_PRESERVE src0_sel:WORD_1
v_exp_f16 v67, v83
v_pk_add_f16 v80, v64, 1.0 op_sel_hi:[1,0]
v_mad_u32_u16 v115, v115, 2, s85 op_sel:[1,0,0,0]
v_mfma_f32_32x32x16_bf16 v[118:133], a[56:59], a[224:227], v[118:133]
ds_read_u16_d16_hi v112, v112
ds_read_u16_d16_hi v113, v113
v_exp_f16_sdwa v65, v81 dst_sel:WORD_1 dst_unused:UNUSED_PRESERVE src0_sel:WORD_1
v_exp_f16_sdwa v66, v82 dst_sel:WORD_1 dst_unused:UNUSED_PRESERVE src0_sel:WORD_1
v_pk_add_f16 v81, v65, 1.0 op_sel_hi:[1,0]
v_mad_u32_u16 v116, v116, 2, s85 op_sel:[1,0,0,0]
v_mfma_f32_32x32x16_bf16 v[118:133], a[60:63], a[228:231], v[118:133]
ds_read_u16_d16_hi v114, v114
ds_read_u16_d16_hi v115, v115
v_pk_add_f16 v82, v66, 1.0 op_sel_hi:[1,0]
v_mad_u32_u16 v117, v117, 2, s85 op_sel:[1,0,0,0]
v_exp_f16_sdwa v67, v83 dst_sel:WORD_1 dst_unused:UNUSED_PRESERVE src0_sel:WORD_1
v_rcp_f16 v62, v78
v_mfma_f32_32x32x16_bf16 v[118:133], a[64:67], a[232:235], v[118:133]
ds_read_u16_d16_hi v116, v116
v_pk_add_f16 v83, v67, 1.0 op_sel_hi:[1,0]
v_add_f32 v24, v24, v150
v_add_f32 v25, v25, v151
s_waitcnt lgkmcnt(9)
v_add_f32 v24, v24, v152
v_add_f32 v25, v25, v153
v_cvt_pk_f16_f32 v86, v134, v135
v_mfma_f32_32x32x16_bf16 v[118:133], a[68:71], a[236:239], v[118:133]
ds_read_u16_d16_hi v117, v117
v_cvt_pk_f16_f32 v87, v136, v137
v_pk_fma_f16 v70, v86, v86, s84
v_cvt_pk_f16_f32 v88, v138, v139
v_pk_fma_f16 v71, v87, v87, s84
v_pk_mul_f16 v70, v86, v70
v_cvt_pk_f16_f32 v89, v140, v141
v_rcp_f16 v63, v79
v_pk_fma_f16 v72, v88, v88, s84
v_pk_mul_f16 v71, v87, v71
v_cvt_pk_f16_f32 v90, v142, v143
v_rcp_f16 v64, v80
v_rcp_f16_sdwa v62, v78 dst_sel:WORD_1 dst_unused:UNUSED_PRESERVE src0_sel:WORD_1
v_rcp_f16 v65, v81
v_pk_mul_f16 v94, v94, v62
v_pk_fma_f16 v73, v89, v89, s84
v_pk_mul_f16 v72, v88, v72
v_cvt_pk_f16_f32 v91, v144, v145
v_rcp_f16_sdwa v63, v79 dst_sel:WORD_1 dst_unused:UNUSED_PRESERVE src0_sel:WORD_1
v_rcp_f16 v66, v82
v_pk_mul_f16 v95, v95, v63
v_pk_fma_f16 v74, v90, v90, s84
v_pk_mul_f16 v73, v89, v73
v_cvt_pk_f16_f32 v92, v146, v147
v_rcp_f16_sdwa v64, v80 dst_sel:WORD_1 dst_unused:UNUSED_PRESERVE src0_sel:WORD_1
s_waitcnt lgkmcnt(4)
v_cmp_gt_u32 vcc, 6, v156
v_pk_mul_f16 v96, v96, v64
v_pk_fma_f16 v75, v91, v91, s84
s_cbranch_vccnz L_spin6
L_ok6:
v_mov_b32 v156, 7
v_pk_mul_f16 v74, v90, v74
v_rcp_f16 v67, v83
v_rcp_f16_sdwa v65, v81 dst_sel:WORD_1 dst_unused:UNUSED_PRESERVE src0_sel:WORD_1
v_rcp_f16_sdwa v66, v82 dst_sel:WORD_1 dst_unused:UNUSED_PRESERVE src0_sel:WORD_1
v_pk_mul_f16 v97, v97, v65
v_cvt_pk_f16_f32 v93, v148, v149
v_mfma_f32_32x32x16_bf16 v[134:149], a[72:75], a[216:219], 0
ds_read_b128 a[216:219], v1 offset:30720
ds_read_b128 a[156:159], v6 offset:0
ds_read_b128 a[160:163], v7 offset:0
ds_read_b128 a[144:147], v5 offset:0
v_pk_fma_f16 v76, v92, v92, s84
v_rcp_f16_sdwa v67, v83 dst_sel:WORD_1 dst_unused:UNUSED_PRESERVE src0_sel:WORD_1
v_pk_mul_f16 v75, v91, v75
v_mfma_f32_32x32x16_bf16 v[134:149], a[76:79], a[220:223], v[134:149]
ds_read_b128 a[220:223], v1 offset:31744
ds_read_b128 a[164:167], v6 offset:2176
ds_read_b128 a[168:171], v7 offset:2176
ds_read_b128 a[148:151], v5 offset:1536
v_pk_mul_f16 v98, v98, v66
v_exp_f16 v62, v70
v_pk_fma_f16 v77, v93, v93, s84
v_mfma_f32_32x32x16_bf16 v[134:149], a[80:83], a[224:227], v[134:149]
ds_read_b128 a[224:227], v1 offset:32768
ds_read_b128 a[172:175], v6 offset:4352
ds_read_b128 a[176:179], v7 offset:4352
s_add_u32 m0, s70, 121856
v_pk_mul_f16 v76, v92, v76
v_pk_mul_f16 v77, v93, v77
v_exp_f16 v63, v71
s_waitcnt lgkmcnt(8)
v_pk_add_f32 v[26:27], v[26:27], v[116:117]
v_pk_add_f32 v[26:27], v[26:27], v[114:115]
v_pk_add_f32 v[26:27], v[26:27], v[112:113]
v_exp_f16 v64, v72
v_pk_add_f32 v[26:27], v[26:27], v[110:111]
v_pk_add_f32 v[26:27], v[26:27], v[108:109]
v_pk_add_f32 v[26:27], v[26:27], v[106:107]
v_exp_f16_sdwa v62, v70 dst_sel:WORD_1 dst_unused:UNUSED_PRESERVE src0_sel:WORD_1
v_pk_add_f32 v[26:27], v[26:27], v[104:105]
v_pk_add_f32 v[26:27], v[26:27], v[102:103]
v_mfma_f32_32x32x16_bf16 v[134:149], a[84:87], a[228:231], v[134:149]
ds_read_b128 a[228:231], v1 offset:33792
ds_read_b128 a[152:155], v5 offset:3072
buffer_load_dwordx4 v12, s[4:7], s90 offen  lds
v_pk_mul_f16 v99, v99, v67
v_mad_u32_u16 v118, v118, 2, s85 op_sel:[1,0,0,0]
v_mad_u32_u16 v119, v119, 2, s85 op_sel:[1,0,0,0]
v_dot2c_f32_f16 v25, v99, v99
v_dot2c_f32_f16 v24, v98, v98
v_dot2c_f32_f16 v25, v97, v97
v_dot2c_f32_f16 v24, v96, v96
v_dot2c_f32_f16 v25, v95, v95
v_dot2c_f32_f16 v24, v94, v94
s_waitcnt lgkmcnt(2)
v_smfmac_f32_32x32x32_bf16 v[160:175], a[144:147], a[156:163], v4
ds_read_b128 a[156:159], v6 offset:6528
v_mad_u32_u16 v120, v120, 2, s85 op_sel:[1,0,0,0]
v_mad_u32_u16 v121, v121, 2, s85 op_sel:[1,0,0,0]
v_mad_u32_u16 v122, v122, 2, s85 op_sel:[1,0,0,0]
v_mad_u32_u16 v123, v123, 2, s85 op_sel:[1,0,0,0]
v_mad_u32_u16 v124, v124, 2, s85 op_sel:[1,0,0,0]
v_exp_f16 v65, v73
v_mfma_f32_32x32x16_bf16 v[134:149], a[88:91], a[232:235], v[134:149]
ds_read_b128 a[232:235], v1 offset:34816
ds_read_b128 a[160:163], v7 offset:6528
ds_read_u16_d16_hi v118, v118
ds_read_u16_d16_hi v119, v119
v_mad_u32_u16 v125, v125, 2, s85 op_sel:[1,0,0,0]
v_mad_u32_u16 v126, v126, 2, s85 op_sel:[1,0,0,0]
v_exp_f16_sdwa v63, v71 dst_sel:WORD_1 dst_unused:UNUSED_PRESERVE src0_sel:WORD_1
v_smfmac_f32_32x32x32_bf16 v[160:175], a[148:151], a[164:171], v4
ds_read_u16_d16_hi v120, v120
v_mad_u32_u16 v127, v127, 2, s85 op_sel:[1,0,0,0]
v_pk_add_f16 v70, v62, 1.0 op_sel_hi:[1,0]
v_mad_u32_u16 v128, v128, 2, s85 op_sel:[1,0,0,0]
v_pk_add_f16 v71, v63, 1.0 op_sel_hi:[1,0]
v_mad_u32_u16 v129, v129, 2, s85 op_sel:[1,0,0,0]
v_exp_f16 v66, v74
v_mfma_f32_32x32x16_bf16 v[134:149], a[92:95], a[236:239], v[134:149]
ds_read_b128 a[236:239], v1 offset:35840
s_add_u32 m0, s71, 121856
ds_read_u16_d16_hi v121, v121
buffer_load_dwordx4 v13, s[4:7], s90 offen  lds
ds_read_u16_d16_hi v122, v122
v_exp_f16_sdwa v64, v72 dst_sel:WORD_1 dst_unused:UNUSED_PRESERVE src0_sel:WORD_1
v_smfmac_f32_32x32x32_bf16 v[208:223], a[144:147], a[164:171], v4
ds_read_b128 a[164:167], v8 offset:0
v_pk_add_f16 v72, v64, 1.0 op_sel_hi:[1,0]
v_mad_u32_u16 v130, v130, 2, s85 op_sel:[1,0,0,0]
v_exp_f16 v67, v75
v_exp_f16_sdwa v65, v73 dst_sel:WORD_1 dst_unused:UNUSED_PRESERVE src0_sel:WORD_1
v_mfma_f32_32x32x16_bf16 v[102:117], a[48:51], a[192:195], 0
ds_read_b128 a[168:171], v9 offset:0
ds_read_b128 a[144:147], v5 offset:512
ds_read_u16_d16_hi v123, v123
ds_read_u16_d16_hi v124, v124
v_pk_add_f16 v73, v65, 1.0 op_sel_hi:[1,0]
v_exp_f16 v68, v76
v_exp_f16_sdwa v66, v74 dst_sel:WORD_1 dst_unused:UNUSED_PRESERVE src0_sel:WORD_1
s_waitcnt lgkmcnt(7)
v_smfmac_f32_32x32x32_bf16 v[160:175], a[152:155], a[172:179], v4
ds_read_u16_d16_hi v125, v125
v_pk_add_f16 v74, v66, 1.0 op_sel_hi:[1,0]
v_mad_u32_u16 v131, v131, 2, s85 op_sel:[1,0,0,0]
v_exp_f16 v69, v77
v_exp_f16_sdwa v67, v75 dst_sel:WORD_1 dst_unused:UNUSED_PRESERVE src0_sel:WORD_1
v_mfma_f32_32x32x16_bf16 v[102:117], a[52:55], a[196:199], v[102:117]
ds_read_u16_d16_hi v126, v126
s_add_u32 m0, s72, 121856
ds_read_u16_d16_hi v127, v127
buffer_load_dwordx4 v14, s[4:7], s90 offen  lds
ds_read_u16_d16_hi v128, v128
v_pk_add_f16 v75, v67, 1.0 op_sel_hi:[1,0]
v_smfmac_f32_32x32x32_bf16 v[208:223], a[148:151], a[172:179], v4
ds_read_b128 a[172:175], v8 offset:2176
v_mad_u32_u16 v132, v132, 2, s85 op_sel:[1,0,0,0]
v_exp_f16_sdwa v68, v76 dst_sel:WORD_1 dst_unused:UNUSED_PRESERVE src0_sel:WORD_1
v_exp_f16_sdwa v69, v77 dst_sel:WORD_1 dst_unused:UNUSED_PRESERVE src0_sel:WORD_1
v_pk_add_f16 v76, v68, 1.0 op_sel_hi:[1,0]
v_mfma_f32_32x32x16_bf16 v[102:117], a[56:59], a[200:203], v[102:117]
ds_read_b128 a[176:179], v9 offset:2176
ds_read_b128 a[148:151], v5 offset:2048
ds_read_u16_d16_hi v129, v129
ds_read_u16_d16_hi v130, v130
v_rcp_f16 v62, v70
v_mad_u32_u16 v133, v133, 2, s85 op_sel:[1,0,0,0]
v_pk_add_f16 v77, v69, 1.0 op_sel_hi:[1,0]
v_smfmac_f32_32x32x32_bf16 v[208:223], a[152:155], a[156:163], v4
ds_read_b128 a[156:159], v8 offset:4352
v_mul_f32 v150, s60, v146
v_mul_f32 v151, s60, v147
v_mul_f32 v152, s60, v148
v_mul_f32 v153, s60, v149
v_mad_u32_u16 v150, v150, 2, s85 op_sel:[1,0,0,0]
v_mad_u32_u16 v151, v151, 2, s85 op_sel:[1,0,0,0]
v_mfma_f32_32x32x16_bf16 v[102:117], a[60:63], a[204:207], v[102:117]
ds_read_b128 a[160:163], v9 offset:4352
ds_read_b128 a[152:155], v5 offset:3584
v_mad_u32_u16 v152, v152, 2, s85 op_sel:[1,0,0,0]
v_mad_u32_u16 v153, v153, 2, s85 op_sel:[1,0,0,0]
v_cvt_pk_f16_f32 v94, v134, v135
v_cvt_pk_f16_f32 v95, v136, v137
v_rcp_f16 v63, v71
s_waitcnt lgkmcnt(9)
v_smfmac_f32_32x32x32_bf16 v[160:175], a[144:147], a[164:171], v4
ds_read_b128 a[164:167], v8 offset:6528
v_rcp_f16 v64, v72
v_rcp_f16_sdwa v62, v70 dst_sel:WORD_1 dst_unused:UNUSED_PRESERVE src0_sel:WORD_1
v_rcp_f16 v65, v73
v_mfma_f32_32x32x16_bf16 v[102:117], a[64:67], a[208:211], v[102:117]
ds_read_b128 a[168:171], v9 offset:6528
s_add_u32 m0, s73, 121856
ds_read_u16_d16_hi v131, v131
buffer_load_dwordx4 v15, s[4:7], s90 offen  lds
v_pk_mul_f16 v86, v86, v62
v_pk_fma_f16 v78, v94, v94, s84
v_mfma_f32_32x32x16_bf16 v[102:117], a[68:71], a[212:215], v[102:117]
ds_read_u16_d16_hi v132, v132
v_cvt_pk_f16_f32 v96, v138, v139
v_rcp_f16_sdwa v63, v71 dst_sel:WORD_1 dst_unused:UNUSED_PRESERVE src0_sel:WORD_1
v_rcp_f16 v66, v74
v_pk_mul_f16 v87, v87, v63
v_pk_fma_f16 v79, v95, v95, s84
v_pk_mul_f16 v78, v94, v78
v_rcp_f16_sdwa v64, v72 dst_sel:WORD_1 dst_unused:UNUSED_PRESERVE src0_sel:WORD_1
s_waitcnt lgkmcnt(7)
v_smfmac_f32_32x32x32_bf16 v[160:175], a[148:151], a[172:179], v4
ds_read_u16_d16_hi v133, v133
v_pk_mul_f16 v88, v88, v64
v_cvt_pk_f16_f32 v97, v140, v141
v_pk_fma_f16 v80, v96, v96, s84
v_pk_mul_f16 v79, v95, v79
v_rcp_f16 v67, v75
v_smfmac_f32_32x32x32_bf16 v[208:223], a[144:147], a[172:179], v4
ds_read_b128 a[172:175], v10 offset:0
v_rcp_f16_sdwa v65, v73 dst_sel:WORD_1 dst_unused:UNUSED_PRESERVE src0_sel:WORD_1
v_rcp_f16 v68, v76
v_pk_mul_f16 v89, v89, v65
v_cvt_pk_f16_f32 v98, v142, v143
v_pk_fma_f16 v81, v97, v97, s84
v_rcp_f16_sdwa v66, v74 dst_sel:WORD_1 dst_unused:UNUSED_PRESERVE src0_sel:WORD_1
v_rcp_f16 v69, v77
s_waitcnt lgkmcnt(4)
v_smfmac_f32_32x32x32_bf16 v[160:175], a[152:155], a[156:163], v4
ds_read_b128 a[176:179], v11 offset:0
v_pk_mul_f16 v90, v90, v66
v_pk_mul_f16 v80, v96, v80
v_rcp_f16_sdwa v67, v75 dst_sel:WORD_1 dst_unused:UNUSED_PRESERVE src0_sel:WORD_1
v_cvt_pk_f16_f32 v99, v144, v145
v_pk_mul_f16 v91, v91, v67
v_mfma_f32_32x32x16_bf16 v[134:149], a[72:75], a[192:195], 0
ds_read_b128 a[192:195], v1 offset:36864
ds_read_b128 a[144:147], v5 offset:1024
s_add_u32 m0, s74, 121856
ds_read_u16_d16_hi v150, v150
buffer_load_dwordx4 v16, s[4:7], s90 offen  lds
v_pk_fma_f16 v82, v98, v98, s84
v_smfmac_f32_32x32x32_bf16 v[208:223], a[148:151], a[156:163], v4
ds_read_b128 a[156:159], v10 offset:2176
v_pk_mul_f16 v81, v97, v81
v_rcp_f16_sdwa v68, v76 dst_sel:WORD_1 dst_unused:UNUSED_PRESERVE src0_sel:WORD_1
v_rcp_f16_sdwa v69, v77 dst_sel:WORD_1 dst_unused:UNUSED_PRESERVE src0_sel:WORD_1
v_pk_mul_f16 v92, v92, v68
s_waitcnt lgkmcnt(3)
v_pk_add_f32 v[28:29], v[28:29], v[132:133]
v_pk_add_f32 v[28:29], v[28:29], v[130:131]
v_pk_add_f32 v[28:29], v[28:29], v[128:129]
v_pk_add_f32 v[28:29], v[28:29], v[126:127]
v_exp_f16 v62, v78
v_pk_add_f32 v[28:29], v[28:29], v[124:125]
v_pk_add_f32 v[28:29], v[28:29], v[122:123]
v_pk_add_f32 v[28:29], v[28:29], v[120:121]
v_exp_f16 v63, v79
v_pk_add_f32 v[28:29], v[28:29], v[118:119]
v_mfma_f32_32x32x16_f16 v[118:133], v[86:89], a[240:243], 0
ds_read_b128 a[160:163], v11 offset:2176
ds_read_b128 a[148:151], v5 offset:2560
ds_read_u16_d16_hi v151, v151
ds_read_u16_d16_hi v152, v152
v_pk_fma_f16 v83, v99, v99, s84
v_pk_mul_f16 v82, v98, v82
v_exp_f16 v64, v80
v_mfma_f32_32x32x16_bf16 v[134:149], a[76:79], a[196:199], v[134:149]
ds_read_b128 a[196:199], v1 offset:37888
ds_read_u16_d16_hi v153, v153
s_add_u32 m0, s75, 121856
buffer_store_dwordx4 v[86:89], v1, s[12:15], s101 offen offset:0 sc1
v_smfmac_f32_32x32x32_bf16 v[208:223], a[152:155], a[164:171], v4
ds_read_b128 a[164:167], v10 offset:4352
v_pk_mul_f16 v83, v99, v83
v_pk_mul_f16 v93, v93, v69
v_mad_u32_u16 v102, v102, 2, s85 op_sel:[1,0,0,0]
v_mad_u32_u16 v103, v103, 2, s85 op_sel:[1,0,0,0]
v_exp_f16_sdwa v62, v78 dst_sel:WORD_1 dst_unused:UNUSED_PRESERVE src0_sel:WORD_1
v_mfma_f32_32x32x16_f16 v[118:133], v[90:93], a[244:247], v[118:133]
ds_read_b128 a[168:171], v11 offset:4352
ds_read_b128 a[152:155], v5 offset:4096
ds_read_u16_d16_hi v102, v102
ds_read_u16_d16_hi v103, v103
v_mad_u32_u16 v104, v104, 2, s85 op_sel:[1,0,0,0]
v_mad_u32_u16 v105, v105, 2, s85 op_sel:[1,0,0,0]
v_exp_f16 v65, v81
v_mfma_f32_32x32x16_bf16 v[134:149], a[80:83], a[200:203], v[134:149]
ds_read_b128 a[200:203], v1 offset:38912
ds_read_u16_d16_hi v104, v104
ds_read_u16_d16_hi v105, v105
v_mad_u32_u16 v106, v106, 2, s85 op_sel:[1,0,0,0]
v_mad_u32_u16 v107, v107, 2, s85 op_sel:[1,0,0,0]
v_mad_u32_u16 v108, v108, 2, s85 op_sel:[1,0,0,0]
v_mad_u32_u16 v109, v109, 2, s85 op_sel:[1,0,0,0]
v_mad_u32_u16 v110, v110, 2, s85 op_sel:[1,0,0,0]
v_pk_fma_f32 v[26:27], v[118:119], v[118:119], v[26:27]
v_pk_fma_f32 v[26:27], v[120:121], v[120:121], v[26:27]
v_pk_fma_f32 v[26:27], v[122:123], v[122:123], v[26:27]
v_pk_fma_f32 v[26:27], v[124:125], v[124:125], v[26:27]
v_pk_fma_f32 v[26:27], v[126:127], v[126:127], v[26:27]
v_pk_fma_f32 v[26:27], v[128:129], v[128:129], v[26:27]
v_pk_fma_f32 v[26:27], v[130:131], v[130:131], v[26:27]
v_pk_fma_f32 v[26:27], v[132:133], v[132:133], v[26:27]
s_waitcnt lgkmcnt(5)
v_smfmac_f32_32x32x32_bf16 v[160:175], a[144:147], a[172:179], v4
ds_read_b128 a[172:175], v10 offset:6528
v_mad_u32_u16 v111, v111, 2, s85 op_sel:[1,0,0,0]
v_mad_u32_u16 v112, v112, 2, s85 op_sel:[1,0,0,0]
v_pk_add_f16 v78, v62, 1.0 op_sel_hi:[1,0]
v_mad_u32_u16 v113, v113, 2, s85 op_sel:[1,0,0,0]
v_exp_f16_sdwa v63, v79 dst_sel:WORD_1 dst_unused:UNUSED_PRESERVE src0_sel:WORD_1
v_mfma_f32_32x32x16_bf16 v[134:149], a[84:87], a[204:207], v[134:149]
ds_read_b128 a[204:207], v1 offset:39936
ds_read_b128 a[176:179], v11 offset:6528
buffer_load_dwordx4 v17, s[4:7], s90 offen  lds
ds_read_u16_d16_hi v106, v106
v_pk_add_f16 v79, v63, 1.0 op_sel_hi:[1,0]
v_mad_u32_u16 v114, v114, 2, s85 op_sel:[1,0,0,0]
v_smfmac_f32_32x32x32_bf16 v[160:175], a[148:151], a[156:163], v4
ds_read_u16_d16_hi v107, v107
v_exp_f16 v66, v82
v_exp_f16_sdwa v64, v80 dst_sel:WORD_1 dst_unused:UNUSED_PRESERVE src0_sel:WORD_1
v_exp_f16 v67, v83
v_mfma_f32_32x32x16_bf16 v[134:149], a[88:91], a[208:211], v[134:149]
ds_read_b128 a[208:211], v1 offset:40960
ds_read_u16_d16_hi v108, v108
ds_read_u16_d16_hi v109, v109
v_exp_f16_sdwa v65, v81 dst_sel:WORD_1 dst_unused:UNUSED_PRESERVE src0_sel:WORD_1
v_pk_add_f16 v80, v64, 1.0 op_sel_hi:[1,0]
v_mad_u32_u16 v115, v115, 2, s85 op_sel:[1,0,0,0]
v_pk_add_f16 v81, v65, 1.0 op_sel_hi:[1,0]
v_smfmac_f32_32x32x32_bf16 v[208:223], a[144:147], a[156:163], v4
ds_read_u16_d16_hi v110, v110
v_mad_u32_u16 v116, v116, 2, s85 op_sel:[1,0,0,0]
v_exp_f16_sdwa v66, v82 dst_sel:WORD_1 dst_unused:UNUSED_PRESERVE src0_sel:WORD_1
v_exp_f16_sdwa v67, v83 dst_sel:WORD_1 dst_unused:UNUSED_PRESERVE src0_sel:WORD_1
v_pk_add_f16 v82, v66, 1.0 op_sel_hi:[1,0]
v_mfma_f32_32x32x16_bf16 v[134:149], a[92:95], a[212:215], v[134:149]
ds_read_b128 a[212:215], v1 offset:41984
ds_read_u16_d16_hi v111, v111
ds_read_u16_d16_hi v112, v112
ds_read_u16_d16_hi v113, v113
v_mad_u32_u16 v117, v117, 2, s85 op_sel:[1,0,0,0]
v_rcp_f16 v62, v78
s_waitcnt vmcnt(11) lgkmcnt(8)
ds_write_b32 v154, v156
v_smfmac_f32_32x32x32_bf16 v[160:175], a[152:155], a[164:171], v4
ds_read_u16_d16_hi v114, v114
v_pk_add_f16 v83, v67, 1.0 op_sel_hi:[1,0]
v_add_f32 v28, v28, v150
v_add_f32 v29, v29, v151
v_add_f32 v28, v28, v152
v_add_f32 v29, v29, v153
v_mul_f32 v150, s60, v146
v_mfma_f32_32x32x16_bf16 v[118:133], a[48:51], a[216:219], 0
ds_read_u16_d16_hi v115, v115
ds_read_u16_d16_hi v116, v116
buffer_store_dwordx4 v[90:93], v1, s[12:15], s101 offen offset:1024 sc1
ds_read_u16_d16_hi v117, v117
v_pk_mul_f32 v[48:49], v[160:161], v[160:161]
v_pk_fma_f32 v[48:49], v[162:163], v[162:163], v[48:49]
v_pk_add_f32 v[46:47], v[160:161], v[162:163]
v_pk_fma_f32 v[48:49], v[164:165], v[164:165], v[48:49]
v_mul_f32 v151, s60, v147
v_pk_add_f32 v[46:47], v[46:47], v[164:165]
v_pk_fma_f32 v[48:49], v[166:167], v[166:167], v[48:49]
v_pk_add_f32 v[46:47], v[46:47], v[166:167]
v_mul_f32 v152, s60, v148
v_mul_f32 v153, s60, v149
v_pk_fma_f32 v[48:49], v[168:169], v[168:169], v[48:49]
v_pk_add_f32 v[46:47], v[46:47], v[168:169]
v_pk_fma_f32 v[48:49], v[170:171], v[170:171], v[48:49]
v_rcp_f16 v63, v79
v_pk_add_f32 v[46:47], v[46:47], v[170:171]
v_pk_fma_f32 v[48:49], v[172:173], v[172:173], v[48:49]
v_pk_add_f32 v[46:47], v[46:47], v[172:173]
v_pk_fma_f32 v[48:49], v[174:175], v[174:175], v[48:49]
v_rcp_f16 v64, v80
v_pk_add_f32 v[46:47], v[46:47], v[174:175]
v_smfmac_f32_32x32x32_bf16 v[208:223], a[148:151], a[164:171], v4
v_mad_u32_u16 v150, v150, 2, s85 op_sel:[1,0,0,0]
v_mad_u32_u16 v151, v151, 2, s85 op_sel:[1,0,0,0]
v_mad_u32_u16 v152, v152, 2, s85 op_sel:[1,0,0,0]
v_mad_u32_u16 v153, v153, 2, s85 op_sel:[1,0,0,0]
v_cvt_pk_f16_f32 v86, v134, v135
v_rcp_f16_sdwa v62, v78 dst_sel:WORD_1 dst_unused:UNUSED_PRESERVE src0_sel:WORD_1
v_mfma_f32_32x32x16_bf16 v[118:133], a[52:55], a[220:223], v[118:133]
ds_read_u16_d16_hi v150, v150
ds_read_u16_d16_hi v151, v151
ds_read_u16_d16_hi v152, v152
ds_read_u16_d16_hi v153, v153
v_cvt_pk_f16_f32 v87, v136, v137
v_pk_fma_f16 v70, v86, v86, s84
v_rcp_f16 v65, v81
v_smfmac_f32_32x32x32_bf16 v[208:223], a[152:155], a[172:179], v4
s_add_u32 s101, s3, 34816
v_pk_mul_f16 v94, v94, v62
v_cvt_pk_f16_f32 v88, v138, v139
v_pk_fma_f16 v71, v87, v87, s84
v_pk_mul_f16 v70, v86, v70
v_rcp_f16_sdwa v63, v79 dst_sel:WORD_1 dst_unused:UNUSED_PRESERVE src0_sel:WORD_1
v_mfma_f32_32x32x16_bf16 v[118:133], a[56:59], a[224:227], v[118:133]
v_pk_mul_f16 v95, v95, v63
v_cvt_pk_f16_f32 v89, v140, v141
v_pk_fma_f16 v72, v88, v88, s84
v_pk_mul_f16 v71, v87, v71
v_rcp_f16 v66, v82
v_rcp_f16_sdwa v64, v80 dst_sel:WORD_1 dst_unused:UNUSED_PRESERVE src0_sel:WORD_1
v_pk_mul_f32 v[52:53], v[208:209], v[208:209]
v_pk_fma_f32 v[52:53], v[210:211], v[210:211], v[52:53]
v_pk_add_f32 v[50:51], v[208:209], v[210:211]
v_pk_fma_f32 v[52:53], v[212:213], v[212:213], v[52:53]
v_pk_add_f32 v[50:51], v[50:51], v[212:213]
v_pk_fma_f32 v[52:53], v[214:215], v[214:215], v[52:53]
v_rcp_f16 v67, v83
v_pk_add_f32 v[50:51], v[50:51], v[214:215]
v_pk_fma_f32 v[52:53], v[216:217], v[216:217], v[52:53]
v_pk_add_f32 v[50:51], v[50:51], v[216:217]
v_pk_fma_f32 v[52:53], v[218:219], v[218:219], v[52:53]
v_pk_add_f32 v[50:51], v[50:51], v[218:219]
v_pk_fma_f32 v[52:53], v[220:221], v[220:221], v[52:53]
v_pk_add_f32 v[50:51], v[50:51], v[220:221]
v_pk_fma_f32 v[52:53], v[222:223], v[222:223], v[52:53]
v_pk_add_f32 v[50:51], v[50:51], v[222:223]
s_waitcnt lgkmcnt(2)
v_pk_add_f32 v[30:31], v[30:31], v[116:117]
v_pk_add_f32 v[30:31], v[30:31], v[114:115]
v_pk_add_f32 v[30:31], v[30:31], v[112:113]
v_pk_add_f32 v[30:31], v[30:31], v[110:111]
v_pk_add_f32 v[30:31], v[30:31], v[108:109]
v_pk_add_f32 v[30:31], v[30:31], v[106:107]
v_rcp_f16_sdwa v65, v81 dst_sel:WORD_1 dst_unused:UNUSED_PRESERVE src0_sel:WORD_1
v_pk_add_f32 v[30:31], v[30:31], v[104:105]
v_pk_add_f32 v[30:31], v[30:31], v[102:103]
v_mfma_f32_32x32x16_bf16 v[176:191], a[248:251], a[248:251], 0
v_add_u32 v12, 786432, v12
v_pk_mul_f16 v96, v96, v64
v_add_u32 v13, 786432, v13
v_cvt_pk_f16_f32 v90, v142, v143
v_rcp_f16_sdwa v66, v82 dst_sel:WORD_1 dst_unused:UNUSED_PRESERVE src0_sel:WORD_1
v_add_u32 v14, 786432, v14
v_pk_fma_f16 v73, v89, v89, s84
v_mfma_f32_32x32x16_bf16 v[118:133], a[60:63], a[228:231], v[118:133]
v_add_u32 v15, 786432, v15
v_pk_mul_f16 v72, v88, v72
v_add_u32 v16, 786432, v16
v_pk_mul_f16 v97, v97, v65
v_rcp_f16_sdwa v67, v83 dst_sel:WORD_1 dst_unused:UNUSED_PRESERVE src0_sel:WORD_1
v_add_u32 v17, 786432, v17
v_cvt_pk_f16_f32 v91, v144, v145
v_mfma_f32_32x32x16_bf16 v[224:239], a[248:251], a[248:251], 0
v_pk_fma_f16 v74, v90, v90, s84
v_pk_mul_f16 v73, v89, v73
v_pk_mul_f16 v98, v98, v66
v_pk_fma_f16 v75, v91, v91, s84
v_exp_f16 v62, v70
v_pk_mul_f16 v74, v90, v74
v_pk_mul_f16 v75, v91, v75
v_mfma_f32_32x32x16_bf16 v[118:133], a[64:67], a[232:235], v[118:133]
v_pk_mul_f16 v99, v99, v67
v_exp_f16 v63, v71
v_exp_f16 v64, v72
v_exp_f16_sdwa v62, v70 dst_sel:WORD_1 dst_unused:UNUSED_PRESERVE src0_sel:WORD_1
v_exp_f16 v65, v73
v_dot2c_f32_f16 v29, v99, v99
v_dot2c_f32_f16 v28, v98, v98
v_dot2c_f32_f16 v29, v97, v97
v_dot2c_f32_f16 v28, v96, v96
v_dot2c_f32_f16 v29, v95, v95
v_dot2c_f32_f16 v28, v94, v94
v_mfma_f32_32x32x16_bf16 v[118:133], a[68:71], a[236:239], v[118:133]
v_exp_f16_sdwa v63, v71 dst_sel:WORD_1 dst_unused:UNUSED_PRESERVE src0_sel:WORD_1
v_exp_f16 v66, v74
v_exp_f16_sdwa v64, v72 dst_sel:WORD_1 dst_unused:UNUSED_PRESERVE src0_sel:WORD_1
v_exp_f16 v67, v75
v_mfma_f32_32x32x16_bf16 v[134:149], a[216:219], a[72:75], 0
ds_read_b128 a[216:219], v1 offset:43008
v_exp_f16_sdwa v65, v73 dst_sel:WORD_1 dst_unused:UNUSED_PRESERVE src0_sel:WORD_1
v_exp_f16_sdwa v66, v74 dst_sel:WORD_1 dst_unused:UNUSED_PRESERVE src0_sel:WORD_1
v_exp_f16_sdwa v67, v75 dst_sel:WORD_1 dst_unused:UNUSED_PRESERVE src0_sel:WORD_1
v_mfma_f32_32x32x16_bf16 v[134:149], a[220:223], a[76:79], v[134:149]
ds_read_b128 a[220:223], v1 offset:44032
s_nop 0
v_mad_u32_u16 v118, v118, 2, s85 op_sel:[1,0,0,0]
v_mad_u32_u16 v119, v119, 2, s85 op_sel:[1,0,0,0]
v_mad_u32_u16 v120, v120, 2, s85 op_sel:[1,0,0,0]
v_mad_u32_u16 v121, v121, 2, s85 op_sel:[1,0,0,0]
v_mad_u32_u16 v122, v122, 2, s85 op_sel:[1,0,0,0]
v_mfma_f32_32x32x16_bf16 v[134:149], a[224:227], a[80:83], v[134:149]
ds_read_b128 a[224:227], v1 offset:45056
ds_read_u16_d16_hi v118, v118
ds_read_u16_d16_hi v119, v119
ds_read_u16_d16_hi v120, v120
v_mad_u32_u16 v123, v123, 2, s85 op_sel:[1,0,0,0]
v_mad_u32_u16 v124, v124, 2, s85 op_sel:[1,0,0,0]
v_mad_u32_u16 v125, v125, 2, s85 op_sel:[1,0,0,0]
v_mfma_f32_32x32x16_bf16 v[134:149], a[228:231], a[84:87], v[134:149]
ds_read_b128 a[228:231], v1 offset:46080
ds_read_u16_d16_hi v121, v121
ds_read_u16_d16_hi v122, v122
ds_read_u16_d16_hi v123, v123
v_mad_u32_u16 v126, v126, 2, s85 op_sel:[1,0,0,0]
v_mad_u32_u16 v127, v127, 2, s85 op_sel:[1,0,0,0]
v_mad_u32_u16 v128, v128, 2, s85 op_sel:[1,0,0,0]
v_mfma_f32_32x32x16_bf16 v[134:149], a[232:235], a[88:91], v[134:149]
ds_read_b128 a[232:235], v1 offset:47104
ds_read_u16_d16_hi v124, v124
ds_read_u16_d16_hi v125, v125
ds_read_u16_d16_hi v126, v126
v_pk_add_f16 v70, v62, 1.0 op_sel_hi:[1,0]
v_rcp_f16 v62, v70
v_mad_u32_u16 v129, v129, 2, s85 op_sel:[1,0,0,0]
v_mfma_f32_32x32x16_bf16 v[134:149], a[236:239], a[92:95], v[134:149]
v_pk_add_f16 v71, v63, 1.0 op_sel_hi:[1,0]
v_mad_u32_u16 v130, v130, 2, s85 op_sel:[1,0,0,0]
v_pk_add_f16 v72, v64, 1.0 op_sel_hi:[1,0]
v_mad_u32_u16 v131, v131, 2, s85 op_sel:[1,0,0,0]
v_pk_add_f16 v73, v65, 1.0 op_sel_hi:[1,0]
v_rcp_f16 v63, v71
v_mad_u32_u16 v132, v132, 2, s85 op_sel:[1,0,0,0]
v_mfma_f32_32x32x16_bf16 v[102:117], a[48:51], a[192:195], 0
ds_read_b128 a[236:239], v1 offset:48128
ds_read_u16_d16_hi v127, v127
ds_read_b32 v156, v155
v_pk_add_f16 v74, v66, 1.0 op_sel_hi:[1,0]
v_mad_u32_u16 v133, v133, 2, s85 op_sel:[1,0,0,0]
v_pk_add_f16 v75, v67, 1.0 op_sel_hi:[1,0]
v_add_f32 v30, v30, v150
v_add_f32 v31, v31, v151
v_mfma_f32_32x32x16_bf16 v[102:117], a[52:55], a[196:199], v[102:117]
s_waitcnt lgkmcnt(10)
v_add_f32 v30, v30, v152
v_add_f32 v31, v31, v153
v_cvt_pk_f16_f32 v94, v134, v135
v_cvt_pk_f16_f32 v95, v136, v137
v_pk_fma_f16 v78, v94, v94, s84
v_cvt_pk_f16_f32 v96, v138, v139
v_rcp_f16 v64, v72
v_mfma_f32_32x32x16_bf16 v[102:117], a[56:59], a[200:203], v[102:117]
ds_read_u16_d16_hi v128, v128
ds_read_u16_d16_hi v129, v129
v_pk_fma_f16 v79, v95, v95, s84
v_pk_mul_f16 v78, v94, v78
v_cvt_pk_f16_f32 v97, v140, v141
v_pk_fma_f16 v80, v96, v96, s84
v_pk_mul_f16 v79, v95, v79
v_cvt_pk_f16_f32 v98, v142, v143
v_mfma_f32_32x32x16_bf16 v[102:117], a[60:63], a[204:207], v[102:117]
ds_read_u16_d16_hi v130, v130
ds_read_u16_d16_hi v131, v131
v_rcp_f16_sdwa v62, v70 dst_sel:WORD_1 dst_unused:UNUSED_PRESERVE src0_sel:WORD_1
v_rcp_f16 v65, v73
v_pk_mul_f16 v86, v86, v62
v_pk_fma_f16 v81, v97, v97, s84
v_mfma_f32_32x32x16_bf16 v[102:117], a[64:67], a[208:211], v[102:117]
ds_read_u16_d16_hi v132, v132
v_pk_mul_f16 v80, v96, v80
v_cvt_pk_f16_f32 v99, v144, v145
v_rcp_f16_sdwa v63, v71 dst_sel:WORD_1 dst_unused:UNUSED_PRESERVE src0_sel:WORD_1
v_rcp_f16 v66, v74
v_pk_mul_f16 v87, v87, v63
v_mfma_f32_32x32x16_bf16 v[102:117], a[68:71], a[212:215], v[102:117]
ds_read_u16_d16_hi v133, v133
v_pk_fma_f16 v82, v98, v98, s84
v_pk_mul_f16 v81, v97, v81
v_cvt_pk_f16_f32 v100, v146, v147
v_rcp_f16_sdwa v64, v72 dst_sel:WORD_1 dst_unused:UNUSED_PRESERVE src0_sel:WORD_1
v_rcp_f16 v67, v75
v_pk_mul_f16 v88, v88, v64
v_pk_fma_f16 v83, v99, v99, s84
v_pk_mul_f16 v82, v98, v82
v_rcp_f16_sdwa v65, v73 dst_sel:WORD_1 dst_unused:UNUSED_PRESERVE src0_sel:WORD_1
v_rcp_f16_sdwa v66, v74 dst_sel:WORD_1 dst_unused:UNUSED_PRESERVE src0_sel:WORD_1
v_pk_mul_f16 v89, v89, v65
v_cvt_pk_f16_f32 v101, v148, v149
v_mfma_f32_32x32x16_bf16 v[134:149], a[72:75], a[192:195], 0
ds_read_b128 a[192:195], v1 offset:49152
v_pk_fma_f16 v84, v100, v100, s84
v_pk_mul_f16 v83, v99, v83
v_rcp_f16_sdwa v67, v75 dst_sel:WORD_1 dst_unused:UNUSED_PRESERVE src0_sel:WORD_1
v_pk_mul_f16 v90, v90, v66
v_pk_fma_f16 v85, v101, v101, s84
v_pk_mul_f16 v84, v100, v84
v_mfma_f32_32x32x16_bf16 v[134:149], a[76:79], a[196:199], v[134:149]
ds_read_b128 a[196:199], v1 offset:50176
v_pk_mul_f16 v85, v101, v85
s_waitcnt lgkmcnt(6)
v_cmp_gt_u32 vcc, 7, v156
v_pk_mul_f16 v91, v91, v67
v_mad_u32_u16 v102, v102, 2, s85 op_sel:[1,0,0,0]
s_cbranch_vccnz L_spin7
L_ok7:
v_mov_b32 v156, 8
v_mfma_f32_32x32x16_bf16 v[134:149], a[80:83], a[200:203], v[134:149]
ds_read_b128 a[200:203], v1 offset:51200
ds_read_b128 a[156:159], v6 offset:28416
ds_read_b128 a[160:163], v7 offset:28416
ds_read_b128 a[144:147], v5 offset:4608
v_exp_f16 v62, v78
v_mad_u32_u16 v103, v103, 2, s85 op_sel:[1,0,0,0]
v_mad_u32_u16 v104, v104, 2, s85 op_sel:[1,0,0,0]
v_mfma_f32_32x32x16_bf16 v[134:149], a[84:87], a[204:207], v[134:149]
ds_read_b128 a[204:207], v1 offset:52224
ds_read_b128 a[164:167], v6 offset:30592
s_add_u32 m0, s70, 71680
v_mad_u32_u16 v105, v105, 2, s85 op_sel:[1,0,0,0]
v_mad_u32_u16 v106, v106, 2, s85 op_sel:[1,0,0,0]
v_exp_f16 v63, v79
v_mad_u32_u16 v107, v107, 2, s85 op_sel:[1,0,0,0]
v_mfma_f32_32x32x16_bf16 v[134:149], a[88:91], a[208:211], v[134:149]
ds_read_b128 a[208:211], v1 offset:53248
buffer_load_dwordx4 v12, s[4:7], 0 offen  lds
ds_read_b128 a[168:171], v7 offset:30592
v_mad_u32_u16 v108, v108, 2, s85 op_sel:[1,0,0,0]
v_mad_u32_u16 v109, v109, 2, s85 op_sel:[1,0,0,0]
v_exp_f16 v64, v80
v_mfma_f32_32x32x16_bf16 v[134:149], a[92:95], a[212:215], v[134:149]
ds_read_b128 a[212:215], v1 offset:54272
v_mad_u32_u16 v110, v110, 2, s85 op_sel:[1,0,0,0]
v_mad_u32_u16 v111, v111, 2, s85 op_sel:[1,0,0,0]
v_exp_f16_sdwa v62, v78 dst_sel:WORD_1 dst_unused:UNUSED_PRESERVE src0_sel:WORD_1
v_exp_f16 v65, v81
v_pk_add_f16 v78, v62, 1.0 op_sel_hi:[1,0]
s_waitcnt lgkmcnt(7)
v_pk_add_f32 v[32:33], v[32:33], v[132:133]
v_pk_add_f32 v[32:33], v[32:33], v[130:131]
v_pk_add_f32 v[32:33], v[32:33], v[128:129]
v_pk_add_f32 v[32:33], v[32:33], v[126:127]
v_pk_add_f32 v[32:33], v[32:33], v[124:125]
v_pk_add_f32 v[32:33], v[32:33], v[122:123]
v_pk_add_f32 v[32:33], v[32:33], v[120:121]
v_pk_add_f32 v[32:33], v[32:33], v[118:119]
v_dot2c_f32_f16 v31, v91, v91
v_dot2c_f32_f16 v30, v90, v90
v_dot2c_f32_f16 v31, v89, v89
v_dot2c_f32_f16 v30, v88, v88
v_dot2c_f32_f16 v31, v87, v87
v_dot2c_f32_f16 v30, v86, v86
v_mfma_f32_32x32x16_bf16 v[118:133], a[48:51], a[216:219], 0
ds_read_b128 a[148:151], v5 offset:6144
ds_read_b128 a[172:175], v6 offset:32768
ds_read_b128 a[176:179], v7 offset:32768
ds_read_b128 a[152:155], v5 offset:7680
v_mad_u32_u16 v112, v112, 2, s85 op_sel:[1,0,0,0]
v_exp_f16_sdwa v63, v79 dst_sel:WORD_1 dst_unused:UNUSED_PRESERVE src0_sel:WORD_1
s_waitcnt lgkmcnt(5)
v_smfmac_f32_32x32x32_bf16 v[176:191], a[144:147], a[156:163], v4
ds_read_b128 a[156:159], v6 offset:34944
v_pk_add_f16 v79, v63, 1.0 op_sel_hi:[1,0]
v_mad_u32_u16 v113, v113, 2, s85 op_sel:[1,0,0,0]
v_exp_f16 v66, v82
v_exp_f16_sdwa v64, v80 dst_sel:WORD_1 dst_unused:UNUSED_PRESERVE src0_sel:WORD_1
v_mfma_f32_32x32x16_bf16 v[118:133], a[52:55], a[220:223], v[118:133]
global_load_dword a255, v[158:159], off
ds_read_b128 a[160:163], v7 offset:34944
s_add_u32 m0, s71, 71680
ds_read_u16_d16_hi v102, v102
buffer_load_dwordx4 v13, s[4:7], 0 offen  lds
ds_read_u16_d16_hi v103, v103
s_waitcnt lgkmcnt(4)
v_smfmac_f32_32x32x32_bf16 v[176:191], a[148:151], a[164:171], v4
ds_read_u16_d16_hi v104, v104
v_pk_add_f16 v80, v64, 1.0 op_sel_hi:[1,0]
v_mad_u32_u16 v114, v114, 2, s85 op_sel:[1,0,0,0]
v_exp_f16 v67, v83
v_lshl_add_u64 v[158:159], v[158:159], 0, s[42:43]
v_exp_f16_sdwa v65, v81 dst_sel:WORD_1 dst_unused:UNUSED_PRESERVE src0_sel:WORD_1
v_mfma_f32_32x32x16_bf16 v[118:133], a[56:59], a[224:227], v[118:133]
ds_read_u16_d16_hi v105, v105
ds_read_u16_d16_hi v106, v106
ds_read_u16_d16_hi v107, v107
ds_read_u16_d16_hi v108, v108
v_pk_add_f16 v81, v65, 1.0 op_sel_hi:[1,0]
v_exp_f16 v68, v84
v_exp_f16_sdwa v66, v82 dst_sel:WORD_1 dst_unused:UNUSED_PRESERVE src0_sel:WORD_1
v_smfmac_f32_32x32x32_bf16 v[224:239], a[144:147], a[164:171], v4
ds_read_b128 a[164:167], v8 offset:28416
v_pk_add_f16 v82, v66, 1.0 op_sel_hi:[1,0]
v_mad_u32_u16 v115, v115, 2, s85 op_sel:[1,0,0,0]
v_exp_f16 v69, v85
v_exp_f16_sdwa v67, v83 dst_sel:WORD_1 dst_unused:UNUSED_PRESERVE src0_sel:WORD_1
v_mfma_f32_32x32x16_bf16 v[118:133], a[60:63], a[228:231], v[118:133]
ds_read_b128 a[168:171], v9 offset:28416
ds_read_b128 a[144:147], v5 offset:5120
s_add_u32 m0, s72, 71680
ds_read_u16_d16_hi v109, v109
buffer_load_dwordx4 v14, s[4:7], 0 offen  lds
v_pk_add_f16 v83, v67, 1.0 op_sel_hi:[1,0]
v_smfmac_f32_32x32x32_bf16 v[176:191], a[152:155], a[172:179], v4
ds_read_u16_d16_hi v110, v110
v_mad_u32_u16 v116, v116, 2, s85 op_sel:[1,0,0,0]
v_exp_f16_sdwa v68, v84 dst_sel:WORD_1 dst_unused:UNUSED_PRESERVE src0_sel:WORD_1
v_exp_f16_sdwa v69, v85 dst_sel:WORD_1 dst_unused:UNUSED_PRESERVE src0_sel:WORD_1
v_pk_add_f16 v84, v68, 1.0 op_sel_hi:[1,0]
v_mfma_f32_32x32x16_bf16 v[118:133], a[64:67], a[232:235], v[118:133]
ds_read_u16_d16_hi v111, v111
ds_read_u16_d16_hi v112, v112
ds_read_u16_d16_hi v113, v113
ds_read_u16_d16_hi v114, v114
v_rcp_f16 v62, v78
v_mad_u32_u16 v117, v117, 2, s85 op_sel:[1,0,0,0]
v_pk_add_f16 v85, v69, 1.0 op_sel_hi:[1,0]
v_smfmac_f32_32x32x32_bf16 v[224:239], a[148:151], a[172:179], v4
ds_read_b128 a[172:175], v8 offset:30592
v_mul_f32 v150, s60, v146
v_mul_f32 v151, s60, v147
v_mul_f32 v152, s60, v148
v_mul_f32 v153, s60, v149
v_mad_u32_u16 v150, v150, 2, s85 op_sel:[1,0,0,0]
v_mad_u32_u16 v151, v151, 2, s85 op_sel:[1,0,0,0]
v_mfma_f32_32x32x16_bf16 v[118:133], a[68:71], a[236:239], v[118:133]
ds_read_b128 a[176:179], v9 offset:30592
v_mad_u32_u16 v152, v152, 2, s85 op_sel:[1,0,0,0]
v_mad_u32_u16 v153, v153, 2, s85 op_sel:[1,0,0,0]
v_cvt_pk_f16_f32 v86, v134, v135
v_cvt_pk_f16_f32 v87, v136, v137
v_rcp_f16 v63, v79
v_rcp_f16 v64, v80
s_waitcnt lgkmcnt(7)
v_smfmac_f32_32x32x32_bf16 v[224:239], a[152:155], a[156:163], v4
ds_read_b128 a[148:151], v5 offset:6656
v_rcp_f16_sdwa v62, v78 dst_sel:WORD_1 dst_unused:UNUSED_PRESERVE src0_sel:WORD_1
v_rcp_f16 v65, v81
v_pk_mul_f16 v94, v94, v62
v_pk_fma_f16 v70, v86, v86, s84
v_smfmac_f32_32x32x32_bf16 v[176:191], a[144:147], a[164:171], v4
ds_read_b128 a[156:159], v8 offset:32768
v_cvt_pk_f16_f32 v88, v138, v139
v_rcp_f16_sdwa v63, v79 dst_sel:WORD_1 dst_unused:UNUSED_PRESERVE src0_sel:WORD_1
v_rcp_f16 v66, v82
v_pk_mul_f16 v95, v95, v63
v_pk_fma_f16 v71, v87, v87, s84
v_pk_mul_f16 v70, v86, v70
v_rcp_f16_sdwa v64, v80 dst_sel:WORD_1 dst_unused:UNUSED_PRESERVE src0_sel:WORD_1
v_rcp_f16 v67, v83
v_pk_mul_f16 v96, v96, v64
v_cvt_pk_f16_f32 v89, v140, v141
v_pk_fma_f16 v72, v88, v88, s84
v_pk_mul_f16 v71, v87, v71
v_rcp_f16_sdwa v65, v81 dst_sel:WORD_1 dst_unused:UNUSED_PRESERVE src0_sel:WORD_1
v_rcp_f16 v68, v84
v_pk_mul_f16 v97, v97, v65
v_cvt_pk_f16_f32 v90, v142, v143
v_pk_fma_f16 v73, v89, v89, s84
v_rcp_f16_sdwa v66, v82 dst_sel:WORD_1 dst_unused:UNUSED_PRESERVE src0_sel:WORD_1
v_rcp_f16 v69, v85
v_pk_mul_f16 v98, v98, v66
v_pk_mul_f16 v72, v88, v72
v_cvt_pk_f16_f32 v91, v144, v145
v_mfma_f32_32x32x16_bf16 v[134:149], a[72:75], a[216:219], 0
ds_read_b128 a[216:219], v1 offset:55296
ds_read_b128 a[160:163], v9 offset:32768
ds_read_b128 a[152:155], v5 offset:8192
buffer_store_dwordx4 v[94:97], v1, s[12:15], s101 offen offset:0 sc1
v_mfma_f32_32x32x16_bf16 v[134:149], a[76:79], a[220:223], v[134:149]
ds_read_b128 a[220:223], v1 offset:56320
ds_read_b128 a[164:167], v8 offset:34944
ds_read_b128 a[168:171], v9 offset:34944
ds_read_u16_d16_hi v115, v115
v_rcp_f16_sdwa v67, v83 dst_sel:WORD_1 dst_unused:UNUSED_PRESERVE src0_sel:WORD_1
v_rcp_f16_sdwa v68, v84 dst_sel:WORD_1 dst_unused:UNUSED_PRESERVE src0_sel:WORD_1
s_waitcnt lgkmcnt(6)
v_smfmac_f32_32x32x32_bf16 v[176:191], a[148:151], a[172:179], v4
ds_read_u16_d16_hi v116, v116
v_pk_mul_f16 v99, v99, v67
v_pk_fma_f16 v74, v90, v90, s84
v_pk_mul_f16 v73, v89, v73
v_pk_mul_f16 v100, v100, v68
v_pk_fma_f16 v75, v91, v91, s84
v_pk_mul_f16 v74, v90, v74
v_mfma_f32_32x32x16_bf16 v[134:149], a[80:83], a[224:227], v[134:149]
ds_read_b128 a[224:227], v1 offset:57344
ds_read_u16_d16_hi v117, v117
ds_read_u16_d16_hi v150, v150
ds_read_u16_d16_hi v151, v151
v_pk_mul_f16 v75, v91, v75
v_rcp_f16_sdwa v69, v85 dst_sel:WORD_1 dst_unused:UNUSED_PRESERVE src0_sel:WORD_1
v_exp_f16 v62, v70
v_smfmac_f32_32x32x32_bf16 v[224:239], a[144:147], a[172:179], v4
ds_read_b128 a[172:175], v10 offset:28416
v_pk_mul_f16 v101, v101, v69
v_mad_u32_u16 v118, v118, 2, s85 op_sel:[1,0,0,0]
v_exp_f16 v63, v71
v_mad_u32_u16 v119, v119, 2, s85 op_sel:[1,0,0,0]
v_mad_u32_u16 v120, v120, 2, s85 op_sel:[1,0,0,0]
v_mfma_f32_32x32x16_bf16 v[134:149], a[84:87], a[228:231], v[134:149]
ds_read_b128 a[228:231], v1 offset:58368
ds_read_b128 a[176:179], v11 offset:28416
ds_read_b128 a[144:147], v5 offset:5632
s_add_u32 m0, s73, 71680
ds_read_u16_d16_hi v152, v152
v_exp_f16 v64, v72
v_mad_u32_u16 v121, v121, 2, s85 op_sel:[1,0,0,0]
s_waitcnt lgkmcnt(8)
v_smfmac_f32_32x32x32_bf16 v[176:191], a[152:155], a[156:163], v4
buffer_load_dwordx4 v15, s[4:7], 0 offen  lds
v_mad_u32_u16 v122, v122, 2, s85 op_sel:[1,0,0,0]
v_mad_u32_u16 v123, v123, 2, s85 op_sel:[1,0,0,0]
v_mad_u32_u16 v124, v124, 2, s85 op_sel:[1,0,0,0]
v_mad_u32_u16 v125, v125, 2, s85 op_sel:[1,0,0,0]
v_mfma_f32_32x32x16_bf16 v[134:149], a[88:91], a[232:235], v[134:149]
ds_read_b128 a[232:235], v1 offset:59392
ds_read_u16_d16_hi v153, v153
ds_read_u16_d16_hi v118, v118
ds_read_u16_d16_hi v119, v119
v_mad_u32_u16 v126, v126, 2, s85 op_sel:[1,0,0,0]
v_mad_u32_u16 v127, v127, 2, s85 op_sel:[1,0,0,0]
v_mad_u32_u16 v128, v128, 2, s85 op_sel:[1,0,0,0]
v_exp_f16_sdwa v62, v70 dst_sel:WORD_1 dst_unused:UNUSED_PRESERVE src0_sel:WORD_1
s_waitcnt lgkmcnt(7)
v_pk_add_f32 v[34:35], v[34:35], v[116:117]
v_pk_add_f32 v[34:35], v[34:35], v[114:115]
v_pk_add_f32 v[34:35], v[34:35], v[112:113]
v_pk_add_f32 v[34:35], v[34:35], v[110:111]
v_pk_add_f32 v[34:35], v[34:35], v[108:109]
v_pk_add_f32 v[34:35], v[34:35], v[106:107]
v_exp_f16 v65, v73
v_pk_add_f32 v[34:35], v[34:35], v[104:105]
v_pk_add_f32 v[34:35], v[34:35], v[102:103]
v_smfmac_f32_32x32x32_bf16 v[224:239], a[148:151], a[156:163], v4
ds_read_b128 a[156:159], v10 offset:30592
v_pk_add_f16 v70, v62, 1.0 op_sel_hi:[1,0]
v_mad_u32_u16 v129, v129, 2, s85 op_sel:[1,0,0,0]
v_exp_f16_sdwa v63, v71 dst_sel:WORD_1 dst_unused:UNUSED_PRESERVE src0_sel:WORD_1
v_exp_f16 v66, v74
v_mfma_f32_32x32x16_f16 v[102:117], v[94:97], a[240:243], 0
ds_read_b128 a[160:163], v11 offset:30592
ds_read_b128 a[148:151], v5 offset:7168
s_add_u32 m0, s74, 71680
ds_read_u16_d16_hi v120, v120
v_pk_add_f16 v71, v63, 1.0 op_sel_hi:[1,0]
v_mad_u32_u16 v130, v130, 2, s85 op_sel:[1,0,0,0]
v_exp_f16_sdwa v64, v72 dst_sel:WORD_1 dst_unused:UNUSED_PRESERVE src0_sel:WORD_1
v_mfma_f32_32x32x16_bf16 v[134:149], a[92:95], a[236:239], v[134:149]
ds_read_b128 a[236:239], v1 offset:60416
buffer_load_dwordx4 v16, s[4:7], 0 offen  lds
ds_read_u16_d16_hi v121, v121
ds_read_u16_d16_hi v122, v122
v_pk_add_f16 v72, v64, 1.0 op_sel_hi:[1,0]
v_mad_u32_u16 v131, v131, 2, s85 op_sel:[1,0,0,0]
v_smfmac_f32_32x32x32_bf16 v[224:239], a[152:155], a[164:171], v4
ds_read_b128 a[164:167], v10 offset:32768
v_exp_f16 v67, v75
v_exp_f16_sdwa v65, v73 dst_sel:WORD_1 dst_unused:UNUSED_PRESERVE src0_sel:WORD_1
v_exp_f16_sdwa v66, v74 dst_sel:WORD_1 dst_unused:UNUSED_PRESERVE src0_sel:WORD_1
v_mfma_f32_32x32x16_f16 v[102:117], v[98:101], a[244:247], v[102:117]
ds_read_b128 a[168:171], v11 offset:32768
ds_read_b128 a[152:155], v5 offset:8704
ds_read_u16_d16_hi v123, v123
ds_read_u16_d16_hi v124, v124
v_pk_add_f16 v73, v65, 1.0 op_sel_hi:[1,0]
v_mad_u32_u16 v132, v132, 2, s85 op_sel:[1,0,0,0]
v_pk_add_f16 v74, v66, 1.0 op_sel_hi:[1,0]
s_waitcnt lgkmcnt(8)
v_smfmac_f32_32x32x32_bf16 v[176:191], a[144:147], a[172:179], v4
ds_read_b128 a[172:175], v10 offset:34944
v_mad_u32_u16 v133, v133, 2, s85 op_sel:[1,0,0,0]
v_exp_f16_sdwa v67, v75 dst_sel:WORD_1 dst_unused:UNUSED_PRESERVE src0_sel:WORD_1
v_rcp_f16 v62, v70
v_pk_add_f16 v75, v67, 1.0 op_sel_hi:[1,0]
v_pk_fma_f32 v[32:33], v[102:103], v[102:103], v[32:33]
v_pk_fma_f32 v[32:33], v[104:105], v[104:105], v[32:33]
v_pk_fma_f32 v[32:33], v[106:107], v[106:107], v[32:33]
v_pk_fma_f32 v[32:33], v[108:109], v[108:109], v[32:33]
v_pk_fma_f32 v[32:33], v[110:111], v[110:111], v[32:33]
v_pk_fma_f32 v[32:33], v[112:113], v[112:113], v[32:33]
v_pk_fma_f32 v[32:33], v[114:115], v[114:115], v[32:33]
v_add_f32 v34, v34, v150
v_pk_fma_f32 v[32:33], v[116:117], v[116:117], v[32:33]
v_mfma_f32_32x32x16_bf16 v[102:117], a[48:51], a[192:195], 0
ds_read_b128 a[176:179], v11 offset:34944
s_add_u32 m0, s75, 71680
ds_read_u16_d16_hi v125, v125
buffer_load_dwordx4 v17, s[4:7], 0 offen  lds
ds_read_u16_d16_hi v126, v126
v_add_f32 v35, v35, v151
v_smfmac_f32_32x32x32_bf16 v[176:191], a[148:151], a[156:163], v4
ds_read_u16_d16_hi v127, v127
v_add_f32 v34, v34, v152
v_add_f32 v35, v35, v153
v_mul_f32 v150, s60, v146
v_mul_f32 v151, s60, v147
v_mul_f32 v152, s60, v148
v_mul_f32 v153, s60, v149
v_mfma_f32_32x32x16_bf16 v[102:117], a[52:55], a[196:199], v[102:117]
ds_read_u16_d16_hi v128, v128
ds_read_u16_d16_hi v129, v129
ds_read_u16_d16_hi v130, v130
ds_read_u16_d16_hi v131, v131
v_mad_u32_u16 v150, v150, 2, s85 op_sel:[1,0,0,0]
v_mad_u32_u16 v151, v151, 2, s85 op_sel:[1,0,0,0]
v_rcp_f16 v63, v71
v_smfmac_f32_32x32x32_bf16 v[224:239], a[144:147], a[156:163], v4
ds_read_u16_d16_hi v132, v132
v_mad_u32_u16 v152, v152, 2, s85 op_sel:[1,0,0,0]
v_mad_u32_u16 v153, v153, 2, s85 op_sel:[1,0,0,0]
v_cvt_pk_f16_f32 v94, v134, v135
v_cvt_pk_f16_f32 v95, v136, v137
v_pk_fma_f16 v78, v94, v94, s84
v_rcp_f16 v64, v72
v_mfma_f32_32x32x16_bf16 v[102:117], a[56:59], a[200:203], v[102:117]
ds_read_u16_d16_hi v133, v133
ds_read_u16_d16_hi v150, v150
ds_read_u16_d16_hi v151, v151
buffer_store_dwordx4 v[98:101], v1, s[12:15], s101 offen offset:1024 sc1
s_waitcnt vmcnt(10) lgkmcnt(9)
ds_write_b32 v154, v156
v_smfmac_f32_32x32x32_bf16 v[176:191], a[152:155], a[164:171], v4
v_rcp_f16_sdwa v62, v70 dst_sel:WORD_1 dst_unused:UNUSED_PRESERVE src0_sel:WORD_1
v_rcp_f16 v65, v73
v_pk_mul_f16 v86, v86, v62
v_cvt_pk_f16_f32 v96, v138, v139
v_pk_fma_f16 v79, v95, v95, s84
v_mfma_f32_32x32x16_bf16 v[102:117], a[60:63], a[204:207], v[102:117]
ds_read_u16_d16_hi v152, v152
v_pk_mul_f16 v78, v94, v78
v_rcp_f16_sdwa v63, v71 dst_sel:WORD_1 dst_unused:UNUSED_PRESERVE src0_sel:WORD_1
v_rcp_f16 v66, v74
v_pk_mul_f16 v87, v87, v63
v_cvt_pk_f16_f32 v97, v140, v141
v_pk_fma_f32 v[48:49], v[176:177], v[176:177], v[48:49]
v_pk_add_f32 v[46:47], v[46:47], v[176:177]
v_pk_fma_f32 v[48:49], v[178:179], v[178:179], v[48:49]
v_pk_add_f32 v[46:47], v[46:47], v[178:179]
v_pk_fma_f32 v[48:49], v[180:181], v[180:181], v[48:49]
v_rcp_f16_sdwa v64, v72 dst_sel:WORD_1 dst_unused:UNUSED_PRESERVE src0_sel:WORD_1
v_pk_add_f32 v[46:47], v[46:47], v[180:181]
v_pk_fma_f32 v[48:49], v[182:183], v[182:183], v[48:49]
v_pk_add_f32 v[46:47], v[46:47], v[182:183]
v_rcp_f16 v67, v75
v_pk_fma_f32 v[48:49], v[184:185], v[184:185], v[48:49]
v_pk_add_f32 v[46:47], v[46:47], v[184:185]
v_pk_fma_f32 v[48:49], v[186:187], v[186:187], v[48:49]
v_pk_add_f32 v[46:47], v[46:47], v[186:187]
v_pk_fma_f32 v[48:49], v[188:189], v[188:189], v[48:49]
v_pk_add_f32 v[46:47], v[46:47], v[188:189]
v_pk_fma_f32 v[48:49], v[190:191], v[190:191], v[48:49]
v_pk_add_f32 v[46:47], v[46:47], v[190:191]
v_smfmac_f32_32x32x32_bf16 v[224:239], a[148:151], a[164:171], v4
ds_read_u16_d16_hi v153, v153
v_pk_fma_f16 v80, v96, v96, s84
v_pk_mul_f16 v79, v95, v79
v_pk_mul_f16 v88, v88, v64
v_cvt_pk_f16_f32 v98, v142, v143
v_pk_fma_f16 v81, v97, v97, s84
v_pk_mul_f16 v80, v96, v80
v_mfma_f32_32x32x16_bf16 v[102:117], a[64:67], a[208:211], v[102:117]
s_add_u32 s101, s3, 40960
v_rcp_f16_sdwa v65, v73 dst_sel:WORD_1 dst_unused:UNUSED_PRESERVE src0_sel:WORD_1
v_rcp_f16_sdwa v66, v74 dst_sel:WORD_1 dst_unused:UNUSED_PRESERVE src0_sel:WORD_1
v_pk_mul_f16 v89, v89, v65
v_cvt_pk_f16_f32 v99, v144, v145
v_pk_fma_f16 v82, v98, v98, s84
s_waitcnt lgkmcnt(3)
v_pk_add_f32 v[36:37], v[36:37], v[132:133]
v_pk_add_f32 v[36:37], v[36:37], v[130:131]
v_pk_add_f32 v[36:37], v[36:37], v[128:129]
v_pk_add_f32 v[36:37], v[36:37], v[126:127]
v_rcp_f16_sdwa v67, v75 dst_sel:WORD_1 dst_unused:UNUSED_PRESERVE src0_sel:WORD_1
v_pk_add_f32 v[36:37], v[36:37], v[124:125]
v_pk_add_f32 v[36:37], v[36:37], v[122:123]
v_pk_add_f32 v[36:37], v[36:37], v[120:121]
v_exp_f16 v62, v78
v_pk_add_f32 v[36:37], v[36:37], v[118:119]
v_smfmac_f32_32x32x32_bf16 v[224:239], a[152:155], a[172:179], v4
v_pk_mul_f16 v81, v97, v81
v_pk_mul_f16 v90, v90, v66
v_pk_fma_f16 v83, v99, v99, s84
v_pk_mul_f16 v82, v98, v82
v_pk_mul_f16 v83, v99, v83
v_pk_mul_f16 v91, v91, v67
v_exp_f16 v63, v79
v_dot2c_f32_f16 v35, v91, v91
v_dot2c_f32_f16 v34, v90, v90
v_dot2c_f32_f16 v35, v89, v89
v_dot2c_f32_f16 v34, v88, v88
v_dot2c_f32_f16 v35, v87, v87
v_dot2c_f32_f16 v34, v86, v86
v_pk_fma_f32 v[52:53], v[224:225], v[224:225], v[52:53]
v_pk_add_f32 v[50:51], v[50:51], v[224:225]
v_pk_fma_f32 v[52:53], v[226:227], v[226:227], v[52:53]
v_pk_add_f32 v[50:51], v[50:51], v[226:227]
v_exp_f16 v64, v80
v_pk_fma_f32 v[52:53], v[228:229], v[228:229], v[52:53]
v_pk_add_f32 v[50:51], v[50:51], v[228:229]
v_pk_fma_f32 v[52:53], v[230:231], v[230:231], v[52:53]
v_pk_add_f32 v[50:51], v[50:51], v[230:231]
v_pk_fma_f32 v[52:53], v[232:233], v[232:233], v[52:53]
v_pk_add_f32 v[50:51], v[50:51], v[232:233]
v_pk_fma_f32 v[52:53], v[234:235], v[234:235], v[52:53]
v_pk_add_f32 v[50:51], v[50:51], v[234:235]
v_pk_fma_f32 v[52:53], v[236:237], v[236:237], v[52:53]
v_pk_add_f32 v[50:51], v[50:51], v[236:237]
v_pk_fma_f32 v[52:53], v[238:239], v[238:239], v[52:53]
v_pk_add_f32 v[50:51], v[50:51], v[238:239]
v_mfma_f32_32x32x16_bf16 v[102:117], a[68:71], a[212:215], v[102:117]
v_exp_f16_sdwa v62, v78 dst_sel:WORD_1 dst_unused:UNUSED_PRESERVE src0_sel:WORD_1
v_exp_f16 v65, v81
v_exp_f16_sdwa v63, v79 dst_sel:WORD_1 dst_unused:UNUSED_PRESERVE src0_sel:WORD_1
v_exp_f16 v66, v82
v_mfma_f32_32x32x16_bf16 v[192:207], a[248:251], a[248:251], 0
v_exp_f16_sdwa v64, v80 dst_sel:WORD_1 dst_unused:UNUSED_PRESERVE src0_sel:WORD_1
v_exp_f16 v67, v83
v_exp_f16_sdwa v65, v81 dst_sel:WORD_1 dst_unused:UNUSED_PRESERVE src0_sel:WORD_1
v_exp_f16_sdwa v66, v82 dst_sel:WORD_1 dst_unused:UNUSED_PRESERVE src0_sel:WORD_1
v_mfma_f32_32x32x16_bf16 v[134:149], a[192:195], a[72:75], 0
ds_read_b128 a[192:195], v1 offset:61440
v_exp_f16_sdwa v67, v83 dst_sel:WORD_1 dst_unused:UNUSED_PRESERVE src0_sel:WORD_1
v_mad_u32_u16 v102, v102, 2, s85 op_sel:[1,0,0,0]
v_mad_u32_u16 v103, v103, 2, s85 op_sel:[1,0,0,0]
v_mad_u32_u16 v104, v104, 2, s85 op_sel:[1,0,0,0]
v_mad_u32_u16 v105, v105, 2, s85 op_sel:[1,0,0,0]
v_mad_u32_u16 v106, v106, 2, s85 op_sel:[1,0,0,0]
v_mfma_f32_32x32x16_bf16 v[240:255], a[248:251], a[248:251], 0
ds_read_u16_d16_hi v102, v102
ds_read_u16_d16_hi v103, v103
ds_read_u16_d16_hi v104, v104
ds_read_u16_d16_hi v105, v105
v_mad_u32_u16 v107, v107, 2, s85 op_sel:[1,0,0,0]
v_mad_u32_u16 v108, v108, 2, s85 op_sel:[1,0,0,0]
v_mad_u32_u16 v109, v109, 2, s85 op_sel:[1,0,0,0]
v_mad_u32_u16 v110, v110, 2, s85 op_sel:[1,0,0,0]
v_mfma_f32_32x32x16_bf16 v[134:149], a[196:199], a[76:79], v[134:149]
ds_read_b128 a[196:199], v1 offset:62464
ds_read_u16_d16_hi v106, v106
ds_read_u16_d16_hi v107, v107
ds_read_u16_d16_hi v108, v108
v_mad_u32_u16 v111, v111, 2, s85 op_sel:[1,0,0,0]
v_mad_u32_u16 v112, v112, 2, s85 op_sel:[1,0,0,0]
v_pk_add_f16 v78, v62, 1.0 op_sel_hi:[1,0]
v_mfma_f32_32x32x16_bf16 v[134:149], a[200:203], a[80:83], v[134:149]
ds_read_b128 a[200:203], v1 offset:63488
ds_read_u16_d16_hi v109, v109
ds_read_u16_d16_hi v110, v110
v_mad_u32_u16 v113, v113, 2, s85 op_sel:[1,0,0,0]
v_pk_add_f16 v79, v63, 1.0 op_sel_hi:[1,0]
v_rcp_f16 v62, v78
v_mad_u32_u16 v114, v114, 2, s85 op_sel:[1,0,0,0]
v_mfma_f32_32x32x16_bf16 v[134:149], a[204:207], a[84:87], v[134:149]
ds_read_b128 a[204:207], v1 offset:64512
v_pk_add_f16 v80, v64, 1.0 op_sel_hi:[1,0]
v_mad_u32_u16 v115, v115, 2, s85 op_sel:[1,0,0,0]
v_pk_add_f16 v81, v65, 1.0 op_sel_hi:[1,0]
v_mad_u32_u16 v116, v116, 2, s85 op_sel:[1,0,0,0]
v_pk_add_f16 v82, v66, 1.0 op_sel_hi:[1,0]
v_rcp_f16 v63, v79
v_mfma_f32_32x32x16_bf16 v[134:149], a[208:211], a[88:91], v[134:149]
ds_read_b128 a[208:211], v2 offset:0
v_mad_u32_u16 v117, v117, 2, s85 op_sel:[1,0,0,0]
v_pk_add_f16 v83, v67, 1.0 op_sel_hi:[1,0]
v_add_f32 v36, v36, v150
v_add_f32 v37, v37, v151
s_waitcnt lgkmcnt(9)
v_add_f32 v36, v36, v152
v_add_f32 v37, v37, v153
v_mfma_f32_32x32x16_bf16 v[134:149], a[212:215], a[92:95], v[134:149]
ds_read_b128 a[212:215], v2 offset:1024
ds_read_u16_d16_hi v111, v111
v_rcp_f16 v64, v80
v_rcp_f16_sdwa v62, v78 dst_sel:WORD_1 dst_unused:UNUSED_PRESERVE src0_sel:WORD_1
v_rcp_f16 v65, v81
v_mfma_f32_32x32x16_bf16 v[118:133], a[48:51], a[216:219], 0
ds_read_u16_d16_hi v112, v112
ds_read_u16_d16_hi v113, v113
ds_read_b32 v156, v155
v_rcp_f16_sdwa v63, v79 dst_sel:WORD_1 dst_unused:UNUSED_PRESERVE src0_sel:WORD_1
v_rcp_f16 v66, v82
v_rcp_f16_sdwa v64, v80 dst_sel:WORD_1 dst_unused:UNUSED_PRESERVE src0_sel:WORD_1
v_mfma_f32_32x32x16_bf16 v[118:133], a[52:55], a[220:223], v[118:133]
v_cvt_pk_f16_f32 v86, v134, v135
v_cvt_pk_f16_f32 v87, v136, v137
v_pk_fma_f16 v70, v86, v86, s84
v_cvt_pk_f16_f32 v88, v138, v139
v_rcp_f16 v67, v83
v_pk_fma_f16 v71, v87, v87, s84
v_pk_mul_f16 v70, v86, v70
v_mfma_f32_32x32x16_bf16 v[118:133], a[56:59], a[224:227], v[118:133]
ds_read_u16_d16_hi v114, v114
v_cvt_pk_f16_f32 v89, v140, v141
v_pk_fma_f16 v72, v88, v88, s84
v_pk_mul_f16 v71, v87, v71
v_cvt_pk_f16_f32 v90, v142, v143
v_pk_mul_f16 v94, v94, v62
v_pk_fma_f16 v73, v89, v89, s84
v_mfma_f32_32x32x16_bf16 v[118:133], a[60:63], a[228:231], v[118:133]
ds_read_u16_d16_hi v115, v115
ds_read_u16_d16_hi v116, v116
v_pk_mul_f16 v72, v88, v72
v_cvt_pk_f16_f32 v91, v144, v145
v_pk_mul_f16 v95, v95, v63
v_pk_fma_f16 v74, v90, v90, s84
v_pk_mul_f16 v73, v89, v73
v_mfma_f32_32x32x16_bf16 v[118:133], a[64:67], a[232:235], v[118:133]
ds_read_u16_d16_hi v117, v117
v_cvt_pk_f16_f32 v92, v146, v147
v_pk_mul_f16 v96, v96, v64
v_pk_fma_f16 v75, v91, v91, s84
v_pk_mul_f16 v74, v90, v74
v_rcp_f16_sdwa v65, v81 dst_sel:WORD_1 dst_unused:UNUSED_PRESERVE src0_sel:WORD_1
v_mfma_f32_32x32x16_bf16 v[118:133], a[68:71], a[236:239], v[118:133]
v_pk_mul_f16 v97, v97, v65
v_cvt_pk_f16_f32 v93, v148, v149
v_pk_fma_f16 v76, v92, v92, s84
v_pk_mul_f16 v75, v91, v75
v_rcp_f16_sdwa v66, v82 dst_sel:WORD_1 dst_unused:UNUSED_PRESERVE src0_sel:WORD_1
v_rcp_f16_sdwa v67, v83 dst_sel:WORD_1 dst_unused:UNUSED_PRESERVE src0_sel:WORD_1
v_mfma_f32_32x32x16_bf16 v[134:149], a[72:75], a[216:219], 0
ds_read_b128 a[216:219], v2 offset:2048
v_pk_mul_f16 v98, v98, v66
v_pk_fma_f16 v77, v93, v93, s84
v_pk_mul_f16 v76, v92, v76
v_pk_mul_f16 v77, v93, v77
v_pk_mul_f16 v99, v99, v67
v_mad_u32_u16 v118, v118, 2, s85 op_sel:[1,0,0,0]
v_exp_f16 v62, v70
v_mfma_f32_32x32x16_bf16 v[134:149], a[76:79], a[220:223], v[134:149]
ds_read_b128 a[220:223], v2 offset:3072
ds_read_u16_d16_hi v118, v118
v_mad_u32_u16 v119, v119, 2, s85 op_sel:[1,0,0,0]
v_mad_u32_u16 v120, v120, 2, s85 op_sel:[1,0,0,0]
v_mad_u32_u16 v121, v121, 2, s85 op_sel:[1,0,0,0]
v_mad_u32_u16 v122, v122, 2, s85 op_sel:[1,0,0,0]
v_exp_f16 v63, v71
v_mfma_f32_32x32x16_bf16 v[134:149], a[80:83], a[224:227], v[134:149]
ds_read_b128 a[224:227], v2 offset:4096
ds_read_u16_d16_hi v119, v119
ds_read_u16_d16_hi v120, v120
ds_read_u16_d16_hi v121, v121
s_waitcnt lgkmcnt(9)
v_cmp_gt_u32 vcc, 8, v156
v_mad_u32_u16 v123, v123, 2, s85 op_sel:[1,0,0,0]
v_mad_u32_u16 v124, v124, 2, s85 op_sel:[1,0,0,0]
s_cbranch_vccnz L_spin8
L_ok8:
v_mov_b32 v156, 9
v_mfma_f32_32x32x16_bf16 v[134:149], a[84:87], a[228:231], v[134:149]
ds_read_b128 a[228:231], v2 offset:5120
ds_read_b128 a[156:159], v6 offset:50176
ds_read_b128 a[160:163], v7 offset:50176
s_add_u32 m0, s70, 100096
v_mad_u32_u16 v125, v125, 2, s85 op_sel:[1,0,0,0]
v_mad_u32_u16 v126, v126, 2, s85 op_sel:[1,0,0,0]
v_exp_f16 v64, v72
v_mfma_f32_32x32x16_bf16 v[134:149], a[88:91], a[232:235], v[134:149]
ds_read_b128 a[232:235], v3 offset:26368
buffer_load_dwordx4 v12, s[4:7], s89 offen  lds
v_mad_u32_u16 v127, v127, 2, s85 op_sel:[1,0,0,0]
v_exp_f16_sdwa v62, v70 dst_sel:WORD_1 dst_unused:UNUSED_PRESERVE src0_sel:WORD_1
v_exp_f16 v65, v73
s_waitcnt lgkmcnt(8)
v_pk_add_f32 v[38:39], v[38:39], v[116:117]
v_pk_add_f32 v[38:39], v[38:39], v[114:115]
v_pk_add_f32 v[38:39], v[38:39], v[112:113]
v_pk_add_f32 v[38:39], v[38:39], v[110:111]
v_pk_add_f32 v[38:39], v[38:39], v[108:109]
v_exp_f16_sdwa v63, v71 dst_sel:WORD_1 dst_unused:UNUSED_PRESERVE src0_sel:WORD_1
v_pk_add_f32 v[38:39], v[38:39], v[106:107]
v_pk_add_f32 v[38:39], v[38:39], v[104:105]
v_pk_add_f32 v[38:39], v[38:39], v[102:103]
v_dot2c_f32_f16 v37, v99, v99
v_dot2c_f32_f16 v36, v98, v98
v_dot2c_f32_f16 v37, v97, v97
v_dot2c_f32_f16 v36, v96, v96
v_dot2c_f32_f16 v37, v95, v95
v_dot2c_f32_f16 v36, v94, v94
v_mfma_f32_32x32x16_bf16 v[134:149], a[92:95], a[236:239], v[134:149]
ds_read_b128 a[236:239], v3 offset:27392
ds_read_b128 a[144:147], v5 offset:9216
ds_read_b128 a[164:167], v6 offset:52352
ds_read_b128 a[168:171], v7 offset:52352
v_exp_f16 v66, v74
v_pk_add_f16 v70, v62, 1.0 op_sel_hi:[1,0]
v_mad_u32_u16 v128, v128, 2, s85 op_sel:[1,0,0,0]
v_mfma_f32_32x32x16_bf16 v[102:117], a[48:51], a[192:195], 0
ds_read_b128 a[148:151], v5 offset:10752
ds_read_b128 a[172:175], v6 offset:54528
v_pk_add_f16 v71, v63, 1.0 op_sel_hi:[1,0]
v_mad_u32_u16 v129, v129, 2, s85 op_sel:[1,0,0,0]
v_exp_f16_sdwa v64, v72 dst_sel:WORD_1 dst_unused:UNUSED_PRESERVE src0_sel:WORD_1
v_exp_f16 v67, v75
v_mfma_f32_32x32x16_bf16 v[102:117], a[52:55], a[196:199], v[102:117]
ds_read_b128 a[176:179], v7 offset:54528
ds_read_b128 a[152:155], v5 offset:12288
s_add_u32 m0, s71, 100096
v_pk_add_f16 v72, v64, 1.0 op_sel_hi:[1,0]
v_mad_u32_u16 v130, v130, 2, s85 op_sel:[1,0,0,0]
v_exp_f16_sdwa v65, v73 dst_sel:WORD_1 dst_unused:UNUSED_PRESERVE src0_sel:WORD_1
v_exp_f16 v68, v76
v_mfma_f32_32x32x16_bf16 v[102:117], a[56:59], a[200:203], v[102:117]
buffer_load_dwordx4 v13, s[4:7], s89 offen  lds
ds_read_u16_d16_hi v122, v122
ds_read_u16_d16_hi v123, v123
ds_read_u16_d16_hi v124, v124
v_pk_add_f16 v73, v65, 1.0 op_sel_hi:[1,0]
v_exp_f16_sdwa v66, v74 dst_sel:WORD_1 dst_unused:UNUSED_PRESERVE src0_sel:WORD_1
v_mfma_f32_32x32x16_bf16 v[102:117], a[60:63], a[204:207], v[102:117]
ds_read_u16_d16_hi v125, v125
ds_read_u16_d16_hi v126, v126
v_pk_add_f16 v74, v66, 1.0 op_sel_hi:[1,0]
v_mad_u32_u16 v131, v131, 2, s85 op_sel:[1,0,0,0]
v_exp_f16 v69, v77
v_exp_f16_sdwa v67, v75 dst_sel:WORD_1 dst_unused:UNUSED_PRESERVE src0_sel:WORD_1
s_waitcnt lgkmcnt(6)
v_smfmac_f32_32x32x32_bf16 v[192:207], a[144:147], a[156:163], v4
ds_read_b128 a[156:159], v6 offset:56704
v_pk_add_f16 v75, v67, 1.0 op_sel_hi:[1,0]
v_mad_u32_u16 v132, v132, 2, s85 op_sel:[1,0,0,0]
v_exp_f16_sdwa v68, v76 dst_sel:WORD_1 dst_unused:UNUSED_PRESERVE src0_sel:WORD_1
v_exp_f16_sdwa v69, v77 dst_sel:WORD_1 dst_unused:UNUSED_PRESERVE src0_sel:WORD_1
v_mfma_f32_32x32x16_bf16 v[102:117], a[64:67], a[208:211], v[102:117]
ds_read_b128 a[160:163], v7 offset:56704
ds_read_u16_d16_hi v127, v127
ds_read_u16_d16_hi v128, v128
ds_read_u16_d16_hi v129, v129
v_pk_add_f16 v76, v68, 1.0 op_sel_hi:[1,0]
v_mad_u32_u16 v133, v133, 2, s85 op_sel:[1,0,0,0]
v_pk_add_f16 v77, v69, 1.0 op_sel_hi:[1,0]
v_mul_f32 v150, s60, v146
v_smfmac_f32_32x32x32_bf16 v[192:207], a[148:151], a[164:171], v4
s_add_u32 m0, s72, 100096
ds_read_u16_d16_hi v130, v130
v_mul_f32 v151, s60, v147
v_mul_f32 v152, s60, v148
v_mul_f32 v153, s60, v149
v_mad_u32_u16 v150, v150, 2, s85 op_sel:[1,0,0,0]
v_mad_u32_u16 v151, v151, 2, s85 op_sel:[1,0,0,0]
v_mfma_f32_32x32x16_bf16 v[102:117], a[68:71], a[212:215], v[102:117]
buffer_load_dwordx4 v14, s[4:7], s89 offen  lds
ds_read_u16_d16_hi v131, v131
ds_read_u16_d16_hi v132, v132
ds_read_u16_d16_hi v133, v133
v_mad_u32_u16 v152, v152, 2, s85 op_sel:[1,0,0,0]
v_mad_u32_u16 v153, v153, 2, s85 op_sel:[1,0,0,0]
v_smfmac_f32_32x32x32_bf16 v[240:255], a[144:147], a[164:171], v4
ds_read_b128 a[164:167], v8 offset:50176
v_cvt_pk_f16_f32 v94, v134, v135
v_cvt_pk_f16_f32 v95, v136, v137
v_rcp_f16 v62, v70
v_rcp_f16 v63, v71
s_waitcnt lgkmcnt(8)
v_smfmac_f32_32x32x32_bf16 v[192:207], a[152:155], a[172:179], v4
ds_read_b128 a[168:171], v9 offset:50176
v_rcp_f16 v64, v72
v_rcp_f16_sdwa v62, v70 dst_sel:WORD_1 dst_unused:UNUSED_PRESERVE src0_sel:WORD_1
v_rcp_f16 v65, v73
v_smfmac_f32_32x32x32_bf16 v[240:255], a[148:151], a[172:179], v4
ds_read_b128 a[144:147], v5 offset:9728
v_pk_mul_f16 v86, v86, v62
v_pk_fma_f16 v78, v94, v94, s84
v_rcp_f16_sdwa v63, v71 dst_sel:WORD_1 dst_unused:UNUSED_PRESERVE src0_sel:WORD_1
v_cvt_pk_f16_f32 v96, v138, v139
v_pk_mul_f16 v87, v87, v63
v_smfmac_f32_32x32x32_bf16 v[240:255], a[152:155], a[156:163], v4
ds_read_b128 a[172:175], v8 offset:52352
v_pk_fma_f16 v79, v95, v95, s84
v_pk_mul_f16 v78, v94, v78
v_rcp_f16 v66, v74
v_rcp_f16_sdwa v64, v72 dst_sel:WORD_1 dst_unused:UNUSED_PRESERVE src0_sel:WORD_1
v_rcp_f16 v67, v75
v_pk_mul_f16 v88, v88, v64
v_cvt_pk_f16_f32 v97, v140, v141
v_pk_fma_f16 v80, v96, v96, s84
v_rcp_f16_sdwa v65, v73 dst_sel:WORD_1 dst_unused:UNUSED_PRESERVE src0_sel:WORD_1
v_pk_mul_f16 v79, v95, v79
v_pk_mul_f16 v89, v89, v65
v_cvt_pk_f16_f32 v98, v142, v143
v_rcp_f16 v68, v76
v_pk_fma_f16 v81, v97, v97, s84
v_rcp_f16_sdwa v66, v74 dst_sel:WORD_1 dst_unused:UNUSED_PRESERVE src0_sel:WORD_1
v_rcp_f16 v69, v77
v_pk_mul_f16 v90, v90, v66
v_pk_mul_f16 v80, v96, v80
v_cvt_pk_f16_f32 v99, v144, v145
v_mfma_f32_32x32x16_bf16 v[134:149], a[72:75], a[192:195], 0
ds_read_b128 a[192:195], v1 offset:0
ds_read_b128 a[176:179], v9 offset:52352
ds_read_b128 a[148:151], v5 offset:11264
ds_read_b128 a[156:159], v8 offset:54528
v_rcp_f16_sdwa v67, v75 dst_sel:WORD_1 dst_unused:UNUSED_PRESERVE src0_sel:WORD_1
v_rcp_f16_sdwa v68, v76 dst_sel:WORD_1 dst_unused:UNUSED_PRESERVE src0_sel:WORD_1
v_mfma_f32_32x32x16_bf16 v[134:149], a[76:79], a[196:199], v[134:149]
ds_read_b128 a[196:199], v1 offset:1024
ds_read_b128 a[160:163], v9 offset:54528
ds_read_b128 a[152:155], v5 offset:12800
s_add_u32 m0, s73, 100096
ds_read_u16_d16_hi v150, v150
v_pk_mul_f16 v91, v91, v67
v_rcp_f16_sdwa v69, v77 dst_sel:WORD_1 dst_unused:UNUSED_PRESERVE src0_sel:WORD_1
s_waitcnt lgkmcnt(7)
v_pk_add_f32 v[40:41], v[40:41], v[132:133]
v_pk_add_f32 v[40:41], v[40:41], v[130:131]
v_pk_add_f32 v[40:41], v[40:41], v[128:129]
v_exp_f16 v62, v78
v_pk_add_f32 v[40:41], v[40:41], v[126:127]
v_pk_add_f32 v[40:41], v[40:41], v[124:125]
v_pk_add_f32 v[40:41], v[40:41], v[122:123]
v_exp_f16 v63, v79
v_pk_add_f32 v[40:41], v[40:41], v[120:121]
v_pk_add_f32 v[40:41], v[40:41], v[118:119]
v_smfmac_f32_32x32x32_bf16 v[192:207], a[144:147], a[164:171], v4
ds_read_b128 a[164:167], v8 offset:56704
v_pk_fma_f16 v82, v98, v98, s84
v_pk_mul_f16 v81, v97, v81
v_pk_mul_f16 v92, v92, v68
v_pk_fma_f16 v83, v99, v99, s84
v_exp_f16 v64, v80
v_mfma_f32_32x32x16_f16 v[118:133], v[86:89], a[240:243], 0
ds_read_b128 a[168:171], v9 offset:56704
buffer_load_dwordx4 v15, s[4:7], s89 offen  lds
ds_read_u16_d16_hi v151, v151
ds_read_u16_d16_hi v152, v152
v_pk_mul_f16 v82, v98, v82
v_pk_mul_f16 v83, v99, v83
v_mfma_f32_32x32x16_bf16 v[134:149], a[80:83], a[200:203], v[134:149]
ds_read_b128 a[200:203], v1 offset:2048
ds_read_u16_d16_hi v153, v153
v_pk_mul_f16 v93, v93, v69
v_exp_f16_sdwa v62, v78 dst_sel:WORD_1 dst_unused:UNUSED_PRESERVE src0_sel:WORD_1
v_mad_u32_u16 v102, v102, 2, s85 op_sel:[1,0,0,0]
v_mad_u32_u16 v103, v103, 2, s85 op_sel:[1,0,0,0]
v_mad_u32_u16 v104, v104, 2, s85 op_sel:[1,0,0,0]
s_waitcnt lgkmcnt(4)
v_smfmac_f32_32x32x32_bf16 v[192:207], a[148:151], a[172:179], v4
ds_read_u16_d16_hi v102, v102
v_mad_u32_u16 v105, v105, 2, s85 op_sel:[1,0,0,0]
v_mad_u32_u16 v106, v106, 2, s85 op_sel:[1,0,0,0]
v_mad_u32_u16 v107, v107, 2, s85 op_sel:[1,0,0,0]
v_mad_u32_u16 v108, v108, 2, s85 op_sel:[1,0,0,0]
v_mad_u32_u16 v109, v109, 2, s85 op_sel:[1,0,0,0]
v_mad_u32_u16 v110, v110, 2, s85 op_sel:[1,0,0,0]
v_mfma_f32_32x32x16_f16 v[118:133], v[90:93], a[244:247], v[118:133]
ds_read_u16_d16_hi v103, v103
ds_read_u16_d16_hi v104, v104
ds_read_u16_d16_hi v105, v105
ds_read_u16_d16_hi v106, v106
v_mad_u32_u16 v111, v111, 2, s85 op_sel:[1,0,0,0]
v_mad_u32_u16 v112, v112, 2, s85 op_sel:[1,0,0,0]
v_pk_add_f16 v78, v62, 1.0 op_sel_hi:[1,0]
v_exp_f16 v65, v81
v_mfma_f32_32x32x16_bf16 v[134:149], a[84:87], a[204:207], v[134:149]
ds_read_b128 a[204:207], v1 offset:3072
s_add_u32 m0, s74, 100096
ds_read_u16_d16_hi v107, v107
buffer_load_dwordx4 v16, s[4:7], s89 offen  lds
ds_read_u16_d16_hi v108, v108
v_mad_u32_u16 v113, v113, 2, s85 op_sel:[1,0,0,0]
v_pk_fma_f32 v[38:39], v[118:119], v[118:119], v[38:39]
v_pk_fma_f32 v[38:39], v[120:121], v[120:121], v[38:39]
v_pk_fma_f32 v[38:39], v[122:123], v[122:123], v[38:39]
v_pk_fma_f32 v[38:39], v[124:125], v[124:125], v[38:39]
v_exp_f16_sdwa v63, v79 dst_sel:WORD_1 dst_unused:UNUSED_PRESERVE src0_sel:WORD_1
v_pk_fma_f32 v[38:39], v[126:127], v[126:127], v[38:39]
v_pk_fma_f32 v[38:39], v[128:129], v[128:129], v[38:39]
v_pk_fma_f32 v[38:39], v[130:131], v[130:131], v[38:39]
v_exp_f16 v66, v82
v_pk_fma_f32 v[38:39], v[132:133], v[132:133], v[38:39]
v_smfmac_f32_32x32x32_bf16 v[240:255], a[144:147], a[172:179], v4
ds_read_b128 a[172:175], v10 offset:50176
v_pk_add_f16 v79, v63, 1.0 op_sel_hi:[1,0]
v_mad_u32_u16 v114, v114, 2, s85 op_sel:[1,0,0,0]
v_exp_f16_sdwa v64, v80 dst_sel:WORD_1 dst_unused:UNUSED_PRESERVE src0_sel:WORD_1
v_exp_f16 v67, v83
v_mfma_f32_32x32x16_bf16 v[134:149], a[88:91], a[208:211], v[134:149]
ds_read_b128 a[208:211], v1 offset:4096
ds_read_b128 a[176:179], v11 offset:50176
ds_read_b128 a[144:147], v5 offset:10240
ds_read_u16_d16_hi v109, v109
v_exp_f16_sdwa v65, v81 dst_sel:WORD_1 dst_unused:UNUSED_PRESERVE src0_sel:WORD_1
v_pk_add_f16 v80, v64, 1.0 op_sel_hi:[1,0]
v_mad_u32_u16 v115, v115, 2, s85 op_sel:[1,0,0,0]
v_smfmac_f32_32x32x32_bf16 v[192:207], a[152:155], a[156:163], v4
s_add_u32 m0, s75, 100096
ds_read_u16_d16_hi v110, v110
v_pk_add_f16 v81, v65, 1.0 op_sel_hi:[1,0]
v_mad_u32_u16 v116, v116, 2, s85 op_sel:[1,0,0,0]
v_exp_f16_sdwa v66, v82 dst_sel:WORD_1 dst_unused:UNUSED_PRESERVE src0_sel:WORD_1
v_exp_f16_sdwa v67, v83 dst_sel:WORD_1 dst_unused:UNUSED_PRESERVE src0_sel:WORD_1
v_mfma_f32_32x32x16_bf16 v[134:149], a[92:95], a[212:215], v[134:149]
ds_read_b128 a[212:215], v1 offset:5120
buffer_load_dwordx4 v17, s[4:7], s89 offen  lds
ds_read_u16_d16_hi v111, v111
ds_read_u16_d16_hi v112, v112
v_pk_add_f16 v82, v66, 1.0 op_sel_hi:[1,0]
v_rcp_f16 v62, v78
v_smfmac_f32_32x32x32_bf16 v[240:255], a[148:151], a[156:163], v4
ds_read_b128 a[156:159], v10 offset:52352
v_mad_u32_u16 v117, v117, 2, s85 op_sel:[1,0,0,0]
v_pk_add_f16 v83, v67, 1.0 op_sel_hi:[1,0]
v_add_f32 v40, v40, v150
s_waitcnt lgkmcnt(7)
v_add_f32 v41, v41, v151
v_add_f32 v40, v40, v152
v_mfma_f32_32x32x16_bf16 v[118:133], a[48:51], a[216:219], 0
ds_read_b128 a[160:163], v11 offset:52352
ds_read_b128 a[148:151], v5 offset:11776
ds_read_u16_d16_hi v113, v113
v_add_f32 v41, v41, v153
v_mul_f32 v150, s60, v146
v_mul_f32 v151, s60, v147
v_mul_f32 v152, s60, v148
v_mul_f32 v153, s60, v149
v_smfmac_f32_32x32x32_bf16 v[240:255], a[152:155], a[164:171], v4
ds_read_b128 a[164:167], v10 offset:54528
v_mad_u32_u16 v150, v150, 2, s85 op_sel:[1,0,0,0]
v_mad_u32_u16 v151, v151, 2, s85 op_sel:[1,0,0,0]
v_mad_u32_u16 v152, v152, 2, s85 op_sel:[1,0,0,0]
v_mad_u32_u16 v153, v153, 2, s85 op_sel:[1,0,0,0]
v_rcp_f16 v63, v79
v_mfma_f32_32x32x16_bf16 v[118:133], a[52:55], a[220:223], v[118:133]
ds_read_b128 a[168:171], v11 offset:54528
ds_read_b128 a[152:155], v5 offset:13312
ds_read_u16_d16_hi v114, v114
buffer_store_dwordx4 v[86:89], v1, s[12:15], s101 offen offset:0 sc1
s_waitcnt lgkmcnt(9)
v_smfmac_f32_32x32x32_bf16 v[192:207], a[144:147], a[172:179], v4
ds_read_b128 a[172:175], v10 offset:56704
v_cvt_pk_f16_f32 v86, v134, v135
v_cvt_pk_f16_f32 v87, v136, v137
v_pk_fma_f16 v70, v86, v86, s84
v_rcp_f16 v64, v80
v_rcp_f16_sdwa v62, v78 dst_sel:WORD_1 dst_unused:UNUSED_PRESERVE src0_sel:WORD_1
v_mfma_f32_32x32x16_bf16 v[118:133], a[56:59], a[224:227], v[118:133]
ds_read_b128 a[176:179], v11 offset:56704
ds_read_u16_d16_hi v115, v115
v_pk_mul_f16 v94, v94, v62
v_cvt_pk_f16_f32 v88, v138, v139
v_rcp_f16 v65, v81
v_pk_fma_f16 v71, v87, v87, s84
v_pk_mul_f16 v70, v86, v70
v_mfma_f32_32x32x16_bf16 v[118:133], a[60:63], a[228:231], v[118:133]
ds_read_u16_d16_hi v116, v116
ds_read_u16_d16_hi v117, v117
ds_read_u16_d16_hi v150, v150
v_rcp_f16_sdwa v63, v79 dst_sel:WORD_1 dst_unused:UNUSED_PRESERVE src0_sel:WORD_1
v_rcp_f16 v66, v82
v_pk_mul_f16 v95, v95, v63
s_waitcnt lgkmcnt(8)
v_smfmac_f32_32x32x32_bf16 v[192:207], a[148:151], a[156:163], v4
ds_read_u16_d16_hi v151, v151
v_cvt_pk_f16_f32 v89, v140, v141
v_pk_fma_f16 v72, v88, v88, s84
v_pk_mul_f16 v71, v87, v71
v_rcp_f16_sdwa v64, v80 dst_sel:WORD_1 dst_unused:UNUSED_PRESERVE src0_sel:WORD_1
v_rcp_f16 v67, v83
v_mfma_f32_32x32x16_bf16 v[118:133], a[64:67], a[232:235], v[118:133]
ds_read_u16_d16_hi v152, v152
ds_read_u16_d16_hi v153, v153
buffer_store_dwordx4 v[90:93], v1, s[12:15], s101 offen offset:1024 sc1
v_smfmac_f32_32x32x32_bf16 v[240:255], a[144:147], a[156:163], v4
v_pk_mul_f16 v96, v96, v64
v_cvt_pk_f16_f32 v90, v142, v143
v_pk_fma_f16 v73, v89, v89, s84
v_pk_mul_f16 v72, v88, v72
v_rcp_f16_sdwa v65, v81 dst_sel:WORD_1 dst_unused:UNUSED_PRESERVE src0_sel:WORD_1
v_rcp_f16_sdwa v66, v82 dst_sel:WORD_1 dst_unused:UNUSED_PRESERVE src0_sel:WORD_1
s_waitcnt vmcnt(9) lgkmcnt(5)
ds_write_b32 v154, v156
v_mfma_f32_32x32x16_bf16 v[118:133], a[68:71], a[236:239], v[118:133]
v_pk_mul_f16 v97, v97, v65
v_cvt_pk_f16_f32 v91, v144, v145
v_pk_fma_f16 v74, v90, v90, s84
v_pk_mul_f16 v73, v89, v73
v_pk_mul_f16 v98, v98, v66
v_pk_fma_f16 v75, v91, v91, s84
v_rcp_f16_sdwa v67, v83 dst_sel:WORD_1 dst_unused:UNUSED_PRESERVE src0_sel:WORD_1
v_smfmac_f32_32x32x32_bf16 v[192:207], a[152:155], a[164:171], v4
v_pk_mul_f16 v74, v90, v74
v_pk_mul_f16 v75, v91, v75
v_pk_mul_f16 v99, v99, v67
v_exp_f16 v62, v70
v_mad_u32_u16 v118, v118, 2, s85 op_sel:[1,0,0,0]
v_mad_u32_u16 v119, v119, 2, s85 op_sel:[1,0,0,0]
s_waitcnt lgkmcnt(3)
v_pk_add_f32 v[42:43], v[42:43], v[116:117]
v_pk_add_f32 v[42:43], v[42:43], v[114:115]
v_pk_add_f32 v[42:43], v[42:43], v[112:113]
v_pk_add_f32 v[42:43], v[42:43], v[110:111]
v_exp_f16 v63, v71
v_pk_add_f32 v[42:43], v[42:43], v[108:109]
v_pk_add_f32 v[42:43], v[42:43], v[106:107]
v_pk_add_f32 v[42:43], v[42:43], v[104:105]
v_pk_add_f32 v[42:43], v[42:43], v[102:103]
v_dot2c_f32_f16 v41, v99, v99
v_dot2c_f32_f16 v40, v98, v98
v_dot2c_f32_f16 v41, v97, v97
v_dot2c_f32_f16 v40, v96, v96
v_dot2c_f32_f16 v41, v95, v95
v_dot2c_f32_f16 v40, v94, v94
v_pk_fma_f32 v[48:49], v[192:193], v[192:193], v[48:49]
v_pk_add_f32 v[46:47], v[46:47], v[192:193]
v_pk_fma_f32 v[48:49], v[194:195], v[194:195], v[48:49]
v_pk_add_f32 v[46:47], v[46:47], v[194:195]
v_pk_fma_f32 v[48:49], v[196:197], v[196:197], v[48:49]
v_exp_f16 v64, v72
v_pk_add_f32 v[46:47], v[46:47], v[196:197]
v_pk_fma_f32 v[48:49], v[198:199], v[198:199], v[48:49]
v_pk_add_f32 v[46:47], v[46:47], v[198:199]
v_exp_f16_sdwa v62, v70 dst_sel:WORD_1 dst_unused:UNUSED_PRESERVE src0_sel:WORD_1
v_pk_fma_f32 v[48:49], v[200:201], v[200:201], v[48:49]
v_pk_add_f32 v[46:47], v[46:47], v[200:201]
v_pk_fma_f32 v[48:49], v[202:203], v[202:203], v[48:49]
v_exp_f16 v65, v73
v_pk_add_f32 v[46:47], v[46:47], v[202:203]
v_pk_fma_f32 v[48:49], v[204:205], v[204:205], v[48:49]
v_pk_add_f32 v[46:47], v[46:47], v[204:205]
v_pk_fma_f32 v[48:49], v[206:207], v[206:207], v[48:49]
v_pk_add_f32 v[46:47], v[46:47], v[206:207]
v_mfma_f32_32x32x16_bf16 v[134:149], a[216:219], a[72:75], 0
ds_read_b128 a[216:219], v1 offset:6144
ds_read_u16_d16_hi v118, v118
ds_read_u16_d16_hi v119, v119
s_add_u32 s101, s3, 47104
v_mad_u32_u16 v120, v120, 2, s85 op_sel:[1,0,0,0]
v_mad_u32_u16 v121, v121, 2, s85 op_sel:[1,0,0,0]
v_mad_u32_u16 v122, v122, 2, s85 op_sel:[1,0,0,0]
v_smfmac_f32_32x32x32_bf16 v[240:255], a[148:151], a[164:171], v4
ds_read_u16_d16_hi v120, v120
v_mad_u32_u16 v123, v123, 2, s85 op_sel:[1,0,0,0]
v_mad_u32_u16 v124, v124, 2, s85 op_sel:[1,0,0,0]
v_mad_u32_u16 v125, v125, 2, s85 op_sel:[1,0,0,0]
v_mad_u32_u16 v126, v126, 2, s85 op_sel:[1,0,0,0]
v_mad_u32_u16 v127, v127, 2, s85 op_sel:[1,0,0,0]
v_mad_u32_u16 v128, v128, 2, s85 op_sel:[1,0,0,0]
v_mfma_f32_32x32x16_bf16 v[134:149], a[220:223], a[76:79], v[134:149]
ds_read_b128 a[220:223], v1 offset:7168
ds_read_u16_d16_hi v121, v121
ds_read_u16_d16_hi v122, v122
ds_read_u16_d16_hi v123, v123
v_pk_add_f16 v70, v62, 1.0 op_sel_hi:[1,0]
v_mad_u32_u16 v129, v129, 2, s85 op_sel:[1,0,0,0]
v_exp_f16_sdwa v63, v71 dst_sel:WORD_1 dst_unused:UNUSED_PRESERVE src0_sel:WORD_1
v_smfmac_f32_32x32x32_bf16 v[240:255], a[152:155], a[172:179], v4
ds_read_u16_d16_hi v124, v124
v_pk_add_f16 v71, v63, 1.0 op_sel_hi:[1,0]
v_mad_u32_u16 v130, v130, 2, s85 op_sel:[1,0,0,0]
v_exp_f16 v66, v74
v_exp_f16_sdwa v64, v72 dst_sel:WORD_1 dst_unused:UNUSED_PRESERVE src0_sel:WORD_1
v_mfma_f32_32x32x16_bf16 v[134:149], a[224:227], a[80:83], v[134:149]
ds_read_b128 a[224:227], v1 offset:8192
ds_read_u16_d16_hi v125, v125
ds_read_u16_d16_hi v126, v126
ds_read_u16_d16_hi v127, v127
v_exp_f16 v67, v75
v_pk_add_f16 v72, v64, 1.0 op_sel_hi:[1,0]
v_mad_u32_u16 v131, v131, 2, s85 op_sel:[1,0,0,0]
v_pk_fma_f32 v[52:53], v[240:241], v[240:241], v[52:53]
v_pk_add_f32 v[50:51], v[50:51], v[240:241]
v_pk_fma_f32 v[52:53], v[242:243], v[242:243], v[52:53]
v_pk_add_f32 v[50:51], v[50:51], v[242:243]
v_pk_fma_f32 v[52:53], v[244:245], v[244:245], v[52:53]
v_pk_add_f32 v[50:51], v[50:51], v[244:245]
v_pk_fma_f32 v[52:53], v[246:247], v[246:247], v[52:53]
v_pk_add_f32 v[50:51], v[50:51], v[246:247]
v_pk_fma_f32 v[52:53], v[248:249], v[248:249], v[52:53]
v_pk_add_f32 v[50:51], v[50:51], v[248:249]
v_pk_fma_f32 v[52:53], v[250:251], v[250:251], v[52:53]
v_pk_add_f32 v[50:51], v[50:51], v[250:251]
v_pk_fma_f32 v[52:53], v[252:253], v[252:253], v[52:53]
v_pk_add_f32 v[50:51], v[50:51], v[252:253]
v_pk_fma_f32 v[52:53], v[254:255], v[254:255], v[52:53]
v_pk_add_f32 v[50:51], v[50:51], v[254:255]
v_mfma_f32_32x32x16_bf16 v[134:149], a[228:231], a[84:87], v[134:149]
ds_read_b128 a[228:231], v1 offset:9216
ds_read_u16_d16_hi v128, v128
ds_read_u16_d16_hi v129, v129
ds_read_u16_d16_hi v130, v130
v_add_f32 v46, v46, v47
v_exp_f16_sdwa v65, v73 dst_sel:WORD_1 dst_unused:UNUSED_PRESERVE src0_sel:WORD_1
v_add_f32 v48, v48, v49
v_mfma_f32_32x32x16_bf16 v[134:149], a[232:235], a[88:91], v[134:149]
ds_read_b128 a[232:235], v1 offset:10240
ds_read_u16_d16_hi v131, v131
v_add_f32 v50, v50, v51
v_pk_add_f16 v73, v65, 1.0 op_sel_hi:[1,0]
v_add_f32 v52, v52, v53
v_mad_u32_u16 v132, v132, 2, s85 op_sel:[1,0,0,0]
v_permlane32_swap_b32 v46, v48
v_mfma_f32_32x32x16_bf16 v[134:149], a[236:239], a[92:95], v[134:149]
ds_read_b128 a[236:239], v1 offset:11264
ds_read_u16_d16_hi v132, v132
v_permlane32_swap_b32 v50, v52
v_exp_f16_sdwa v66, v74 dst_sel:WORD_1 dst_unused:UNUSED_PRESERVE src0_sel:WORD_1
v_add_f32 v46, v46, v48
v_pk_add_f16 v74, v66, 1.0 op_sel_hi:[1,0]
v_add_f32 v50, v50, v52
v_mad_u32_u16 v133, v133, 2, s85 op_sel:[1,0,0,0]
v_mov_b32 v48, v46
v_exp_f16_sdwa v67, v75 dst_sel:WORD_1 dst_unused:UNUSED_PRESERVE src0_sel:WORD_1
v_mov_b32 v52, v50
v_pk_add_f16 v75, v67, 1.0 op_sel_hi:[1,0]
v_permlane32_swap_b32 v46, v48
v_add_f32 v42, v42, v150
v_permlane32_swap_b32 v50, v52
v_add_f32 v43, v43, v151
v_mul_f32 v46, 0x3c2aaaab, v46
s_waitcnt lgkmcnt(6)
v_add_f32 v42, v42, v152
v_mul_f32 v50, 0x3c2aaaab, v50
v_add_f32 v43, v43, v153
v_mul_f32 v48, 0x3c2aaaab, v48
v_cvt_pk_f16_f32 v94, v134, v135
v_mul_f32 v52, 0x3c2aaaab, v52
v_cvt_pk_f16_f32 v95, v136, v137
v_rcp_f16 v62, v70
v_fma_f32 v48, -v46, v46, v48
v_pk_fma_f16 v78, v94, v94, s84
v_fma_f32 v52, -v50, v50, v52
v_cvt_pk_f16_f32 v96, v138, v139
v_max_f32 v48, 0, v48
v_pk_fma_f16 v79, v95, v95, s84
v_max_f32 v52, 0, v52
v_pk_mul_f16 v78, v94, v78
v_add_f32 v48, 0x3727c5ac, v48
v_rcp_f16 v63, v71
v_add_f32 v52, 0x3727c5ac, v52
v_cvt_pk_f16_f32 v97, v140, v141
v_rsq_f32 v48, v48
v_pk_fma_f16 v80, v96, v96, s84
v_rsq_f32 v52, v52
v_pk_mul_f16 v79, v95, v79
v_mul_f32 v48, s86, v48
v_cvt_pk_f16_f32 v98, v142, v143
v_mul_f32_e64 v46, -v46, v48
v_rcp_f16 v64, v72
v_pk_fma_f32 v[160:161], v[160:161], v[48:49], v[46:47] op_sel_hi:[1,0,0]
v_pk_fma_f32 v[162:163], v[162:163], v[48:49], v[46:47] op_sel_hi:[1,0,0]
v_pk_fma_f32 v[164:165], v[164:165], v[48:49], v[46:47] op_sel_hi:[1,0,0]
v_rcp_f16_sdwa v62, v70 dst_sel:WORD_1 dst_unused:UNUSED_PRESERVE src0_sel:WORD_1
v_pk_fma_f32 v[166:167], v[166:167], v[48:49], v[46:47] op_sel_hi:[1,0,0]
v_pk_fma_f32 v[168:169], v[168:169], v[48:49], v[46:47] op_sel_hi:[1,0,0]
v_pk_fma_f32 v[170:171], v[170:171], v[48:49], v[46:47] op_sel_hi:[1,0,0]
v_rcp_f16 v65, v73
v_pk_fma_f32 v[172:173], v[172:173], v[48:49], v[46:47] op_sel_hi:[1,0,0]
v_pk_fma_f32 v[174:175], v[174:175], v[48:49], v[46:47] op_sel_hi:[1,0,0]
v_pk_fma_f32 v[176:177], v[176:177], v[48:49], v[46:47] op_sel_hi:[1,0,0]
v_pk_fma_f32 v[178:179], v[178:179], v[48:49], v[46:47] op_sel_hi:[1,0,0]
v_pk_fma_f32 v[180:181], v[180:181], v[48:49], v[46:47] op_sel_hi:[1,0,0]
v_pk_fma_f32 v[182:183], v[182:183], v[48:49], v[46:47] op_sel_hi:[1,0,0]
v_pk_fma_f32 v[184:185], v[184:185], v[48:49], v[46:47] op_sel_hi:[1,0,0]
v_pk_fma_f32 v[186:187], v[186:187], v[48:49], v[46:47] op_sel_hi:[1,0,0]
v_pk_fma_f32 v[188:189], v[188:189], v[48:49], v[46:47] op_sel_hi:[1,0,0]
v_pk_fma_f32 v[190:191], v[190:191], v[48:49], v[46:47] op_sel_hi:[1,0,0]
v_pk_fma_f32 v[192:193], v[192:193], v[48:49], v[46:47] op_sel_hi:[1,0,0]
v_pk_fma_f32 v[194:195], v[194:195], v[48:49], v[46:47] op_sel_hi:[1,0,0]
v_pk_fma_f32 v[196:197], v[196:197], v[48:49], v[46:47] op_sel_hi:[1,0,0]
v_pk_fma_f32 v[198:199], v[198:199], v[48:49], v[46:47] op_sel_hi:[1,0,0]
v_pk_fma_f32 v[200:201], v[200:201], v[48:49], v[46:47] op_sel_hi:[1,0,0]
v_pk_fma_f32 v[202:203], v[202:203], v[48:49], v[46:47] op_sel_hi:[1,0,0]
v_pk_fma_f32 v[204:205], v[204:205], v[48:49], v[46:47] op_sel_hi:[1,0,0]
v_pk_fma_f32 v[206:207], v[206:207], v[48:49], v[46:47] op_sel_hi:[1,0,0]
v_pk_mul_f16 v86, v86, v62
v_mul_f32 v52, 0xbeeff558, v52
v_pk_fma_f16 v81, v97, v97, s84
v_mul_f32_e64 v50, -v50, v52
v_pk_fma_f32 v[208:209], v[208:209], v[52:53], v[50:51] op_sel_hi:[1,0,0]
v_pk_fma_f32 v[210:211], v[210:211], v[52:53], v[50:51] op_sel_hi:[1,0,0]
v_pk_fma_f32 v[212:213], v[212:213], v[52:53], v[50:51] op_sel_hi:[1,0,0]
v_pk_fma_f32 v[214:215], v[214:215], v[52:53], v[50:51] op_sel_hi:[1,0,0]
v_pk_fma_f32 v[216:217], v[216:217], v[52:53], v[50:51] op_sel_hi:[1,0,0]
v_pk_fma_f32 v[218:219], v[218:219], v[52:53], v[50:51] op_sel_hi:[1,0,0]
v_pk_fma_f32 v[220:221], v[220:221], v[52:53], v[50:51] op_sel_hi:[1,0,0]
v_pk_fma_f32 v[222:223], v[222:223], v[52:53], v[50:51] op_sel_hi:[1,0,0]
v_pk_fma_f32 v[224:225], v[224:225], v[52:53], v[50:51] op_sel_hi:[1,0,0]
v_pk_fma_f32 v[226:227], v[226:227], v[52:53], v[50:51] op_sel_hi:[1,0,0]
v_pk_fma_f32 v[228:229], v[228:229], v[52:53], v[50:51] op_sel_hi:[1,0,0]
v_pk_fma_f32 v[230:231], v[230:231], v[52:53], v[50:51] op_sel_hi:[1,0,0]
v_pk_fma_f32 v[232:233], v[232:233], v[52:53], v[50:51] op_sel_hi:[1,0,0]
v_pk_fma_f32 v[234:235], v[234:235], v[52:53], v[50:51] op_sel_hi:[1,0,0]
v_pk_fma_f32 v[236:237], v[236:237], v[52:53], v[50:51] op_sel_hi:[1,0,0]
v_pk_fma_f32 v[238:239], v[238:239], v[52:53], v[50:51] op_sel_hi:[1,0,0]
v_pk_fma_f32 v[240:241], v[240:241], v[52:53], v[50:51] op_sel_hi:[1,0,0]
v_pk_fma_f32 v[242:243], v[242:243], v[52:53], v[50:51] op_sel_hi:[1,0,0]
v_pk_fma_f32 v[244:245], v[244:245], v[52:53], v[50:51] op_sel_hi:[1,0,0]
v_pk_fma_f32 v[246:247], v[246:247], v[52:53], v[50:51] op_sel_hi:[1,0,0]
v_pk_fma_f32 v[248:249], v[248:249], v[52:53], v[50:51] op_sel_hi:[1,0,0]
v_pk_fma_f32 v[250:251], v[250:251], v[52:53], v[50:51] op_sel_hi:[1,0,0]
v_pk_fma_f32 v[252:253], v[252:253], v[52:53], v[50:51] op_sel_hi:[1,0,0]
v_pk_fma_f32 v[254:255], v[254:255], v[52:53], v[50:51] op_sel_hi:[1,0,0]
v_pk_mul_f16 v80, v96, v80
v_cvt_pk_bf16_f32 v54, v160, v161
v_cvt_pk_f16_f32 v99, v144, v145
v_cvt_pk_bf16_f32 v55, v162, v163
v_rcp_f16_sdwa v63, v71 dst_sel:WORD_1 dst_unused:UNUSED_PRESERVE src0_sel:WORD_1
v_cvt_pk_bf16_f32 v56, v164, v165
v_pk_mul_f16 v87, v87, v63
v_accvgpr_write_b32 a96, v54
v_pk_fma_f16 v82, v98, v98, s84
v_cvt_pk_bf16_f32 v57, v166, v167
v_rcp_f16 v66, v74
v_accvgpr_write_b32 a97, v55
v_pk_mul_f16 v81, v97, v81
v_cvt_pk_bf16_f32 v58, v168, v169
v_rcp_f16_sdwa v64, v72 dst_sel:WORD_1 dst_unused:UNUSED_PRESERVE src0_sel:WORD_1
v_accvgpr_write_b32 a98, v56
v_cvt_pk_f16_f32 v100, v146, v147
v_cvt_pk_bf16_f32 v59, v170, v171
v_rcp_f16 v67, v75
v_accvgpr_write_b32 a99, v57
v_pk_mul_f16 v88, v88, v64
v_cvt_pk_bf16_f32 v60, v172, v173
v_mfma_f32_32x32x16_bf16 v[102:117], a[96:99], a[192:195], 0
ds_read_u16_d16_hi v133, v133
v_accvgpr_write_b32 a100, v58
v_pk_fma_f16 v83, v99, v99, s84
v_cvt_pk_bf16_f32 v61, v174, v175
v_pk_mul_f16 v82, v98, v82
v_accvgpr_write_b32 a101, v59
v_rcp_f16_sdwa v65, v73 dst_sel:WORD_1 dst_unused:UNUSED_PRESERVE src0_sel:WORD_1
v_mfma_f32_32x32x16_bf16 v[160:175], a[248:251], a[248:251], 0
v_cvt_pk_bf16_f32 v54, v176, v177
v_pk_mul_f16 v89, v89, v65
v_accvgpr_write_b32 a102, v60
v_cvt_pk_f16_f32 v101, v148, v149
v_cvt_pk_bf16_f32 v55, v178, v179
v_pk_fma_f16 v84, v100, v100, s84
v_accvgpr_write_b32 a103, v61
v_pk_mul_f16 v83, v99, v83
v_cvt_pk_bf16_f32 v56, v180, v181
v_mfma_f32_32x32x16_bf16 v[102:117], a[100:103], a[196:199], v[102:117]
v_accvgpr_write_b32 a104, v54
v_rcp_f16_sdwa v66, v74 dst_sel:WORD_1 dst_unused:UNUSED_PRESERVE src0_sel:WORD_1
v_cvt_pk_bf16_f32 v57, v182, v183
v_pk_mul_f16 v90, v90, v66
v_accvgpr_write_b32 a105, v55
v_pk_fma_f16 v85, v101, v101, s84
v_cvt_pk_bf16_f32 v58, v184, v185
v_pk_mul_f16 v84, v100, v84
s_waitcnt lgkmcnt(0)
v_pk_add_f32 v[44:45], v[44:45], v[132:133]
v_pk_add_f32 v[44:45], v[44:45], v[130:131]
v_pk_add_f32 v[44:45], v[44:45], v[128:129]
v_pk_add_f32 v[44:45], v[44:45], v[126:127]
v_pk_add_f32 v[44:45], v[44:45], v[124:125]
v_rcp_f16_sdwa v67, v75 dst_sel:WORD_1 dst_unused:UNUSED_PRESERVE src0_sel:WORD_1
v_pk_add_f32 v[44:45], v[44:45], v[122:123]
v_pk_add_f32 v[44:45], v[44:45], v[120:121]
v_pk_add_f32 v[44:45], v[44:45], v[118:119]
v_exp_f16 v62, v78
v_accvgpr_write_b32 a106, v56
v_pk_mul_f16 v85, v101, v85
v_cvt_pk_bf16_f32 v59, v186, v187
v_pk_mul_f16 v91, v91, v67
v_dot2c_f32_f16 v43, v91, v91
v_dot2c_f32_f16 v42, v90, v90
v_dot2c_f32_f16 v43, v89, v89
v_dot2c_f32_f16 v42, v88, v88
v_dot2c_f32_f16 v43, v87, v87
v_dot2c_f32_f16 v42, v86, v86
v_accvgpr_write_b32 a107, v57
v_exp_f16 v63, v79
v_cvt_pk_bf16_f32 v60, v188, v189
v_mfma_f32_32x32x16_bf16 v[102:117], a[104:107], a[200:203], v[102:117]
v_accvgpr_write_b32 a108, v58
v_exp_f16 v64, v80
v_cvt_pk_bf16_f32 v61, v190, v191
v_exp_f16_sdwa v62, v78 dst_sel:WORD_1 dst_unused:UNUSED_PRESERVE src0_sel:WORD_1
v_accvgpr_write_b32 a109, v59
v_exp_f16 v65, v81
v_cvt_pk_bf16_f32 v54, v192, v193
v_exp_f16_sdwa v63, v79 dst_sel:WORD_1 dst_unused:UNUSED_PRESERVE src0_sel:WORD_1
v_accvgpr_write_b32 a110, v60
v_exp_f16 v66, v82
v_cvt_pk_bf16_f32 v55, v194, v195
v_exp_f16_sdwa v64, v80 dst_sel:WORD_1 dst_unused:UNUSED_PRESERVE src0_sel:WORD_1
v_accvgpr_write_b32 a111, v61
v_exp_f16 v67, v83
v_cvt_pk_bf16_f32 v56, v196, v197
v_mfma_f32_32x32x16_bf16 v[102:117], a[108:111], a[204:207], v[102:117]
global_load_dword a255, v[158:159], off
v_accvgpr_write_b32 a112, v54
v_exp_f16_sdwa v65, v81 dst_sel:WORD_1 dst_unused:UNUSED_PRESERVE src0_sel:WORD_1
v_lshl_add_u64 v[158:159], v[158:159], 0, s[42:43]
v_cvt_pk_bf16_f32 v57, v198, v199
v_exp_f16 v68, v84
v_accvgpr_write_b32 a113, v55
v_exp_f16_sdwa v66, v82 dst_sel:WORD_1 dst_unused:UNUSED_PRESERVE src0_sel:WORD_1
v_cvt_pk_bf16_f32 v58, v200, v201
v_exp_f16 v69, v85
v_accvgpr_write_b32 a114, v56
v_exp_f16_sdwa v67, v83 dst_sel:WORD_1 dst_unused:UNUSED_PRESERVE src0_sel:WORD_1
v_cvt_pk_bf16_f32 v59, v202, v203
v_exp_f16_sdwa v68, v84 dst_sel:WORD_1 dst_unused:UNUSED_PRESERVE src0_sel:WORD_1
v_accvgpr_write_b32 a115, v57
v_exp_f16_sdwa v69, v85 dst_sel:WORD_1 dst_unused:UNUSED_PRESERVE src0_sel:WORD_1
v_cvt_pk_bf16_f32 v60, v204, v205
v_mfma_f32_32x32x16_bf16 v[102:117], a[112:115], a[208:211], v[102:117]
v_accvgpr_write_b32 a116, v58
v_cvt_pk_bf16_f32 v61, v206, v207
v_accvgpr_write_b32 a117, v59
v_cvt_pk_bf16_f32 v54, v208, v209
v_accvgpr_write_b32 a118, v60
v_cvt_pk_bf16_f32 v55, v210, v211
v_accvgpr_write_b32 a119, v61
v_cvt_pk_bf16_f32 v56, v212, v213
v_accvgpr_write_b32 a120, v54
v_mfma_f32_32x32x16_bf16 v[102:117], a[116:119], a[212:215], v[102:117]
v_cvt_pk_bf16_f32 v57, v214, v215
v_accvgpr_write_b32 a121, v55
v_cvt_pk_bf16_f32 v58, v216, v217
v_accvgpr_write_b32 a122, v56
v_cvt_pk_bf16_f32 v59, v218, v219
v_accvgpr_write_b32 a123, v57
v_cvt_pk_bf16_f32 v60, v220, v221
v_accvgpr_write_b32 a124, v58
v_mfma_f32_32x32x16_bf16 v[134:149], a[120:123], a[192:195], 0
ds_read_b128 a[192:195], v1 offset:12288
v_cvt_pk_bf16_f32 v61, v222, v223
v_accvgpr_write_b32 a125, v59
v_mad_u32_u16 v102, v102, 2, s85 op_sel:[1,0,0,0]
v_cvt_pk_bf16_f32 v54, v224, v225
v_mad_u32_u16 v103, v103, 2, s85 op_sel:[1,0,0,0]
v_accvgpr_write_b32 a126, v60
v_mfma_f32_32x32x16_bf16 v[208:223], a[248:251], a[248:251], 0
ds_read_u16_d16_hi v102, v102
ds_read_u16_d16_hi v103, v103
v_cvt_pk_bf16_f32 v55, v226, v227
v_mad_u32_u16 v104, v104, 2, s85 op_sel:[1,0,0,0]
v_accvgpr_write_b32 a127, v61
v_mad_u32_u16 v105, v105, 2, s85 op_sel:[1,0,0,0]
v_cvt_pk_bf16_f32 v56, v228, v229
v_mfma_f32_32x32x16_bf16 v[134:149], a[124:127], a[196:199], v[134:149]
ds_read_b128 a[196:199], v1 offset:13312
ds_read_u16_d16_hi v104, v104
ds_read_u16_d16_hi v105, v105
v_accvgpr_write_b32 a128, v54
v_mad_u32_u16 v106, v106, 2, s85 op_sel:[1,0,0,0]
v_cvt_pk_bf16_f32 v57, v230, v231
v_mad_u32_u16 v107, v107, 2, s85 op_sel:[1,0,0,0]
v_accvgpr_write_b32 a129, v55
v_mad_u32_u16 v108, v108, 2, s85 op_sel:[1,0,0,0]
v_cvt_pk_bf16_f32 v58, v232, v233
v_mad_u32_u16 v109, v109, 2, s85 op_sel:[1,0,0,0]
v_accvgpr_write_b32 a130, v56
v_mad_u32_u16 v110, v110, 2, s85 op_sel:[1,0,0,0]
v_cvt_pk_bf16_f32 v59, v234, v235
v_mad_u32_u16 v111, v111, 2, s85 op_sel:[1,0,0,0]
v_accvgpr_write_b32 a131, v57
v_pk_add_f16 v78, v62, 1.0 op_sel_hi:[1,0]
v_cvt_pk_bf16_f32 v60, v236, v237
v_mfma_f32_32x32x16_bf16 v[134:149], a[128:131], a[200:203], v[134:149]
ds_read_b128 a[200:203], v1 offset:14336
ds_read_u16_d16_hi v106, v106
ds_read_u16_d16_hi v107, v107
ds_read_u16_d16_hi v108, v108
v_rcp_f16 v62, v78
v_accvgpr_write_b32 a132, v58
v_mad_u32_u16 v112, v112, 2, s85 op_sel:[1,0,0,0]
v_cvt_pk_bf16_f32 v61, v238, v239
v_pk_add_f16 v79, v63, 1.0 op_sel_hi:[1,0]
v_rcp_f16 v63, v79
v_accvgpr_write_b32 a133, v59
v_mad_u32_u16 v113, v113, 2, s85 op_sel:[1,0,0,0]
v_cvt_pk_bf16_f32 v54, v240, v241
v_pk_add_f16 v80, v64, 1.0 op_sel_hi:[1,0]
v_accvgpr_write_b32 a134, v60
v_mad_u32_u16 v114, v114, 2, s85 op_sel:[1,0,0,0]
v_cvt_pk_bf16_f32 v55, v242, v243
v_rcp_f16 v64, v80
v_accvgpr_write_b32 a135, v61
v_pk_add_f16 v81, v65, 1.0 op_sel_hi:[1,0]
v_cvt_pk_bf16_f32 v56, v244, v245
v_mfma_f32_32x32x16_bf16 v[134:149], a[132:135], a[204:207], v[134:149]
ds_read_b128 a[204:207], v1 offset:15360
ds_read_u16_d16_hi v109, v109
ds_read_u16_d16_hi v110, v110
ds_read_u16_d16_hi v111, v111
v_accvgpr_write_b32 a136, v54
v_pk_add_f16 v82, v66, 1.0 op_sel_hi:[1,0]
v_cvt_pk_bf16_f32 v57, v246, v247
v_mad_u32_u16 v115, v115, 2, s85 op_sel:[1,0,0,0]
v_accvgpr_write_b32 a137, v55
v_pk_add_f16 v83, v67, 1.0 op_sel_hi:[1,0]
v_cvt_pk_bf16_f32 v58, v248, v249
v_mad_u32_u16 v116, v116, 2, s85 op_sel:[1,0,0,0]
v_accvgpr_write_b32 a138, v56
v_pk_add_f16 v84, v68, 1.0 op_sel_hi:[1,0]
v_cvt_pk_bf16_f32 v59, v250, v251
v_mad_u32_u16 v117, v117, 2, s85 op_sel:[1,0,0,0]
v_accvgpr_write_b32 a139, v57
v_pk_add_f16 v85, v69, 1.0 op_sel_hi:[1,0]
v_cvt_pk_bf16_f32 v60, v252, v253
v_mfma_f32_32x32x16_bf16 v[134:149], a[136:139], a[208:211], v[134:149]
ds_read_b128 a[208:211], v1 offset:16384
ds_read_u16_d16_hi v112, v112
ds_read_u16_d16_hi v113, v113
ds_read_u16_d16_hi v114, v114
v_accvgpr_write_b32 a140, v58
v_rcp_f16_sdwa v62, v78 dst_sel:WORD_1 dst_unused:UNUSED_PRESERVE src0_sel:WORD_1
v_cvt_pk_bf16_f32 v61, v254, v255
v_rcp_f16 v65, v81
v_accvgpr_write_b32 a141, v59
v_rcp_f16_sdwa v63, v79 dst_sel:WORD_1 dst_unused:UNUSED_PRESERVE src0_sel:WORD_1
v_accvgpr_write_b32 a142, v60
v_rcp_f16 v66, v82
v_accvgpr_write_b32 a143, v61
v_rcp_f16_sdwa v64, v80 dst_sel:WORD_1 dst_unused:UNUSED_PRESERVE src0_sel:WORD_1
v_rcp_f16 v67, v83
v_mfma_f32_32x32x16_bf16 v[134:149], a[140:143], a[212:215], v[134:149]
ds_read_b128 a[212:215], v1 offset:17408
ds_read_u16_d16_hi v115, v115
ds_read_u16_d16_hi v116, v116
ds_read_u16_d16_hi v117, v117
v_rcp_f16_sdwa v65, v81 dst_sel:WORD_1 dst_unused:UNUSED_PRESERVE src0_sel:WORD_1
v_rcp_f16 v68, v84
v_mfma_f32_32x32x16_bf16 v[118:133], a[96:99], a[216:219], 0
v_rcp_f16_sdwa v66, v82 dst_sel:WORD_1 dst_unused:UNUSED_PRESERVE src0_sel:WORD_1
v_rcp_f16 v69, v85
v_rcp_f16_sdwa v67, v83 dst_sel:WORD_1 dst_unused:UNUSED_PRESERVE src0_sel:WORD_1
v_rcp_f16_sdwa v68, v84 dst_sel:WORD_1 dst_unused:UNUSED_PRESERVE src0_sel:WORD_1
v_mfma_f32_32x32x16_bf16 v[118:133], a[100:103], a[220:223], v[118:133]
v_mul_f32 v150, s60, v146
v_mul_f32 v151, s60, v147
v_mul_f32 v152, s60, v148
v_mul_f32 v153, s60, v149
v_mad_u32_u16 v150, v150, 2, s85 op_sel:[1,0,0,0]
v_mad_u32_u16 v151, v151, 2, s85 op_sel:[1,0,0,0]
v_mad_u32_u16 v152, v152, 2, s85 op_sel:[1,0,0,0]
v_mad_u32_u16 v153, v153, 2, s85 op_sel:[1,0,0,0]
v_mfma_f32_32x32x16_bf16 v[118:133], a[104:107], a[224:227], v[118:133]
ds_read_u16_d16_hi v150, v150
ds_read_u16_d16_hi v151, v151
ds_read_u16_d16_hi v152, v152
v_rcp_f16_sdwa v69, v85 dst_sel:WORD_1 dst_unused:UNUSED_PRESERVE src0_sel:WORD_1
v_cvt_pk_f16_f32 v86, v134, v135
v_cvt_pk_f16_f32 v87, v136, v137
v_pk_mul_f16 v94, v94, v62
v_mfma_f32_32x32x16_bf16 v[118:133], a[108:111], a[228:231], v[118:133]
ds_read_u16_d16_hi v153, v153
v_pk_fma_f16 v70, v86, v86, s84
v_cvt_pk_f16_f32 v88, v138, v139
v_pk_mul_f16 v95, v95, v63
v_pk_fma_f16 v71, v87, v87, s84
v_pk_mul_f16 v70, v86, v70
v_pk_mul_f16 v96, v96, v64
v_mfma_f32_32x32x16_bf16 v[118:133], a[112:115], a[232:235], v[118:133]
v_cvt_pk_f16_f32 v89, v140, v141
v_pk_fma_f16 v72, v88, v88, s84
v_pk_mul_f16 v71, v87, v71
v_exp_f16 v62, v70
v_pk_mul_f16 v97, v97, v65
v_cvt_pk_f16_f32 v90, v142, v143
v_pk_fma_f16 v73, v89, v89, s84
s_waitcnt lgkmcnt(2)
v_pk_add_f32 v[22:23], v[22:23], v[116:117]
v_pk_add_f32 v[22:23], v[22:23], v[114:115]
v_pk_add_f32 v[22:23], v[22:23], v[112:113]
v_pk_add_f32 v[22:23], v[22:23], v[110:111]
v_exp_f16 v63, v71
v_pk_add_f32 v[22:23], v[22:23], v[108:109]
v_pk_add_f32 v[22:23], v[22:23], v[106:107]
v_pk_add_f32 v[22:23], v[22:23], v[104:105]
v_pk_add_f32 v[22:23], v[22:23], v[102:103]
v_mfma_f32_32x32x16_f16 v[102:117], v[94:97], a[240:243], 0
buffer_store_dwordx4 v[94:97], v1, s[12:15], s101 offen offset:0 sc1
v_pk_mul_f16 v98, v98, v66
v_pk_mul_f16 v72, v88, v72
v_mfma_f32_32x32x16_bf16 v[118:133], a[116:119], a[236:239], v[118:133]
v_cvt_pk_f16_f32 v91, v144, v145
v_pk_mul_f16 v99, v99, v67
v_pk_fma_f16 v74, v90, v90, s84
v_pk_mul_f16 v73, v89, v73
v_pk_mul_f16 v100, v100, v68
v_pk_fma_f16 v75, v91, v91, s84
v_pk_mul_f16 v74, v90, v74
v_exp_f16 v64, v72
v_mfma_f32_32x32x16_bf16 v[134:149], a[120:123], a[216:219], 0
ds_read_b128 a[216:219], v1 offset:18432
v_pk_mul_f16 v75, v91, v75
v_pk_mul_f16 v101, v101, v69
v_mad_u32_u16 v118, v118, 2, s85 op_sel:[1,0,0,0]
v_mad_u32_u16 v119, v119, 2, s85 op_sel:[1,0,0,0]
v_mad_u32_u16 v120, v120, 2, s85 op_sel:[1,0,0,0]
v_exp_f16_sdwa v62, v70 dst_sel:WORD_1 dst_unused:UNUSED_PRESERVE src0_sel:WORD_1
v_mfma_f32_32x32x16_f16 v[102:117], v[98:101], a[244:247], v[102:117]
ds_read_u16_d16_hi v118, v118
ds_read_u16_d16_hi v119, v119
ds_read_u16_d16_hi v120, v120
v_mad_u32_u16 v121, v121, 2, s85 op_sel:[1,0,0,0]
v_mad_u32_u16 v122, v122, 2, s85 op_sel:[1,0,0,0]
v_mad_u32_u16 v123, v123, 2, s85 op_sel:[1,0,0,0]
v_exp_f16 v65, v73
v_mfma_f32_32x32x16_bf16 v[134:149], a[124:127], a[220:223], v[134:149]
ds_read_b128 a[220:223], v1 offset:19456
ds_read_u16_d16_hi v121, v121
ds_read_u16_d16_hi v122, v122
ds_read_u16_d16_hi v123, v123
v_mad_u32_u16 v124, v124, 2, s85 op_sel:[1,0,0,0]
v_mad_u32_u16 v125, v125, 2, s85 op_sel:[1,0,0,0]
v_mad_u32_u16 v126, v126, 2, s85 op_sel:[1,0,0,0]
v_mad_u32_u16 v127, v127, 2, s85 op_sel:[1,0,0,0]
v_pk_fma_f32 v[44:45], v[102:103], v[102:103], v[44:45]
v_pk_fma_f32 v[44:45], v[104:105], v[104:105], v[44:45]
v_pk_fma_f32 v[44:45], v[106:107], v[106:107], v[44:45]
v_pk_fma_f32 v[44:45], v[108:109], v[108:109], v[44:45]
v_pk_fma_f32 v[44:45], v[110:111], v[110:111], v[44:45]
v_pk_fma_f32 v[44:45], v[112:113], v[112:113], v[44:45]
v_pk_fma_f32 v[44:45], v[114:115], v[114:115], v[44:45]
v_pk_fma_f32 v[44:45], v[116:117], v[116:117], v[44:45]
v_mfma_f32_32x32x16_bf16 v[134:149], a[128:131], a[224:227], v[134:149]
ds_read_b128 a[224:227], v1 offset:20480
ds_read_u16_d16_hi v124, v124
ds_read_u16_d16_hi v125, v125
ds_read_u16_d16_hi v126, v126
v_mad_u32_u16 v128, v128, 2, s85 op_sel:[1,0,0,0]
v_pk_add_f16 v70, v62, 1.0 op_sel_hi:[1,0]
v_mad_u32_u16 v129, v129, 2, s85 op_sel:[1,0,0,0]
v_mfma_f32_32x32x16_bf16 v[134:149], a[132:135], a[228:231], v[134:149]
ds_read_b128 a[228:231], v1 offset:21504
ds_read_u16_d16_hi v127, v127
ds_read_u16_d16_hi v128, v128
buffer_store_dwordx4 v[98:101], v1, s[12:15], s101 offen offset:1024 sc1
v_mfma_f32_32x32x16_bf16 v[134:149], a[136:139], a[232:235], v[134:149]
ds_read_b128 a[232:235], v1 offset:22528
v_exp_f16_sdwa v63, v71 dst_sel:WORD_1 dst_unused:UNUSED_PRESERVE src0_sel:WORD_1
v_exp_f16 v66, v74
v_pk_add_f16 v71, v63, 1.0 op_sel_hi:[1,0]
v_mad_u32_u16 v130, v130, 2, s85 op_sel:[1,0,0,0]
v_exp_f16_sdwa v64, v72 dst_sel:WORD_1 dst_unused:UNUSED_PRESERVE src0_sel:WORD_1
v_mfma_f32_32x32x16_bf16 v[134:149], a[140:143], a[236:239], v[134:149]
ds_read_b128 a[236:239], v1 offset:23552
ds_read_u16_d16_hi v129, v129
v_pk_add_f16 v72, v64, 1.0 op_sel_hi:[1,0]
v_mad_u32_u16 v131, v131, 2, s85 op_sel:[1,0,0,0]
v_exp_f16 v67, v75
v_exp_f16_sdwa v65, v73 dst_sel:WORD_1 dst_unused:UNUSED_PRESERVE src0_sel:WORD_1
v_mfma_f32_32x32x16_bf16 v[102:117], a[96:99], a[192:195], 0
ds_read_u16_d16_hi v130, v130
v_pk_add_f16 v73, v65, 1.0 op_sel_hi:[1,0]
v_mad_u32_u16 v132, v132, 2, s85 op_sel:[1,0,0,0]
v_exp_f16_sdwa v66, v74 dst_sel:WORD_1 dst_unused:UNUSED_PRESERVE src0_sel:WORD_1
v_exp_f16_sdwa v67, v75 dst_sel:WORD_1 dst_unused:UNUSED_PRESERVE src0_sel:WORD_1
v_pk_add_f16 v74, v66, 1.0 op_sel_hi:[1,0]
v_mfma_f32_32x32x16_bf16 v[102:117], a[100:103], a[196:199], v[102:117]
ds_read_u16_d16_hi v131, v131
ds_read_u16_d16_hi v132, v132
v_mad_u32_u16 v133, v133, 2, s85 op_sel:[1,0,0,0]
v_pk_add_f16 v75, v67, 1.0 op_sel_hi:[1,0]
v_add_f32 v22, v22, v150
v_add_f32 v23, v23, v151
s_waitcnt lgkmcnt(9)
v_add_f32 v22, v22, v152
v_mfma_f32_32x32x16_bf16 v[102:117], a[104:107], a[200:203], v[102:117]
ds_read_u16_d16_hi v133, v133
s_add_u32 s101, s3, 53248
v_add_f32 v23, v23, v153
v_mul_f32 v150, s60, v146
v_mul_f32 v151, s60, v147
v_mul_f32 v152, s60, v148
v_mul_f32 v153, s60, v149
v_mad_u32_u16 v150, v150, 2, s85 op_sel:[1,0,0,0]
v_mfma_f32_32x32x16_bf16 v[102:117], a[108:111], a[204:207], v[102:117]
ds_read_u16_d16_hi v150, v150
v_mad_u32_u16 v151, v151, 2, s85 op_sel:[1,0,0,0]
v_mad_u32_u16 v152, v152, 2, s85 op_sel:[1,0,0,0]
v_rcp_f16 v62, v70
v_mad_u32_u16 v153, v153, 2, s85 op_sel:[1,0,0,0]
v_cvt_pk_f16_f32 v94, v134, v135
v_cvt_pk_f16_f32 v95, v136, v137
v_mfma_f32_32x32x16_bf16 v[102:117], a[112:115], a[208:211], v[102:117]
ds_read_u16_d16_hi v151, v151
ds_read_u16_d16_hi v152, v152
ds_read_u16_d16_hi v153, v153
v_pk_fma_f16 v78, v94, v94, s84
v_rcp_f16 v63, v71
v_rcp_f16 v64, v72
v_mfma_f32_32x32x16_bf16 v[102:117], a[116:119], a[212:215], v[102:117]
v_rcp_f16_sdwa v62, v70 dst_sel:WORD_1 dst_unused:UNUSED_PRESERVE src0_sel:WORD_1
v_rcp_f16 v65, v73
v_pk_mul_f16 v86, v86, v62
v_cvt_pk_f16_f32 v96, v138, v139
v_pk_fma_f16 v79, v95, v95, s84
v_pk_mul_f16 v78, v94, v78
v_rcp_f16_sdwa v63, v71 dst_sel:WORD_1 dst_unused:UNUSED_PRESERVE src0_sel:WORD_1
v_rcp_f16 v66, v74
v_pk_mul_f16 v87, v87, v63
v_cvt_pk_f16_f32 v97, v140, v141
v_pk_fma_f16 v80, v96, v96, s84
v_pk_mul_f16 v79, v95, v79
v_rcp_f16_sdwa v64, v72 dst_sel:WORD_1 dst_unused:UNUSED_PRESERVE src0_sel:WORD_1
v_rcp_f16 v67, v75
v_pk_mul_f16 v88, v88, v64
v_cvt_pk_f16_f32 v98, v142, v143
v_pk_fma_f16 v81, v97, v97, s84
v_pk_mul_f16 v80, v96, v80
v_rcp_f16_sdwa v65, v73 dst_sel:WORD_1 dst_unused:UNUSED_PRESERVE src0_sel:WORD_1
v_rcp_f16_sdwa v66, v74 dst_sel:WORD_1 dst_unused:UNUSED_PRESERVE src0_sel:WORD_1
v_pk_mul_f16 v89, v89, v65
v_cvt_pk_f16_f32 v99, v144, v145
v_mfma_f32_32x32x16_bf16 v[134:149], a[192:195], a[120:123], 0
ds_read_b128 a[192:195], v1 offset:24576
v_pk_fma_f16 v82, v98, v98, s84
v_pk_mul_f16 v81, v97, v81
v_pk_mul_f16 v90, v90, v66
v_rcp_f16_sdwa v67, v75 dst_sel:WORD_1 dst_unused:UNUSED_PRESERVE src0_sel:WORD_1
v_pk_fma_f16 v83, v99, v99, s84
v_pk_mul_f16 v82, v98, v82
v_mfma_f32_32x32x16_bf16 v[134:149], a[196:199], a[124:127], v[134:149]
ds_read_b128 a[196:199], v1 offset:25600
v_pk_mul_f16 v83, v99, v83
v_pk_mul_f16 v91, v91, v67
v_mad_u32_u16 v102, v102, 2, s85 op_sel:[1,0,0,0]
v_exp_f16 v62, v78
v_mad_u32_u16 v103, v103, 2, s85 op_sel:[1,0,0,0]
v_mad_u32_u16 v104, v104, 2, s85 op_sel:[1,0,0,0]
s_waitcnt lgkmcnt(4)
v_pk_add_f32 v[24:25], v[24:25], v[132:133]
v_pk_add_f32 v[24:25], v[24:25], v[130:131]
v_pk_add_f32 v[24:25], v[24:25], v[128:129]
v_pk_add_f32 v[24:25], v[24:25], v[126:127]
v_pk_add_f32 v[24:25], v[24:25], v[124:125]
v_exp_f16 v63, v79
v_pk_add_f32 v[24:25], v[24:25], v[122:123]
v_pk_add_f32 v[24:25], v[24:25], v[120:121]
v_pk_add_f32 v[24:25], v[24:25], v[118:119]
v_dot2c_f32_f16 v23, v91, v91
v_dot2c_f32_f16 v22, v90, v90
v_dot2c_f32_f16 v23, v89, v89
v_dot2c_f32_f16 v22, v88, v88
v_dot2c_f32_f16 v23, v87, v87
v_dot2c_f32_f16 v22, v86, v86
v_mfma_f32_32x32x16_bf16 v[134:149], a[200:203], a[128:131], v[134:149]
ds_read_b128 a[200:203], v1 offset:26624
ds_read_u16_d16_hi v102, v102
ds_read_u16_d16_hi v103, v103
ds_read_u16_d16_hi v104, v104
v_mad_u32_u16 v105, v105, 2, s85 op_sel:[1,0,0,0]
v_exp_f16 v64, v80
v_mad_u32_u16 v106, v106, 2, s85 op_sel:[1,0,0,0]
v_mfma_f32_32x32x16_bf16 v[134:149], a[204:207], a[132:135], v[134:149]
ds_read_b128 a[204:207], v1 offset:27648
ds_read_u16_d16_hi v105, v105
ds_read_u16_d16_hi v106, v106
v_mad_u32_u16 v107, v107, 2, s85 op_sel:[1,0,0,0]
v_mad_u32_u16 v108, v108, 2, s85 op_sel:[1,0,0,0]
v_exp_f16_sdwa v62, v78 dst_sel:WORD_1 dst_unused:UNUSED_PRESERVE src0_sel:WORD_1
v_mad_u32_u16 v109, v109, 2, s85 op_sel:[1,0,0,0]
v_mfma_f32_32x32x16_bf16 v[134:149], a[208:211], a[136:139], v[134:149]
ds_read_b128 a[208:211], v1 offset:28672
ds_read_u16_d16_hi v107, v107
ds_read_u16_d16_hi v108, v108
ds_read_u16_d16_hi v109, v109
v_mad_u32_u16 v110, v110, 2, s85 op_sel:[1,0,0,0]
v_exp_f16 v65, v81
v_mad_u32_u16 v111, v111, 2, s85 op_sel:[1,0,0,0]
v_mfma_f32_32x32x16_bf16 v[134:149], a[212:215], a[140:143], v[134:149]
ds_read_b128 a[212:215], v1 offset:29696
v_mad_u32_u16 v112, v112, 2, s85 op_sel:[1,0,0,0]
v_pk_add_f16 v78, v62, 1.0 op_sel_hi:[1,0]
v_mad_u32_u16 v113, v113, 2, s85 op_sel:[1,0,0,0]
v_exp_f16_sdwa v63, v79 dst_sel:WORD_1 dst_unused:UNUSED_PRESERVE src0_sel:WORD_1
v_exp_f16 v66, v82
v_mfma_f32_32x32x16_bf16 v[118:133], a[96:99], a[216:219], 0
ds_read_u16_d16_hi v110, v110
ds_read_u16_d16_hi v111, v111
ds_read_b32 v156, v155
v_exp_f16_sdwa v64, v80 dst_sel:WORD_1 dst_unused:UNUSED_PRESERVE src0_sel:WORD_1
v_pk_add_f16 v79, v63, 1.0 op_sel_hi:[1,0]
v_mad_u32_u16 v114, v114, 2, s85 op_sel:[1,0,0,0]
v_pk_add_f16 v80, v64, 1.0 op_sel_hi:[1,0]
v_mfma_f32_32x32x16_bf16 v[118:133], a[100:103], a[220:223], v[118:133]
v_mad_u32_u16 v115, v115, 2, s85 op_sel:[1,0,0,0]
v_exp_f16 v67, v83
v_exp_f16_sdwa v65, v81 dst_sel:WORD_1 dst_unused:UNUSED_PRESERVE src0_sel:WORD_1
v_exp_f16_sdwa v66, v82 dst_sel:WORD_1 dst_unused:UNUSED_PRESERVE src0_sel:WORD_1
v_pk_add_f16 v81, v65, 1.0 op_sel_hi:[1,0]
v_mfma_f32_32x32x16_bf16 v[118:133], a[104:107], a[224:227], v[118:133]
ds_read_u16_d16_hi v112, v112
ds_read_u16_d16_hi v113, v113
v_mad_u32_u16 v116, v116, 2, s85 op_sel:[1,0,0,0]
v_pk_add_f16 v82, v66, 1.0 op_sel_hi:[1,0]
v_mad_u32_u16 v117, v117, 2, s85 op_sel:[1,0,0,0]
v_exp_f16_sdwa v67, v83 dst_sel:WORD_1 dst_unused:UNUSED_PRESERVE src0_sel:WORD_1
v_rcp_f16 v62, v78
v_mfma_f32_32x32x16_bf16 v[118:133], a[108:111], a[228:231], v[118:133]
ds_read_u16_d16_hi v114, v114
v_pk_add_f16 v83, v67, 1.0 op_sel_hi:[1,0]
v_add_f32 v24, v24, v150
v_add_f32 v25, v25, v151
s_waitcnt lgkmcnt(9)
v_add_f32 v24, v24, v152
v_add_f32 v25, v25, v153
v_cvt_pk_f16_f32 v86, v134, v135
v_mfma_f32_32x32x16_bf16 v[118:133], a[112:115], a[232:235], v[118:133]
ds_read_u16_d16_hi v115, v115
ds_read_u16_d16_hi v116, v116
v_cvt_pk_f16_f32 v87, v136, v137
v_pk_fma_f16 v70, v86, v86, s84
v_rcp_f16 v63, v79
v_cvt_pk_f16_f32 v88, v138, v139
v_pk_fma_f16 v71, v87, v87, s84
v_mfma_f32_32x32x16_bf16 v[118:133], a[116:119], a[236:239], v[118:133]
ds_read_u16_d16_hi v117, v117
v_pk_mul_f16 v70, v86, v70
v_cvt_pk_f16_f32 v89, v140, v141
v_pk_fma_f16 v72, v88, v88, s84
v_rcp_f16 v64, v80
v_pk_mul_f16 v71, v87, v71
v_cvt_pk_f16_f32 v90, v142, v143
v_rcp_f16_sdwa v62, v78 dst_sel:WORD_1 dst_unused:UNUSED_PRESERVE src0_sel:WORD_1
v_rcp_f16 v65, v81
v_pk_mul_f16 v94, v94, v62
v_pk_fma_f16 v73, v89, v89, s84
v_pk_mul_f16 v72, v88, v72
v_cvt_pk_f16_f32 v91, v144, v145
v_rcp_f16_sdwa v63, v79 dst_sel:WORD_1 dst_unused:UNUSED_PRESERVE src0_sel:WORD_1
v_rcp_f16 v66, v82
v_pk_mul_f16 v95, v95, v63
v_pk_fma_f16 v74, v90, v90, s84
v_pk_mul_f16 v73, v89, v73
v_cvt_pk_f16_f32 v92, v146, v147
v_rcp_f16_sdwa v64, v80 dst_sel:WORD_1 dst_unused:UNUSED_PRESERVE src0_sel:WORD_1
v_rcp_f16 v67, v83
v_pk_mul_f16 v96, v96, v64
v_pk_fma_f16 v75, v91, v91, s84
v_pk_mul_f16 v74, v90, v74
v_rcp_f16_sdwa v65, v81 dst_sel:WORD_1 dst_unused:UNUSED_PRESERVE src0_sel:WORD_1
s_waitcnt lgkmcnt(4)
v_cmp_gt_u32 vcc, 9, v156
v_pk_mul_f16 v97, v97, v65
v_cvt_pk_f16_f32 v93, v148, v149
s_cbranch_vccnz L_spin9
L_ok9:
v_mov_b32 v156, 10
v_mfma_f32_32x32x16_bf16 v[134:149], a[120:123], a[216:219], 0
ds_read_b128 a[216:219], v1 offset:30720
ds_read_b128 a[156:159], v6 offset:0
ds_read_b128 a[160:163], v7 offset:0
ds_read_b128 a[144:147], v5 offset:0
v_rcp_f16_sdwa v66, v82 dst_sel:WORD_1 dst_unused:UNUSED_PRESERVE src0_sel:WORD_1
v_pk_fma_f16 v76, v92, v92, s84
v_pk_mul_f16 v75, v91, v75
v_mfma_f32_32x32x16_bf16 v[134:149], a[124:127], a[220:223], v[134:149]
ds_read_b128 a[220:223], v1 offset:31744
ds_read_b128 a[164:167], v6 offset:2176
ds_read_b128 a[168:171], v7 offset:2176
ds_read_b128 a[148:151], v5 offset:1536
v_rcp_f16_sdwa v67, v83 dst_sel:WORD_1 dst_unused:UNUSED_PRESERVE src0_sel:WORD_1
v_pk_mul_f16 v98, v98, v66
v_pk_fma_f16 v77, v93, v93, s84
v_mfma_f32_32x32x16_bf16 v[134:149], a[128:131], a[224:227], v[134:149]
ds_read_b128 a[224:227], v1 offset:32768
ds_read_b128 a[172:175], v6 offset:4352
s_add_u32 m0, s70, 121856
v_pk_mul_f16 v76, v92, v76
v_exp_f16 v62, v70
v_pk_mul_f16 v77, v93, v77
v_pk_mul_f16 v99, v99, v67
v_mfma_f32_32x32x16_bf16 v[134:149], a[132:135], a[228:231], v[134:149]
ds_read_b128 a[228:231], v1 offset:33792
buffer_load_dwordx4 v12, s[4:7], s90 offen  lds
v_mad_u32_u16 v118, v118, 2, s85 op_sel:[1,0,0,0]
v_mad_u32_u16 v119, v119, 2, s85 op_sel:[1,0,0,0]
v_mad_u32_u16 v120, v120, 2, s85 op_sel:[1,0,0,0]
v_mad_u32_u16 v121, v121, 2, s85 op_sel:[1,0,0,0]
s_waitcnt lgkmcnt(7)
v_pk_add_f32 v[26:27], v[26:27], v[116:117]
v_pk_add_f32 v[26:27], v[26:27], v[114:115]
v_pk_add_f32 v[26:27], v[26:27], v[112:113]
v_pk_add_f32 v[26:27], v[26:27], v[110:111]
v_pk_add_f32 v[26:27], v[26:27], v[108:109]
v_pk_add_f32 v[26:27], v[26:27], v[106:107]
v_exp_f16 v63, v71
v_pk_add_f32 v[26:27], v[26:27], v[104:105]
v_pk_add_f32 v[26:27], v[26:27], v[102:103]
v_dot2c_f32_f16 v25, v99, v99
v_dot2c_f32_f16 v24, v98, v98
v_dot2c_f32_f16 v25, v97, v97
v_dot2c_f32_f16 v24, v96, v96
v_dot2c_f32_f16 v25, v95, v95
v_dot2c_f32_f16 v24, v94, v94
v_smfmac_f32_32x32x32_bf16 v[160:175], a[144:147], a[156:163], v4
ds_read_b128 a[176:179], v7 offset:4352
v_mad_u32_u16 v122, v122, 2, s85 op_sel:[1,0,0,0]
v_mad_u32_u16 v123, v123, 2, s85 op_sel:[1,0,0,0]
v_mad_u32_u16 v124, v124, 2, s85 op_sel:[1,0,0,0]
v_mad_u32_u16 v125, v125, 2, s85 op_sel:[1,0,0,0]
v_mad_u32_u16 v126, v126, 2, s85 op_sel:[1,0,0,0]
v_exp_f16 v64, v72
v_mfma_f32_32x32x16_bf16 v[134:149], a[136:139], a[232:235], v[134:149]
ds_read_b128 a[232:235], v1 offset:34816
ds_read_b128 a[152:155], v5 offset:3072
ds_read_b128 a[156:159], v6 offset:6528
ds_read_b128 a[160:163], v7 offset:6528
v_mad_u32_u16 v127, v127, 2, s85 op_sel:[1,0,0,0]
v_exp_f16_sdwa v62, v70 dst_sel:WORD_1 dst_unused:UNUSED_PRESERVE src0_sel:WORD_1
v_exp_f16 v65, v73
s_waitcnt lgkmcnt(4)
v_smfmac_f32_32x32x32_bf16 v[160:175], a[148:151], a[164:171], v4
s_add_u32 m0, s71, 121856
ds_read_u16_d16_hi v118, v118
v_pk_add_f16 v70, v62, 1.0 op_sel_hi:[1,0]
v_mad_u32_u16 v128, v128, 2, s85 op_sel:[1,0,0,0]
v_exp_f16_sdwa v63, v71 dst_sel:WORD_1 dst_unused:UNUSED_PRESERVE src0_sel:WORD_1
v_exp_f16 v66, v74
v_mfma_f32_32x32x16_bf16 v[134:149], a[140:143], a[236:239], v[134:149]
ds_read_b128 a[236:239], v1 offset:35840
buffer_load_dwordx4 v13, s[4:7], s90 offen  lds
ds_read_u16_d16_hi v119, v119
ds_read_u16_d16_hi v120, v120
v_pk_add_f16 v71, v63, 1.0 op_sel_hi:[1,0]
v_mad_u32_u16 v129, v129, 2, s85 op_sel:[1,0,0,0]
v_smfmac_f32_32x32x32_bf16 v[208:223], a[144:147], a[164:171], v4
ds_read_b128 a[164:167], v8 offset:0
v_exp_f16_sdwa v64, v72 dst_sel:WORD_1 dst_unused:UNUSED_PRESERVE src0_sel:WORD_1
v_exp_f16 v67, v75
v_pk_add_f16 v72, v64, 1.0 op_sel_hi:[1,0]
v_mad_u32_u16 v130, v130, 2, s85 op_sel:[1,0,0,0]
v_mfma_f32_32x32x16_bf16 v[102:117], a[96:99], a[192:195], 0
ds_read_b128 a[168:171], v9 offset:0
ds_read_b128 a[144:147], v5 offset:512
ds_read_u16_d16_hi v121, v121
v_exp_f16_sdwa v65, v73 dst_sel:WORD_1 dst_unused:UNUSED_PRESERVE src0_sel:WORD_1
v_exp_f16 v68, v76
v_pk_add_f16 v73, v65, 1.0 op_sel_hi:[1,0]
s_waitcnt lgkmcnt(5)
v_smfmac_f32_32x32x32_bf16 v[160:175], a[152:155], a[172:179], v4
ds_read_u16_d16_hi v122, v122
v_exp_f16_sdwa v66, v74 dst_sel:WORD_1 dst_unused:UNUSED_PRESERVE src0_sel:WORD_1
v_exp_f16 v69, v77
v_pk_add_f16 v74, v66, 1.0 op_sel_hi:[1,0]
v_mad_u32_u16 v131, v131, 2, s85 op_sel:[1,0,0,0]
v_mfma_f32_32x32x16_bf16 v[102:117], a[100:103], a[196:199], v[102:117]
ds_read_u16_d16_hi v123, v123
s_add_u32 m0, s72, 121856
ds_read_u16_d16_hi v124, v124
buffer_load_dwordx4 v14, s[4:7], s90 offen  lds
ds_read_u16_d16_hi v125, v125
v_exp_f16_sdwa v67, v75 dst_sel:WORD_1 dst_unused:UNUSED_PRESERVE src0_sel:WORD_1
v_smfmac_f32_32x32x32_bf16 v[208:223], a[148:151], a[172:179], v4
ds_read_b128 a[172:175], v8 offset:2176
v_pk_add_f16 v75, v67, 1.0 op_sel_hi:[1,0]
v_mad_u32_u16 v132, v132, 2, s85 op_sel:[1,0,0,0]
v_exp_f16_sdwa v68, v76 dst_sel:WORD_1 dst_unused:UNUSED_PRESERVE src0_sel:WORD_1
v_exp_f16_sdwa v69, v77 dst_sel:WORD_1 dst_unused:UNUSED_PRESERVE src0_sel:WORD_1
v_mfma_f32_32x32x16_bf16 v[102:117], a[104:107], a[200:203], v[102:117]
ds_read_b128 a[176:179], v9 offset:2176
ds_read_b128 a[148:151], v5 offset:2048
ds_read_u16_d16_hi v126, v126
ds_read_u16_d16_hi v127, v127
v_pk_add_f16 v76, v68, 1.0 op_sel_hi:[1,0]
v_mad_u32_u16 v133, v133, 2, s85 op_sel:[1,0,0,0]
v_rcp_f16 v62, v70
v_smfmac_f32_32x32x32_bf16 v[208:223], a[152:155], a[156:163], v4
ds_read_b128 a[156:159], v8 offset:4352
v_pk_add_f16 v77, v69, 1.0 op_sel_hi:[1,0]
v_mul_f32 v150, s60, v146
v_mul_f32 v151, s60, v147
v_mul_f32 v152, s60, v148
v_mul_f32 v153, s60, v149
v_mad_u32_u16 v150, v150, 2, s85 op_sel:[1,0,0,0]
v_mfma_f32_32x32x16_bf16 v[102:117], a[108:111], a[204:207], v[102:117]
ds_read_b128 a[160:163], v9 offset:4352
ds_read_b128 a[152:155], v5 offset:3584
ds_read_u16_d16_hi v128, v128
s_add_u32 m0, s73, 121856
v_rcp_f16 v63, v71
v_mad_u32_u16 v151, v151, 2, s85 op_sel:[1,0,0,0]
v_mad_u32_u16 v152, v152, 2, s85 op_sel:[1,0,0,0]
s_waitcnt lgkmcnt(7)
v_smfmac_f32_32x32x32_bf16 v[160:175], a[144:147], a[164:171], v4
ds_read_b128 a[164:167], v8 offset:6528
v_mad_u32_u16 v153, v153, 2, s85 op_sel:[1,0,0,0]
v_cvt_pk_f16_f32 v94, v134, v135
v_cvt_pk_f16_f32 v95, v136, v137
v_rcp_f16 v64, v72
v_rcp_f16_sdwa v62, v70 dst_sel:WORD_1 dst_unused:UNUSED_PRESERVE src0_sel:WORD_1
v_mfma_f32_32x32x16_bf16 v[102:117], a[112:115], a[208:211], v[102:117]
ds_read_b128 a[168:171], v9 offset:6528
buffer_load_dwordx4 v15, s[4:7], s90 offen  lds
ds_read_u16_d16_hi v129, v129
ds_read_u16_d16_hi v130, v130
v_pk_mul_f16 v86, v86, v62
v_pk_fma_f16 v78, v94, v94, s84
s_waitcnt lgkmcnt(8)
v_smfmac_f32_32x32x32_bf16 v[160:175], a[148:151], a[172:179], v4
ds_read_u16_d16_hi v131, v131
v_cvt_pk_f16_f32 v96, v138, v139
v_rcp_f16 v65, v73
v_rcp_f16_sdwa v63, v71 dst_sel:WORD_1 dst_unused:UNUSED_PRESERVE src0_sel:WORD_1
v_rcp_f16 v66, v74
v_mfma_f32_32x32x16_bf16 v[102:117], a[116:119], a[212:215], v[102:117]
ds_read_u16_d16_hi v132, v132
ds_read_u16_d16_hi v133, v133
ds_read_u16_d16_hi v150, v150
ds_read_u16_d16_hi v151, v151
v_pk_mul_f16 v87, v87, v63
v_rcp_f16_sdwa v64, v72 dst_sel:WORD_1 dst_unused:UNUSED_PRESERVE src0_sel:WORD_1
v_pk_fma_f16 v79, v95, v95, s84
v_smfmac_f32_32x32x32_bf16 v[208:223], a[144:147], a[172:179], v4
ds_read_b128 a[172:175], v10 offset:0
v_pk_mul_f16 v78, v94, v78
v_pk_mul_f16 v88, v88, v64
v_cvt_pk_f16_f32 v97, v140, v141
v_pk_fma_f16 v80, v96, v96, s84
v_rcp_f16 v67, v75
s_waitcnt lgkmcnt(7)
v_smfmac_f32_32x32x32_bf16 v[160:175], a[152:155], a[156:163], v4
ds_read_b128 a[176:179], v11 offset:0
v_pk_mul_f16 v79, v95, v79
v_rcp_f16_sdwa v65, v73 dst_sel:WORD_1 dst_unused:UNUSED_PRESERVE src0_sel:WORD_1
v_rcp_f16 v68, v76
v_pk_mul_f16 v89, v89, v65
v_smfmac_f32_32x32x32_bf16 v[208:223], a[148:151], a[156:163], v4
ds_read_b128 a[144:147], v5 offset:1024
v_cvt_pk_f16_f32 v98, v142, v143
v_pk_fma_f16 v81, v97, v97, s84
v_rcp_f16_sdwa v66, v74 dst_sel:WORD_1 dst_unused:UNUSED_PRESERVE src0_sel:WORD_1
v_rcp_f16 v69, v77
v_smfmac_f32_32x32x32_bf16 v[208:223], a[152:155], a[164:171], v4
ds_read_b128 a[156:159], v10 offset:2176
v_pk_mul_f16 v90, v90, v66
v_pk_mul_f16 v80, v96, v80
v_rcp_f16_sdwa v67, v75 dst_sel:WORD_1 dst_unused:UNUSED_PRESERVE src0_sel:WORD_1
v_cvt_pk_f16_f32 v99, v144, v145
v_pk_mul_f16 v91, v91, v67
v_mfma_f32_32x32x16_bf16 v[134:149], a[120:123], a[192:195], 0
ds_read_b128 a[192:195], v1 offset:36864
ds_read_b128 a[160:163], v11 offset:2176
ds_read_b128 a[148:151], v5 offset:2560
ds_read_b128 a[164:167], v10 offset:4352
v_rcp_f16_sdwa v68, v76 dst_sel:WORD_1 dst_unused:UNUSED_PRESERVE src0_sel:WORD_1
v_pk_fma_f16 v82, v98, v98, s84
v_pk_mul_f16 v81, v97, v81
v_mfma_f32_32x32x16_bf16 v[134:149], a[124:127], a[196:199], v[134:149]
ds_read_b128 a[196:199], v1 offset:37888
s_add_u32 m0, s74, 121856
ds_read_b128 a[168:171], v11 offset:4352
buffer_load_dwordx4 v16, s[4:7], s90 offen  lds
v_pk_mul_f16 v92, v92, v68
v_pk_fma_f16 v83, v99, v99, s84
s_waitcnt lgkmcnt(9)
v_pk_add_f32 v[28:29], v[28:29], v[132:133]
v_pk_add_f32 v[28:29], v[28:29], v[130:131]
v_pk_add_f32 v[28:29], v[28:29], v[128:129]
v_pk_add_f32 v[28:29], v[28:29], v[126:127]
v_pk_add_f32 v[28:29], v[28:29], v[124:125]
v_pk_add_f32 v[28:29], v[28:29], v[122:123]
v_pk_add_f32 v[28:29], v[28:29], v[120:121]
v_pk_add_f32 v[28:29], v[28:29], v[118:119]
v_mfma_f32_32x32x16_f16 v[118:133], v[86:89], a[240:243], 0
ds_read_b128 a[152:155], v5 offset:4096
ds_read_u16_d16_hi v152, v152
ds_read_u16_d16_hi v153, v153
v_pk_mul_f16 v82, v98, v82
v_pk_mul_f16 v83, v99, v83
v_rcp_f16_sdwa v69, v77 dst_sel:WORD_1 dst_unused:UNUSED_PRESERVE src0_sel:WORD_1
v_mfma_f32_32x32x16_bf16 v[134:149], a[128:131], a[200:203], v[134:149]
ds_read_b128 a[200:203], v1 offset:38912
v_pk_mul_f16 v93, v93, v69
v_mad_u32_u16 v102, v102, 2, s85 op_sel:[1,0,0,0]
v_mad_u32_u16 v103, v103, 2, s85 op_sel:[1,0,0,0]
v_mad_u32_u16 v104, v104, 2, s85 op_sel:[1,0,0,0]
v_mad_u32_u16 v105, v105, 2, s85 op_sel:[1,0,0,0]
v_exp_f16 v62, v78
s_waitcnt lgkmcnt(5)
v_smfmac_f32_32x32x32_bf16 v[160:175], a[144:147], a[172:179], v4
ds_read_b128 a[172:175], v10 offset:6528
v_mad_u32_u16 v106, v106, 2, s85 op_sel:[1,0,0,0]
v_mad_u32_u16 v107, v107, 2, s85 op_sel:[1,0,0,0]
v_mad_u32_u16 v108, v108, 2, s85 op_sel:[1,0,0,0]
v_mad_u32_u16 v109, v109, 2, s85 op_sel:[1,0,0,0]
v_mad_u32_u16 v110, v110, 2, s85 op_sel:[1,0,0,0]
v_exp_f16 v63, v79
v_mfma_f32_32x32x16_f16 v[118:133], v[90:93], a[244:247], v[118:133]
ds_read_b128 a[176:179], v11 offset:6528
s_add_u32 m0, s75, 121856
ds_read_u16_d16_hi v102, v102
buffer_load_dwordx4 v17, s[4:7], s90 offen  lds
ds_read_u16_d16_hi v103, v103
v_mad_u32_u16 v111, v111, 2, s85 op_sel:[1,0,0,0]
v_mfma_f32_32x32x16_bf16 v[134:149], a[132:135], a[204:207], v[134:149]
ds_read_b128 a[204:207], v1 offset:39936
ds_read_u16_d16_hi v104, v104
ds_read_u16_d16_hi v105, v105
v_exp_f16 v64, v80
v_mad_u32_u16 v112, v112, 2, s85 op_sel:[1,0,0,0]
v_exp_f16_sdwa v62, v78 dst_sel:WORD_1 dst_unused:UNUSED_PRESERVE src0_sel:WORD_1
v_pk_fma_f32 v[26:27], v[118:119], v[118:119], v[26:27]
v_pk_fma_f32 v[26:27], v[120:121], v[120:121], v[26:27]
v_pk_fma_f32 v[26:27], v[122:123], v[122:123], v[26:27]
v_pk_fma_f32 v[26:27], v[124:125], v[124:125], v[26:27]
v_pk_fma_f32 v[26:27], v[126:127], v[126:127], v[26:27]
v_pk_fma_f32 v[26:27], v[128:129], v[128:129], v[26:27]
v_exp_f16 v65, v81
v_pk_fma_f32 v[26:27], v[130:131], v[130:131], v[26:27]
v_pk_fma_f32 v[26:27], v[132:133], v[132:133], v[26:27]
v_smfmac_f32_32x32x32_bf16 v[160:175], a[148:151], a[156:163], v4
ds_read_u16_d16_hi v106, v106
v_pk_add_f16 v78, v62, 1.0 op_sel_hi:[1,0]
v_mad_u32_u16 v113, v113, 2, s85 op_sel:[1,0,0,0]
s_waitcnt vmcnt(11) lgkmcnt(4)
ds_write_b32 v154, v156
v_exp_f16_sdwa v63, v79 dst_sel:WORD_1 dst_unused:UNUSED_PRESERVE src0_sel:WORD_1
v_mfma_f32_32x32x16_bf16 v[134:149], a[136:139], a[208:211], v[134:149]
ds_read_b128 a[208:211], v1 offset:40960
ds_read_u16_d16_hi v107, v107
ds_read_u16_d16_hi v108, v108
ds_read_u16_d16_hi v109, v109
v_pk_add_f16 v79, v63, 1.0 op_sel_hi:[1,0]
v_mad_u32_u16 v114, v114, 2, s85 op_sel:[1,0,0,0]
v_exp_f16 v66, v82
v_smfmac_f32_32x32x32_bf16 v[208:223], a[144:147], a[156:163], v4
ds_read_u16_d16_hi v110, v110
v_exp_f16_sdwa v64, v80 dst_sel:WORD_1 dst_unused:UNUSED_PRESERVE src0_sel:WORD_1
v_exp_f16 v67, v83
v_pk_add_f16 v80, v64, 1.0 op_sel_hi:[1,0]
v_mad_u32_u16 v115, v115, 2, s85 op_sel:[1,0,0,0]
v_mfma_f32_32x32x16_bf16 v[134:149], a[140:143], a[212:215], v[134:149]
ds_read_b128 a[212:215], v1 offset:41984
ds_read_u16_d16_hi v111, v111
ds_read_u16_d16_hi v112, v112
ds_read_u16_d16_hi v113, v113
v_exp_f16_sdwa v65, v81 dst_sel:WORD_1 dst_unused:UNUSED_PRESERVE src0_sel:WORD_1
v_exp_f16_sdwa v66, v82 dst_sel:WORD_1 dst_unused:UNUSED_PRESERVE src0_sel:WORD_1
v_smfmac_f32_32x32x32_bf16 v[160:175], a[152:155], a[164:171], v4
ds_read_u16_d16_hi v114, v114
v_pk_add_f16 v81, v65, 1.0 op_sel_hi:[1,0]
v_mad_u32_u16 v116, v116, 2, s85 op_sel:[1,0,0,0]
v_pk_add_f16 v82, v66, 1.0 op_sel_hi:[1,0]
v_mad_u32_u16 v117, v117, 2, s85 op_sel:[1,0,0,0]
v_exp_f16_sdwa v67, v83 dst_sel:WORD_1 dst_unused:UNUSED_PRESERVE src0_sel:WORD_1
v_mfma_f32_32x32x16_bf16 v[118:133], a[96:99], a[216:219], 0
ds_read_u16_d16_hi v115, v115
buffer_store_dwordx4 v[86:89], v1, s[12:15], s101 offen offset:0 sc1
ds_read_u16_d16_hi v116, v116
ds_read_u16_d16_hi v117, v117
v_smfmac_f32_32x32x32_bf16 v[208:223], a[148:151], a[164:171], v4
v_pk_add_f16 v83, v67, 1.0 op_sel_hi:[1,0]
v_add_f32 v28, v28, v150
v_add_f32 v29, v29, v151
v_add_f32 v28, v28, v152
v_add_f32 v29, v29, v153
v_mul_f32 v150, s60, v146
v_mul_f32 v151, s60, v147
v_pk_mul_f32 v[48:49], v[160:161], v[160:161]
v_pk_fma_f32 v[48:49], v[162:163], v[162:163], v[48:49]
v_pk_add_f32 v[46:47], v[160:161], v[162:163]
v_pk_fma_f32 v[48:49], v[164:165], v[164:165], v[48:49]
v_pk_add_f32 v[46:47], v[46:47], v[164:165]
v_pk_fma_f32 v[48:49], v[166:167], v[166:167], v[48:49]
v_mul_f32 v152, s60, v148
v_pk_add_f32 v[46:47], v[46:47], v[166:167]
v_pk_fma_f32 v[48:49], v[168:169], v[168:169], v[48:49]
v_pk_add_f32 v[46:47], v[46:47], v[168:169]
v_mul_f32 v153, s60, v149
v_rcp_f16 v62, v78
v_pk_fma_f32 v[48:49], v[170:171], v[170:171], v[48:49]
v_pk_add_f32 v[46:47], v[46:47], v[170:171]
v_pk_fma_f32 v[48:49], v[172:173], v[172:173], v[48:49]
v_rcp_f16 v63, v79
v_pk_add_f32 v[46:47], v[46:47], v[172:173]
v_pk_fma_f32 v[48:49], v[174:175], v[174:175], v[48:49]
v_pk_add_f32 v[46:47], v[46:47], v[174:175]
v_mfma_f32_32x32x16_bf16 v[118:133], a[100:103], a[220:223], v[118:133]
v_mad_u32_u16 v150, v150, 2, s85 op_sel:[1,0,0,0]
v_mad_u32_u16 v151, v151, 2, s85 op_sel:[1,0,0,0]
v_mad_u32_u16 v152, v152, 2, s85 op_sel:[1,0,0,0]
v_mad_u32_u16 v153, v153, 2, s85 op_sel:[1,0,0,0]
v_rcp_f16 v64, v80
v_cvt_pk_f16_f32 v86, v134, v135
v_cvt_pk_f16_f32 v87, v136, v137
v_smfmac_f32_32x32x32_bf16 v[208:223], a[152:155], a[172:179], v4
ds_read_u16_d16_hi v150, v150
v_pk_fma_f16 v70, v86, v86, s84
v_rcp_f16_sdwa v62, v78 dst_sel:WORD_1 dst_unused:UNUSED_PRESERVE src0_sel:WORD_1
v_rcp_f16 v65, v81
v_pk_mul_f16 v94, v94, v62
v_mfma_f32_32x32x16_bf16 v[118:133], a[104:107], a[224:227], v[118:133]
ds_read_u16_d16_hi v151, v151
ds_read_u16_d16_hi v152, v152
ds_read_u16_d16_hi v153, v153
buffer_store_dwordx4 v[90:93], v1, s[12:15], s101 offen offset:1024 sc1
v_mfma_f32_32x32x16_bf16 v[176:191], a[248:251], a[248:251], 0
v_cvt_pk_f16_f32 v88, v138, v139
v_pk_fma_f16 v71, v87, v87, s84
v_pk_mul_f16 v70, v86, v70
v_rcp_f16_sdwa v63, v79 dst_sel:WORD_1 dst_unused:UNUSED_PRESERVE src0_sel:WORD_1
v_rcp_f16 v66, v82
v_pk_mul_f16 v95, v95, v63
v_pk_mul_f32 v[52:53], v[208:209], v[208:209]
v_pk_fma_f32 v[52:53], v[210:211], v[210:211], v[52:53]
v_pk_add_f32 v[50:51], v[208:209], v[210:211]
v_pk_fma_f32 v[52:53], v[212:213], v[212:213], v[52:53]
v_rcp_f16_sdwa v64, v80 dst_sel:WORD_1 dst_unused:UNUSED_PRESERVE src0_sel:WORD_1
v_pk_add_f32 v[50:51], v[50:51], v[212:213]
v_pk_fma_f32 v[52:53], v[214:215], v[214:215], v[52:53]
v_pk_add_f32 v[50:51], v[50:51], v[214:215]
v_rcp_f16 v67, v83
s_waitcnt lgkmcnt(2)
v_pk_add_f32 v[30:31], v[30:31], v[116:117]
v_pk_add_f32 v[30:31], v[30:31], v[114:115]
v_pk_add_f32 v[30:31], v[30:31], v[112:113]
v_rcp_f16_sdwa v65, v81 dst_sel:WORD_1 dst_unused:UNUSED_PRESERVE src0_sel:WORD_1
v_pk_add_f32 v[30:31], v[30:31], v[110:111]
v_pk_add_f32 v[30:31], v[30:31], v[108:109]
v_pk_add_f32 v[30:31], v[30:31], v[106:107]
v_rcp_f16_sdwa v66, v82 dst_sel:WORD_1 dst_unused:UNUSED_PRESERVE src0_sel:WORD_1
v_pk_add_f32 v[30:31], v[30:31], v[104:105]
v_pk_add_f32 v[30:31], v[30:31], v[102:103]
v_pk_fma_f32 v[52:53], v[216:217], v[216:217], v[52:53]
v_rcp_f16_sdwa v67, v83 dst_sel:WORD_1 dst_unused:UNUSED_PRESERVE src0_sel:WORD_1
v_pk_add_f32 v[50:51], v[50:51], v[216:217]
v_pk_fma_f32 v[52:53], v[218:219], v[218:219], v[52:53]
v_pk_add_f32 v[50:51], v[50:51], v[218:219]
v_exp_f16 v62, v70
v_pk_fma_f32 v[52:53], v[220:221], v[220:221], v[52:53]
v_pk_add_f32 v[50:51], v[50:51], v[220:221]
v_pk_fma_f32 v[52:53], v[222:223], v[222:223], v[52:53]
v_pk_add_f32 v[50:51], v[50:51], v[222:223]
v_mfma_f32_32x32x16_bf16 v[118:133], a[108:111], a[228:231], v[118:133]
s_add_u32 s101, s3, 59392
v_cvt_pk_f16_f32 v89, v140, v141
v_pk_fma_f16 v72, v88, v88, s84
v_pk_mul_f16 v71, v87, v71
v_pk_mul_f16 v96, v96, v64
v_cvt_pk_f16_f32 v90, v142, v143
v_pk_fma_f16 v73, v89, v89, s84
v_exp_f16 v63, v71
v_mfma_f32_32x32x16_bf16 v[224:239], a[248:251], a[248:251], 0
v_pk_mul_f16 v72, v88, v72
v_pk_mul_f16 v97, v97, v65
v_cvt_pk_f16_f32 v91, v144, v145
v_pk_fma_f16 v74, v90, v90, s84
v_pk_mul_f16 v73, v89, v73
v_pk_mul_f16 v98, v98, v66
v_exp_f16 v64, v72
v_mfma_f32_32x32x16_bf16 v[118:133], a[112:115], a[232:235], v[118:133]
v_pk_fma_f16 v75, v91, v91, s84
v_pk_mul_f16 v74, v90, v74
v_pk_mul_f16 v75, v91, v75
v_pk_mul_f16 v99, v99, v67
v_exp_f16_sdwa v62, v70 dst_sel:WORD_1 dst_unused:UNUSED_PRESERVE src0_sel:WORD_1
v_exp_f16 v65, v73
v_dot2c_f32_f16 v29, v99, v99
v_dot2c_f32_f16 v28, v98, v98
v_dot2c_f32_f16 v29, v97, v97
v_dot2c_f32_f16 v28, v96, v96
v_dot2c_f32_f16 v29, v95, v95
v_dot2c_f32_f16 v28, v94, v94
v_mfma_f32_32x32x16_bf16 v[118:133], a[116:119], a[236:239], v[118:133]
v_exp_f16_sdwa v63, v71 dst_sel:WORD_1 dst_unused:UNUSED_PRESERVE src0_sel:WORD_1
v_exp_f16 v66, v74
v_exp_f16_sdwa v64, v72 dst_sel:WORD_1 dst_unused:UNUSED_PRESERVE src0_sel:WORD_1
v_exp_f16 v67, v75
v_mfma_f32_32x32x16_bf16 v[134:149], a[216:219], a[120:123], 0
ds_read_b128 a[216:219], v1 offset:43008
v_exp_f16_sdwa v65, v73 dst_sel:WORD_1 dst_unused:UNUSED_PRESERVE src0_sel:WORD_1
v_exp_f16_sdwa v66, v74 dst_sel:WORD_1 dst_unused:UNUSED_PRESERVE src0_sel:WORD_1
v_exp_f16_sdwa v67, v75 dst_sel:WORD_1 dst_unused:UNUSED_PRESERVE src0_sel:WORD_1
v_mfma_f32_32x32x16_bf16 v[134:149], a[220:223], a[124:127], v[134:149]
ds_read_b128 a[220:223], v1 offset:44032
s_nop 0
v_mad_u32_u16 v118, v118, 2, s85 op_sel:[1,0,0,0]
v_mad_u32_u16 v119, v119, 2, s85 op_sel:[1,0,0,0]
v_mad_u32_u16 v120, v120, 2, s85 op_sel:[1,0,0,0]
v_mad_u32_u16 v121, v121, 2, s85 op_sel:[1,0,0,0]
v_mad_u32_u16 v122, v122, 2, s85 op_sel:[1,0,0,0]
v_mfma_f32_32x32x16_bf16 v[134:149], a[224:227], a[128:131], v[134:149]
ds_read_b128 a[224:227], v1 offset:45056
ds_read_u16_d16_hi v118, v118
ds_read_u16_d16_hi v119, v119
ds_read_u16_d16_hi v120, v120
v_mad_u32_u16 v123, v123, 2, s85 op_sel:[1,0,0,0]
v_mad_u32_u16 v124, v124, 2, s85 op_sel:[1,0,0,0]
v_mad_u32_u16 v125, v125, 2, s85 op_sel:[1,0,0,0]
v_mfma_f32_32x32x16_bf16 v[134:149], a[228:231], a[132:135], v[134:149]
ds_read_b128 a[228:231], v1 offset:46080
ds_read_u16_d16_hi v121, v121
ds_read_u16_d16_hi v122, v122
ds_read_u16_d16_hi v123, v123
v_mad_u32_u16 v126, v126, 2, s85 op_sel:[1,0,0,0]
v_mad_u32_u16 v127, v127, 2, s85 op_sel:[1,0,0,0]
v_mad_u32_u16 v128, v128, 2, s85 op_sel:[1,0,0,0]
v_mfma_f32_32x32x16_bf16 v[134:149], a[232:235], a[136:139], v[134:149]
ds_read_b128 a[232:235], v1 offset:47104
ds_read_u16_d16_hi v124, v124
ds_read_u16_d16_hi v125, v125
ds_read_u16_d16_hi v126, v126
v_pk_add_f16 v70, v62, 1.0 op_sel_hi:[1,0]
v_rcp_f16 v62, v70
v_mad_u32_u16 v129, v129, 2, s85 op_sel:[1,0,0,0]
v_mfma_f32_32x32x16_bf16 v[134:149], a[236:239], a[140:143], v[134:149]
v_pk_add_f16 v71, v63, 1.0 op_sel_hi:[1,0]
v_mad_u32_u16 v130, v130, 2, s85 op_sel:[1,0,0,0]
v_pk_add_f16 v72, v64, 1.0 op_sel_hi:[1,0]
v_mad_u32_u16 v131, v131, 2, s85 op_sel:[1,0,0,0]
v_pk_add_f16 v73, v65, 1.0 op_sel_hi:[1,0]
v_rcp_f16 v63, v71
v_mad_u32_u16 v132, v132, 2, s85 op_sel:[1,0,0,0]
v_mfma_f32_32x32x16_bf16 v[102:117], a[96:99], a[192:195], 0
ds_read_b128 a[236:239], v1 offset:48128
ds_read_u16_d16_hi v127, v127
ds_read_b32 v156, v155
v_pk_add_f16 v74, v66, 1.0 op_sel_hi:[1,0]
v_mad_u32_u16 v133, v133, 2, s85 op_sel:[1,0,0,0]
v_pk_add_f16 v75, v67, 1.0 op_sel_hi:[1,0]
v_add_f32 v30, v30, v150
v_add_f32 v31, v31, v151
v_mfma_f32_32x32x16_bf16 v[102:117], a[100:103], a[196:199], v[102:117]
s_waitcnt lgkmcnt(10)
v_add_f32 v30, v30, v152
v_add_f32 v31, v31, v153
v_cvt_pk_f16_f32 v94, v134, v135
v_cvt_pk_f16_f32 v95, v136, v137
v_pk_fma_f16 v78, v94, v94, s84
v_cvt_pk_f16_f32 v96, v138, v139
v_rcp_f16 v64, v72
v_mfma_f32_32x32x16_bf16 v[102:117], a[104:107], a[200:203], v[102:117]
ds_read_u16_d16_hi v128, v128
ds_read_u16_d16_hi v129, v129
v_pk_fma_f16 v79, v95, v95, s84
v_pk_mul_f16 v78, v94, v78
v_cvt_pk_f16_f32 v97, v140, v141
v_pk_fma_f16 v80, v96, v96, s84
v_pk_mul_f16 v79, v95, v79
v_cvt_pk_f16_f32 v98, v142, v143
v_mfma_f32_32x32x16_bf16 v[102:117], a[108:111], a[204:207], v[102:117]
ds_read_u16_d16_hi v130, v130
ds_read_u16_d16_hi v131, v131
v_rcp_f16_sdwa v62, v70 dst_sel:WORD_1 dst_unused:UNUSED_PRESERVE src0_sel:WORD_1
v_rcp_f16 v65, v73
v_pk_mul_f16 v86, v86, v62
v_pk_fma_f16 v81, v97, v97, s84
v_mfma_f32_32x32x16_bf16 v[102:117], a[112:115], a[208:211], v[102:117]
ds_read_u16_d16_hi v132, v132
v_pk_mul_f16 v80, v96, v80
v_cvt_pk_f16_f32 v99, v144, v145
v_rcp_f16_sdwa v63, v71 dst_sel:WORD_1 dst_unused:UNUSED_PRESERVE src0_sel:WORD_1
v_rcp_f16 v66, v74
v_pk_mul_f16 v87, v87, v63
v_mfma_f32_32x32x16_bf16 v[102:117], a[116:119], a[212:215], v[102:117]
ds_read_u16_d16_hi v133, v133
v_pk_fma_f16 v82, v98, v98, s84
v_pk_mul_f16 v81, v97, v81
v_cvt_pk_f16_f32 v100, v146, v147
v_rcp_f16_sdwa v64, v72 dst_sel:WORD_1 dst_unused:UNUSED_PRESERVE src0_sel:WORD_1
v_rcp_f16 v67, v75
v_pk_mul_f16 v88, v88, v64
v_pk_fma_f16 v83, v99, v99, s84
v_pk_mul_f16 v82, v98, v82
v_rcp_f16_sdwa v65, v73 dst_sel:WORD_1 dst_unused:UNUSED_PRESERVE src0_sel:WORD_1
v_rcp_f16_sdwa v66, v74 dst_sel:WORD_1 dst_unused:UNUSED_PRESERVE src0_sel:WORD_1
v_pk_mul_f16 v89, v89, v65
v_cvt_pk_f16_f32 v101, v148, v149
v_mfma_f32_32x32x16_bf16 v[134:149], a[120:123], a[192:195], 0
ds_read_b128 a[192:195], v1 offset:49152
v_pk_fma_f16 v84, v100, v100, s84
v_pk_mul_f16 v83, v99, v83
v_rcp_f16_sdwa v67, v75 dst_sel:WORD_1 dst_unused:UNUSED_PRESERVE src0_sel:WORD_1
v_pk_mul_f16 v90, v90, v66
v_pk_fma_f16 v85, v101, v101, s84
v_pk_mul_f16 v84, v100, v84
v_mfma_f32_32x32x16_bf16 v[134:149], a[124:127], a[196:199], v[134:149]
ds_read_b128 a[196:199], v1 offset:50176
v_pk_mul_f16 v85, v101, v85
s_waitcnt lgkmcnt(6)
v_cmp_gt_u32 vcc, 10, v156
v_pk_mul_f16 v91, v91, v67
v_mad_u32_u16 v102, v102, 2, s85 op_sel:[1,0,0,0]
s_cbranch_vccnz L_spin10
L_ok10:
v_mov_b32 v156, 11
v_mfma_f32_32x32x16_bf16 v[134:149], a[128:131], a[200:203], v[134:149]
ds_read_b128 a[200:203], v1 offset:51200
ds_read_b128 a[156:159], v6 offset:28416
ds_read_b128 a[160:163], v7 offset:28416
ds_read_b128 a[144:147], v5 offset:4608
v_exp_f16 v62, v78
v_mad_u32_u16 v103, v103, 2, s85 op_sel:[1,0,0,0]
v_mad_u32_u16 v104, v104, 2, s85 op_sel:[1,0,0,0]
v_mfma_f32_32x32x16_bf16 v[134:149], a[132:135], a[204:207], v[134:149]
ds_read_b128 a[204:207], v1 offset:52224
ds_read_b128 a[164:167], v6 offset:30592
v_mad_u32_u16 v105, v105, 2, s85 op_sel:[1,0,0,0]
v_mad_u32_u16 v106, v106, 2, s85 op_sel:[1,0,0,0]
v_mad_u32_u16 v107, v107, 2, s85 op_sel:[1,0,0,0]
v_exp_f16 v63, v79
v_mad_u32_u16 v108, v108, 2, s85 op_sel:[1,0,0,0]
v_mfma_f32_32x32x16_bf16 v[134:149], a[136:139], a[208:211], v[134:149]
ds_read_b128 a[208:211], v1 offset:53248
v_mad_u32_u16 v109, v109, 2, s85 op_sel:[1,0,0,0]
v_mad_u32_u16 v110, v110, 2, s85 op_sel:[1,0,0,0]
v_mad_u32_u16 v111, v111, 2, s85 op_sel:[1,0,0,0]
v_exp_f16 v64, v80
v_exp_f16_sdwa v62, v78 dst_sel:WORD_1 dst_unused:UNUSED_PRESERVE src0_sel:WORD_1
v_mfma_f32_32x32x16_bf16 v[134:149], a[140:143], a[212:215], v[134:149]
ds_read_b128 a[212:215], v1 offset:54272
ds_read_b128 a[168:171], v7 offset:30592
v_pk_add_f16 v78, v62, 1.0 op_sel_hi:[1,0]
v_mad_u32_u16 v112, v112, 2, s85 op_sel:[1,0,0,0]
v_exp_f16 v65, v81
v_exp_f16_sdwa v63, v79 dst_sel:WORD_1 dst_unused:UNUSED_PRESERVE src0_sel:WORD_1
s_waitcnt lgkmcnt(7)
v_pk_add_f32 v[32:33], v[32:33], v[132:133]
v_pk_add_f32 v[32:33], v[32:33], v[130:131]
v_pk_add_f32 v[32:33], v[32:33], v[128:129]
v_pk_add_f32 v[32:33], v[32:33], v[126:127]
v_pk_add_f32 v[32:33], v[32:33], v[124:125]
v_exp_f16 v66, v82
v_pk_add_f32 v[32:33], v[32:33], v[122:123]
v_pk_add_f32 v[32:33], v[32:33], v[120:121]
v_pk_add_f32 v[32:33], v[32:33], v[118:119]
v_dot2c_f32_f16 v31, v91, v91
v_dot2c_f32_f16 v30, v90, v90
v_dot2c_f32_f16 v31, v89, v89
v_dot2c_f32_f16 v30, v88, v88
v_dot2c_f32_f16 v31, v87, v87
v_dot2c_f32_f16 v30, v86, v86
v_mfma_f32_32x32x16_bf16 v[118:133], a[96:99], a[216:219], 0
ds_read_b128 a[148:151], v5 offset:6144
ds_read_b128 a[172:175], v6 offset:32768
ds_read_b128 a[176:179], v7 offset:32768
ds_read_b128 a[152:155], v5 offset:7680
v_exp_f16_sdwa v64, v80 dst_sel:WORD_1 dst_unused:UNUSED_PRESERVE src0_sel:WORD_1
v_pk_add_f16 v79, v63, 1.0 op_sel_hi:[1,0]
v_mad_u32_u16 v113, v113, 2, s85 op_sel:[1,0,0,0]
s_waitcnt lgkmcnt(5)
v_smfmac_f32_32x32x32_bf16 v[176:191], a[144:147], a[156:163], v4
ds_read_b128 a[156:159], v6 offset:34944
v_pk_add_f16 v80, v64, 1.0 op_sel_hi:[1,0]
v_mad_u32_u16 v114, v114, 2, s85 op_sel:[1,0,0,0]
v_exp_f16 v67, v83
v_exp_f16_sdwa v65, v81 dst_sel:WORD_1 dst_unused:UNUSED_PRESERVE src0_sel:WORD_1
v_mfma_f32_32x32x16_bf16 v[118:133], a[100:103], a[220:223], v[118:133]
ds_read_b128 a[160:163], v7 offset:34944
ds_read_u16_d16_hi v102, v102
ds_read_u16_d16_hi v103, v103
ds_read_u16_d16_hi v104, v104
v_pk_add_f16 v81, v65, 1.0 op_sel_hi:[1,0]
v_exp_f16 v68, v84
v_exp_f16_sdwa v66, v82 dst_sel:WORD_1 dst_unused:UNUSED_PRESERVE src0_sel:WORD_1
v_mfma_f32_32x32x16_bf16 v[118:133], a[104:107], a[224:227], v[118:133]
ds_read_u16_d16_hi v105, v105
ds_read_u16_d16_hi v106, v106
ds_read_u16_d16_hi v107, v107
ds_read_u16_d16_hi v108, v108
v_pk_add_f16 v82, v66, 1.0 op_sel_hi:[1,0]
v_mad_u32_u16 v115, v115, 2, s85 op_sel:[1,0,0,0]
v_exp_f16 v69, v85
s_waitcnt lgkmcnt(7)
v_smfmac_f32_32x32x32_bf16 v[176:191], a[148:151], a[164:171], v4
ds_read_u16_d16_hi v109, v109
v_exp_f16_sdwa v67, v83 dst_sel:WORD_1 dst_unused:UNUSED_PRESERVE src0_sel:WORD_1
v_exp_f16_sdwa v68, v84 dst_sel:WORD_1 dst_unused:UNUSED_PRESERVE src0_sel:WORD_1
v_pk_add_f16 v83, v67, 1.0 op_sel_hi:[1,0]
v_mad_u32_u16 v116, v116, 2, s85 op_sel:[1,0,0,0]
v_mfma_f32_32x32x16_bf16 v[118:133], a[108:111], a[228:231], v[118:133]
ds_read_u16_d16_hi v110, v110
ds_read_u16_d16_hi v111, v111
ds_read_u16_d16_hi v112, v112
v_pk_add_f16 v84, v68, 1.0 op_sel_hi:[1,0]
v_mad_u32_u16 v117, v117, 2, s85 op_sel:[1,0,0,0]
v_exp_f16_sdwa v69, v85 dst_sel:WORD_1 dst_unused:UNUSED_PRESERVE src0_sel:WORD_1
v_smfmac_f32_32x32x32_bf16 v[224:239], a[144:147], a[164:171], v4
ds_read_b128 a[164:167], v8 offset:28416
v_pk_add_f16 v85, v69, 1.0 op_sel_hi:[1,0]
v_mul_f32 v150, s60, v146
v_mul_f32 v151, s60, v147
v_mul_f32 v152, s60, v148
v_mul_f32 v153, s60, v149
v_mad_u32_u16 v150, v150, 2, s85 op_sel:[1,0,0,0]
v_mfma_f32_32x32x16_bf16 v[118:133], a[112:115], a[232:235], v[118:133]
ds_read_b128 a[168:171], v9 offset:28416
ds_read_b128 a[144:147], v5 offset:5120
ds_read_u16_d16_hi v113, v113
v_mad_u32_u16 v151, v151, 2, s85 op_sel:[1,0,0,0]
v_rcp_f16 v62, v78
v_mad_u32_u16 v152, v152, 2, s85 op_sel:[1,0,0,0]
v_mad_u32_u16 v153, v153, 2, s85 op_sel:[1,0,0,0]
v_smfmac_f32_32x32x32_bf16 v[176:191], a[152:155], a[172:179], v4
ds_read_u16_d16_hi v114, v114
v_cvt_pk_f16_f32 v86, v134, v135
v_cvt_pk_f16_f32 v87, v136, v137
v_rcp_f16 v63, v79
v_rcp_f16 v64, v80
v_mfma_f32_32x32x16_bf16 v[118:133], a[116:119], a[236:239], v[118:133]
ds_read_u16_d16_hi v115, v115
v_rcp_f16_sdwa v62, v78 dst_sel:WORD_1 dst_unused:UNUSED_PRESERVE src0_sel:WORD_1
v_rcp_f16 v65, v81
v_pk_mul_f16 v94, v94, v62
v_pk_fma_f16 v70, v86, v86, s84
v_cvt_pk_f16_f32 v88, v138, v139
v_smfmac_f32_32x32x32_bf16 v[224:239], a[148:151], a[172:179], v4
global_load_dword a255, v[158:159], off
ds_read_b128 a[172:175], v8 offset:30592
v_rcp_f16_sdwa v63, v79 dst_sel:WORD_1 dst_unused:UNUSED_PRESERVE src0_sel:WORD_1
v_lshl_add_u64 v[158:159], v[158:159], 0, s[42:43]
v_rcp_f16 v66, v82
v_smfmac_f32_32x32x32_bf16 v[224:239], a[152:155], a[156:163], v4
ds_read_b128 a[176:179], v9 offset:30592
v_pk_mul_f16 v95, v95, v63
v_pk_fma_f16 v71, v87, v87, s84
v_rcp_f16_sdwa v64, v80 dst_sel:WORD_1 dst_unused:UNUSED_PRESERVE src0_sel:WORD_1
v_pk_mul_f16 v70, v86, v70
v_pk_mul_f16 v96, v96, v64
v_cvt_pk_f16_f32 v89, v140, v141
v_rcp_f16 v67, v83
v_pk_fma_f16 v72, v88, v88, s84
v_pk_mul_f16 v71, v87, v71
v_rcp_f16_sdwa v65, v81 dst_sel:WORD_1 dst_unused:UNUSED_PRESERVE src0_sel:WORD_1
v_rcp_f16 v68, v84
v_pk_mul_f16 v97, v97, v65
v_cvt_pk_f16_f32 v90, v142, v143
v_pk_fma_f16 v73, v89, v89, s84
v_rcp_f16_sdwa v66, v82 dst_sel:WORD_1 dst_unused:UNUSED_PRESERVE src0_sel:WORD_1
v_rcp_f16 v69, v85
v_pk_mul_f16 v98, v98, v66
v_pk_mul_f16 v72, v88, v72
v_cvt_pk_f16_f32 v91, v144, v145
v_mfma_f32_32x32x16_bf16 v[134:149], a[120:123], a[216:219], 0
ds_read_b128 a[216:219], v1 offset:55296
ds_read_b128 a[148:151], v5 offset:6656
ds_read_b128 a[156:159], v8 offset:32768
ds_read_b128 a[160:163], v9 offset:32768
v_rcp_f16_sdwa v67, v83 dst_sel:WORD_1 dst_unused:UNUSED_PRESERVE src0_sel:WORD_1
v_rcp_f16_sdwa v68, v84 dst_sel:WORD_1 dst_unused:UNUSED_PRESERVE src0_sel:WORD_1
s_waitcnt lgkmcnt(7)
v_smfmac_f32_32x32x32_bf16 v[176:191], a[144:147], a[164:171], v4
ds_read_b128 a[152:155], v5 offset:8192
v_pk_mul_f16 v99, v99, v67
v_pk_fma_f16 v74, v90, v90, s84
v_pk_mul_f16 v73, v89, v73
v_rcp_f16_sdwa v69, v85 dst_sel:WORD_1 dst_unused:UNUSED_PRESERVE src0_sel:WORD_1
v_pk_mul_f16 v100, v100, v68
v_mfma_f32_32x32x16_bf16 v[134:149], a[124:127], a[220:223], v[134:149]
ds_read_b128 a[220:223], v1 offset:56320
ds_read_b128 a[164:167], v8 offset:34944
ds_read_b128 a[168:171], v9 offset:34944
ds_read_u16_d16_hi v116, v116
v_pk_fma_f16 v75, v91, v91, s84
v_exp_f16 v62, v70
v_pk_mul_f16 v74, v90, v74
v_mfma_f32_32x32x16_bf16 v[134:149], a[128:131], a[224:227], v[134:149]
ds_read_b128 a[224:227], v1 offset:57344
ds_read_u16_d16_hi v117, v117
ds_read_u16_d16_hi v150, v150
buffer_store_dwordx4 v[94:97], v1, s[12:15], s101 offen offset:0 sc1
s_waitcnt lgkmcnt(7)
v_smfmac_f32_32x32x32_bf16 v[176:191], a[148:151], a[172:179], v4
ds_read_u16_d16_hi v151, v151
v_pk_mul_f16 v75, v91, v75
v_pk_mul_f16 v101, v101, v69
v_mad_u32_u16 v118, v118, 2, s85 op_sel:[1,0,0,0]
v_exp_f16 v63, v71
v_mad_u32_u16 v119, v119, 2, s85 op_sel:[1,0,0,0]
v_mfma_f32_32x32x16_bf16 v[134:149], a[132:135], a[228:231], v[134:149]
ds_read_b128 a[228:231], v1 offset:58368
ds_read_u16_d16_hi v152, v152
ds_read_u16_d16_hi v153, v153
ds_read_u16_d16_hi v118, v118
v_mad_u32_u16 v120, v120, 2, s85 op_sel:[1,0,0,0]
v_mad_u32_u16 v121, v121, 2, s85 op_sel:[1,0,0,0]
v_exp_f16 v64, v72
v_smfmac_f32_32x32x32_bf16 v[224:239], a[144:147], a[172:179], v4
ds_read_b128 a[172:175], v10 offset:28416
v_mad_u32_u16 v122, v122, 2, s85 op_sel:[1,0,0,0]
v_mad_u32_u16 v123, v123, 2, s85 op_sel:[1,0,0,0]
v_mad_u32_u16 v124, v124, 2, s85 op_sel:[1,0,0,0]
v_mad_u32_u16 v125, v125, 2, s85 op_sel:[1,0,0,0]
v_mad_u32_u16 v126, v126, 2, s85 op_sel:[1,0,0,0]
v_exp_f16_sdwa v62, v70 dst_sel:WORD_1 dst_unused:UNUSED_PRESERVE src0_sel:WORD_1
v_mfma_f32_32x32x16_bf16 v[134:149], a[136:139], a[232:235], v[134:149]
ds_read_b128 a[232:235], v1 offset:59392
ds_read_b128 a[176:179], v11 offset:28416
ds_read_b128 a[144:147], v5 offset:5632
ds_read_u16_d16_hi v119, v119
v_mad_u32_u16 v127, v127, 2, s85 op_sel:[1,0,0,0]
v_mad_u32_u16 v128, v128, 2, s85 op_sel:[1,0,0,0]
v_exp_f16 v65, v73
v_smfmac_f32_32x32x32_bf16 v[176:191], a[152:155], a[156:163], v4
ds_read_u16_d16_hi v120, v120
v_pk_add_f16 v70, v62, 1.0 op_sel_hi:[1,0]
v_mad_u32_u16 v129, v129, 2, s85 op_sel:[1,0,0,0]
v_exp_f16_sdwa v63, v71 dst_sel:WORD_1 dst_unused:UNUSED_PRESERVE src0_sel:WORD_1
v_exp_f16 v66, v74
s_waitcnt lgkmcnt(9)
v_pk_add_f32 v[34:35], v[34:35], v[116:117]
v_pk_add_f32 v[34:35], v[34:35], v[114:115]
v_pk_add_f32 v[34:35], v[34:35], v[112:113]
v_pk_add_f32 v[34:35], v[34:35], v[110:111]
v_pk_add_f32 v[34:35], v[34:35], v[108:109]
v_pk_add_f32 v[34:35], v[34:35], v[106:107]
v_pk_add_f32 v[34:35], v[34:35], v[104:105]
v_pk_add_f32 v[34:35], v[34:35], v[102:103]
v_mfma_f32_32x32x16_f16 v[102:117], v[94:97], a[240:243], 0
ds_read_u16_d16_hi v121, v121
ds_read_u16_d16_hi v122, v122
ds_read_u16_d16_hi v123, v123
buffer_store_dwordx4 v[98:101], v1, s[12:15], s101 offen offset:1024 sc1
v_mfma_f32_32x32x16_bf16 v[134:149], a[140:143], a[236:239], v[134:149]
ds_read_b128 a[236:239], v1 offset:60416
v_pk_add_f16 v71, v63, 1.0 op_sel_hi:[1,0]
v_mad_u32_u16 v130, v130, 2, s85 op_sel:[1,0,0,0]
v_exp_f16_sdwa v64, v72 dst_sel:WORD_1 dst_unused:UNUSED_PRESERVE src0_sel:WORD_1
v_exp_f16 v67, v75
v_pk_add_f16 v72, v64, 1.0 op_sel_hi:[1,0]
v_smfmac_f32_32x32x32_bf16 v[224:239], a[148:151], a[156:163], v4
ds_read_b128 a[156:159], v10 offset:30592
v_mad_u32_u16 v131, v131, 2, s85 op_sel:[1,0,0,0]
v_exp_f16_sdwa v65, v73 dst_sel:WORD_1 dst_unused:UNUSED_PRESERVE src0_sel:WORD_1
v_exp_f16_sdwa v66, v74 dst_sel:WORD_1 dst_unused:UNUSED_PRESERVE src0_sel:WORD_1
v_pk_add_f16 v73, v65, 1.0 op_sel_hi:[1,0]
v_mfma_f32_32x32x16_f16 v[102:117], v[98:101], a[244:247], v[102:117]
ds_read_b128 a[160:163], v11 offset:30592
ds_read_b128 a[148:151], v5 offset:7168
ds_read_u16_d16_hi v124, v124
v_exp_f16_sdwa v67, v75 dst_sel:WORD_1 dst_unused:UNUSED_PRESERVE src0_sel:WORD_1
v_mad_u32_u16 v132, v132, 2, s85 op_sel:[1,0,0,0]
v_pk_add_f16 v74, v66, 1.0 op_sel_hi:[1,0]
v_mad_u32_u16 v133, v133, 2, s85 op_sel:[1,0,0,0]
v_smfmac_f32_32x32x32_bf16 v[224:239], a[152:155], a[164:171], v4
ds_read_b128 a[164:167], v10 offset:32768
v_pk_add_f16 v75, v67, 1.0 op_sel_hi:[1,0]
v_add_f32 v34, v34, v150
v_add_f32 v35, v35, v151
s_waitcnt lgkmcnt(8)
v_add_f32 v34, v34, v152
v_add_f32 v35, v35, v153
v_pk_fma_f32 v[32:33], v[102:103], v[102:103], v[32:33]
v_pk_fma_f32 v[32:33], v[104:105], v[104:105], v[32:33]
v_pk_fma_f32 v[32:33], v[106:107], v[106:107], v[32:33]
v_pk_fma_f32 v[32:33], v[108:109], v[108:109], v[32:33]
v_pk_fma_f32 v[32:33], v[110:111], v[110:111], v[32:33]
v_pk_fma_f32 v[32:33], v[112:113], v[112:113], v[32:33]
v_pk_fma_f32 v[32:33], v[114:115], v[114:115], v[32:33]
v_mul_f32 v150, s60, v146
v_pk_fma_f32 v[32:33], v[116:117], v[116:117], v[32:33]
v_mfma_f32_32x32x16_bf16 v[102:117], a[96:99], a[192:195], 0
ds_read_b128 a[168:171], v11 offset:32768
ds_read_b128 a[152:155], v5 offset:8704
ds_read_u16_d16_hi v125, v125
ds_read_u16_d16_hi v126, v126
v_mul_f32 v151, s60, v147
v_mul_f32 v152, s60, v148
v_mul_f32 v153, s60, v149
v_mad_u32_u16 v150, v150, 2, s85 op_sel:[1,0,0,0]
v_smfmac_f32_32x32x32_bf16 v[176:191], a[144:147], a[172:179], v4
ds_read_b128 a[172:175], v10 offset:34944
v_mad_u32_u16 v151, v151, 2, s85 op_sel:[1,0,0,0]
v_mad_u32_u16 v152, v152, 2, s85 op_sel:[1,0,0,0]
v_mad_u32_u16 v153, v153, 2, s85 op_sel:[1,0,0,0]
v_cvt_pk_f16_f32 v94, v134, v135
v_cvt_pk_f16_f32 v95, v136, v137
v_rcp_f16 v62, v70
v_mfma_f32_32x32x16_bf16 v[102:117], a[100:103], a[196:199], v[102:117]
ds_read_b128 a[176:179], v11 offset:34944
ds_read_u16_d16_hi v127, v127
ds_read_u16_d16_hi v128, v128
s_add_u32 s101, s3, 65536
v_pk_fma_f16 v78, v94, v94, s84
v_rcp_f16 v63, v71
v_rcp_f16 v64, v72
s_waitcnt lgkmcnt(7)
v_smfmac_f32_32x32x32_bf16 v[176:191], a[148:151], a[156:163], v4
ds_read_u16_d16_hi v129, v129
v_rcp_f16_sdwa v62, v70 dst_sel:WORD_1 dst_unused:UNUSED_PRESERVE src0_sel:WORD_1
v_rcp_f16 v65, v73
v_pk_mul_f16 v86, v86, v62
v_cvt_pk_f16_f32 v96, v138, v139
v_mfma_f32_32x32x16_bf16 v[102:117], a[104:107], a[200:203], v[102:117]
ds_read_u16_d16_hi v130, v130
ds_read_u16_d16_hi v131, v131
ds_read_u16_d16_hi v132, v132
ds_read_u16_d16_hi v133, v133
v_pk_fma_f16 v79, v95, v95, s84
v_rcp_f16_sdwa v63, v71 dst_sel:WORD_1 dst_unused:UNUSED_PRESERVE src0_sel:WORD_1
v_pk_mul_f16 v78, v94, v78
v_smfmac_f32_32x32x32_bf16 v[224:239], a[144:147], a[156:163], v4
ds_read_u16_d16_hi v150, v150
v_pk_mul_f16 v87, v87, v63
v_cvt_pk_f16_f32 v97, v140, v141
v_pk_fma_f16 v80, v96, v96, s84
v_pk_mul_f16 v79, v95, v79
v_rcp_f16 v66, v74
v_mfma_f32_32x32x16_bf16 v[102:117], a[108:111], a[204:207], v[102:117]
ds_read_u16_d16_hi v151, v151
ds_read_u16_d16_hi v152, v152
v_rcp_f16_sdwa v64, v72 dst_sel:WORD_1 dst_unused:UNUSED_PRESERVE src0_sel:WORD_1
v_rcp_f16 v67, v75
v_pk_mul_f16 v88, v88, v64
v_cvt_pk_f16_f32 v98, v142, v143
s_waitcnt lgkmcnt(9)
v_smfmac_f32_32x32x32_bf16 v[176:191], a[152:155], a[164:171], v4
ds_read_u16_d16_hi v153, v153
s_waitcnt vmcnt(5)
ds_write_b32 v154, v156
v_pk_fma_f16 v81, v97, v97, s84
v_pk_mul_f16 v80, v96, v80
v_rcp_f16_sdwa v65, v73 dst_sel:WORD_1 dst_unused:UNUSED_PRESERVE src0_sel:WORD_1
v_mfma_f32_32x32x16_bf16 v[102:117], a[112:115], a[208:211], v[102:117]
v_pk_mul_f16 v89, v89, v65
v_cvt_pk_f16_f32 v99, v144, v145
v_pk_fma_f16 v82, v98, v98, s84
v_pk_mul_f16 v81, v97, v81
v_rcp_f16_sdwa v66, v74 dst_sel:WORD_1 dst_unused:UNUSED_PRESERVE src0_sel:WORD_1
v_rcp_f16_sdwa v67, v75 dst_sel:WORD_1 dst_unused:UNUSED_PRESERVE src0_sel:WORD_1
v_pk_fma_f32 v[48:49], v[176:177], v[176:177], v[48:49]
v_pk_add_f32 v[46:47], v[46:47], v[176:177]
v_pk_fma_f32 v[48:49], v[178:179], v[178:179], v[48:49]
v_exp_f16 v62, v78
v_pk_add_f32 v[46:47], v[46:47], v[178:179]
v_pk_fma_f32 v[48:49], v[180:181], v[180:181], v[48:49]
v_pk_add_f32 v[46:47], v[46:47], v[180:181]
v_pk_fma_f32 v[48:49], v[182:183], v[182:183], v[48:49]
v_exp_f16 v63, v79
v_pk_add_f32 v[46:47], v[46:47], v[182:183]
v_pk_fma_f32 v[48:49], v[184:185], v[184:185], v[48:49]
v_pk_add_f32 v[46:47], v[46:47], v[184:185]
v_exp_f16 v64, v80
v_pk_fma_f32 v[48:49], v[186:187], v[186:187], v[48:49]
v_pk_add_f32 v[46:47], v[46:47], v[186:187]
v_pk_fma_f32 v[48:49], v[188:189], v[188:189], v[48:49]
v_pk_add_f32 v[46:47], v[46:47], v[188:189]
v_pk_fma_f32 v[48:49], v[190:191], v[190:191], v[48:49]
v_pk_add_f32 v[46:47], v[46:47], v[190:191]
v_smfmac_f32_32x32x32_bf16 v[224:239], a[148:151], a[164:171], v4
v_pk_mul_f16 v90, v90, v66
v_pk_fma_f16 v83, v99, v99, s84
v_pk_mul_f16 v82, v98, v82
v_pk_mul_f16 v83, v99, v83
v_pk_mul_f16 v91, v91, v67
v_exp_f16_sdwa v62, v78 dst_sel:WORD_1 dst_unused:UNUSED_PRESERVE src0_sel:WORD_1
s_waitcnt lgkmcnt(3)
v_pk_add_f32 v[36:37], v[36:37], v[132:133]
v_pk_add_f32 v[36:37], v[36:37], v[130:131]
v_pk_add_f32 v[36:37], v[36:37], v[128:129]
v_pk_add_f32 v[36:37], v[36:37], v[126:127]
v_pk_add_f32 v[36:37], v[36:37], v[124:125]
v_pk_add_f32 v[36:37], v[36:37], v[122:123]
v_exp_f16 v65, v81
v_pk_add_f32 v[36:37], v[36:37], v[120:121]
v_pk_add_f32 v[36:37], v[36:37], v[118:119]
v_dot2c_f32_f16 v35, v91, v91
v_dot2c_f32_f16 v34, v90, v90
v_dot2c_f32_f16 v35, v89, v89
v_dot2c_f32_f16 v34, v88, v88
v_dot2c_f32_f16 v35, v87, v87
v_dot2c_f32_f16 v34, v86, v86
v_mfma_f32_32x32x16_bf16 v[102:117], a[116:119], a[212:215], v[102:117]
v_exp_f16_sdwa v63, v79 dst_sel:WORD_1 dst_unused:UNUSED_PRESERVE src0_sel:WORD_1
v_exp_f16 v66, v82
v_exp_f16_sdwa v64, v80 dst_sel:WORD_1 dst_unused:UNUSED_PRESERVE src0_sel:WORD_1
v_exp_f16 v67, v83
v_smfmac_f32_32x32x32_bf16 v[224:239], a[152:155], a[172:179], v4
v_exp_f16_sdwa v65, v81 dst_sel:WORD_1 dst_unused:UNUSED_PRESERVE src0_sel:WORD_1
v_exp_f16_sdwa v66, v82 dst_sel:WORD_1 dst_unused:UNUSED_PRESERVE src0_sel:WORD_1
v_exp_f16_sdwa v67, v83 dst_sel:WORD_1 dst_unused:UNUSED_PRESERVE src0_sel:WORD_1
v_mfma_f32_32x32x16_bf16 v[134:149], a[192:195], a[120:123], 0
ds_read_b128 a[192:195], v1 offset:61440
s_nop 1
v_mad_u32_u16 v102, v102, 2, s85 op_sel:[1,0,0,0]
v_mad_u32_u16 v103, v103, 2, s85 op_sel:[1,0,0,0]
v_mad_u32_u16 v104, v104, 2, s85 op_sel:[1,0,0,0]
v_mad_u32_u16 v105, v105, 2, s85 op_sel:[1,0,0,0]
v_mad_u32_u16 v106, v106, 2, s85 op_sel:[1,0,0,0]
v_pk_fma_f32 v[52:53], v[224:225], v[224:225], v[52:53]
v_pk_add_f32 v[50:51], v[50:51], v[224:225]
v_pk_fma_f32 v[52:53], v[226:227], v[226:227], v[52:53]
v_pk_add_f32 v[50:51], v[50:51], v[226:227]
v_pk_fma_f32 v[52:53], v[228:229], v[228:229], v[52:53]
v_pk_add_f32 v[50:51], v[50:51], v[228:229]
v_pk_fma_f32 v[52:53], v[230:231], v[230:231], v[52:53]
v_pk_add_f32 v[50:51], v[50:51], v[230:231]
v_pk_fma_f32 v[52:53], v[232:233], v[232:233], v[52:53]
v_pk_add_f32 v[50:51], v[50:51], v[232:233]
v_pk_fma_f32 v[52:53], v[234:235], v[234:235], v[52:53]
v_pk_add_f32 v[50:51], v[50:51], v[234:235]
v_pk_fma_f32 v[52:53], v[236:237], v[236:237], v[52:53]
v_pk_add_f32 v[50:51], v[50:51], v[236:237]
v_pk_fma_f32 v[52:53], v[238:239], v[238:239], v[52:53]
v_pk_add_f32 v[50:51], v[50:51], v[238:239]
v_mfma_f32_32x32x16_bf16 v[134:149], a[196:199], a[124:127], v[134:149]
ds_read_b128 a[196:199], v1 offset:62464
ds_read_u16_d16_hi v102, v102
ds_read_u16_d16_hi v103, v103
ds_read_u16_d16_hi v104, v104
v_mad_u32_u16 v107, v107, 2, s85 op_sel:[1,0,0,0]
v_mad_u32_u16 v108, v108, 2, s85 op_sel:[1,0,0,0]
v_mad_u32_u16 v109, v109, 2, s85 op_sel:[1,0,0,0]
v_mad_u32_u16 v110, v110, 2, s85 op_sel:[1,0,0,0]
v_mfma_f32_32x32x16_bf16 v[192:207], a[248:251], a[248:251], 0
ds_read_u16_d16_hi v105, v105
ds_read_u16_d16_hi v106, v106
ds_read_u16_d16_hi v107, v107
ds_read_u16_d16_hi v108, v108
v_mad_u32_u16 v111, v111, 2, s85 op_sel:[1,0,0,0]
v_mad_u32_u16 v112, v112, 2, s85 op_sel:[1,0,0,0]
v_pk_add_f16 v78, v62, 1.0 op_sel_hi:[1,0]
v_mfma_f32_32x32x16_bf16 v[134:149], a[200:203], a[128:131], v[134:149]
ds_read_b128 a[200:203], v1 offset:63488
ds_read_u16_d16_hi v109, v109
ds_read_u16_d16_hi v110, v110
v_mad_u32_u16 v113, v113, 2, s85 op_sel:[1,0,0,0]
v_pk_add_f16 v79, v63, 1.0 op_sel_hi:[1,0]
v_rcp_f16 v62, v78
v_mad_u32_u16 v114, v114, 2, s85 op_sel:[1,0,0,0]
v_mfma_f32_32x32x16_bf16 v[240:255], a[248:251], a[248:251], 0
ds_read_u16_d16_hi v111, v111
v_pk_add_f16 v80, v64, 1.0 op_sel_hi:[1,0]
v_mad_u32_u16 v115, v115, 2, s85 op_sel:[1,0,0,0]
v_pk_add_f16 v81, v65, 1.0 op_sel_hi:[1,0]
v_mad_u32_u16 v116, v116, 2, s85 op_sel:[1,0,0,0]
v_pk_add_f16 v82, v66, 1.0 op_sel_hi:[1,0]
v_rcp_f16 v63, v79
v_mfma_f32_32x32x16_bf16 v[134:149], a[204:207], a[132:135], v[134:149]
ds_read_b128 a[204:207], v1 offset:64512
ds_read_u16_d16_hi v112, v112
v_mad_u32_u16 v117, v117, 2, s85 op_sel:[1,0,0,0]
v_pk_add_f16 v83, v67, 1.0 op_sel_hi:[1,0]
v_add_f32 v36, v36, v150
v_add_f32 v37, v37, v151
s_waitcnt lgkmcnt(9)
v_add_f32 v36, v36, v152
v_mfma_f32_32x32x16_bf16 v[134:149], a[208:211], a[136:139], v[134:149]
ds_read_b128 a[208:211], v2 offset:0
v_add_f32 v37, v37, v153
v_rcp_f16 v64, v80
v_rcp_f16_sdwa v62, v78 dst_sel:WORD_1 dst_unused:UNUSED_PRESERVE src0_sel:WORD_1
v_rcp_f16 v65, v81
v_mfma_f32_32x32x16_bf16 v[134:149], a[212:215], a[140:143], v[134:149]
ds_read_b128 a[212:215], v2 offset:1024
ds_read_u16_d16_hi v113, v113
v_rcp_f16_sdwa v63, v79 dst_sel:WORD_1 dst_unused:UNUSED_PRESERVE src0_sel:WORD_1
v_rcp_f16 v66, v82
v_rcp_f16_sdwa v64, v80 dst_sel:WORD_1 dst_unused:UNUSED_PRESERVE src0_sel:WORD_1
v_mfma_f32_32x32x16_bf16 v[118:133], a[96:99], a[216:219], 0
ds_read_u16_d16_hi v114, v114
v_rcp_f16 v67, v83
ds_read_b32 v156, v155
v_rcp_f16_sdwa v65, v81 dst_sel:WORD_1 dst_unused:UNUSED_PRESERVE src0_sel:WORD_1
v_mfma_f32_32x32x16_bf16 v[118:133], a[100:103], a[220:223], v[118:133]
v_rcp_f16_sdwa v66, v82 dst_sel:WORD_1 dst_unused:UNUSED_PRESERVE src0_sel:WORD_1
v_cvt_pk_f16_f32 v86, v134, v135
v_cvt_pk_f16_f32 v87, v136, v137
v_pk_fma_f16 v70, v86, v86, s84
v_cvt_pk_f16_f32 v88, v138, v139
v_pk_fma_f16 v71, v87, v87, s84
v_mfma_f32_32x32x16_bf16 v[118:133], a[104:107], a[224:227], v[118:133]
ds_read_u16_d16_hi v115, v115
ds_read_u16_d16_hi v116, v116
v_pk_mul_f16 v70, v86, v70
v_cvt_pk_f16_f32 v89, v140, v141
v_pk_fma_f16 v72, v88, v88, s84
v_pk_mul_f16 v71, v87, v71
v_cvt_pk_f16_f32 v90, v142, v143
v_mfma_f32_32x32x16_bf16 v[118:133], a[108:111], a[228:231], v[118:133]
ds_read_u16_d16_hi v117, v117
v_pk_mul_f16 v94, v94, v62
v_pk_fma_f16 v73, v89, v89, s84
v_pk_mul_f16 v72, v88, v72
v_cvt_pk_f16_f32 v91, v144, v145
v_pk_mul_f16 v95, v95, v63
v_pk_fma_f16 v74, v90, v90, s84
v_mfma_f32_32x32x16_bf16 v[118:133], a[112:115], a[232:235], v[118:133]
v_pk_mul_f16 v73, v89, v73
v_cvt_pk_f16_f32 v92, v146, v147
v_pk_mul_f16 v96, v96, v64
v_pk_fma_f16 v75, v91, v91, s84
v_pk_mul_f16 v74, v90, v74
v_pk_mul_f16 v97, v97, v65
v_cvt_pk_f16_f32 v93, v148, v149
v_mfma_f32_32x32x16_bf16 v[118:133], a[116:119], a[236:239], v[118:133]
v_pk_fma_f16 v76, v92, v92, s84
v_pk_mul_f16 v75, v91, v75
v_pk_mul_f16 v98, v98, v66
v_pk_fma_f16 v77, v93, v93, s84
v_pk_mul_f16 v76, v92, v76
v_pk_mul_f16 v77, v93, v77
v_rcp_f16_sdwa v67, v83 dst_sel:WORD_1 dst_unused:UNUSED_PRESERVE src0_sel:WORD_1
v_mfma_f32_32x32x16_bf16 v[134:149], a[120:123], a[216:219], 0
ds_read_b128 a[216:219], v2 offset:2048
v_pk_mul_f16 v99, v99, v67
v_exp_f16 v62, v70
v_exp_f16 v63, v71
v_mad_u32_u16 v118, v118, 2, s85 op_sel:[1,0,0,0]
v_mad_u32_u16 v119, v119, 2, s85 op_sel:[1,0,0,0]
v_mfma_f32_32x32x16_bf16 v[134:149], a[124:127], a[220:223], v[134:149]
ds_read_b128 a[220:223], v2 offset:3072
ds_read_u16_d16_hi v118, v118
ds_read_u16_d16_hi v119, v119
v_mad_u32_u16 v120, v120, 2, s85 op_sel:[1,0,0,0]
v_exp_f16 v64, v72
v_mad_u32_u16 v121, v121, 2, s85 op_sel:[1,0,0,0]
s_waitcnt lgkmcnt(5)
v_cmp_gt_u32 vcc, 11, v156
v_mfma_f32_32x32x16_bf16 v[134:149], a[128:131], a[224:227], v[134:149]
ds_read_b128 a[224:227], v2 offset:4096
ds_read_u16_d16_hi v120, v120
ds_read_u16_d16_hi v121, v121
s_cbranch_vccnz L_spin11
L_ok11:
v_mov_b32 v156, 12
v_mad_u32_u16 v122, v122, 2, s85 op_sel:[1,0,0,0]
v_mad_u32_u16 v123, v123, 2, s85 op_sel:[1,0,0,0]
v_mad_u32_u16 v124, v124, 2, s85 op_sel:[1,0,0,0]
v_mfma_f32_32x32x16_bf16 v[134:149], a[132:135], a[228:231], v[134:149]
ds_read_b128 a[228:231], v2 offset:5120
ds_read_b128 a[156:159], v6 offset:50176
ds_read_b128 a[160:163], v7 offset:50176
ds_read_b128 a[144:147], v5 offset:9216
v_exp_f16_sdwa v62, v70 dst_sel:WORD_1 dst_unused:UNUSED_PRESERVE src0_sel:WORD_1
v_mad_u32_u16 v125, v125, 2, s85 op_sel:[1,0,0,0]
v_mad_u32_u16 v126, v126, 2, s85 op_sel:[1,0,0,0]
s_waitcnt lgkmcnt(9)
v_pk_add_f32 v[38:39], v[38:39], v[116:117]
v_exp_f16 v65, v73
v_pk_add_f32 v[38:39], v[38:39], v[114:115]
v_pk_add_f32 v[38:39], v[38:39], v[112:113]
v_pk_add_f32 v[38:39], v[38:39], v[110:111]
v_exp_f16_sdwa v63, v71 dst_sel:WORD_1 dst_unused:UNUSED_PRESERVE src0_sel:WORD_1
v_pk_add_f32 v[38:39], v[38:39], v[108:109]
v_pk_add_f32 v[38:39], v[38:39], v[106:107]
v_pk_add_f32 v[38:39], v[38:39], v[104:105]
v_exp_f16 v66, v74
v_pk_add_f32 v[38:39], v[38:39], v[102:103]
v_dot2c_f32_f16 v37, v99, v99
v_dot2c_f32_f16 v36, v98, v98
v_dot2c_f32_f16 v37, v97, v97
v_dot2c_f32_f16 v36, v96, v96
v_dot2c_f32_f16 v37, v95, v95
v_dot2c_f32_f16 v36, v94, v94
v_mfma_f32_32x32x16_bf16 v[134:149], a[136:139], a[232:235], v[134:149]
ds_read_b128 a[232:235], v3 offset:26368
ds_read_b128 a[164:167], v6 offset:52352
ds_read_b128 a[168:171], v7 offset:52352
ds_read_b128 a[148:151], v5 offset:10752
v_mad_u32_u16 v127, v127, 2, s85 op_sel:[1,0,0,0]
v_pk_add_f16 v70, v62, 1.0 op_sel_hi:[1,0]
v_mad_u32_u16 v128, v128, 2, s85 op_sel:[1,0,0,0]
v_pk_add_f16 v71, v63, 1.0 op_sel_hi:[1,0]
v_mfma_f32_32x32x16_bf16 v[134:149], a[140:143], a[236:239], v[134:149]
ds_read_b128 a[236:239], v3 offset:27392
ds_read_b128 a[172:175], v6 offset:54528
ds_read_b128 a[176:179], v7 offset:54528
v_mad_u32_u16 v129, v129, 2, s85 op_sel:[1,0,0,0]
v_exp_f16_sdwa v64, v72 dst_sel:WORD_1 dst_unused:UNUSED_PRESERVE src0_sel:WORD_1
v_exp_f16 v67, v75
v_mfma_f32_32x32x16_bf16 v[102:117], a[96:99], a[192:195], 0
ds_read_b128 a[152:155], v5 offset:12288
v_pk_add_f16 v72, v64, 1.0 op_sel_hi:[1,0]
v_mad_u32_u16 v130, v130, 2, s85 op_sel:[1,0,0,0]
v_exp_f16_sdwa v65, v73 dst_sel:WORD_1 dst_unused:UNUSED_PRESERVE src0_sel:WORD_1
v_exp_f16 v68, v76
v_pk_add_f16 v73, v65, 1.0 op_sel_hi:[1,0]
v_mfma_f32_32x32x16_bf16 v[102:117], a[100:103], a[196:199], v[102:117]
ds_read_u16_d16_hi v122, v122
ds_read_u16_d16_hi v123, v123
ds_read_u16_d16_hi v124, v124
v_exp_f16_sdwa v66, v74 dst_sel:WORD_1 dst_unused:UNUSED_PRESERVE src0_sel:WORD_1
v_exp_f16 v69, v77
v_pk_add_f16 v74, v66, 1.0 op_sel_hi:[1,0]
s_waitcnt lgkmcnt(7)
v_smfmac_f32_32x32x32_bf16 v[192:207], a[144:147], a[156:163], v4
ds_read_b128 a[156:159], v6 offset:56704
v_mad_u32_u16 v131, v131, 2, s85 op_sel:[1,0,0,0]
v_exp_f16_sdwa v67, v75 dst_sel:WORD_1 dst_unused:UNUSED_PRESERVE src0_sel:WORD_1
v_exp_f16_sdwa v68, v76 dst_sel:WORD_1 dst_unused:UNUSED_PRESERVE src0_sel:WORD_1
v_pk_add_f16 v75, v67, 1.0 op_sel_hi:[1,0]
v_mfma_f32_32x32x16_bf16 v[102:117], a[104:107], a[200:203], v[102:117]
ds_read_b128 a[160:163], v7 offset:56704
ds_read_u16_d16_hi v125, v125
ds_read_u16_d16_hi v126, v126
ds_read_u16_d16_hi v127, v127
v_mad_u32_u16 v132, v132, 2, s85 op_sel:[1,0,0,0]
v_pk_add_f16 v76, v68, 1.0 op_sel_hi:[1,0]
v_mad_u32_u16 v133, v133, 2, s85 op_sel:[1,0,0,0]
v_smfmac_f32_32x32x32_bf16 v[192:207], a[148:151], a[164:171], v4
ds_read_u16_d16_hi v128, v128
v_exp_f16_sdwa v69, v77 dst_sel:WORD_1 dst_unused:UNUSED_PRESERVE src0_sel:WORD_1
v_rcp_f16 v62, v70
v_pk_add_f16 v77, v69, 1.0 op_sel_hi:[1,0]
v_mul_f32 v150, s60, v146
v_mfma_f32_32x32x16_bf16 v[102:117], a[108:111], a[204:207], v[102:117]
ds_read_u16_d16_hi v129, v129
ds_read_u16_d16_hi v130, v130
ds_read_u16_d16_hi v131, v131
ds_read_u16_d16_hi v132, v132
v_mul_f32 v151, s60, v147
v_mul_f32 v152, s60, v148
v_mul_f32 v153, s60, v149
v_mad_u32_u16 v150, v150, 2, s85 op_sel:[1,0,0,0]
v_smfmac_f32_32x32x32_bf16 v[240:255], a[144:147], a[164:171], v4
ds_read_b128 a[164:167], v8 offset:50176
v_mad_u32_u16 v151, v151, 2, s85 op_sel:[1,0,0,0]
v_mad_u32_u16 v152, v152, 2, s85 op_sel:[1,0,0,0]
v_rcp_f16 v63, v71
v_mad_u32_u16 v153, v153, 2, s85 op_sel:[1,0,0,0]
v_cvt_pk_f16_f32 v94, v134, v135
v_mfma_f32_32x32x16_bf16 v[102:117], a[112:115], a[208:211], v[102:117]
ds_read_b128 a[168:171], v9 offset:50176
v_cvt_pk_f16_f32 v95, v136, v137
v_rcp_f16 v64, v72
v_rcp_f16_sdwa v62, v70 dst_sel:WORD_1 dst_unused:UNUSED_PRESERVE src0_sel:WORD_1
v_rcp_f16 v65, v73
s_waitcnt lgkmcnt(8)
v_smfmac_f32_32x32x32_bf16 v[192:207], a[152:155], a[172:179], v4
ds_read_b128 a[144:147], v5 offset:9728
v_pk_mul_f16 v86, v86, v62
v_pk_fma_f16 v78, v94, v94, s84
v_rcp_f16_sdwa v63, v71 dst_sel:WORD_1 dst_unused:UNUSED_PRESERVE src0_sel:WORD_1
v_cvt_pk_f16_f32 v96, v138, v139
v_pk_mul_f16 v87, v87, v63
v_mfma_f32_32x32x16_bf16 v[102:117], a[116:119], a[212:215], v[102:117]
ds_read_u16_d16_hi v133, v133
ds_read_u16_d16_hi v150, v150
ds_read_u16_d16_hi v151, v151
v_pk_fma_f16 v79, v95, v95, s84
v_rcp_f16 v66, v74
v_pk_mul_f16 v78, v94, v78
v_rcp_f16_sdwa v64, v72 dst_sel:WORD_1 dst_unused:UNUSED_PRESERVE src0_sel:WORD_1
v_smfmac_f32_32x32x32_bf16 v[240:255], a[148:151], a[172:179], v4
ds_read_b128 a[172:175], v8 offset:52352
v_pk_mul_f16 v88, v88, v64
v_cvt_pk_f16_f32 v97, v140, v141
v_pk_fma_f16 v80, v96, v96, s84
v_pk_mul_f16 v79, v95, v79
v_rcp_f16 v67, v75
v_smfmac_f32_32x32x32_bf16 v[240:255], a[152:155], a[156:163], v4
ds_read_b128 a[176:179], v9 offset:52352
v_rcp_f16_sdwa v65, v73 dst_sel:WORD_1 dst_unused:UNUSED_PRESERVE src0_sel:WORD_1
v_rcp_f16 v68, v76
v_pk_mul_f16 v89, v89, v65
v_cvt_pk_f16_f32 v98, v142, v143
v_pk_fma_f16 v81, v97, v97, s84
v_rcp_f16_sdwa v66, v74 dst_sel:WORD_1 dst_unused:UNUSED_PRESERVE src0_sel:WORD_1
v_rcp_f16 v69, v77
v_pk_mul_f16 v90, v90, v66
v_pk_mul_f16 v80, v96, v80
v_cvt_pk_f16_f32 v99, v144, v145
v_mfma_f32_32x32x16_bf16 v[134:149], a[120:123], a[192:195], 0
ds_read_b128 a[192:195], v1 offset:0
ds_read_b128 a[148:151], v5 offset:11264
ds_read_b128 a[156:159], v8 offset:54528
buffer_store_dwordx4 v[86:89], v1, s[12:15], s101 offen offset:0 sc1
v_mfma_f32_32x32x16_bf16 v[134:149], a[124:127], a[196:199], v[134:149]
ds_read_b128 a[196:199], v1 offset:1024
ds_read_b128 a[160:163], v9 offset:54528
v_rcp_f16_sdwa v67, v75 dst_sel:WORD_1 dst_unused:UNUSED_PRESERVE src0_sel:WORD_1
v_rcp_f16_sdwa v68, v76 dst_sel:WORD_1 dst_unused:UNUSED_PRESERVE src0_sel:WORD_1
v_pk_mul_f16 v91, v91, v67
v_pk_fma_f16 v82, v98, v98, s84
s_waitcnt lgkmcnt(8)
v_smfmac_f32_32x32x32_bf16 v[192:207], a[144:147], a[164:171], v4
ds_read_b128 a[152:155], v5 offset:12800
v_pk_mul_f16 v81, v97, v81
v_pk_mul_f16 v92, v92, v68
v_pk_fma_f16 v83, v99, v99, s84
v_pk_mul_f16 v82, v98, v82
v_pk_mul_f16 v83, v99, v83
v_rcp_f16_sdwa v69, v77 dst_sel:WORD_1 dst_unused:UNUSED_PRESERVE src0_sel:WORD_1
v_pk_add_f32 v[40:41], v[40:41], v[132:133]
v_pk_add_f32 v[40:41], v[40:41], v[130:131]
v_pk_add_f32 v[40:41], v[40:41], v[128:129]
v_pk_add_f32 v[40:41], v[40:41], v[126:127]
v_exp_f16 v62, v78
v_pk_add_f32 v[40:41], v[40:41], v[124:125]
v_pk_add_f32 v[40:41], v[40:41], v[122:123]
v_pk_add_f32 v[40:41], v[40:41], v[120:121]
v_exp_f16 v63, v79
v_pk_add_f32 v[40:41], v[40:41], v[118:119]
v_mfma_f32_32x32x16_f16 v[118:133], v[86:89], a[240:243], 0
ds_read_b128 a[164:167], v8 offset:56704
ds_read_b128 a[168:171], v9 offset:56704
ds_read_u16_d16_hi v152, v152
ds_read_u16_d16_hi v153, v153
v_pk_mul_f16 v93, v93, v69
v_mad_u32_u16 v102, v102, 2, s85 op_sel:[1,0,0,0]
v_exp_f16 v64, v80
v_mfma_f32_32x32x16_bf16 v[134:149], a[128:131], a[200:203], v[134:149]
ds_read_b128 a[200:203], v1 offset:2048
ds_read_u16_d16_hi v102, v102
buffer_store_dwordx4 v[90:93], v1, s[12:15], s101 offen offset:1024 sc1
s_waitcnt lgkmcnt(5)
v_smfmac_f32_32x32x32_bf16 v[192:207], a[148:151], a[172:179], v4
v_mad_u32_u16 v103, v103, 2, s85 op_sel:[1,0,0,0]
v_mad_u32_u16 v104, v104, 2, s85 op_sel:[1,0,0,0]
v_mad_u32_u16 v105, v105, 2, s85 op_sel:[1,0,0,0]
v_mad_u32_u16 v106, v106, 2, s85 op_sel:[1,0,0,0]
v_mad_u32_u16 v107, v107, 2, s85 op_sel:[1,0,0,0]
v_mad_u32_u16 v108, v108, 2, s85 op_sel:[1,0,0,0]
v_mad_u32_u16 v109, v109, 2, s85 op_sel:[1,0,0,0]
v_mfma_f32_32x32x16_f16 v[118:133], v[90:93], a[244:247], v[118:133]
ds_read_u16_d16_hi v103, v103
ds_read_u16_d16_hi v104, v104
ds_read_u16_d16_hi v105, v105
ds_read_u16_d16_hi v106, v106
v_mad_u32_u16 v110, v110, 2, s85 op_sel:[1,0,0,0]
v_mad_u32_u16 v111, v111, 2, s85 op_sel:[1,0,0,0]
v_mad_u32_u16 v112, v112, 2, s85 op_sel:[1,0,0,0]
v_mfma_f32_32x32x16_bf16 v[134:149], a[132:135], a[204:207], v[134:149]
ds_read_b128 a[204:207], v1 offset:3072
ds_read_u16_d16_hi v107, v107
ds_read_u16_d16_hi v108, v108
ds_read_u16_d16_hi v109, v109
v_exp_f16_sdwa v62, v78 dst_sel:WORD_1 dst_unused:UNUSED_PRESERVE src0_sel:WORD_1
v_exp_f16 v65, v81
v_pk_fma_f32 v[38:39], v[118:119], v[118:119], v[38:39]
v_pk_fma_f32 v[38:39], v[120:121], v[120:121], v[38:39]
v_pk_fma_f32 v[38:39], v[122:123], v[122:123], v[38:39]
v_pk_fma_f32 v[38:39], v[124:125], v[124:125], v[38:39]
v_exp_f16_sdwa v63, v79 dst_sel:WORD_1 dst_unused:UNUSED_PRESERVE src0_sel:WORD_1
v_pk_fma_f32 v[38:39], v[126:127], v[126:127], v[38:39]
v_pk_fma_f32 v[38:39], v[128:129], v[128:129], v[38:39]
v_pk_fma_f32 v[38:39], v[130:131], v[130:131], v[38:39]
v_exp_f16 v66, v82
v_pk_fma_f32 v[38:39], v[132:133], v[132:133], v[38:39]
v_smfmac_f32_32x32x32_bf16 v[240:255], a[144:147], a[172:179], v4
ds_read_b128 a[172:175], v10 offset:50176
v_pk_add_f16 v78, v62, 1.0 op_sel_hi:[1,0]
v_mad_u32_u16 v113, v113, 2, s85 op_sel:[1,0,0,0]
v_pk_add_f16 v79, v63, 1.0 op_sel_hi:[1,0]
v_mad_u32_u16 v114, v114, 2, s85 op_sel:[1,0,0,0]
v_exp_f16_sdwa v64, v80 dst_sel:WORD_1 dst_unused:UNUSED_PRESERVE src0_sel:WORD_1
v_mfma_f32_32x32x16_bf16 v[134:149], a[136:139], a[208:211], v[134:149]
ds_read_b128 a[208:211], v1 offset:4096
ds_read_b128 a[176:179], v11 offset:50176
ds_read_b128 a[144:147], v5 offset:10240
ds_read_u16_d16_hi v110, v110
v_pk_add_f16 v80, v64, 1.0 op_sel_hi:[1,0]
v_mad_u32_u16 v115, v115, 2, s85 op_sel:[1,0,0,0]
v_exp_f16 v67, v83
v_smfmac_f32_32x32x32_bf16 v[192:207], a[152:155], a[156:163], v4
ds_read_u16_d16_hi v111, v111
v_exp_f16_sdwa v65, v81 dst_sel:WORD_1 dst_unused:UNUSED_PRESERVE src0_sel:WORD_1
v_exp_f16_sdwa v66, v82 dst_sel:WORD_1 dst_unused:UNUSED_PRESERVE src0_sel:WORD_1
v_pk_add_f16 v81, v65, 1.0 op_sel_hi:[1,0]
v_mad_u32_u16 v116, v116, 2, s85 op_sel:[1,0,0,0]
v_mfma_f32_32x32x16_bf16 v[134:149], a[140:143], a[212:215], v[134:149]
ds_read_b128 a[212:215], v1 offset:5120
ds_read_u16_d16_hi v112, v112
ds_read_u16_d16_hi v113, v113
s_add_u32 s101, s3, 71680
v_pk_add_f16 v82, v66, 1.0 op_sel_hi:[1,0]
v_exp_f16_sdwa v67, v83 dst_sel:WORD_1 dst_unused:UNUSED_PRESERVE src0_sel:WORD_1
v_mad_u32_u16 v117, v117, 2, s85 op_sel:[1,0,0,0]
v_smfmac_f32_32x32x32_bf16 v[240:255], a[148:151], a[156:163], v4
ds_read_b128 a[156:159], v10 offset:52352
v_pk_add_f16 v83, v67, 1.0 op_sel_hi:[1,0]
v_add_f32 v40, v40, v150
v_add_f32 v41, v41, v151
s_waitcnt lgkmcnt(9)
v_add_f32 v40, v40, v152
v_add_f32 v41, v41, v153
v_mfma_f32_32x32x16_bf16 v[118:133], a[96:99], a[216:219], 0
ds_read_b128 a[160:163], v11 offset:52352
v_mul_f32 v150, s60, v146
v_mul_f32 v151, s60, v147
v_mul_f32 v152, s60, v148
v_mul_f32 v153, s60, v149
v_mad_u32_u16 v150, v150, 2, s85 op_sel:[1,0,0,0]
v_mad_u32_u16 v151, v151, 2, s85 op_sel:[1,0,0,0]
v_mad_u32_u16 v152, v152, 2, s85 op_sel:[1,0,0,0]
v_smfmac_f32_32x32x32_bf16 v[240:255], a[152:155], a[164:171], v4
ds_read_b128 a[148:151], v5 offset:11776
v_mad_u32_u16 v153, v153, 2, s85 op_sel:[1,0,0,0]
v_cvt_pk_f16_f32 v86, v134, v135
v_cvt_pk_f16_f32 v87, v136, v137
v_pk_fma_f16 v70, v86, v86, s84
v_rcp_f16 v62, v78
v_mfma_f32_32x32x16_bf16 v[118:133], a[100:103], a[220:223], v[118:133]
ds_read_b128 a[164:167], v10 offset:54528
ds_read_b128 a[168:171], v11 offset:54528
ds_read_b128 a[152:155], v5 offset:13312
ds_read_u16_d16_hi v114, v114
v_rcp_f16 v63, v79
v_rcp_f16 v64, v80
s_waitcnt lgkmcnt(9)
v_smfmac_f32_32x32x32_bf16 v[192:207], a[144:147], a[172:179], v4
ds_read_b128 a[172:175], v10 offset:56704
v_rcp_f16_sdwa v62, v78 dst_sel:WORD_1 dst_unused:UNUSED_PRESERVE src0_sel:WORD_1
v_rcp_f16 v65, v81
v_pk_mul_f16 v94, v94, v62
v_cvt_pk_f16_f32 v88, v138, v139
v_mfma_f32_32x32x16_bf16 v[118:133], a[104:107], a[224:227], v[118:133]
ds_read_b128 a[176:179], v11 offset:56704
ds_read_u16_d16_hi v115, v115
v_pk_fma_f16 v71, v87, v87, s84
v_pk_mul_f16 v70, v86, v70
v_rcp_f16_sdwa v63, v79 dst_sel:WORD_1 dst_unused:UNUSED_PRESERVE src0_sel:WORD_1
v_rcp_f16 v66, v82
v_mfma_f32_32x32x16_bf16 v[118:133], a[108:111], a[228:231], v[118:133]
ds_read_u16_d16_hi v116, v116
v_pk_mul_f16 v95, v95, v63
v_cvt_pk_f16_f32 v89, v140, v141
v_pk_fma_f16 v72, v88, v88, s84
v_pk_mul_f16 v71, v87, v71
v_rcp_f16_sdwa v64, v80 dst_sel:WORD_1 dst_unused:UNUSED_PRESERVE src0_sel:WORD_1
v_mfma_f32_32x32x16_bf16 v[118:133], a[112:115], a[232:235], v[118:133]
ds_read_u16_d16_hi v117, v117
ds_read_u16_d16_hi v150, v150
ds_read_u16_d16_hi v151, v151
v_pk_mul_f16 v96, v96, v64
v_cvt_pk_f16_f32 v90, v142, v143
v_rcp_f16 v67, v83
v_pk_fma_f16 v73, v89, v89, s84
s_waitcnt lgkmcnt(8)
v_smfmac_f32_32x32x32_bf16 v[192:207], a[148:151], a[156:163], v4
ds_read_u16_d16_hi v152, v152
v_pk_mul_f16 v72, v88, v72
v_rcp_f16_sdwa v65, v81 dst_sel:WORD_1 dst_unused:UNUSED_PRESERVE src0_sel:WORD_1
v_rcp_f16_sdwa v66, v82 dst_sel:WORD_1 dst_unused:UNUSED_PRESERVE src0_sel:WORD_1
v_pk_mul_f16 v97, v97, v65
v_mfma_f32_32x32x16_bf16 v[118:133], a[116:119], a[236:239], v[118:133]
ds_read_u16_d16_hi v153, v153
v_cvt_pk_f16_f32 v91, v144, v145
v_pk_fma_f16 v74, v90, v90, s84
v_pk_mul_f16 v73, v89, v73
v_pk_mul_f16 v98, v98, v66
v_pk_fma_f16 v75, v91, v91, s84
v_pk_mul_f16 v74, v90, v74
v_pk_mul_f16 v75, v91, v75
v_smfmac_f32_32x32x32_bf16 v[240:255], a[144:147], a[156:163], v4
s_waitcnt lgkmcnt(5)
ds_write_b32 v154, v156
v_rcp_f16_sdwa v67, v83 dst_sel:WORD_1 dst_unused:UNUSED_PRESERVE src0_sel:WORD_1
v_exp_f16 v62, v70
v_pk_mul_f16 v99, v99, v67
v_mfma_f32_32x32x16_bf16 v[134:149], a[216:219], a[120:123], 0
ds_read_b128 a[216:219], v1 offset:6144
v_mad_u32_u16 v118, v118, 2, s85 op_sel:[1,0,0,0]
v_mad_u32_u16 v119, v119, 2, s85 op_sel:[1,0,0,0]
v_mad_u32_u16 v120, v120, 2, s85 op_sel:[1,0,0,0]
v_mad_u32_u16 v121, v121, 2, s85 op_sel:[1,0,0,0]
v_exp_f16 v63, v71
v_mad_u32_u16 v122, v122, 2, s85 op_sel:[1,0,0,0]
v_smfmac_f32_32x32x32_bf16 v[192:207], a[152:155], a[164:171], v4
ds_read_u16_d16_hi v118, v118
v_mad_u32_u16 v123, v123, 2, s85 op_sel:[1,0,0,0]
v_mad_u32_u16 v124, v124, 2, s85 op_sel:[1,0,0,0]
v_mad_u32_u16 v125, v125, 2, s85 op_sel:[1,0,0,0]
v_mad_u32_u16 v126, v126, 2, s85 op_sel:[1,0,0,0]
v_exp_f16 v64, v72
s_waitcnt lgkmcnt(5)
v_pk_add_f32 v[42:43], v[42:43], v[116:117]
v_pk_add_f32 v[42:43], v[42:43], v[114:115]
v_pk_add_f32 v[42:43], v[42:43], v[112:113]
v_exp_f16_sdwa v62, v70 dst_sel:WORD_1 dst_unused:UNUSED_PRESERVE src0_sel:WORD_1
v_pk_add_f32 v[42:43], v[42:43], v[110:111]
v_pk_add_f32 v[42:43], v[42:43], v[108:109]
v_pk_add_f32 v[42:43], v[42:43], v[106:107]
v_exp_f16 v65, v73
v_pk_add_f32 v[42:43], v[42:43], v[104:105]
v_pk_add_f32 v[42:43], v[42:43], v[102:103]
v_dot2c_f32_f16 v41, v99, v99
v_dot2c_f32_f16 v40, v98, v98
v_dot2c_f32_f16 v41, v97, v97
v_dot2c_f32_f16 v40, v96, v96
v_dot2c_f32_f16 v41, v95, v95
v_dot2c_f32_f16 v40, v94, v94
v_pk_fma_f32 v[48:49], v[192:193], v[192:193], v[48:49]
v_pk_add_f32 v[46:47], v[46:47], v[192:193]
v_pk_fma_f32 v[48:49], v[194:195], v[194:195], v[48:49]
v_pk_add_f32 v[46:47], v[46:47], v[194:195]
v_pk_fma_f32 v[48:49], v[196:197], v[196:197], v[48:49]
v_pk_add_f32 v[46:47], v[46:47], v[196:197]
v_pk_fma_f32 v[48:49], v[198:199], v[198:199], v[48:49]
v_pk_add_f32 v[46:47], v[46:47], v[198:199]
v_pk_fma_f32 v[48:49], v[200:201], v[200:201], v[48:49]
v_pk_add_f32 v[46:47], v[46:47], v[200:201]
v_pk_fma_f32 v[48:49], v[202:203], v[202:203], v[48:49]
v_pk_add_f32 v[46:47], v[46:47], v[202:203]
v_pk_fma_f32 v[48:49], v[204:205], v[204:205], v[48:49]
v_pk_add_f32 v[46:47], v[46:47], v[204:205]
v_pk_fma_f32 v[48:49], v[206:207], v[206:207], v[48:49]
v_pk_add_f32 v[46:47], v[46:47], v[206:207]
v_mfma_f32_32x32x16_bf16 v[134:149], a[220:223], a[124:127], v[134:149]
ds_read_b128 a[220:223], v1 offset:7168
ds_read_u16_d16_hi v119, v119
ds_read_u16_d16_hi v120, v120
ds_read_u16_d16_hi v121, v121
v_mad_u32_u16 v127, v127, 2, s85 op_sel:[1,0,0,0]
v_mad_u32_u16 v128, v128, 2, s85 op_sel:[1,0,0,0]
v_pk_add_f16 v70, v62, 1.0 op_sel_hi:[1,0]
v_smfmac_f32_32x32x32_bf16 v[240:255], a[148:151], a[164:171], v4
ds_read_u16_d16_hi v122, v122
v_mad_u32_u16 v129, v129, 2, s85 op_sel:[1,0,0,0]
v_exp_f16_sdwa v63, v71 dst_sel:WORD_1 dst_unused:UNUSED_PRESERVE src0_sel:WORD_1
v_exp_f16 v66, v74
v_pk_add_f16 v71, v63, 1.0 op_sel_hi:[1,0]
v_mfma_f32_32x32x16_bf16 v[134:149], a[224:227], a[128:131], v[134:149]
ds_read_b128 a[224:227], v1 offset:8192
ds_read_u16_d16_hi v123, v123
ds_read_u16_d16_hi v124, v124
ds_read_u16_d16_hi v125, v125
v_exp_f16_sdwa v64, v72 dst_sel:WORD_1 dst_unused:UNUSED_PRESERVE src0_sel:WORD_1
v_mad_u32_u16 v130, v130, 2, s85 op_sel:[1,0,0,0]
v_pk_add_f16 v72, v64, 1.0 op_sel_hi:[1,0]
v_smfmac_f32_32x32x32_bf16 v[240:255], a[152:155], a[172:179], v4
ds_read_u16_d16_hi v126, v126
v_mad_u32_u16 v131, v131, 2, s85 op_sel:[1,0,0,0]
v_exp_f16 v67, v75
v_exp_f16_sdwa v65, v73 dst_sel:WORD_1 dst_unused:UNUSED_PRESERVE src0_sel:WORD_1
v_exp_f16_sdwa v66, v74 dst_sel:WORD_1 dst_unused:UNUSED_PRESERVE src0_sel:WORD_1
v_mfma_f32_32x32x16_bf16 v[134:149], a[228:231], a[132:135], v[134:149]
ds_read_b128 a[228:231], v1 offset:9216
ds_read_u16_d16_hi v127, v127
ds_read_u16_d16_hi v128, v128
ds_read_u16_d16_hi v129, v129
v_pk_add_f16 v73, v65, 1.0 op_sel_hi:[1,0]
v_mad_u32_u16 v132, v132, 2, s85 op_sel:[1,0,0,0]
v_pk_add_f16 v74, v66, 1.0 op_sel_hi:[1,0]
v_mad_u32_u16 v133, v133, 2, s85 op_sel:[1,0,0,0]
v_pk_fma_f32 v[52:53], v[240:241], v[240:241], v[52:53]
v_pk_add_f32 v[50:51], v[50:51], v[240:241]
v_pk_fma_f32 v[52:53], v[242:243], v[242:243], v[52:53]
v_pk_add_f32 v[50:51], v[50:51], v[242:243]
v_pk_fma_f32 v[52:53], v[244:245], v[244:245], v[52:53]
v_pk_add_f32 v[50:51], v[50:51], v[244:245]
v_pk_fma_f32 v[52:53], v[246:247], v[246:247], v[52:53]
v_pk_add_f32 v[50:51], v[50:51], v[246:247]
v_pk_fma_f32 v[52:53], v[248:249], v[248:249], v[52:53]
v_pk_add_f32 v[50:51], v[50:51], v[248:249]
v_pk_fma_f32 v[52:53], v[250:251], v[250:251], v[52:53]
v_pk_add_f32 v[50:51], v[50:51], v[250:251]
v_pk_fma_f32 v[52:53], v[252:253], v[252:253], v[52:53]
v_pk_add_f32 v[50:51], v[50:51], v[252:253]
v_pk_fma_f32 v[52:53], v[254:255], v[254:255], v[52:53]
v_pk_add_f32 v[50:51], v[50:51], v[254:255]
v_mfma_f32_32x32x16_bf16 v[134:149], a[232:235], a[136:139], v[134:149]
ds_read_b128 a[232:235], v1 offset:10240
ds_read_u16_d16_hi v130, v130
ds_read_u16_d16_hi v131, v131
ds_read_u16_d16_hi v132, v132
v_add_f32 v46, v46, v47
v_exp_f16_sdwa v67, v75 dst_sel:WORD_1 dst_unused:UNUSED_PRESERVE src0_sel:WORD_1
v_add_f32 v48, v48, v49
v_mfma_f32_32x32x16_bf16 v[134:149], a[236:239], a[140:143], v[134:149]
ds_read_b128 a[236:239], v1 offset:11264
ds_read_u16_d16_hi v133, v133
v_add_f32 v50, v50, v51
v_pk_add_f16 v75, v67, 1.0 op_sel_hi:[1,0]
v_add_f32 v52, v52, v53
v_add_f32 v42, v42, v150
v_permlane32_swap_b32 v46, v48
v_add_f32 v43, v43, v151
v_permlane32_swap_b32 v50, v52
s_waitcnt lgkmcnt(8)
v_add_f32 v42, v42, v152
ds_read_b32 v156, v155
v_add_f32 v46, v46, v48
v_add_f32 v43, v43, v153
v_add_f32 v50, v50, v52
v_cvt_pk_f16_f32 v94, v134, v135
v_mov_b32 v48, v46
v_cvt_pk_f16_f32 v95, v136, v137
v_mov_b32 v52, v50
v_pk_fma_f16 v78, v94, v94, s84
v_permlane32_swap_b32 v46, v48
v_cvt_pk_f16_f32 v96, v138, v139
v_permlane32_swap_b32 v50, v52
v_pk_fma_f16 v79, v95, v95, s84
v_mul_f32 v46, 0x3c2aaaab, v46
v_pk_mul_f16 v78, v94, v78
v_rcp_f16 v62, v70
v_mul_f32 v50, 0x3c2aaaab, v50
v_cvt_pk_f16_f32 v97, v140, v141
v_mul_f32 v48, 0x3c2aaaab, v48
v_pk_fma_f16 v80, v96, v96, s84
v_rcp_f16 v63, v71
v_mul_f32 v52, 0x3c2aaaab, v52
v_pk_mul_f16 v79, v95, v79
v_fma_f32 v48, -v46, v46, v48
v_rcp_f16 v64, v72
v_fma_f32 v52, -v50, v50, v52
v_cvt_pk_f16_f32 v98, v142, v143
v_max_f32 v48, 0, v48
v_rcp_f16_sdwa v62, v70 dst_sel:WORD_1 dst_unused:UNUSED_PRESERVE src0_sel:WORD_1
v_max_f32 v52, 0, v52
v_pk_mul_f16 v86, v86, v62
v_add_f32 v48, 0x3727c5ac, v48
v_pk_fma_f16 v81, v97, v97, s84
v_add_f32 v52, 0x3727c5ac, v52
v_rcp_f16 v65, v73
v_rsq_f32 v48, v48
v_pk_mul_f16 v80, v96, v80
v_rsq_f32 v52, v52
v_cvt_pk_f16_f32 v99, v144, v145
v_mul_f32 v48, s86, v48
v_rcp_f16_sdwa v63, v71 dst_sel:WORD_1 dst_unused:UNUSED_PRESERVE src0_sel:WORD_1
v_mul_f32_e64 v46, -v46, v48
v_pk_fma_f32 v[160:161], v[160:161], v[48:49], v[46:47] op_sel_hi:[1,0,0]
v_pk_fma_f32 v[162:163], v[162:163], v[48:49], v[46:47] op_sel_hi:[1,0,0]
v_pk_fma_f32 v[164:165], v[164:165], v[48:49], v[46:47] op_sel_hi:[1,0,0]
v_pk_fma_f32 v[166:167], v[166:167], v[48:49], v[46:47] op_sel_hi:[1,0,0]
v_pk_fma_f32 v[168:169], v[168:169], v[48:49], v[46:47] op_sel_hi:[1,0,0]
v_pk_fma_f32 v[170:171], v[170:171], v[48:49], v[46:47] op_sel_hi:[1,0,0]
v_rcp_f16 v66, v74
v_pk_fma_f32 v[172:173], v[172:173], v[48:49], v[46:47] op_sel_hi:[1,0,0]
v_pk_fma_f32 v[174:175], v[174:175], v[48:49], v[46:47] op_sel_hi:[1,0,0]
s_waitcnt lgkmcnt(0)
v_pk_add_f32 v[44:45], v[44:45], v[132:133]
v_pk_add_f32 v[44:45], v[44:45], v[130:131]
v_pk_add_f32 v[44:45], v[44:45], v[128:129]
v_cmp_gt_u32 vcc, 12, v156
v_pk_add_f32 v[44:45], v[44:45], v[126:127]
v_pk_add_f32 v[44:45], v[44:45], v[124:125]
s_cbranch_vccnz L_spin12
L_ok12:
v_pk_add_f32 v[44:45], v[44:45], v[122:123]
v_pk_add_f32 v[44:45], v[44:45], v[120:121]
v_pk_add_f32 v[44:45], v[44:45], v[118:119]
v_pk_fma_f32 v[176:177], v[176:177], v[48:49], v[46:47] op_sel_hi:[1,0,0]
v_pk_fma_f32 v[178:179], v[178:179], v[48:49], v[46:47] op_sel_hi:[1,0,0]
v_pk_fma_f32 v[180:181], v[180:181], v[48:49], v[46:47] op_sel_hi:[1,0,0]
v_pk_fma_f32 v[182:183], v[182:183], v[48:49], v[46:47] op_sel_hi:[1,0,0]
v_pk_fma_f32 v[184:185], v[184:185], v[48:49], v[46:47] op_sel_hi:[1,0,0]
v_pk_fma_f32 v[186:187], v[186:187], v[48:49], v[46:47] op_sel_hi:[1,0,0]
v_pk_fma_f32 v[188:189], v[188:189], v[48:49], v[46:47] op_sel_hi:[1,0,0]
v_pk_fma_f32 v[190:191], v[190:191], v[48:49], v[46:47] op_sel_hi:[1,0,0]
v_pk_fma_f32 v[192:193], v[192:193], v[48:49], v[46:47] op_sel_hi:[1,0,0]
v_pk_fma_f32 v[194:195], v[194:195], v[48:49], v[46:47] op_sel_hi:[1,0,0]
v_pk_fma_f32 v[196:197], v[196:197], v[48:49], v[46:47] op_sel_hi:[1,0,0]
v_pk_fma_f32 v[198:199], v[198:199], v[48:49], v[46:47] op_sel_hi:[1,0,0]
v_pk_fma_f32 v[200:201], v[200:201], v[48:49], v[46:47] op_sel_hi:[1,0,0]
v_pk_fma_f32 v[202:203], v[202:203], v[48:49], v[46:47] op_sel_hi:[1,0,0]
v_pk_fma_f32 v[204:205], v[204:205], v[48:49], v[46:47] op_sel_hi:[1,0,0]
v_pk_fma_f32 v[206:207], v[206:207], v[48:49], v[46:47] op_sel_hi:[1,0,0]
v_pk_mul_f16 v87, v87, v63
v_mul_f32 v52, 0xbeeff558, v52
v_pk_fma_f16 v82, v98, v98, s84
v_mul_f32_e64 v50, -v50, v52
v_pk_fma_f32 v[208:209], v[208:209], v[52:53], v[50:51] op_sel_hi:[1,0,0]
v_pk_fma_f32 v[210:211], v[210:211], v[52:53], v[50:51] op_sel_hi:[1,0,0]
v_pk_fma_f32 v[212:213], v[212:213], v[52:53], v[50:51] op_sel_hi:[1,0,0]
v_pk_fma_f32 v[214:215], v[214:215], v[52:53], v[50:51] op_sel_hi:[1,0,0]
v_pk_fma_f32 v[216:217], v[216:217], v[52:53], v[50:51] op_sel_hi:[1,0,0]
v_pk_fma_f32 v[218:219], v[218:219], v[52:53], v[50:51] op_sel_hi:[1,0,0]
v_pk_fma_f32 v[220:221], v[220:221], v[52:53], v[50:51] op_sel_hi:[1,0,0]
v_pk_fma_f32 v[222:223], v[222:223], v[52:53], v[50:51] op_sel_hi:[1,0,0]
v_pk_fma_f32 v[224:225], v[224:225], v[52:53], v[50:51] op_sel_hi:[1,0,0]
v_pk_fma_f32 v[226:227], v[226:227], v[52:53], v[50:51] op_sel_hi:[1,0,0]
v_pk_fma_f32 v[228:229], v[228:229], v[52:53], v[50:51] op_sel_hi:[1,0,0]
v_pk_fma_f32 v[230:231], v[230:231], v[52:53], v[50:51] op_sel_hi:[1,0,0]
v_pk_fma_f32 v[232:233], v[232:233], v[52:53], v[50:51] op_sel_hi:[1,0,0]
v_pk_fma_f32 v[234:235], v[234:235], v[52:53], v[50:51] op_sel_hi:[1,0,0]
v_pk_fma_f32 v[236:237], v[236:237], v[52:53], v[50:51] op_sel_hi:[1,0,0]
v_pk_fma_f32 v[238:239], v[238:239], v[52:53], v[50:51] op_sel_hi:[1,0,0]
v_pk_fma_f32 v[240:241], v[240:241], v[52:53], v[50:51] op_sel_hi:[1,0,0]
v_pk_fma_f32 v[242:243], v[242:243], v[52:53], v[50:51] op_sel_hi:[1,0,0]
v_pk_fma_f32 v[244:245], v[244:245], v[52:53], v[50:51] op_sel_hi:[1,0,0]
v_pk_fma_f32 v[246:247], v[246:247], v[52:53], v[50:51] op_sel_hi:[1,0,0]
v_pk_fma_f32 v[248:249], v[248:249], v[52:53], v[50:51] op_sel_hi:[1,0,0]
v_pk_fma_f32 v[250:251], v[250:251], v[52:53], v[50:51] op_sel_hi:[1,0,0]
v_pk_fma_f32 v[252:253], v[252:253], v[52:53], v[50:51] op_sel_hi:[1,0,0]
v_pk_fma_f32 v[254:255], v[254:255], v[52:53], v[50:51] op_sel_hi:[1,0,0]
v_pk_mul_f16 v81, v97, v81
v_cvt_pk_bf16_f32 v54, v160, v161
v_cvt_pk_f16_f32 v100, v146, v147
v_cvt_pk_bf16_f32 v55, v162, v163
v_rcp_f16_sdwa v64, v72 dst_sel:WORD_1 dst_unused:UNUSED_PRESERVE src0_sel:WORD_1
v_cvt_pk_bf16_f32 v56, v164, v165
v_pk_mul_f16 v88, v88, v64
v_accvgpr_write_b32 a144, v54
v_pk_fma_f16 v83, v99, v99, s84
v_cvt_pk_bf16_f32 v57, v166, v167
v_pk_mul_f16 v82, v98, v82
v_accvgpr_write_b32 a145, v55
v_rcp_f16 v67, v75
v_cvt_pk_bf16_f32 v58, v168, v169
v_rcp_f16_sdwa v65, v73 dst_sel:WORD_1 dst_unused:UNUSED_PRESERVE src0_sel:WORD_1
v_accvgpr_write_b32 a146, v56
v_pk_mul_f16 v89, v89, v65
v_cvt_pk_bf16_f32 v59, v170, v171
v_cvt_pk_f16_f32 v101, v148, v149
v_accvgpr_write_b32 a147, v57
v_rcp_f16_sdwa v66, v74 dst_sel:WORD_1 dst_unused:UNUSED_PRESERVE src0_sel:WORD_1
v_cvt_pk_bf16_f32 v60, v172, v173
v_mfma_f32_32x32x16_bf16 v[102:117], a[144:147], a[192:195], 0
v_accvgpr_write_b32 a148, v58
v_pk_fma_f16 v84, v100, v100, s84
v_cvt_pk_bf16_f32 v61, v174, v175
v_pk_mul_f16 v83, v99, v83
v_accvgpr_write_b32 a149, v59
v_rcp_f16_sdwa v67, v75 dst_sel:WORD_1 dst_unused:UNUSED_PRESERVE src0_sel:WORD_1
v_cvt_pk_bf16_f32 v54, v176, v177
v_pk_mul_f16 v90, v90, v66
v_accvgpr_write_b32 a150, v60
v_exp_f16 v62, v78
v_cvt_pk_bf16_f32 v55, v178, v179
v_pk_fma_f16 v85, v101, v101, s84
v_accvgpr_write_b32 a151, v61
v_pk_mul_f16 v84, v100, v84
v_exp_f16 v63, v79
v_mfma_f32_32x32x16_bf16 v[102:117], a[148:151], a[196:199], v[102:117]
v_cvt_pk_bf16_f32 v56, v180, v181
v_pk_mul_f16 v85, v101, v85
v_accvgpr_write_b32 a152, v54
v_pk_mul_f16 v91, v91, v67
v_cvt_pk_bf16_f32 v57, v182, v183
v_exp_f16 v64, v80
v_accvgpr_write_b32 a153, v55
v_dot2c_f32_f16 v43, v91, v91
v_dot2c_f32_f16 v42, v90, v90
v_dot2c_f32_f16 v43, v89, v89
v_dot2c_f32_f16 v42, v88, v88
v_dot2c_f32_f16 v43, v87, v87
v_dot2c_f32_f16 v42, v86, v86
v_cvt_pk_bf16_f32 v58, v184, v185
v_exp_f16_sdwa v62, v78 dst_sel:WORD_1 dst_unused:UNUSED_PRESERVE src0_sel:WORD_1
v_accvgpr_write_b32 a154, v56
v_exp_f16 v65, v81
v_cvt_pk_bf16_f32 v59, v186, v187
v_exp_f16_sdwa v63, v79 dst_sel:WORD_1 dst_unused:UNUSED_PRESERVE src0_sel:WORD_1
v_accvgpr_write_b32 a155, v57
v_exp_f16 v66, v82
v_cvt_pk_bf16_f32 v60, v188, v189
v_mfma_f32_32x32x16_bf16 v[102:117], a[152:155], a[200:203], v[102:117]
v_accvgpr_write_b32 a156, v58
v_exp_f16_sdwa v64, v80 dst_sel:WORD_1 dst_unused:UNUSED_PRESERVE src0_sel:WORD_1
v_cvt_pk_bf16_f32 v61, v190, v191
v_exp_f16 v67, v83
v_accvgpr_write_b32 a157, v59
v_exp_f16_sdwa v65, v81 dst_sel:WORD_1 dst_unused:UNUSED_PRESERVE src0_sel:WORD_1
v_cvt_pk_bf16_f32 v54, v192, v193
v_exp_f16 v68, v84
v_accvgpr_write_b32 a158, v60
v_exp_f16_sdwa v66, v82 dst_sel:WORD_1 dst_unused:UNUSED_PRESERVE src0_sel:WORD_1
v_cvt_pk_bf16_f32 v55, v194, v195
v_exp_f16 v69, v85
v_accvgpr_write_b32 a159, v61
v_exp_f16_sdwa v67, v83 dst_sel:WORD_1 dst_unused:UNUSED_PRESERVE src0_sel:WORD_1
v_cvt_pk_bf16_f32 v56, v196, v197
v_mfma_f32_32x32x16_bf16 v[102:117], a[156:159], a[204:207], v[102:117]
v_accvgpr_write_b32 a160, v54
v_exp_f16_sdwa v68, v84 dst_sel:WORD_1 dst_unused:UNUSED_PRESERVE src0_sel:WORD_1
v_cvt_pk_bf16_f32 v57, v198, v199
v_exp_f16_sdwa v69, v85 dst_sel:WORD_1 dst_unused:UNUSED_PRESERVE src0_sel:WORD_1
v_accvgpr_write_b32 a161, v55
v_cvt_pk_bf16_f32 v58, v200, v201
v_accvgpr_write_b32 a162, v56
v_cvt_pk_bf16_f32 v59, v202, v203
v_accvgpr_write_b32 a163, v57
v_cvt_pk_bf16_f32 v60, v204, v205
v_accvgpr_write_b32 a164, v58
v_mfma_f32_32x32x16_bf16 v[102:117], a[160:163], a[208:211], v[102:117]
v_cvt_pk_bf16_f32 v61, v206, v207
v_accvgpr_write_b32 a165, v59
v_cvt_pk_bf16_f32 v54, v208, v209
v_accvgpr_write_b32 a166, v60
v_cvt_pk_bf16_f32 v55, v210, v211
v_accvgpr_write_b32 a167, v61
v_cvt_pk_bf16_f32 v56, v212, v213
v_accvgpr_write_b32 a168, v54
v_mfma_f32_32x32x16_bf16 v[102:117], a[164:167], a[212:215], v[102:117]
v_cvt_pk_bf16_f32 v57, v214, v215
v_accvgpr_write_b32 a169, v55
v_cvt_pk_bf16_f32 v58, v216, v217
v_accvgpr_write_b32 a170, v56
v_cvt_pk_bf16_f32 v59, v218, v219
v_accvgpr_write_b32 a171, v57
v_cvt_pk_bf16_f32 v60, v220, v221
v_accvgpr_write_b32 a172, v58
v_mfma_f32_32x32x16_bf16 v[134:149], a[192:195], a[168:171], 0
ds_read_b128 a[192:195], v1 offset:12288
v_cvt_pk_bf16_f32 v61, v222, v223
v_accvgpr_write_b32 a173, v59
v_mad_u32_u16 v102, v102, 2, s85 op_sel:[1,0,0,0]
v_cvt_pk_bf16_f32 v54, v224, v225
v_mad_u32_u16 v103, v103, 2, s85 op_sel:[1,0,0,0]
v_accvgpr_write_b32 a174, v60
v_mad_u32_u16 v104, v104, 2, s85 op_sel:[1,0,0,0]
v_cvt_pk_bf16_f32 v55, v226, v227
v_mad_u32_u16 v105, v105, 2, s85 op_sel:[1,0,0,0]
v_accvgpr_write_b32 a175, v61
v_mad_u32_u16 v106, v106, 2, s85 op_sel:[1,0,0,0]
v_cvt_pk_bf16_f32 v56, v228, v229
v_mfma_f32_32x32x16_bf16 v[134:149], a[196:199], a[172:175], v[134:149]
ds_read_b128 a[196:199], v1 offset:13312
ds_read_u16_d16_hi v102, v102
ds_read_u16_d16_hi v103, v103
ds_read_u16_d16_hi v104, v104
v_accvgpr_write_b32 a176, v54
v_mad_u32_u16 v107, v107, 2, s85 op_sel:[1,0,0,0]
v_cvt_pk_bf16_f32 v57, v230, v231
v_mad_u32_u16 v108, v108, 2, s85 op_sel:[1,0,0,0]
v_accvgpr_write_b32 a177, v55
v_mad_u32_u16 v109, v109, 2, s85 op_sel:[1,0,0,0]
v_cvt_pk_bf16_f32 v58, v232, v233
v_mad_u32_u16 v110, v110, 2, s85 op_sel:[1,0,0,0]
v_accvgpr_write_b32 a178, v56
v_mad_u32_u16 v111, v111, 2, s85 op_sel:[1,0,0,0]
v_cvt_pk_bf16_f32 v59, v234, v235
v_pk_add_f16 v78, v62, 1.0 op_sel_hi:[1,0]
v_accvgpr_write_b32 a179, v57
v_rcp_f16 v62, v78
v_cvt_pk_bf16_f32 v60, v236, v237
v_mfma_f32_32x32x16_bf16 v[134:149], a[200:203], a[176:179], v[134:149]
ds_read_b128 a[200:203], v1 offset:14336
ds_read_u16_d16_hi v105, v105
ds_read_u16_d16_hi v106, v106
ds_read_u16_d16_hi v107, v107
v_accvgpr_write_b32 a180, v58
v_mad_u32_u16 v112, v112, 2, s85 op_sel:[1,0,0,0]
v_cvt_pk_bf16_f32 v61, v238, v239
v_pk_add_f16 v79, v63, 1.0 op_sel_hi:[1,0]
v_accvgpr_write_b32 a181, v59
v_mad_u32_u16 v113, v113, 2, s85 op_sel:[1,0,0,0]
v_rcp_f16 v63, v79
v_cvt_pk_bf16_f32 v54, v240, v241
v_pk_add_f16 v80, v64, 1.0 op_sel_hi:[1,0]
v_accvgpr_write_b32 a182, v60
v_rcp_f16 v64, v80
v_cvt_pk_bf16_f32 v55, v242, v243
v_mad_u32_u16 v114, v114, 2, s85 op_sel:[1,0,0,0]
v_accvgpr_write_b32 a183, v61
v_pk_add_f16 v81, v65, 1.0 op_sel_hi:[1,0]
v_cvt_pk_bf16_f32 v56, v244, v245
v_mfma_f32_32x32x16_bf16 v[134:149], a[204:207], a[180:183], v[134:149]
global_load_dword a255, v[158:159], off
ds_read_b128 a[204:207], v1 offset:15360
ds_read_u16_d16_hi v108, v108
ds_read_u16_d16_hi v109, v109
ds_read_u16_d16_hi v110, v110
v_accvgpr_write_b32 a184, v54
v_pk_add_f16 v82, v66, 1.0 op_sel_hi:[1,0]
v_cvt_pk_bf16_f32 v57, v246, v247
v_mad_u32_u16 v115, v115, 2, s85 op_sel:[1,0,0,0]
v_accvgpr_write_b32 a185, v55
v_pk_add_f16 v83, v67, 1.0 op_sel_hi:[1,0]
v_cvt_pk_bf16_f32 v58, v248, v249
v_mad_u32_u16 v116, v116, 2, s85 op_sel:[1,0,0,0]
v_accvgpr_write_b32 a186, v56
v_pk_add_f16 v84, v68, 1.0 op_sel_hi:[1,0]
v_cvt_pk_bf16_f32 v59, v250, v251
v_mad_u32_u16 v117, v117, 2, s85 op_sel:[1,0,0,0]
v_accvgpr_write_b32 a187, v57
v_pk_add_f16 v85, v69, 1.0 op_sel_hi:[1,0]
v_cvt_pk_bf16_f32 v60, v252, v253
v_mfma_f32_32x32x16_bf16 v[134:149], a[208:211], a[184:187], v[134:149]
ds_read_b128 a[208:211], v1 offset:16384
ds_read_u16_d16_hi v111, v111
ds_read_u16_d16_hi v112, v112
ds_read_u16_d16_hi v113, v113
v_accvgpr_write_b32 a188, v58
v_rcp_f16_sdwa v62, v78 dst_sel:WORD_1 dst_unused:UNUSED_PRESERVE src0_sel:WORD_1
v_lshl_add_u64 v[158:159], v[158:159], 0, s[42:43]
v_cvt_pk_bf16_f32 v61, v254, v255
v_rcp_f16 v65, v81
v_accvgpr_write_b32 a189, v59
v_rcp_f16_sdwa v63, v79 dst_sel:WORD_1 dst_unused:UNUSED_PRESERVE src0_sel:WORD_1
v_accvgpr_write_b32 a190, v60
v_rcp_f16 v66, v82
v_accvgpr_write_b32 a191, v61
v_rcp_f16_sdwa v64, v80 dst_sel:WORD_1 dst_unused:UNUSED_PRESERVE src0_sel:WORD_1
s_lshl_b32 s66, s62, 10
v_mfma_f32_32x32x16_bf16 v[134:149], a[212:215], a[188:191], v[134:149]
ds_read_b128 a[212:215], v1 offset:17408
s_add_u32 s65, s66, 0
s_add_u32 m0, s65, 71680
ds_read_u16_d16_hi v114, v114
buffer_load_dwordx4 v1, s[20:23], s65 offen lds
ds_read_u16_d16_hi v115, v115
v_mfma_f32_32x32x16_bf16 v[118:133], a[144:147], a[216:219], 0
ds_read_u16_d16_hi v116, v116
ds_read_u16_d16_hi v117, v117
v_mov_b32 v6, 0
v_rcp_f16 v67, v83
v_lshrrev_b32 v8, 2, v1
v_cvt_pk_f16_f32 v160, v134, v135
v_min_u32 v8, 188, v8
v_mfma_f32_32x32x16_bf16 v[118:133], a[148:151], a[220:223], v[118:133]
s_mul_i32 s68, s62, 192
v_cvt_pk_f16_f32 v161, v136, v137
s_add_u32 s68, s68, 93184
v_pk_fma_f16 v70, v160, v160, s84
v_add_u32 v8, s68, v8
v_cvt_pk_f16_f32 v162, v138, v139
v_pk_fma_f16 v71, v161, v161, s84
v_mfma_f32_32x32x16_bf16 v[118:133], a[152:155], a[224:227], v[118:133]
v_pk_mul_f16 v70, v160, v70
v_cvt_pk_f16_f32 v163, v140, v141
v_pk_fma_f16 v72, v162, v162, s84
v_pk_mul_f16 v71, v161, v71
v_cvt_pk_f16_f32 v164, v142, v143
v_pk_mul_f16 v94, v94, v62
v_pk_fma_f16 v73, v163, v163, s84
v_mfma_f32_32x32x16_bf16 v[118:133], a[156:159], a[228:231], v[118:133]
v_pk_mul_f16 v72, v162, v72
v_pk_mul_f16 v95, v95, v63
v_cvt_pk_f16_f32 v165, v144, v145
v_pk_fma_f16 v74, v164, v164, s84
v_pk_mul_f16 v96, v96, v64
v_pk_mul_f16 v73, v163, v73
v_cvt_pk_f16_f32 v166, v146, v147
v_mfma_f32_32x32x16_bf16 v[118:133], a[160:163], a[232:235], v[118:133]
s_add_u32 s65, s66, 4096
s_add_u32 m0, s65, 71680
v_rcp_f16_sdwa v65, v81 dst_sel:WORD_1 dst_unused:UNUSED_PRESERVE src0_sel:WORD_1
v_rcp_f16 v68, v84
v_pk_mul_f16 v97, v97, v65
v_pk_fma_f16 v75, v165, v165, s84
v_mfma_f32_32x32x16_bf16 v[118:133], a[164:167], a[236:239], v[118:133]
buffer_load_dwordx4 v1, s[20:23], s65 offen lds
v_pk_mul_f16 v74, v164, v74
v_rcp_f16_sdwa v66, v82 dst_sel:WORD_1 dst_unused:UNUSED_PRESERVE src0_sel:WORD_1
v_rcp_f16 v69, v85
s_waitcnt lgkmcnt(0)
v_pk_add_f32 v[22:23], v[22:23], v[116:117]
v_pk_add_f32 v[22:23], v[22:23], v[114:115]
v_pk_add_f32 v[22:23], v[22:23], v[112:113]
v_pk_add_f32 v[22:23], v[22:23], v[110:111]
v_pk_add_f32 v[22:23], v[22:23], v[108:109]
v_pk_add_f32 v[22:23], v[22:23], v[106:107]
v_rcp_f16_sdwa v67, v83 dst_sel:WORD_1 dst_unused:UNUSED_PRESERVE src0_sel:WORD_1
v_pk_add_f32 v[22:23], v[22:23], v[104:105]
v_pk_add_f32 v[22:23], v[22:23], v[102:103]
v_mfma_f32_32x32x16_f16 v[102:117], v[94:97], a[240:243], 0
v_pk_mul_f16 v98, v98, v66
v_cvt_pk_f16_f32 v167, v148, v149
v_pk_fma_f16 v76, v166, v166, s84
v_pk_mul_f16 v99, v99, v67
v_rcp_f16_sdwa v68, v84 dst_sel:WORD_1 dst_unused:UNUSED_PRESERVE src0_sel:WORD_1
v_pk_mul_f16 v75, v165, v75
v_pk_fma_f16 v77, v167, v167, s84
v_mfma_f32_32x32x16_bf16 v[134:149], a[216:219], a[168:171], 0
ds_read_b128 a[216:219], v1 offset:18432
v_pk_mul_f16 v100, v100, v68
v_pk_mul_f16 v76, v166, v76
v_pk_mul_f16 v77, v167, v77
v_rcp_f16_sdwa v69, v85 dst_sel:WORD_1 dst_unused:UNUSED_PRESERVE src0_sel:WORD_1
v_exp_f16 v62, v70
v_mfma_f32_32x32x16_bf16 v[134:149], a[220:223], a[172:175], v[134:149]
ds_read_b128 a[220:223], v1 offset:19456
s_add_u32 s65, s66, 8192
s_add_u32 m0, s65, 71680
buffer_store_dwordx4 v[94:97], v1, s[12:15], s101 offen offset:0 sc1
v_mfma_f32_32x32x16_bf16 v[134:149], a[224:227], a[176:179], v[134:149]
ds_read_b128 a[224:227], v1 offset:20480
v_pk_mul_f16 v101, v101, v69
v_mad_u32_u16 v118, v118, 2, s85 op_sel:[1,0,0,0]
v_mad_u32_u16 v119, v119, 2, s85 op_sel:[1,0,0,0]
v_mad_u32_u16 v120, v120, 2, s85 op_sel:[1,0,0,0]
v_exp_f16 v63, v71
v_mad_u32_u16 v121, v121, 2, s85 op_sel:[1,0,0,0]
v_mfma_f32_32x32x16_f16 v[102:117], v[98:101], a[244:247], v[102:117]
ds_read_u16_d16_hi v118, v118
ds_read_u16_d16_hi v119, v119
ds_read_u16_d16_hi v120, v120
ds_read_u16_d16_hi v121, v121
v_mad_u32_u16 v122, v122, 2, s85 op_sel:[1,0,0,0]
v_exp_f16 v64, v72
v_mad_u32_u16 v123, v123, 2, s85 op_sel:[1,0,0,0]
v_mfma_f32_32x32x16_bf16 v[134:149], a[228:231], a[180:183], v[134:149]
ds_read_b128 a[228:231], v1 offset:21504
ds_read_u16_d16_hi v122, v122
ds_read_u16_d16_hi v123, v123
v_mad_u32_u16 v124, v124, 2, s85 op_sel:[1,0,0,0]
v_mad_u32_u16 v125, v125, 2, s85 op_sel:[1,0,0,0]
v_mad_u32_u16 v126, v126, 2, s85 op_sel:[1,0,0,0]
v_mad_u32_u16 v127, v127, 2, s85 op_sel:[1,0,0,0]
v_pk_fma_f32 v[44:45], v[102:103], v[102:103], v[44:45]
v_pk_fma_f32 v[44:45], v[104:105], v[104:105], v[44:45]
v_pk_fma_f32 v[44:45], v[106:107], v[106:107], v[44:45]
v_pk_fma_f32 v[44:45], v[108:109], v[108:109], v[44:45]
v_pk_fma_f32 v[44:45], v[110:111], v[110:111], v[44:45]
v_pk_fma_f32 v[44:45], v[112:113], v[112:113], v[44:45]
v_pk_fma_f32 v[44:45], v[114:115], v[114:115], v[44:45]
v_pk_fma_f32 v[44:45], v[116:117], v[116:117], v[44:45]
v_mfma_f32_32x32x16_bf16 v[134:149], a[232:235], a[184:187], v[134:149]
ds_read_b128 a[232:235], v1 offset:22528
buffer_load_dwordx4 v1, s[20:23], s65 offen lds
ds_read_u16_d16_hi v124, v124
ds_read_u16_d16_hi v125, v125
v_exp_f16_sdwa v62, v70 dst_sel:WORD_1 dst_unused:UNUSED_PRESERVE src0_sel:WORD_1
v_mfma_f32_32x32x16_bf16 v[134:149], a[236:239], a[188:191], v[134:149]
ds_read_b128 a[236:239], v1 offset:23552
ds_read_u16_d16_hi v126, v126
ds_read_u16_d16_hi v127, v127
v_pk_add_f16 v70, v62, 1.0 op_sel_hi:[1,0]
v_exp_f16 v65, v73
v_mad_u32_u16 v128, v128, 2, s85 op_sel:[1,0,0,0]
v_exp_f16_sdwa v63, v71 dst_sel:WORD_1 dst_unused:UNUSED_PRESERVE src0_sel:WORD_1
v_mfma_f32_32x32x16_bf16 v[102:117], a[144:147], a[192:195], 0
ds_read_u16_d16_hi v128, v128
v_pk_add_f16 v71, v63, 1.0 op_sel_hi:[1,0]
v_mad_u32_u16 v129, v129, 2, s85 op_sel:[1,0,0,0]
v_exp_f16 v66, v74
v_exp_f16_sdwa v64, v72 dst_sel:WORD_1 dst_unused:UNUSED_PRESERVE src0_sel:WORD_1
v_exp_f16 v67, v75
v_mfma_f32_32x32x16_bf16 v[102:117], a[148:151], a[196:199], v[102:117]
ds_read_u16_d16_hi v129, v129
v_pk_add_f16 v72, v64, 1.0 op_sel_hi:[1,0]
v_mad_u32_u16 v130, v130, 2, s85 op_sel:[1,0,0,0]
v_exp_f16_sdwa v65, v73 dst_sel:WORD_1 dst_unused:UNUSED_PRESERVE src0_sel:WORD_1
v_exp_f16 v68, v76
v_pk_add_f16 v73, v65, 1.0 op_sel_hi:[1,0]
v_mfma_f32_32x32x16_bf16 v[102:117], a[152:155], a[200:203], v[102:117]
s_add_u32 s65, s66, 12288
s_add_u32 m0, s65, 71680
ds_read_u16_d16_hi v130, v130
buffer_load_dwordx4 v1, s[20:23], s65 offen lds
v_exp_f16_sdwa v66, v74 dst_sel:WORD_1 dst_unused:UNUSED_PRESERVE src0_sel:WORD_1
v_mfma_f32_32x32x16_bf16 v[102:117], a[156:159], a[204:207], v[102:117]
v_pk_add_f16 v74, v66, 1.0 op_sel_hi:[1,0]
v_mad_u32_u16 v131, v131, 2, s85 op_sel:[1,0,0,0]
v_exp_f16 v69, v77
v_exp_f16_sdwa v67, v75 dst_sel:WORD_1 dst_unused:UNUSED_PRESERVE src0_sel:WORD_1
v_exp_f16_sdwa v68, v76 dst_sel:WORD_1 dst_unused:UNUSED_PRESERVE src0_sel:WORD_1
v_mfma_f32_32x32x16_bf16 v[102:117], a[160:163], a[208:211], v[102:117]
ds_read_u16_d16_hi v131, v131
v_pk_add_f16 v75, v67, 1.0 op_sel_hi:[1,0]
v_mad_u32_u16 v132, v132, 2, s85 op_sel:[1,0,0,0]
v_pk_add_f16 v76, v68, 1.0 op_sel_hi:[1,0]
v_exp_f16_sdwa v69, v77 dst_sel:WORD_1 dst_unused:UNUSED_PRESERVE src0_sel:WORD_1
v_mad_u32_u16 v133, v133, 2, s85 op_sel:[1,0,0,0]
v_pk_add_f16 v77, v69, 1.0 op_sel_hi:[1,0]
v_mfma_f32_32x32x16_bf16 v[102:117], a[164:167], a[212:215], v[102:117]
ds_read_u16_d16_hi v132, v132
ds_read_u16_d16_hi v133, v133
v_cvt_pk_f16_f32 v168, v134, v135
v_cvt_pk_f16_f32 v169, v136, v137
v_rcp_f16 v62, v70
v_pk_fma_f16 v78, v168, v168, s84
v_cvt_pk_f16_f32 v170, v138, v139
v_pk_fma_f16 v79, v169, v169, s84
v_pk_mul_f16 v78, v168, v78
v_rcp_f16 v63, v71
v_cvt_pk_f16_f32 v171, v140, v141
v_pk_fma_f16 v80, v170, v170, s84
v_pk_mul_f16 v79, v169, v79
v_rcp_f16 v64, v72
v_cvt_pk_f16_f32 v172, v142, v143
v_rcp_f16_sdwa v62, v70 dst_sel:WORD_1 dst_unused:UNUSED_PRESERVE src0_sel:WORD_1
v_rcp_f16 v65, v73
v_pk_mul_f16 v160, v160, v62
v_pk_fma_f16 v81, v171, v171, s84
v_pk_mul_f16 v80, v170, v80
v_rcp_f16_sdwa v63, v71 dst_sel:WORD_1 dst_unused:UNUSED_PRESERVE src0_sel:WORD_1
v_rcp_f16 v66, v74
v_pk_mul_f16 v161, v161, v63
v_cvt_pk_f16_f32 v173, v144, v145
v_pk_fma_f16 v82, v172, v172, s84
v_rcp_f16_sdwa v64, v72 dst_sel:WORD_1 dst_unused:UNUSED_PRESERVE src0_sel:WORD_1
v_rcp_f16 v67, v75
v_pk_mul_f16 v162, v162, v64
v_pk_mul_f16 v81, v171, v81
v_cvt_pk_f16_f32 v174, v146, v147
v_rcp_f16_sdwa v65, v73 dst_sel:WORD_1 dst_unused:UNUSED_PRESERVE src0_sel:WORD_1
v_rcp_f16 v68, v76
v_pk_mul_f16 v163, v163, v65
v_pk_fma_f16 v83, v173, v173, s84
v_pk_mul_f16 v82, v172, v82
v_rcp_f16_sdwa v66, v74 dst_sel:WORD_1 dst_unused:UNUSED_PRESERVE src0_sel:WORD_1
v_rcp_f16 v69, v77
v_pk_mul_f16 v164, v164, v66
v_cvt_pk_f16_f32 v175, v148, v149
v_mfma_f32_32x32x16_bf16 v[134:149], a[192:195], a[168:171], 0
ds_read_b128 a[192:195], v1 offset:24576
s_add_u32 s65, s66, 16384
s_add_u32 m0, s65, 71680
buffer_store_dwordx4 v[98:101], v1, s[12:15], s101 offen offset:1024 sc1
s_waitcnt lgkmcnt(1)
v_pk_add_f32 v[24:25], v[24:25], v[132:133]
v_pk_add_f32 v[24:25], v[24:25], v[130:131]
v_pk_add_f32 v[24:25], v[24:25], v[128:129]
v_pk_add_f32 v[24:25], v[24:25], v[126:127]
v_pk_add_f32 v[24:25], v[24:25], v[124:125]
v_pk_add_f32 v[24:25], v[24:25], v[122:123]
v_pk_add_f32 v[24:25], v[24:25], v[120:121]
v_pk_add_f32 v[24:25], v[24:25], v[118:119]
v_mfma_f32_32x32x16_f16 v[118:133], v[160:163], a[240:243], 0
v_pk_fma_f16 v84, v174, v174, s84
v_rcp_f16_sdwa v67, v75 dst_sel:WORD_1 dst_unused:UNUSED_PRESERVE src0_sel:WORD_1
v_rcp_f16_sdwa v68, v76 dst_sel:WORD_1 dst_unused:UNUSED_PRESERVE src0_sel:WORD_1
v_pk_mul_f16 v165, v165, v67
v_pk_mul_f16 v83, v173, v83
v_pk_fma_f16 v85, v175, v175, s84
v_mfma_f32_32x32x16_bf16 v[134:149], a[196:199], a[172:175], v[134:149]
ds_read_b128 a[196:199], v1 offset:25600
v_pk_mul_f16 v166, v166, v68
v_pk_mul_f16 v84, v174, v84
v_pk_mul_f16 v85, v175, v85
v_rcp_f16_sdwa v69, v77 dst_sel:WORD_1 dst_unused:UNUSED_PRESERVE src0_sel:WORD_1
v_exp_f16 v62, v78
v_mfma_f32_32x32x16_bf16 v[134:149], a[200:203], a[176:179], v[134:149]
ds_read_b128 a[200:203], v1 offset:26624
v_pk_mul_f16 v167, v167, v69
v_mad_u32_u16 v102, v102, 2, s85 op_sel:[1,0,0,0]
v_mad_u32_u16 v103, v103, 2, s85 op_sel:[1,0,0,0]
v_mad_u32_u16 v104, v104, 2, s85 op_sel:[1,0,0,0]
v_exp_f16 v63, v79
v_mad_u32_u16 v105, v105, 2, s85 op_sel:[1,0,0,0]
v_mfma_f32_32x32x16_f16 v[118:133], v[164:167], a[244:247], v[118:133]
buffer_load_dwordx4 v1, s[20:23], s65 offen lds
ds_read_u16_d16_hi v102, v102
ds_read_u16_d16_hi v103, v103
ds_read_u16_d16_hi v104, v104
v_mad_u32_u16 v106, v106, 2, s85 op_sel:[1,0,0,0]
v_mad_u32_u16 v107, v107, 2, s85 op_sel:[1,0,0,0]
v_mfma_f32_32x32x16_bf16 v[134:149], a[204:207], a[180:183], v[134:149]
ds_read_b128 a[204:207], v1 offset:27648
ds_read_u16_d16_hi v105, v105
ds_read_u16_d16_hi v106, v106
ds_read_u16_d16_hi v107, v107
v_mad_u32_u16 v108, v108, 2, s85 op_sel:[1,0,0,0]
v_mad_u32_u16 v109, v109, 2, s85 op_sel:[1,0,0,0]
v_mad_u32_u16 v110, v110, 2, s85 op_sel:[1,0,0,0]
v_exp_f16 v64, v80
v_pk_fma_f32 v[22:23], v[118:119], v[118:119], v[22:23]
v_pk_fma_f32 v[22:23], v[120:121], v[120:121], v[22:23]
v_pk_fma_f32 v[22:23], v[122:123], v[122:123], v[22:23]
v_exp_f16_sdwa v62, v78 dst_sel:WORD_1 dst_unused:UNUSED_PRESERVE src0_sel:WORD_1
v_pk_fma_f32 v[22:23], v[124:125], v[124:125], v[22:23]
v_pk_fma_f32 v[22:23], v[126:127], v[126:127], v[22:23]
v_pk_fma_f32 v[22:23], v[128:129], v[128:129], v[22:23]
v_exp_f16 v65, v81
v_pk_fma_f32 v[22:23], v[130:131], v[130:131], v[22:23]
v_pk_fma_f32 v[22:23], v[132:133], v[132:133], v[22:23]
v_mfma_f32_32x32x16_bf16 v[134:149], a[208:211], a[184:187], v[134:149]
ds_read_b128 a[208:211], v1 offset:28672
ds_read_u16_d16_hi v108, v108
ds_read_u16_d16_hi v109, v109
ds_read_u16_d16_hi v110, v110
v_mad_u32_u16 v111, v111, 2, s85 op_sel:[1,0,0,0]
v_pk_add_f16 v78, v62, 1.0 op_sel_hi:[1,0]
v_mad_u32_u16 v112, v112, 2, s85 op_sel:[1,0,0,0]
v_mfma_f32_32x32x16_bf16 v[134:149], a[212:215], a[188:191], v[134:149]
ds_read_b128 a[212:215], v1 offset:29696
s_add_u32 s65, s66, 20480
s_mov_b32 m0, s69
ds_read_u16_d16_hi v111, v111
buffer_load_dwordx4 v1, s[20:23], s65 offen lds
ds_read_u16_d16_hi v112, v112
v_mfma_f32_32x32x16_bf16 v[118:133], a[144:147], a[216:219], 0
v_exp_f16_sdwa v63, v79 dst_sel:WORD_1 dst_unused:UNUSED_PRESERVE src0_sel:WORD_1
v_exp_f16 v66, v82
v_pk_add_f16 v79, v63, 1.0 op_sel_hi:[1,0]
v_mad_u32_u16 v113, v113, 2, s85 op_sel:[1,0,0,0]
v_exp_f16_sdwa v64, v80 dst_sel:WORD_1 dst_unused:UNUSED_PRESERVE src0_sel:WORD_1
v_mfma_f32_32x32x16_bf16 v[118:133], a[148:151], a[220:223], v[118:133]
ds_read_u16_d16_hi v113, v113
v_pk_add_f16 v80, v64, 1.0 op_sel_hi:[1,0]
v_mad_u32_u16 v114, v114, 2, s85 op_sel:[1,0,0,0]
v_exp_f16 v67, v83
v_exp_f16_sdwa v65, v81 dst_sel:WORD_1 dst_unused:UNUSED_PRESERVE src0_sel:WORD_1
v_exp_f16 v68, v84
v_mfma_f32_32x32x16_bf16 v[118:133], a[152:155], a[224:227], v[118:133]
ds_read_u16_d16_hi v114, v114
v_pk_add_f16 v81, v65, 1.0 op_sel_hi:[1,0]
v_exp_f16_sdwa v66, v82 dst_sel:WORD_1 dst_unused:UNUSED_PRESERVE src0_sel:WORD_1
v_exp_f16 v69, v85
v_pk_add_f16 v82, v66, 1.0 op_sel_hi:[1,0]
v_mad_u32_u16 v115, v115, 2, s85 op_sel:[1,0,0,0]
v_mfma_f32_32x32x16_bf16 v[118:133], a[156:159], a[228:231], v[118:133]
ds_read_u16_d16_hi v115, v115
v_exp_f16_sdwa v67, v83 dst_sel:WORD_1 dst_unused:UNUSED_PRESERVE src0_sel:WORD_1
v_exp_f16_sdwa v68, v84 dst_sel:WORD_1 dst_unused:UNUSED_PRESERVE src0_sel:WORD_1
v_pk_add_f16 v83, v67, 1.0 op_sel_hi:[1,0]
v_mad_u32_u16 v116, v116, 2, s85 op_sel:[1,0,0,0]
v_pk_add_f16 v84, v68, 1.0 op_sel_hi:[1,0]
v_mfma_f32_32x32x16_bf16 v[118:133], a[160:163], a[232:235], v[118:133]
s_add_u32 s65, s66, 24576
s_add_u32 m0, s65, 78592
ds_read_u16_d16_hi v116, v116
buffer_load_dwordx4 v1, s[20:23], s65 offen lds
v_mad_u32_u16 v117, v117, 2, s85 op_sel:[1,0,0,0]
v_exp_f16_sdwa v69, v85 dst_sel:WORD_1 dst_unused:UNUSED_PRESERVE src0_sel:WORD_1
v_mfma_f32_32x32x16_bf16 v[118:133], a[164:167], a[236:239], v[118:133]
ds_read_u16_d16_hi v117, v117
v_pk_add_f16 v85, v69, 1.0 op_sel_hi:[1,0]
v_cvt_pk_f16_f32 v176, v134, v135
v_cvt_pk_f16_f32 v177, v136, v137
v_pk_fma_f16 v70, v176, v176, s84
v_cvt_pk_f16_f32 v178, v138, v139
v_rcp_f16 v62, v78
v_pk_fma_f16 v71, v177, v177, s84
v_pk_mul_f16 v70, v176, v70
v_cvt_pk_f16_f32 v179, v140, v141
v_pk_fma_f16 v72, v178, v178, s84
v_rcp_f16 v63, v79
v_pk_mul_f16 v71, v177, v71
v_cvt_pk_f16_f32 v180, v142, v143
v_rcp_f16 v64, v80
v_rcp_f16_sdwa v62, v78 dst_sel:WORD_1 dst_unused:UNUSED_PRESERVE src0_sel:WORD_1
v_rcp_f16 v65, v81
v_pk_mul_f16 v168, v168, v62
v_pk_fma_f16 v73, v179, v179, s84
v_pk_mul_f16 v72, v178, v72
v_rcp_f16_sdwa v63, v79 dst_sel:WORD_1 dst_unused:UNUSED_PRESERVE src0_sel:WORD_1
v_rcp_f16 v66, v82
v_pk_mul_f16 v169, v169, v63
v_cvt_pk_f16_f32 v181, v144, v145
v_pk_fma_f16 v74, v180, v180, s84
v_rcp_f16_sdwa v64, v80 dst_sel:WORD_1 dst_unused:UNUSED_PRESERVE src0_sel:WORD_1
v_rcp_f16 v67, v83
v_pk_mul_f16 v170, v170, v64
v_pk_mul_f16 v73, v179, v73
v_cvt_pk_f16_f32 v182, v146, v147
v_rcp_f16_sdwa v65, v81 dst_sel:WORD_1 dst_unused:UNUSED_PRESERVE src0_sel:WORD_1
v_rcp_f16 v68, v84
v_pk_mul_f16 v171, v171, v65
v_pk_fma_f16 v75, v181, v181, s84
v_pk_mul_f16 v74, v180, v74
v_rcp_f16_sdwa v66, v82 dst_sel:WORD_1 dst_unused:UNUSED_PRESERVE src0_sel:WORD_1
v_rcp_f16 v69, v85
v_pk_mul_f16 v172, v172, v66
v_cvt_pk_f16_f32 v183, v148, v149
v_mfma_f32_32x32x16_bf16 v[134:149], a[216:219], a[168:171], 0
ds_read_b128 a[216:219], v1 offset:30720
s_add_u32 s65, s66, 28672
s_add_u32 m0, s65, 78592
v_pk_fma_f16 v76, v182, v182, s84
v_rcp_f16_sdwa v67, v83 dst_sel:WORD_1 dst_unused:UNUSED_PRESERVE src0_sel:WORD_1
v_rcp_f16_sdwa v68, v84 dst_sel:WORD_1 dst_unused:UNUSED_PRESERVE src0_sel:WORD_1
s_waitcnt lgkmcnt(1)
v_pk_add_f32 v[26:27], v[26:27], v[116:117]
v_pk_add_f32 v[26:27], v[26:27], v[114:115]
v_pk_add_f32 v[26:27], v[26:27], v[112:113]
v_pk_add_f32 v[26:27], v[26:27], v[110:111]
v_pk_add_f32 v[26:27], v[26:27], v[108:109]
v_pk_add_f32 v[26:27], v[26:27], v[106:107]
v_pk_add_f32 v[26:27], v[26:27], v[104:105]
v_pk_add_f32 v[26:27], v[26:27], v[102:103]
v_mfma_f32_32x32x16_f16 v[102:117], v[168:171], a[240:243], 0
buffer_load_dwordx4 v1, s[20:23], s65 offen lds
v_pk_mul_f16 v173, v173, v67
v_pk_mul_f16 v75, v181, v75
v_pk_fma_f16 v77, v183, v183, s84
v_pk_mul_f16 v174, v174, v68
v_pk_mul_f16 v76, v182, v76
v_mfma_f32_32x32x16_bf16 v[134:149], a[220:223], a[172:175], v[134:149]
ds_read_b128 a[220:223], v1 offset:31744
v_pk_mul_f16 v77, v183, v77
v_rcp_f16_sdwa v69, v85 dst_sel:WORD_1 dst_unused:UNUSED_PRESERVE src0_sel:WORD_1
v_exp_f16 v62, v70
v_pk_mul_f16 v175, v175, v69
v_mad_u32_u16 v118, v118, 2, s85 op_sel:[1,0,0,0]
v_mfma_f32_32x32x16_bf16 v[134:149], a[224:227], a[176:179], v[134:149]
ds_read_b128 a[224:227], v1 offset:32768
ds_read_u16_d16_hi v118, v118
v_mad_u32_u16 v119, v119, 2, s85 op_sel:[1,0,0,0]
v_mad_u32_u16 v120, v120, 2, s85 op_sel:[1,0,0,0]
v_mad_u32_u16 v121, v121, 2, s85 op_sel:[1,0,0,0]
v_exp_f16 v63, v71
v_mad_u32_u16 v122, v122, 2, s85 op_sel:[1,0,0,0]
v_mfma_f32_32x32x16_f16 v[102:117], v[172:175], a[244:247], v[102:117]
ds_read_u16_d16_hi v119, v119
ds_read_u16_d16_hi v120, v120
ds_read_u16_d16_hi v121, v121
ds_read_u16_d16_hi v122, v122
v_mad_u32_u16 v123, v123, 2, s85 op_sel:[1,0,0,0]
v_mad_u32_u16 v124, v124, 2, s85 op_sel:[1,0,0,0]
v_exp_f16 v64, v72
v_mfma_f32_32x32x16_bf16 v[134:149], a[228:231], a[180:183], v[134:149]
ds_read_b128 a[228:231], v1 offset:33792
s_add_u32 s65, s66, 32768
s_add_u32 m0, s65, 78592
ds_read_u16_d16_hi v123, v123
buffer_load_dwordx4 v1, s[20:23], s65 offen lds
ds_read_u16_d16_hi v124, v124
v_pk_fma_f32 v[24:25], v[102:103], v[102:103], v[24:25]
v_pk_fma_f32 v[24:25], v[104:105], v[104:105], v[24:25]
v_pk_fma_f32 v[24:25], v[106:107], v[106:107], v[24:25]
v_pk_fma_f32 v[24:25], v[108:109], v[108:109], v[24:25]
v_exp_f16_sdwa v62, v70 dst_sel:WORD_1 dst_unused:UNUSED_PRESERVE src0_sel:WORD_1
v_pk_fma_f32 v[24:25], v[110:111], v[110:111], v[24:25]
v_pk_fma_f32 v[24:25], v[112:113], v[112:113], v[24:25]
v_pk_fma_f32 v[24:25], v[114:115], v[114:115], v[24:25]
v_exp_f16 v65, v73
v_pk_fma_f32 v[24:25], v[116:117], v[116:117], v[24:25]
v_mfma_f32_32x32x16_bf16 v[134:149], a[232:235], a[184:187], v[134:149]
ds_read_b128 a[232:235], v1 offset:34816
v_mad_u32_u16 v125, v125, 2, s85 op_sel:[1,0,0,0]
v_mad_u32_u16 v126, v126, 2, s85 op_sel:[1,0,0,0]
v_mad_u32_u16 v127, v127, 2, s85 op_sel:[1,0,0,0]
v_pk_add_f16 v70, v62, 1.0 op_sel_hi:[1,0]
v_mad_u32_u16 v128, v128, 2, s85 op_sel:[1,0,0,0]
v_exp_f16_sdwa v63, v71 dst_sel:WORD_1 dst_unused:UNUSED_PRESERVE src0_sel:WORD_1
v_mfma_f32_32x32x16_bf16 v[134:149], a[236:239], a[188:191], v[134:149]
ds_read_b128 a[236:239], v1 offset:35840
ds_read_u16_d16_hi v125, v125
ds_read_u16_d16_hi v126, v126
ds_read_u16_d16_hi v127, v127
v_pk_add_f16 v71, v63, 1.0 op_sel_hi:[1,0]
v_mad_u32_u16 v129, v129, 2, s85 op_sel:[1,0,0,0]
v_exp_f16 v66, v74
v_mfma_f32_32x32x16_bf16 v[102:117], a[144:147], a[192:195], 0
ds_read_u16_d16_hi v128, v128
s_add_u32 s65, s66, 36864
s_add_u32 m0, s65, 78592
ds_read_u16_d16_hi v129, v129
buffer_load_dwordx4 v1, s[20:23], s65 offen lds
v_exp_f16_sdwa v64, v72 dst_sel:WORD_1 dst_unused:UNUSED_PRESERVE src0_sel:WORD_1
v_mfma_f32_32x32x16_bf16 v[102:117], a[148:151], a[196:199], v[102:117]
v_pk_add_f16 v72, v64, 1.0 op_sel_hi:[1,0]
v_mad_u32_u16 v130, v130, 2, s85 op_sel:[1,0,0,0]
v_exp_f16 v67, v75
v_exp_f16_sdwa v65, v73 dst_sel:WORD_1 dst_unused:UNUSED_PRESERVE src0_sel:WORD_1
v_exp_f16 v68, v76
v_mfma_f32_32x32x16_bf16 v[102:117], a[152:155], a[200:203], v[102:117]
ds_read_u16_d16_hi v130, v130
v_pk_add_f16 v73, v65, 1.0 op_sel_hi:[1,0]
v_exp_f16_sdwa v66, v74 dst_sel:WORD_1 dst_unused:UNUSED_PRESERVE src0_sel:WORD_1
v_exp_f16 v69, v77
v_pk_add_f16 v74, v66, 1.0 op_sel_hi:[1,0]
v_mad_u32_u16 v131, v131, 2, s85 op_sel:[1,0,0,0]
v_mfma_f32_32x32x16_bf16 v[102:117], a[156:159], a[204:207], v[102:117]
ds_read_u16_d16_hi v131, v131
v_exp_f16_sdwa v67, v75 dst_sel:WORD_1 dst_unused:UNUSED_PRESERVE src0_sel:WORD_1
v_exp_f16_sdwa v68, v76 dst_sel:WORD_1 dst_unused:UNUSED_PRESERVE src0_sel:WORD_1
v_pk_add_f16 v75, v67, 1.0 op_sel_hi:[1,0]
v_mad_u32_u16 v132, v132, 2, s85 op_sel:[1,0,0,0]
v_pk_add_f16 v76, v68, 1.0 op_sel_hi:[1,0]
v_mfma_f32_32x32x16_bf16 v[102:117], a[160:163], a[208:211], v[102:117]
ds_read_u16_d16_hi v132, v132
v_mad_u32_u16 v133, v133, 2, s85 op_sel:[1,0,0,0]
v_exp_f16_sdwa v69, v77 dst_sel:WORD_1 dst_unused:UNUSED_PRESERVE src0_sel:WORD_1
v_rcp_f16 v62, v70
v_pk_add_f16 v77, v69, 1.0 op_sel_hi:[1,0]
v_cvt_pk_f16_f32 v184, v134, v135
v_mfma_f32_32x32x16_bf16 v[102:117], a[164:167], a[212:215], v[102:117]
s_add_u32 s65, s66, 40960
s_add_u32 m0, s65, 78592
ds_read_u16_d16_hi v133, v133
buffer_load_dwordx4 v1, s[20:23], s65 offen lds
v_cvt_pk_f16_f32 v185, v136, v137
v_pk_fma_f16 v78, v184, v184, s84
v_cvt_pk_f16_f32 v186, v138, v139
v_pk_fma_f16 v79, v185, v185, s84
v_pk_mul_f16 v78, v184, v78
v_cvt_pk_f16_f32 v187, v140, v141
v_rcp_f16 v63, v71
v_pk_fma_f16 v80, v186, v186, s84
v_pk_mul_f16 v79, v185, v79
v_cvt_pk_f16_f32 v188, v142, v143
v_rcp_f16 v64, v72
v_rcp_f16_sdwa v62, v70 dst_sel:WORD_1 dst_unused:UNUSED_PRESERVE src0_sel:WORD_1
v_rcp_f16 v65, v73
v_pk_mul_f16 v176, v176, v62
v_pk_fma_f16 v81, v187, v187, s84
v_pk_mul_f16 v80, v186, v80
v_rcp_f16_sdwa v63, v71 dst_sel:WORD_1 dst_unused:UNUSED_PRESERVE src0_sel:WORD_1
v_rcp_f16 v66, v74
v_pk_mul_f16 v177, v177, v63
v_cvt_pk_f16_f32 v189, v144, v145
v_pk_fma_f16 v82, v188, v188, s84
v_rcp_f16_sdwa v64, v72 dst_sel:WORD_1 dst_unused:UNUSED_PRESERVE src0_sel:WORD_1
v_rcp_f16 v67, v75
v_pk_mul_f16 v178, v178, v64
v_pk_mul_f16 v81, v187, v81
v_cvt_pk_f16_f32 v190, v146, v147
v_rcp_f16_sdwa v65, v73 dst_sel:WORD_1 dst_unused:UNUSED_PRESERVE src0_sel:WORD_1
v_rcp_f16 v68, v76
v_pk_mul_f16 v179, v179, v65
v_pk_fma_f16 v83, v189, v189, s84
v_pk_mul_f16 v82, v188, v82
v_rcp_f16_sdwa v66, v74 dst_sel:WORD_1 dst_unused:UNUSED_PRESERVE src0_sel:WORD_1
s_waitcnt lgkmcnt(0)
v_pk_add_f32 v[28:29], v[28:29], v[132:133]
v_pk_add_f32 v[28:29], v[28:29], v[130:131]
v_pk_add_f32 v[28:29], v[28:29], v[128:129]
v_pk_add_f32 v[28:29], v[28:29], v[126:127]
v_pk_add_f32 v[28:29], v[28:29], v[124:125]
v_rcp_f16 v69, v77
v_pk_add_f32 v[28:29], v[28:29], v[122:123]
v_pk_add_f32 v[28:29], v[28:29], v[120:121]
v_pk_add_f32 v[28:29], v[28:29], v[118:119]
v_mfma_f32_32x32x16_f16 v[118:133], v[176:179], a[240:243], 0
s_add_u32 s65, s66, 45056
s_add_u32 m0, s65, 78592
v_pk_mul_f16 v180, v180, v66
v_rcp_f16_sdwa v67, v75 dst_sel:WORD_1 dst_unused:UNUSED_PRESERVE src0_sel:WORD_1
v_cvt_pk_f16_f32 v191, v148, v149
v_pk_fma_f16 v84, v190, v190, s84
v_pk_mul_f16 v181, v181, v67
v_mfma_f32_32x32x16_bf16 v[134:149], a[192:195], a[168:171], 0
ds_read_b128 a[192:195], v1 offset:36864
buffer_load_dwordx4 v1, s[20:23], s65 offen lds
v_pk_mul_f16 v83, v189, v83
v_pk_fma_f16 v85, v191, v191, s84
v_rcp_f16_sdwa v68, v76 dst_sel:WORD_1 dst_unused:UNUSED_PRESERVE src0_sel:WORD_1
v_mfma_f32_32x32x16_bf16 v[134:149], a[196:199], a[172:175], v[134:149]
ds_read_b128 a[196:199], v1 offset:37888
v_pk_mul_f16 v182, v182, v68
v_pk_mul_f16 v84, v190, v84
v_pk_mul_f16 v85, v191, v85
v_rcp_f16_sdwa v69, v77 dst_sel:WORD_1 dst_unused:UNUSED_PRESERVE src0_sel:WORD_1
v_exp_f16 v62, v78
v_mfma_f32_32x32x16_bf16 v[134:149], a[200:203], a[176:179], v[134:149]
ds_read_b128 a[200:203], v1 offset:38912
v_pk_mul_f16 v183, v183, v69
v_mad_u32_u16 v102, v102, 2, s85 op_sel:[1,0,0,0]
v_mad_u32_u16 v103, v103, 2, s85 op_sel:[1,0,0,0]
v_mad_u32_u16 v104, v104, 2, s85 op_sel:[1,0,0,0]
v_mad_u32_u16 v105, v105, 2, s85 op_sel:[1,0,0,0]
v_mad_u32_u16 v106, v106, 2, s85 op_sel:[1,0,0,0]
v_exp_f16 v63, v79
v_mfma_f32_32x32x16_f16 v[118:133], v[180:183], a[244:247], v[118:133]
ds_read_u16_d16_hi v102, v102
ds_read_u16_d16_hi v103, v103
ds_read_u16_d16_hi v104, v104
ds_read_u16_d16_hi v105, v105
v_mad_u32_u16 v107, v107, 2, s85 op_sel:[1,0,0,0]
v_mad_u32_u16 v108, v108, 2, s85 op_sel:[1,0,0,0]
v_exp_f16 v64, v80
v_mfma_f32_32x32x16_bf16 v[134:149], a[204:207], a[180:183], v[134:149]
ds_read_b128 a[204:207], v1 offset:39936
s_add_u32 s65, s66, 49152
s_add_u32 m0, s65, 78592
ds_read_u16_d16_hi v106, v106
buffer_load_dwordx4 v1, s[20:23], s65 offen lds
ds_read_u16_d16_hi v107, v107
v_pk_fma_f32 v[26:27], v[118:119], v[118:119], v[26:27]
v_pk_fma_f32 v[26:27], v[120:121], v[120:121], v[26:27]
v_pk_fma_f32 v[26:27], v[122:123], v[122:123], v[26:27]
v_pk_fma_f32 v[26:27], v[124:125], v[124:125], v[26:27]
v_pk_fma_f32 v[26:27], v[126:127], v[126:127], v[26:27]
v_pk_fma_f32 v[26:27], v[128:129], v[128:129], v[26:27]
v_pk_fma_f32 v[26:27], v[130:131], v[130:131], v[26:27]
v_pk_fma_f32 v[26:27], v[132:133], v[132:133], v[26:27]
v_mfma_f32_32x32x16_bf16 v[134:149], a[208:211], a[184:187], v[134:149]
ds_read_b128 a[208:211], v1 offset:40960
ds_read_u16_d16_hi v108, v108
v_mad_u32_u16 v109, v109, 2, s85 op_sel:[1,0,0,0]
v_mad_u32_u16 v110, v110, 2, s85 op_sel:[1,0,0,0]
v_mad_u32_u16 v111, v111, 2, s85 op_sel:[1,0,0,0]
v_exp_f16_sdwa v62, v78 dst_sel:WORD_1 dst_unused:UNUSED_PRESERVE src0_sel:WORD_1
v_mfma_f32_32x32x16_bf16 v[134:149], a[212:215], a[188:191], v[134:149]
ds_read_b128 a[212:215], v1 offset:41984
ds_read_u16_d16_hi v109, v109
ds_read_u16_d16_hi v110, v110
ds_read_u16_d16_hi v111, v111
v_pk_add_f16 v78, v62, 1.0 op_sel_hi:[1,0]
v_exp_f16 v65, v81
v_mad_u32_u16 v112, v112, 2, s85 op_sel:[1,0,0,0]
v_mfma_f32_32x32x16_bf16 v[118:133], a[144:147], a[216:219], 0
ds_read_u16_d16_hi v112, v112
v_exp_f16_sdwa v63, v79 dst_sel:WORD_1 dst_unused:UNUSED_PRESERVE src0_sel:WORD_1
v_exp_f16 v66, v82
v_pk_add_f16 v79, v63, 1.0 op_sel_hi:[1,0]
v_mad_u32_u16 v113, v113, 2, s85 op_sel:[1,0,0,0]
v_exp_f16_sdwa v64, v80 dst_sel:WORD_1 dst_unused:UNUSED_PRESERVE src0_sel:WORD_1
v_mfma_f32_32x32x16_bf16 v[118:133], a[148:151], a[220:223], v[118:133]
s_add_u32 s65, s66, 53248
s_add_u32 m0, s65, 78592
ds_read_u16_d16_hi v113, v113
buffer_load_dwordx4 v1, s[20:23], s65 offen lds
v_pk_add_f16 v80, v64, 1.0 op_sel_hi:[1,0]
v_mad_u32_u16 v114, v114, 2, s85 op_sel:[1,0,0,0]
v_mfma_f32_32x32x16_bf16 v[118:133], a[152:155], a[224:227], v[118:133]
ds_read_u16_d16_hi v114, v114
v_exp_f16 v67, v83
v_exp_f16_sdwa v65, v81 dst_sel:WORD_1 dst_unused:UNUSED_PRESERVE src0_sel:WORD_1
v_exp_f16 v68, v84
v_pk_add_f16 v81, v65, 1.0 op_sel_hi:[1,0]
v_mfma_f32_32x32x16_bf16 v[118:133], a[156:159], a[228:231], v[118:133]
v_exp_f16_sdwa v66, v82 dst_sel:WORD_1 dst_unused:UNUSED_PRESERVE src0_sel:WORD_1
v_exp_f16 v69, v85
v_pk_add_f16 v82, v66, 1.0 op_sel_hi:[1,0]
v_mad_u32_u16 v115, v115, 2, s85 op_sel:[1,0,0,0]
v_exp_f16_sdwa v67, v83 dst_sel:WORD_1 dst_unused:UNUSED_PRESERVE src0_sel:WORD_1
v_mfma_f32_32x32x16_bf16 v[118:133], a[160:163], a[232:235], v[118:133]
ds_read_u16_d16_hi v115, v115
v_pk_add_f16 v83, v67, 1.0 op_sel_hi:[1,0]
v_mad_u32_u16 v116, v116, 2, s85 op_sel:[1,0,0,0]
v_exp_f16_sdwa v68, v84 dst_sel:WORD_1 dst_unused:UNUSED_PRESERVE src0_sel:WORD_1
v_exp_f16_sdwa v69, v85 dst_sel:WORD_1 dst_unused:UNUSED_PRESERVE src0_sel:WORD_1
v_pk_add_f16 v84, v68, 1.0 op_sel_hi:[1,0]
v_mfma_f32_32x32x16_bf16 v[118:133], a[164:167], a[236:239], v[118:133]
ds_read_u16_d16_hi v116, v116
v_mad_u32_u16 v117, v117, 2, s85 op_sel:[1,0,0,0]
v_pk_add_f16 v85, v69, 1.0 op_sel_hi:[1,0]
v_cvt_pk_f16_f32 v192, v134, v135
v_cvt_pk_f16_f32 v193, v136, v137
v_pk_fma_f16 v70, v192, v192, s84
v_rcp_f16 v62, v78
v_cvt_pk_f16_f32 v194, v138, v139
v_pk_fma_f16 v71, v193, v193, s84
v_pk_mul_f16 v70, v192, v70
v_cvt_pk_f16_f32 v195, v140, v141
v_rcp_f16 v63, v79
v_pk_fma_f16 v72, v194, v194, s84
v_pk_mul_f16 v71, v193, v71
v_cvt_pk_f16_f32 v196, v142, v143
v_rcp_f16 v64, v80
v_rcp_f16_sdwa v62, v78 dst_sel:WORD_1 dst_unused:UNUSED_PRESERVE src0_sel:WORD_1
v_rcp_f16 v65, v81
v_pk_mul_f16 v184, v184, v62
v_pk_fma_f16 v73, v195, v195, s84
v_pk_mul_f16 v72, v194, v72
v_rcp_f16_sdwa v63, v79 dst_sel:WORD_1 dst_unused:UNUSED_PRESERVE src0_sel:WORD_1
v_rcp_f16 v66, v82
v_pk_mul_f16 v185, v185, v63
v_cvt_pk_f16_f32 v197, v144, v145
v_pk_fma_f16 v74, v196, v196, s84
v_rcp_f16_sdwa v64, v80 dst_sel:WORD_1 dst_unused:UNUSED_PRESERVE src0_sel:WORD_1
v_rcp_f16 v67, v83
v_pk_mul_f16 v186, v186, v64
v_pk_mul_f16 v73, v195, v73
v_cvt_pk_f16_f32 v198, v146, v147
v_rcp_f16_sdwa v65, v81 dst_sel:WORD_1 dst_unused:UNUSED_PRESERVE src0_sel:WORD_1
v_rcp_f16 v68, v84
v_pk_mul_f16 v187, v187, v65
v_pk_fma_f16 v75, v197, v197, s84
v_pk_mul_f16 v74, v196, v74
v_rcp_f16_sdwa v66, v82 dst_sel:WORD_1 dst_unused:UNUSED_PRESERVE src0_sel:WORD_1
v_rcp_f16 v69, v85
v_pk_mul_f16 v188, v188, v66
v_cvt_pk_f16_f32 v199, v148, v149
v_mfma_f32_32x32x16_bf16 v[134:149], a[216:219], a[168:171], 0
ds_read_b128 a[216:219], v1 offset:43008
s_add_u32 s65, s66, 57344
s_add_u32 m0, s65, 78592
ds_read_u16_d16_hi v117, v117
buffer_load_dwordx4 v1, s[20:23], s65 offen lds
v_pk_fma_f16 v76, v198, v198, s84
v_mfma_f32_32x32x16_bf16 v[134:149], a[220:223], a[172:175], v[134:149]
ds_read_b128 a[220:223], v1 offset:44032
v_rcp_f16_sdwa v67, v83 dst_sel:WORD_1 dst_unused:UNUSED_PRESERVE src0_sel:WORD_1
v_rcp_f16_sdwa v68, v84 dst_sel:WORD_1 dst_unused:UNUSED_PRESERVE src0_sel:WORD_1
v_pk_mul_f16 v189, v189, v67
v_pk_mul_f16 v75, v197, v75
v_pk_fma_f16 v77, v199, v199, s84
v_mfma_f32_32x32x16_bf16 v[134:149], a[224:227], a[176:179], v[134:149]
ds_read_b128 a[224:227], v1 offset:45056
v_pk_mul_f16 v190, v190, v68
v_pk_mul_f16 v76, v198, v76
v_rcp_f16_sdwa v69, v85 dst_sel:WORD_1 dst_unused:UNUSED_PRESERVE src0_sel:WORD_1
v_pk_mul_f16 v77, v199, v77
v_pk_mul_f16 v191, v191, v69
v_mad_u32_u16 v118, v118, 2, s85 op_sel:[1,0,0,0]
v_mfma_f32_32x32x16_bf16 v[134:149], a[228:231], a[180:183], v[134:149]
ds_read_b128 a[228:231], v1 offset:46080
ds_read_u16_d16_hi v118, v118
v_mad_u32_u16 v119, v119, 2, s85 op_sel:[1,0,0,0]
v_exp_f16 v62, v70
v_mad_u32_u16 v120, v120, 2, s85 op_sel:[1,0,0,0]
v_mad_u32_u16 v121, v121, 2, s85 op_sel:[1,0,0,0]
v_mad_u32_u16 v122, v122, 2, s85 op_sel:[1,0,0,0]
s_waitcnt lgkmcnt(2)
v_pk_add_f32 v[30:31], v[30:31], v[116:117]
v_pk_add_f32 v[30:31], v[30:31], v[114:115]
v_pk_add_f32 v[30:31], v[30:31], v[112:113]
v_pk_add_f32 v[30:31], v[30:31], v[110:111]
v_exp_f16 v63, v71
v_pk_add_f32 v[30:31], v[30:31], v[108:109]
v_pk_add_f32 v[30:31], v[30:31], v[106:107]
v_pk_add_f32 v[30:31], v[30:31], v[104:105]
v_pk_add_f32 v[30:31], v[30:31], v[102:103]
v_mfma_f32_32x32x16_f16 v[102:117], v[184:187], a[240:243], 0
s_add_u32 s65, s66, 61440
s_add_u32 m0, s65, 78592
ds_read_u16_d16_hi v119, v119
buffer_load_dwordx4 v1, s[20:23], s65 offen lds
ds_read_u16_d16_hi v120, v120
ds_read_u16_d16_hi v121, v121
v_mfma_f32_32x32x16_bf16 v[134:149], a[232:235], a[184:187], v[134:149]
ds_read_b128 a[232:235], v1 offset:47104
ds_read_u16_d16_hi v122, v122
v_mad_u32_u16 v123, v123, 2, s85 op_sel:[1,0,0,0]
v_mad_u32_u16 v124, v124, 2, s85 op_sel:[1,0,0,0]
v_exp_f16 v64, v72
v_mad_u32_u16 v125, v125, 2, s85 op_sel:[1,0,0,0]
v_mad_u32_u16 v126, v126, 2, s85 op_sel:[1,0,0,0]
v_mfma_f32_32x32x16_f16 v[102:117], v[188:191], a[244:247], v[102:117]
ds_read_u16_d16_hi v123, v123
ds_read_u16_d16_hi v124, v124
ds_read_u16_d16_hi v125, v125
ds_read_u16_d16_hi v126, v126
v_exp_f16_sdwa v62, v70 dst_sel:WORD_1 dst_unused:UNUSED_PRESERVE src0_sel:WORD_1
v_mad_u32_u16 v127, v127, 2, s85 op_sel:[1,0,0,0]
v_pk_add_f16 v70, v62, 1.0 op_sel_hi:[1,0]
v_mfma_f32_32x32x16_bf16 v[134:149], a[236:239], a[188:191], v[134:149]
ds_read_b128 a[236:239], v1 offset:48128
ds_read_u16_d16_hi v127, v127
v_mad_u32_u16 v128, v128, 2, s85 op_sel:[1,0,0,0]
v_exp_f16 v65, v73
v_exp_f16_sdwa v63, v71 dst_sel:WORD_1 dst_unused:UNUSED_PRESERVE src0_sel:WORD_1
v_exp_f16 v66, v74
v_pk_fma_f32 v[28:29], v[102:103], v[102:103], v[28:29]
v_pk_fma_f32 v[28:29], v[104:105], v[104:105], v[28:29]
v_pk_fma_f32 v[28:29], v[106:107], v[106:107], v[28:29]
v_exp_f16_sdwa v64, v72 dst_sel:WORD_1 dst_unused:UNUSED_PRESERVE src0_sel:WORD_1
v_pk_fma_f32 v[28:29], v[108:109], v[108:109], v[28:29]
v_pk_fma_f32 v[28:29], v[110:111], v[110:111], v[28:29]
v_pk_fma_f32 v[28:29], v[112:113], v[112:113], v[28:29]
v_exp_f16 v67, v75
v_pk_fma_f32 v[28:29], v[114:115], v[114:115], v[28:29]
v_pk_fma_f32 v[28:29], v[116:117], v[116:117], v[28:29]
v_mfma_f32_32x32x16_bf16 v[102:117], a[144:147], a[192:195], 0
s_add_u32 s65, s66, 65536
s_add_u32 m0, s65, 78592
ds_read_u16_d16_hi v128, v128
buffer_load_dwordx4 v1, s[20:23], s65 offen lds
v_pk_add_f16 v71, v63, 1.0 op_sel_hi:[1,0]
v_mad_u32_u16 v129, v129, 2, s85 op_sel:[1,0,0,0]
v_mfma_f32_32x32x16_bf16 v[102:117], a[148:151], a[196:199], v[102:117]
ds_read_u16_d16_hi v129, v129
v_pk_add_f16 v72, v64, 1.0 op_sel_hi:[1,0]
v_mad_u32_u16 v130, v130, 2, s85 op_sel:[1,0,0,0]
v_exp_f16_sdwa v65, v73 dst_sel:WORD_1 dst_unused:UNUSED_PRESERVE src0_sel:WORD_1
v_exp_f16 v68, v76
v_pk_add_f16 v73, v65, 1.0 op_sel_hi:[1,0]
v_mfma_f32_32x32x16_bf16 v[102:117], a[152:155], a[200:203], v[102:117]
ds_read_u16_d16_hi v130, v130
v_exp_f16_sdwa v66, v74 dst_sel:WORD_1 dst_unused:UNUSED_PRESERVE src0_sel:WORD_1
v_exp_f16 v69, v77
v_pk_add_f16 v74, v66, 1.0 op_sel_hi:[1,0]
v_mad_u32_u16 v131, v131, 2, s85 op_sel:[1,0,0,0]
v_exp_f16_sdwa v67, v75 dst_sel:WORD_1 dst_unused:UNUSED_PRESERVE src0_sel:WORD_1
v_mfma_f32_32x32x16_bf16 v[102:117], a[156:159], a[204:207], v[102:117]
ds_read_u16_d16_hi v131, v131
v_pk_add_f16 v75, v67, 1.0 op_sel_hi:[1,0]
v_mad_u32_u16 v132, v132, 2, s85 op_sel:[1,0,0,0]
v_exp_f16_sdwa v68, v76 dst_sel:WORD_1 dst_unused:UNUSED_PRESERVE src0_sel:WORD_1
v_exp_f16_sdwa v69, v77 dst_sel:WORD_1 dst_unused:UNUSED_PRESERVE src0_sel:WORD_1
v_pk_add_f16 v76, v68, 1.0 op_sel_hi:[1,0]
v_mfma_f32_32x32x16_bf16 v[102:117], a[160:163], a[208:211], v[102:117]
ds_read_u16_d16_hi v132, v132
v_mad_u32_u16 v133, v133, 2, s85 op_sel:[1,0,0,0]
v_pk_add_f16 v77, v69, 1.0 op_sel_hi:[1,0]
v_cvt_pk_f16_f32 v200, v134, v135
v_cvt_pk_f16_f32 v201, v136, v137
v_pk_fma_f16 v78, v200, v200, s84
v_rcp_f16 v62, v70
v_mfma_f32_32x32x16_bf16 v[102:117], a[164:167], a[212:215], v[102:117]
s_add_u32 s65, s66, 69632
s_add_u32 m0, s65, 78592
ds_read_u16_d16_hi v133, v133
buffer_load_dwordx4 v1, s[20:23], s65 offen lds
v_cvt_pk_f16_f32 v202, v138, v139
v_pk_fma_f16 v79, v201, v201, s84
v_pk_mul_f16 v78, v200, v78
v_cvt_pk_f16_f32 v203, v140, v141
v_pk_fma_f16 v80, v202, v202, s84
v_pk_mul_f16 v79, v201, v79
v_rcp_f16 v63, v71
v_cvt_pk_f16_f32 v204, v142, v143
v_rcp_f16 v64, v72
v_rcp_f16_sdwa v62, v70 dst_sel:WORD_1 dst_unused:UNUSED_PRESERVE src0_sel:WORD_1
v_rcp_f16 v65, v73
v_pk_mul_f16 v192, v192, v62
v_pk_fma_f16 v81, v203, v203, s84
v_pk_mul_f16 v80, v202, v80
v_rcp_f16_sdwa v63, v71 dst_sel:WORD_1 dst_unused:UNUSED_PRESERVE src0_sel:WORD_1
v_rcp_f16 v66, v74
v_pk_mul_f16 v193, v193, v63
v_cvt_pk_f16_f32 v205, v144, v145
v_pk_fma_f16 v82, v204, v204, s84
v_rcp_f16_sdwa v64, v72 dst_sel:WORD_1 dst_unused:UNUSED_PRESERVE src0_sel:WORD_1
v_rcp_f16 v67, v75
v_pk_mul_f16 v194, v194, v64
v_pk_mul_f16 v81, v203, v81
v_cvt_pk_f16_f32 v206, v146, v147
v_rcp_f16_sdwa v65, v73 dst_sel:WORD_1 dst_unused:UNUSED_PRESERVE src0_sel:WORD_1
v_rcp_f16 v68, v76
v_pk_mul_f16 v195, v195, v65
v_pk_fma_f16 v83, v205, v205, s84
v_pk_mul_f16 v82, v204, v82
v_rcp_f16_sdwa v66, v74 dst_sel:WORD_1 dst_unused:UNUSED_PRESERVE src0_sel:WORD_1
s_waitcnt lgkmcnt(0)
v_pk_add_f32 v[32:33], v[32:33], v[132:133]
v_pk_add_f32 v[32:33], v[32:33], v[130:131]
v_pk_add_f32 v[32:33], v[32:33], v[128:129]
v_rcp_f16 v69, v77
v_pk_add_f32 v[32:33], v[32:33], v[126:127]
v_pk_add_f32 v[32:33], v[32:33], v[124:125]
v_pk_add_f32 v[32:33], v[32:33], v[122:123]
v_rcp_f16_sdwa v67, v75 dst_sel:WORD_1 dst_unused:UNUSED_PRESERVE src0_sel:WORD_1
v_pk_add_f32 v[32:33], v[32:33], v[120:121]
v_pk_add_f32 v[32:33], v[32:33], v[118:119]
v_mfma_f32_32x32x16_f16 v[118:133], v[192:195], a[240:243], 0
buffer_load_dword v21, v6, s[36:39], 0 offen sc1
ds_write_b32 v8, v20
v_pk_mul_f16 v196, v196, v66
v_cvt_pk_f16_f32 v207, v148, v149
v_rcp_f16_sdwa v68, v76 dst_sel:WORD_1 dst_unused:UNUSED_PRESERVE src0_sel:WORD_1
v_mfma_f32_32x32x16_bf16 v[134:149], a[192:195], a[168:171], 0
ds_read_b128 a[192:195], v1 offset:49152
v_pk_fma_f16 v84, v206, v206, s84
v_pk_mul_f16 v197, v197, v67
v_pk_mul_f16 v83, v205, v83
v_pk_fma_f16 v85, v207, v207, s84
v_pk_mul_f16 v198, v198, v68
v_rcp_f16_sdwa v69, v77 dst_sel:WORD_1 dst_unused:UNUSED_PRESERVE src0_sel:WORD_1
v_mfma_f32_32x32x16_bf16 v[134:149], a[196:199], a[172:175], v[134:149]
ds_read_b128 a[196:199], v1 offset:50176
v_pk_mul_f16 v84, v206, v84
v_pk_mul_f16 v85, v207, v85
v_pk_mul_f16 v199, v199, v69
v_mad_u32_u16 v102, v102, 2, s85 op_sel:[1,0,0,0]
v_mad_u32_u16 v103, v103, 2, s85 op_sel:[1,0,0,0]
v_exp_f16 v62, v78
v_mfma_f32_32x32x16_f16 v[118:133], v[196:199], a[244:247], v[118:133]
ds_read_u16_d16_hi v102, v102
ds_read_u16_d16_hi v103, v103
v_mad_u32_u16 v104, v104, 2, s85 op_sel:[1,0,0,0]
v_mad_u32_u16 v105, v105, 2, s85 op_sel:[1,0,0,0]
v_mad_u32_u16 v106, v106, 2, s85 op_sel:[1,0,0,0]
v_mad_u32_u16 v107, v107, 2, s85 op_sel:[1,0,0,0]
v_mad_u32_u16 v108, v108, 2, s85 op_sel:[1,0,0,0]
v_exp_f16 v63, v79
v_mfma_f32_32x32x16_bf16 v[134:149], a[200:203], a[176:179], v[134:149]
ds_read_b128 a[200:203], v1 offset:51200
ds_read_u16_d16_hi v104, v104
ds_read_u16_d16_hi v105, v105
ds_read_u16_d16_hi v106, v106
v_mad_u32_u16 v109, v109, 2, s85 op_sel:[1,0,0,0]
v_mad_u32_u16 v110, v110, 2, s85 op_sel:[1,0,0,0]
v_exp_f16 v64, v80
v_pk_fma_f32 v[30:31], v[118:119], v[118:119], v[30:31]
v_pk_fma_f32 v[30:31], v[120:121], v[120:121], v[30:31]
v_pk_fma_f32 v[30:31], v[122:123], v[122:123], v[30:31]
v_pk_fma_f32 v[30:31], v[124:125], v[124:125], v[30:31]
v_pk_fma_f32 v[30:31], v[126:127], v[126:127], v[30:31]
v_pk_fma_f32 v[30:31], v[128:129], v[128:129], v[30:31]
v_pk_fma_f32 v[30:31], v[130:131], v[130:131], v[30:31]
v_pk_fma_f32 v[30:31], v[132:133], v[132:133], v[30:31]
v_mfma_f32_32x32x16_bf16 v[134:149], a[204:207], a[180:183], v[134:149]
ds_read_b128 a[204:207], v1 offset:52224
ds_read_u16_d16_hi v107, v107
ds_read_u16_d16_hi v108, v108
ds_read_u16_d16_hi v109, v109
v_mad_u32_u16 v111, v111, 2, s85 op_sel:[1,0,0,0]
v_exp_f16_sdwa v62, v78 dst_sel:WORD_1 dst_unused:UNUSED_PRESERVE src0_sel:WORD_1
v_exp_f16 v65, v81
v_mfma_f32_32x32x16_bf16 v[134:149], a[208:211], a[184:187], v[134:149]
ds_read_b128 a[208:211], v1 offset:53248
ds_read_u16_d16_hi v110, v110
ds_read_u16_d16_hi v111, v111
v_exp_f16_sdwa v63, v79 dst_sel:WORD_1 dst_unused:UNUSED_PRESERVE src0_sel:WORD_1
v_pk_add_f16 v78, v62, 1.0 op_sel_hi:[1,0]
v_mad_u32_u16 v112, v112, 2, s85 op_sel:[1,0,0,0]
v_pk_add_f16 v79, v63, 1.0 op_sel_hi:[1,0]
v_mfma_f32_32x32x16_bf16 v[134:149], a[212:215], a[188:191], v[134:149]
ds_read_b128 a[212:215], v1 offset:54272
ds_read_u16_d16_hi v112, v112
v_mad_u32_u16 v113, v113, 2, s85 op_sel:[1,0,0,0]
v_exp_f16 v66, v82
v_exp_f16_sdwa v64, v80 dst_sel:WORD_1 dst_unused:UNUSED_PRESERVE src0_sel:WORD_1
v_exp_f16 v67, v83
v_mfma_f32_32x32x16_bf16 v[118:133], a[144:147], a[216:219], 0
ds_read_u16_d16_hi v113, v113
v_pk_add_f16 v80, v64, 1.0 op_sel_hi:[1,0]
v_mad_u32_u16 v114, v114, 2, s85 op_sel:[1,0,0,0]
v_exp_f16_sdwa v65, v81 dst_sel:WORD_1 dst_unused:UNUSED_PRESERVE src0_sel:WORD_1
v_exp_f16 v68, v84
v_pk_add_f16 v81, v65, 1.0 op_sel_hi:[1,0]
v_mfma_f32_32x32x16_bf16 v[118:133], a[148:151], a[220:223], v[118:133]
ds_read_u16_d16_hi v114, v114
v_exp_f16_sdwa v66, v82 dst_sel:WORD_1 dst_unused:UNUSED_PRESERVE src0_sel:WORD_1
v_exp_f16 v69, v85
v_pk_add_f16 v82, v66, 1.0 op_sel_hi:[1,0]
v_mad_u32_u16 v115, v115, 2, s85 op_sel:[1,0,0,0]
v_exp_f16_sdwa v67, v83 dst_sel:WORD_1 dst_unused:UNUSED_PRESERVE src0_sel:WORD_1
v_mfma_f32_32x32x16_bf16 v[118:133], a[152:155], a[224:227], v[118:133]
ds_read_u16_d16_hi v115, v115
v_pk_add_f16 v83, v67, 1.0 op_sel_hi:[1,0]
v_mad_u32_u16 v116, v116, 2, s85 op_sel:[1,0,0,0]
v_exp_f16_sdwa v68, v84 dst_sel:WORD_1 dst_unused:UNUSED_PRESERVE src0_sel:WORD_1
v_exp_f16_sdwa v69, v85 dst_sel:WORD_1 dst_unused:UNUSED_PRESERVE src0_sel:WORD_1
v_pk_add_f16 v84, v68, 1.0 op_sel_hi:[1,0]
v_mfma_f32_32x32x16_bf16 v[118:133], a[156:159], a[228:231], v[118:133]
ds_read_u16_d16_hi v116, v116
v_mad_u32_u16 v117, v117, 2, s85 op_sel:[1,0,0,0]
v_pk_add_f16 v85, v69, 1.0 op_sel_hi:[1,0]
v_cvt_pk_f16_f32 v208, v134, v135
v_cvt_pk_f16_f32 v209, v136, v137
v_rcp_f16 v62, v78
v_pk_fma_f16 v70, v208, v208, s84
v_mfma_f32_32x32x16_bf16 v[118:133], a[160:163], a[232:235], v[118:133]
ds_read_u16_d16_hi v117, v117
v_cvt_pk_f16_f32 v210, v138, v139
v_pk_fma_f16 v71, v209, v209, s84
v_pk_mul_f16 v70, v208, v70
v_cvt_pk_f16_f32 v211, v140, v141
v_pk_fma_f16 v72, v210, v210, s84
v_rcp_f16 v63, v79
v_mfma_f32_32x32x16_bf16 v[118:133], a[164:167], a[236:239], v[118:133]
v_pk_mul_f16 v71, v209, v71
v_cvt_pk_f16_f32 v212, v142, v143
v_rcp_f16 v64, v80
v_rcp_f16_sdwa v62, v78 dst_sel:WORD_1 dst_unused:UNUSED_PRESERVE src0_sel:WORD_1
v_rcp_f16 v65, v81
v_pk_mul_f16 v200, v200, v62
v_pk_fma_f16 v73, v211, v211, s84
v_pk_mul_f16 v72, v210, v72
v_rcp_f16_sdwa v63, v79 dst_sel:WORD_1 dst_unused:UNUSED_PRESERVE src0_sel:WORD_1
v_rcp_f16 v66, v82
v_pk_mul_f16 v201, v201, v63
v_cvt_pk_f16_f32 v213, v144, v145
v_pk_fma_f16 v74, v212, v212, s84
v_rcp_f16_sdwa v64, v80 dst_sel:WORD_1 dst_unused:UNUSED_PRESERVE src0_sel:WORD_1
v_rcp_f16 v67, v83
v_pk_mul_f16 v202, v202, v64
v_pk_mul_f16 v73, v211, v73
v_cvt_pk_f16_f32 v214, v146, v147
v_rcp_f16_sdwa v65, v81 dst_sel:WORD_1 dst_unused:UNUSED_PRESERVE src0_sel:WORD_1
v_rcp_f16 v68, v84
v_pk_mul_f16 v203, v203, v65
v_pk_fma_f16 v75, v213, v213, s84
v_pk_mul_f16 v74, v212, v74
v_rcp_f16_sdwa v66, v82 dst_sel:WORD_1 dst_unused:UNUSED_PRESERVE src0_sel:WORD_1
v_rcp_f16 v69, v85
v_pk_mul_f16 v204, v204, v66
v_cvt_pk_f16_f32 v215, v148, v149
v_mfma_f32_32x32x16_bf16 v[134:149], a[216:219], a[168:171], 0
ds_read_b128 a[216:219], v1 offset:55296
v_pk_fma_f16 v76, v214, v214, s84
v_rcp_f16_sdwa v67, v83 dst_sel:WORD_1 dst_unused:UNUSED_PRESERVE src0_sel:WORD_1
v_rcp_f16_sdwa v68, v84 dst_sel:WORD_1 dst_unused:UNUSED_PRESERVE src0_sel:WORD_1
v_pk_mul_f16 v205, v205, v67
v_pk_mul_f16 v75, v213, v75
s_waitcnt lgkmcnt(1)
v_pk_add_f32 v[34:35], v[34:35], v[116:117]
v_pk_add_f32 v[34:35], v[34:35], v[114:115]
v_pk_add_f32 v[34:35], v[34:35], v[112:113]
v_pk_add_f32 v[34:35], v[34:35], v[110:111]
v_pk_add_f32 v[34:35], v[34:35], v[108:109]
v_pk_add_f32 v[34:35], v[34:35], v[106:107]
v_pk_add_f32 v[34:35], v[34:35], v[104:105]
v_pk_add_f32 v[34:35], v[34:35], v[102:103]
v_mfma_f32_32x32x16_f16 v[102:117], v[200:203], a[240:243], 0
v_pk_fma_f16 v77, v215, v215, s84
v_pk_mul_f16 v206, v206, v68
v_pk_mul_f16 v76, v214, v76
v_pk_mul_f16 v77, v215, v77
v_rcp_f16_sdwa v69, v85 dst_sel:WORD_1 dst_unused:UNUSED_PRESERVE src0_sel:WORD_1
v_exp_f16 v62, v70
v_mfma_f32_32x32x16_bf16 v[134:149], a[220:223], a[172:175], v[134:149]
ds_read_b128 a[220:223], v1 offset:56320
v_pk_mul_f16 v207, v207, v69
v_mad_u32_u16 v118, v118, 2, s85 op_sel:[1,0,0,0]
v_exp_f16 v63, v71
v_mad_u32_u16 v119, v119, 2, s85 op_sel:[1,0,0,0]
v_mad_u32_u16 v120, v120, 2, s85 op_sel:[1,0,0,0]
v_mad_u32_u16 v121, v121, 2, s85 op_sel:[1,0,0,0]
v_mfma_f32_32x32x16_f16 v[102:117], v[204:207], a[244:247], v[102:117]
ds_read_u16_d16_hi v118, v118
ds_read_u16_d16_hi v119, v119
ds_read_u16_d16_hi v120, v120
ds_read_u16_d16_hi v121, v121
v_exp_f16 v64, v72
v_mad_u32_u16 v122, v122, 2, s85 op_sel:[1,0,0,0]
v_mad_u32_u16 v123, v123, 2, s85 op_sel:[1,0,0,0]
v_mfma_f32_32x32x16_bf16 v[134:149], a[224:227], a[176:179], v[134:149]
ds_read_b128 a[224:227], v1 offset:57344
ds_read_u16_d16_hi v122, v122
ds_read_u16_d16_hi v123, v123
v_mad_u32_u16 v124, v124, 2, s85 op_sel:[1,0,0,0]
v_exp_f16_sdwa v62, v70 dst_sel:WORD_1 dst_unused:UNUSED_PRESERVE src0_sel:WORD_1
v_mad_u32_u16 v125, v125, 2, s85 op_sel:[1,0,0,0]
v_mad_u32_u16 v126, v126, 2, s85 op_sel:[1,0,0,0]
v_pk_fma_f32 v[32:33], v[102:103], v[102:103], v[32:33]
v_pk_fma_f32 v[32:33], v[104:105], v[104:105], v[32:33]
v_pk_fma_f32 v[32:33], v[106:107], v[106:107], v[32:33]
v_pk_fma_f32 v[32:33], v[108:109], v[108:109], v[32:33]
v_pk_fma_f32 v[32:33], v[110:111], v[110:111], v[32:33]
v_exp_f16 v65, v73
v_pk_fma_f32 v[32:33], v[112:113], v[112:113], v[32:33]
v_pk_fma_f32 v[32:33], v[114:115], v[114:115], v[32:33]
v_pk_fma_f32 v[32:33], v[116:117], v[116:117], v[32:33]
v_mfma_f32_32x32x16_bf16 v[134:149], a[228:231], a[180:183], v[134:149]
ds_read_b128 a[228:231], v1 offset:58368
ds_read_u16_d16_hi v124, v124
ds_read_u16_d16_hi v125, v125
ds_read_u16_d16_hi v126, v126
v_mad_u32_u16 v127, v127, 2, s85 op_sel:[1,0,0,0]
v_pk_add_f16 v70, v62, 1.0 op_sel_hi:[1,0]
v_mad_u32_u16 v128, v128, 2, s85 op_sel:[1,0,0,0]
v_mfma_f32_32x32x16_bf16 v[134:149], a[232:235], a[184:187], v[134:149]
ds_read_b128 a[232:235], v1 offset:59392
ds_read_u16_d16_hi v127, v127
ds_read_u16_d16_hi v128, v128
v_exp_f16_sdwa v63, v71 dst_sel:WORD_1 dst_unused:UNUSED_PRESERVE src0_sel:WORD_1
v_exp_f16 v66, v74
v_pk_add_f16 v71, v63, 1.0 op_sel_hi:[1,0]
v_mfma_f32_32x32x16_bf16 v[134:149], a[236:239], a[188:191], v[134:149]
ds_read_b128 a[236:239], v1 offset:60416
v_mad_u32_u16 v129, v129, 2, s85 op_sel:[1,0,0,0]
v_exp_f16_sdwa v64, v72 dst_sel:WORD_1 dst_unused:UNUSED_PRESERVE src0_sel:WORD_1
v_exp_f16 v67, v75
v_pk_add_f16 v72, v64, 1.0 op_sel_hi:[1,0]
v_mad_u32_u16 v130, v130, 2, s85 op_sel:[1,0,0,0]
v_mfma_f32_32x32x16_bf16 v[102:117], a[144:147], a[192:195], 0
global_load_dword a255, v[158:159], off
ds_read_u16_d16_hi v129, v129
ds_read_u16_d16_hi v130, v130
v_exp_f16_sdwa v65, v73 dst_sel:WORD_1 dst_unused:UNUSED_PRESERVE src0_sel:WORD_1
v_lshl_add_u64 v[158:159], v[158:159], 0, s[42:43]
v_exp_f16 v68, v76
v_mfma_f32_32x32x16_bf16 v[102:117], a[148:151], a[196:199], v[102:117]
v_pk_add_f16 v73, v65, 1.0 op_sel_hi:[1,0]
v_exp_f16_sdwa v66, v74 dst_sel:WORD_1 dst_unused:UNUSED_PRESERVE src0_sel:WORD_1
v_exp_f16 v69, v77
v_pk_add_f16 v74, v66, 1.0 op_sel_hi:[1,0]
v_mad_u32_u16 v131, v131, 2, s85 op_sel:[1,0,0,0]
v_exp_f16_sdwa v67, v75 dst_sel:WORD_1 dst_unused:UNUSED_PRESERVE src0_sel:WORD_1
v_mfma_f32_32x32x16_bf16 v[102:117], a[152:155], a[200:203], v[102:117]
ds_read_u16_d16_hi v131, v131
v_pk_add_f16 v75, v67, 1.0 op_sel_hi:[1,0]
v_mad_u32_u16 v132, v132, 2, s85 op_sel:[1,0,0,0]
v_exp_f16_sdwa v68, v76 dst_sel:WORD_1 dst_unused:UNUSED_PRESERVE src0_sel:WORD_1
v_exp_f16_sdwa v69, v77 dst_sel:WORD_1 dst_unused:UNUSED_PRESERVE src0_sel:WORD_1
v_pk_add_f16 v76, v68, 1.0 op_sel_hi:[1,0]
v_mfma_f32_32x32x16_bf16 v[102:117], a[156:159], a[204:207], v[102:117]
ds_read_u16_d16_hi v132, v132
v_mad_u32_u16 v133, v133, 2, s85 op_sel:[1,0,0,0]
v_pk_add_f16 v77, v69, 1.0 op_sel_hi:[1,0]
v_cvt_pk_f16_f32 v216, v134, v135
v_cvt_pk_f16_f32 v217, v136, v137
v_pk_fma_f16 v78, v216, v216, s84
v_cvt_pk_f16_f32 v218, v138, v139
v_rcp_f16 v62, v70
v_mfma_f32_32x32x16_bf16 v[102:117], a[160:163], a[208:211], v[102:117]
ds_read_u16_d16_hi v133, v133
v_pk_fma_f16 v79, v217, v217, s84
v_pk_mul_f16 v78, v216, v78
v_cvt_pk_f16_f32 v219, v140, v141
v_pk_fma_f16 v80, v218, v218, s84
v_pk_mul_f16 v79, v217, v79
v_rcp_f16 v63, v71
v_mfma_f32_32x32x16_bf16 v[102:117], a[164:167], a[212:215], v[102:117]
v_cvt_pk_f16_f32 v220, v142, v143
v_rcp_f16 v64, v72
v_rcp_f16_sdwa v62, v70 dst_sel:WORD_1 dst_unused:UNUSED_PRESERVE src0_sel:WORD_1
v_rcp_f16 v65, v73
v_pk_mul_f16 v208, v208, v62
v_pk_fma_f16 v81, v219, v219, s84
v_pk_mul_f16 v80, v218, v80
v_rcp_f16_sdwa v63, v71 dst_sel:WORD_1 dst_unused:UNUSED_PRESERVE src0_sel:WORD_1
v_rcp_f16 v66, v74
v_pk_mul_f16 v209, v209, v63
v_cvt_pk_f16_f32 v221, v144, v145
v_pk_fma_f16 v82, v220, v220, s84
v_rcp_f16_sdwa v64, v72 dst_sel:WORD_1 dst_unused:UNUSED_PRESERVE src0_sel:WORD_1
v_rcp_f16 v67, v75
v_pk_mul_f16 v210, v210, v64
v_pk_mul_f16 v81, v219, v81
v_cvt_pk_f16_f32 v222, v146, v147
v_rcp_f16_sdwa v65, v73 dst_sel:WORD_1 dst_unused:UNUSED_PRESERVE src0_sel:WORD_1
v_rcp_f16 v68, v76
v_pk_mul_f16 v211, v211, v65
v_pk_fma_f16 v83, v221, v221, s84
v_pk_mul_f16 v82, v220, v82
v_rcp_f16_sdwa v66, v74 dst_sel:WORD_1 dst_unused:UNUSED_PRESERVE src0_sel:WORD_1
v_rcp_f16 v69, v77
v_pk_mul_f16 v212, v212, v66
v_cvt_pk_f16_f32 v223, v148, v149
v_mfma_f32_32x32x16_bf16 v[134:149], a[192:195], a[168:171], 0
ds_read_b128 a[192:195], v1 offset:61440
v_pk_fma_f16 v84, v222, v222, s84
v_rcp_f16_sdwa v67, v75 dst_sel:WORD_1 dst_unused:UNUSED_PRESERVE src0_sel:WORD_1
v_rcp_f16_sdwa v68, v76 dst_sel:WORD_1 dst_unused:UNUSED_PRESERVE src0_sel:WORD_1
v_pk_mul_f16 v213, v213, v67
v_pk_mul_f16 v83, v221, v83
v_mfma_f32_32x32x16_bf16 v[134:149], a[196:199], a[172:175], v[134:149]
ds_read_b128 a[196:199], v1 offset:62464
v_pk_fma_f16 v85, v223, v223, s84
v_pk_mul_f16 v214, v214, v68
v_pk_mul_f16 v84, v222, v84
v_pk_mul_f16 v85, v223, v85
v_rcp_f16_sdwa v69, v77 dst_sel:WORD_1 dst_unused:UNUSED_PRESERVE src0_sel:WORD_1
s_waitcnt lgkmcnt(1)
v_pk_add_f32 v[36:37], v[36:37], v[132:133]
v_pk_add_f32 v[36:37], v[36:37], v[130:131]
v_pk_add_f32 v[36:37], v[36:37], v[128:129]
v_pk_add_f32 v[36:37], v[36:37], v[126:127]
v_pk_add_f32 v[36:37], v[36:37], v[124:125]
v_exp_f16 v62, v78
v_pk_add_f32 v[36:37], v[36:37], v[122:123]
v_pk_add_f32 v[36:37], v[36:37], v[120:121]
v_pk_add_f32 v[36:37], v[36:37], v[118:119]
v_mfma_f32_32x32x16_f16 v[118:133], v[208:211], a[240:243], 0
v_pk_mul_f16 v215, v215, v69
v_mad_u32_u16 v102, v102, 2, s85 op_sel:[1,0,0,0]
v_mad_u32_u16 v103, v103, 2, s85 op_sel:[1,0,0,0]
v_mad_u32_u16 v104, v104, 2, s85 op_sel:[1,0,0,0]
v_exp_f16 v63, v79
v_mad_u32_u16 v105, v105, 2, s85 op_sel:[1,0,0,0]
v_mad_u32_u16 v106, v106, 2, s85 op_sel:[1,0,0,0]
v_mfma_f32_32x32x16_bf16 v[134:149], a[200:203], a[176:179], v[134:149]
ds_read_b128 a[200:203], v1 offset:63488
ds_read_u16_d16_hi v102, v102
ds_read_u16_d16_hi v103, v103
ds_read_u16_d16_hi v104, v104
v_exp_f16 v64, v80
v_mad_u32_u16 v107, v107, 2, s85 op_sel:[1,0,0,0]
v_mad_u32_u16 v108, v108, 2, s85 op_sel:[1,0,0,0]
v_mfma_f32_32x32x16_f16 v[118:133], v[212:215], a[244:247], v[118:133]
ds_read_u16_d16_hi v105, v105
ds_read_u16_d16_hi v106, v106
ds_read_u16_d16_hi v107, v107
ds_read_u16_d16_hi v108, v108
v_mad_u32_u16 v109, v109, 2, s85 op_sel:[1,0,0,0]
v_mad_u32_u16 v110, v110, 2, s85 op_sel:[1,0,0,0]
v_mad_u32_u16 v111, v111, 2, s85 op_sel:[1,0,0,0]
v_mfma_f32_32x32x16_bf16 v[134:149], a[204:207], a[180:183], v[134:149]
ds_read_b128 a[204:207], v1 offset:64512
ds_read_u16_d16_hi v109, v109
ds_read_u16_d16_hi v110, v110
v_exp_f16_sdwa v62, v78 dst_sel:WORD_1 dst_unused:UNUSED_PRESERVE src0_sel:WORD_1
v_exp_f16 v65, v81
v_pk_add_f16 v78, v62, 1.0 op_sel_hi:[1,0]
v_pk_fma_f32 v[34:35], v[118:119], v[118:119], v[34:35]
v_pk_fma_f32 v[34:35], v[120:121], v[120:121], v[34:35]
v_pk_fma_f32 v[34:35], v[122:123], v[122:123], v[34:35]
v_exp_f16_sdwa v63, v79 dst_sel:WORD_1 dst_unused:UNUSED_PRESERVE src0_sel:WORD_1
v_pk_fma_f32 v[34:35], v[124:125], v[124:125], v[34:35]
v_pk_fma_f32 v[34:35], v[126:127], v[126:127], v[34:35]
v_pk_fma_f32 v[34:35], v[128:129], v[128:129], v[34:35]
v_exp_f16 v66, v82
v_pk_fma_f32 v[34:35], v[130:131], v[130:131], v[34:35]
v_pk_fma_f32 v[34:35], v[132:133], v[132:133], v[34:35]
v_mfma_f32_32x32x16_bf16 v[134:149], a[208:211], a[184:187], v[134:149]
ds_read_b128 a[208:211], v2 offset:0
ds_read_u16_d16_hi v111, v111
v_mad_u32_u16 v112, v112, 2, s85 op_sel:[1,0,0,0]
v_pk_add_f16 v79, v63, 1.0 op_sel_hi:[1,0]
v_mad_u32_u16 v113, v113, 2, s85 op_sel:[1,0,0,0]
v_exp_f16_sdwa v64, v80 dst_sel:WORD_1 dst_unused:UNUSED_PRESERVE src0_sel:WORD_1
v_mfma_f32_32x32x16_bf16 v[134:149], a[212:215], a[188:191], v[134:149]
ds_read_b128 a[212:215], v2 offset:1024
ds_read_u16_d16_hi v112, v112
ds_read_u16_d16_hi v113, v113
v_pk_add_f16 v80, v64, 1.0 op_sel_hi:[1,0]
v_mad_u32_u16 v114, v114, 2, s85 op_sel:[1,0,0,0]
v_exp_f16 v67, v83
v_exp_f16_sdwa v65, v81 dst_sel:WORD_1 dst_unused:UNUSED_PRESERVE src0_sel:WORD_1
v_mfma_f32_32x32x16_bf16 v[118:133], a[144:147], a[216:219], 0
ds_read_u16_d16_hi v114, v114
v_pk_add_f16 v81, v65, 1.0 op_sel_hi:[1,0]
v_exp_f16 v68, v84
v_exp_f16_sdwa v66, v82 dst_sel:WORD_1 dst_unused:UNUSED_PRESERVE src0_sel:WORD_1
v_exp_f16 v69, v85
v_mfma_f32_32x32x16_bf16 v[118:133], a[148:151], a[220:223], v[118:133]
v_pk_add_f16 v82, v66, 1.0 op_sel_hi:[1,0]
v_mad_u32_u16 v115, v115, 2, s85 op_sel:[1,0,0,0]
v_exp_f16_sdwa v67, v83 dst_sel:WORD_1 dst_unused:UNUSED_PRESERVE src0_sel:WORD_1
v_exp_f16_sdwa v68, v84 dst_sel:WORD_1 dst_unused:UNUSED_PRESERVE src0_sel:WORD_1
v_pk_add_f16 v83, v67, 1.0 op_sel_hi:[1,0]
v_mad_u32_u16 v116, v116, 2, s85 op_sel:[1,0,0,0]
v_mfma_f32_32x32x16_bf16 v[118:133], a[152:155], a[224:227], v[118:133]
ds_read_u16_d16_hi v115, v115
ds_read_u16_d16_hi v116, v116
v_pk_add_f16 v84, v68, 1.0 op_sel_hi:[1,0]
v_mad_u32_u16 v117, v117, 2, s85 op_sel:[1,0,0,0]
v_exp_f16_sdwa v69, v85 dst_sel:WORD_1 dst_unused:UNUSED_PRESERVE src0_sel:WORD_1
v_rcp_f16 v62, v78
v_mfma_f32_32x32x16_bf16 v[118:133], a[156:159], a[228:231], v[118:133]
ds_read_u16_d16_hi v117, v117
v_pk_add_f16 v85, v69, 1.0 op_sel_hi:[1,0]
v_cvt_pk_f16_f32 v224, v134, v135
v_cvt_pk_f16_f32 v225, v136, v137
v_rcp_f16 v63, v79
v_pk_fma_f16 v70, v224, v224, s84
v_cvt_pk_f16_f32 v226, v138, v139
v_mfma_f32_32x32x16_bf16 v[118:133], a[160:163], a[232:235], v[118:133]
v_pk_fma_f16 v71, v225, v225, s84
v_pk_mul_f16 v70, v224, v70
v_cvt_pk_f16_f32 v227, v140, v141
v_pk_fma_f16 v72, v226, v226, s84
v_rcp_f16 v64, v80
v_pk_mul_f16 v71, v225, v71
v_cvt_pk_f16_f32 v228, v142, v143
v_mfma_f32_32x32x16_bf16 v[118:133], a[164:167], a[236:239], v[118:133]
v_rcp_f16_sdwa v62, v78 dst_sel:WORD_1 dst_unused:UNUSED_PRESERVE src0_sel:WORD_1
v_rcp_f16 v65, v81
v_pk_mul_f16 v216, v216, v62
v_pk_fma_f16 v73, v227, v227, s84
v_pk_mul_f16 v72, v226, v72
v_rcp_f16_sdwa v63, v79 dst_sel:WORD_1 dst_unused:UNUSED_PRESERVE src0_sel:WORD_1
v_rcp_f16 v66, v82
v_pk_mul_f16 v217, v217, v63
v_cvt_pk_f16_f32 v229, v144, v145
v_pk_fma_f16 v74, v228, v228, s84
v_rcp_f16_sdwa v64, v80 dst_sel:WORD_1 dst_unused:UNUSED_PRESERVE src0_sel:WORD_1
v_rcp_f16 v67, v83
v_pk_mul_f16 v218, v218, v64
v_pk_mul_f16 v73, v227, v73
v_cvt_pk_f16_f32 v230, v146, v147
v_rcp_f16_sdwa v65, v81 dst_sel:WORD_1 dst_unused:UNUSED_PRESERVE src0_sel:WORD_1
v_rcp_f16 v68, v84
v_pk_mul_f16 v219, v219, v65
v_pk_fma_f16 v75, v229, v229, s84
v_pk_mul_f16 v74, v228, v74
v_rcp_f16_sdwa v66, v82 dst_sel:WORD_1 dst_unused:UNUSED_PRESERVE src0_sel:WORD_1
v_rcp_f16 v69, v85
v_pk_mul_f16 v220, v220, v66
v_cvt_pk_f16_f32 v231, v148, v149
v_mfma_f32_32x32x16_bf16 v[134:149], a[216:219], a[168:171], 0
ds_read_b128 a[216:219], v2 offset:2048
v_pk_fma_f16 v76, v230, v230, s84
v_rcp_f16_sdwa v67, v83 dst_sel:WORD_1 dst_unused:UNUSED_PRESERVE src0_sel:WORD_1
v_rcp_f16_sdwa v68, v84 dst_sel:WORD_1 dst_unused:UNUSED_PRESERVE src0_sel:WORD_1
v_pk_mul_f16 v221, v221, v67
v_pk_mul_f16 v75, v229, v75
v_mfma_f32_32x32x16_bf16 v[134:149], a[220:223], a[172:175], v[134:149]
ds_read_b128 a[220:223], v2 offset:3072
v_pk_fma_f16 v77, v231, v231, s84
v_pk_mul_f16 v222, v222, v68
v_rcp_f16_sdwa v69, v85 dst_sel:WORD_1 dst_unused:UNUSED_PRESERVE src0_sel:WORD_1
v_pk_mul_f16 v76, v230, v76
v_pk_mul_f16 v77, v231, v77
v_pk_mul_f16 v223, v223, v69
v_exp_f16 v62, v70
s_waitcnt lgkmcnt(1)
v_pk_add_f32 v[38:39], v[38:39], v[116:117]
v_pk_add_f32 v[38:39], v[38:39], v[114:115]
v_pk_add_f32 v[38:39], v[38:39], v[112:113]
v_exp_f16 v63, v71
v_pk_add_f32 v[38:39], v[38:39], v[110:111]
v_pk_add_f32 v[38:39], v[38:39], v[108:109]
v_pk_add_f32 v[38:39], v[38:39], v[106:107]
v_pk_add_f32 v[38:39], v[38:39], v[104:105]
v_exp_f16 v64, v72
v_pk_add_f32 v[38:39], v[38:39], v[102:103]
v_mfma_f32_32x32x16_f16 v[102:117], v[216:219], a[240:243], 0
v_mad_u32_u16 v118, v118, 2, s85 op_sel:[1,0,0,0]
v_mad_u32_u16 v119, v119, 2, s85 op_sel:[1,0,0,0]
v_mad_u32_u16 v120, v120, 2, s85 op_sel:[1,0,0,0]
v_mad_u32_u16 v121, v121, 2, s85 op_sel:[1,0,0,0]
v_mad_u32_u16 v122, v122, 2, s85 op_sel:[1,0,0,0]
v_exp_f16_sdwa v62, v70 dst_sel:WORD_1 dst_unused:UNUSED_PRESERVE src0_sel:WORD_1
v_mad_u32_u16 v123, v123, 2, s85 op_sel:[1,0,0,0]
v_mfma_f32_32x32x16_bf16 v[134:149], a[224:227], a[176:179], v[134:149]
ds_read_b128 a[224:227], v2 offset:4096
ds_read_u16_d16_hi v118, v118
ds_read_u16_d16_hi v119, v119
ds_read_u16_d16_hi v120, v120
v_mad_u32_u16 v124, v124, 2, s85 op_sel:[1,0,0,0]
v_exp_f16 v65, v73
v_mad_u32_u16 v125, v125, 2, s85 op_sel:[1,0,0,0]
v_mfma_f32_32x32x16_f16 v[102:117], v[220:223], a[244:247], v[102:117]
ds_read_u16_d16_hi v121, v121
ds_read_u16_d16_hi v122, v122
ds_read_u16_d16_hi v123, v123
ds_read_u16_d16_hi v124, v124
v_mad_u32_u16 v126, v126, 2, s85 op_sel:[1,0,0,0]
v_mad_u32_u16 v127, v127, 2, s85 op_sel:[1,0,0,0]
v_pk_add_f16 v70, v62, 1.0 op_sel_hi:[1,0]
v_mfma_f32_32x32x16_bf16 v[134:149], a[228:231], a[180:183], v[134:149]
ds_read_b128 a[228:231], v2 offset:5120
ds_read_u16_d16_hi v125, v125
ds_read_u16_d16_hi v126, v126
v_mad_u32_u16 v128, v128, 2, s85 op_sel:[1,0,0,0]
v_exp_f16_sdwa v63, v71 dst_sel:WORD_1 dst_unused:UNUSED_PRESERVE src0_sel:WORD_1
v_exp_f16 v66, v74
v_pk_fma_f32 v[36:37], v[102:103], v[102:103], v[36:37]
v_pk_fma_f32 v[36:37], v[104:105], v[104:105], v[36:37]
v_pk_fma_f32 v[36:37], v[106:107], v[106:107], v[36:37]
v_pk_fma_f32 v[36:37], v[108:109], v[108:109], v[36:37]
v_exp_f16_sdwa v64, v72 dst_sel:WORD_1 dst_unused:UNUSED_PRESERVE src0_sel:WORD_1
v_pk_fma_f32 v[36:37], v[110:111], v[110:111], v[36:37]
v_pk_fma_f32 v[36:37], v[112:113], v[112:113], v[36:37]
v_pk_fma_f32 v[36:37], v[114:115], v[114:115], v[36:37]
v_exp_f16 v67, v75
v_pk_fma_f32 v[36:37], v[116:117], v[116:117], v[36:37]
v_mfma_f32_32x32x16_bf16 v[134:149], a[232:235], a[184:187], v[134:149]
ds_read_b128 a[232:235], v3 offset:26368
ds_read_u16_d16_hi v127, v127
ds_read_u16_d16_hi v128, v128
v_pk_add_f16 v71, v63, 1.0 op_sel_hi:[1,0]
v_mad_u32_u16 v129, v129, 2, s85 op_sel:[1,0,0,0]
v_pk_add_f16 v72, v64, 1.0 op_sel_hi:[1,0]
v_mad_u32_u16 v130, v130, 2, s85 op_sel:[1,0,0,0]
v_mfma_f32_32x32x16_bf16 v[134:149], a[236:239], a[188:191], v[134:149]
ds_read_b128 a[236:239], v3 offset:27392
ds_read_u16_d16_hi v129, v129
v_exp_f16_sdwa v65, v73 dst_sel:WORD_1 dst_unused:UNUSED_PRESERVE src0_sel:WORD_1
v_exp_f16 v68, v76
v_pk_add_f16 v73, v65, 1.0 op_sel_hi:[1,0]
v_exp_f16_sdwa v66, v74 dst_sel:WORD_1 dst_unused:UNUSED_PRESERVE src0_sel:WORD_1
v_mfma_f32_32x32x16_bf16 v[102:117], a[144:147], a[192:195], 0
ds_read_u16_d16_hi v130, v130
v_pk_add_f16 v74, v66, 1.0 op_sel_hi:[1,0]
v_mad_u32_u16 v131, v131, 2, s85 op_sel:[1,0,0,0]
v_exp_f16 v69, v77
v_exp_f16_sdwa v67, v75 dst_sel:WORD_1 dst_unused:UNUSED_PRESERVE src0_sel:WORD_1
v_exp_f16_sdwa v68, v76 dst_sel:WORD_1 dst_unused:UNUSED_PRESERVE src0_sel:WORD_1
v_mfma_f32_32x32x16_bf16 v[102:117], a[148:151], a[196:199], v[102:117]
ds_read_u16_d16_hi v131, v131
v_pk_add_f16 v75, v67, 1.0 op_sel_hi:[1,0]
v_mad_u32_u16 v132, v132, 2, s85 op_sel:[1,0,0,0]
v_pk_add_f16 v76, v68, 1.0 op_sel_hi:[1,0]
v_mad_u32_u16 v133, v133, 2, s85 op_sel:[1,0,0,0]
v_exp_f16_sdwa v69, v77 dst_sel:WORD_1 dst_unused:UNUSED_PRESERVE src0_sel:WORD_1
v_mfma_f32_32x32x16_bf16 v[102:117], a[152:155], a[200:203], v[102:117]
ds_read_u16_d16_hi v132, v132
ds_read_u16_d16_hi v133, v133
v_pk_add_f16 v77, v69, 1.0 op_sel_hi:[1,0]
v_cvt_pk_f16_f32 v232, v134, v135
v_cvt_pk_f16_f32 v233, v136, v137
v_pk_fma_f16 v78, v232, v232, s84
v_rcp_f16 v62, v70
v_mfma_f32_32x32x16_bf16 v[102:117], a[156:159], a[204:207], v[102:117]
v_cvt_pk_f16_f32 v234, v138, v139
v_pk_fma_f16 v79, v233, v233, s84
v_pk_mul_f16 v78, v232, v78
v_cvt_pk_f16_f32 v235, v140, v141
v_pk_fma_f16 v80, v234, v234, s84
v_pk_mul_f16 v79, v233, v79
v_rcp_f16 v63, v71
v_mfma_f32_32x32x16_bf16 v[102:117], a[160:163], a[208:211], v[102:117]
v_cvt_pk_f16_f32 v236, v142, v143
v_rcp_f16 v64, v72
v_rcp_f16_sdwa v62, v70 dst_sel:WORD_1 dst_unused:UNUSED_PRESERVE src0_sel:WORD_1
v_rcp_f16 v65, v73
v_pk_mul_f16 v224, v224, v62
v_mfma_f32_32x32x16_bf16 v[102:117], a[164:167], a[212:215], v[102:117]
v_pk_fma_f16 v81, v235, v235, s84
v_pk_mul_f16 v80, v234, v80
v_rcp_f16_sdwa v63, v71 dst_sel:WORD_1 dst_unused:UNUSED_PRESERVE src0_sel:WORD_1
v_rcp_f16 v66, v74
v_pk_mul_f16 v225, v225, v63
v_cvt_pk_f16_f32 v237, v144, v145
v_pk_fma_f16 v82, v236, v236, s84
v_rcp_f16_sdwa v64, v72 dst_sel:WORD_1 dst_unused:UNUSED_PRESERVE src0_sel:WORD_1
v_rcp_f16 v67, v75
v_pk_mul_f16 v226, v226, v64
v_pk_mul_f16 v81, v235, v81
v_cvt_pk_f16_f32 v238, v146, v147
v_rcp_f16_sdwa v65, v73 dst_sel:WORD_1 dst_unused:UNUSED_PRESERVE src0_sel:WORD_1
v_rcp_f16 v68, v76
v_pk_mul_f16 v227, v227, v65
v_pk_fma_f16 v83, v237, v237, s84
v_pk_mul_f16 v82, v236, v82
v_rcp_f16_sdwa v66, v74 dst_sel:WORD_1 dst_unused:UNUSED_PRESERVE src0_sel:WORD_1
v_rcp_f16 v69, v77
v_pk_mul_f16 v228, v228, v66
v_cvt_pk_f16_f32 v239, v148, v149
v_mfma_f32_32x32x16_bf16 v[134:149], a[192:195], a[168:171], 0
v_pk_fma_f16 v84, v238, v238, s84
v_rcp_f16_sdwa v67, v75 dst_sel:WORD_1 dst_unused:UNUSED_PRESERVE src0_sel:WORD_1
v_rcp_f16_sdwa v68, v76 dst_sel:WORD_1 dst_unused:UNUSED_PRESERVE src0_sel:WORD_1
v_pk_mul_f16 v229, v229, v67
v_pk_mul_f16 v83, v237, v83
v_pk_fma_f16 v85, v239, v239, s84
v_mfma_f32_32x32x16_bf16 v[134:149], a[196:199], a[172:175], v[134:149]
v_pk_mul_f16 v230, v230, v68
v_pk_mul_f16 v84, v238, v84
v_pk_mul_f16 v85, v239, v85
v_rcp_f16_sdwa v69, v77 dst_sel:WORD_1 dst_unused:UNUSED_PRESERVE src0_sel:WORD_1
v_exp_f16 v62, v78
v_pk_mul_f16 v231, v231, v69
s_waitcnt lgkmcnt(0)
v_pk_add_f32 v[40:41], v[40:41], v[132:133]
v_pk_add_f32 v[40:41], v[40:41], v[130:131]
v_pk_add_f32 v[40:41], v[40:41], v[128:129]
v_pk_add_f32 v[40:41], v[40:41], v[126:127]
v_pk_add_f32 v[40:41], v[40:41], v[124:125]
v_exp_f16 v63, v79
v_pk_add_f32 v[40:41], v[40:41], v[122:123]
v_pk_add_f32 v[40:41], v[40:41], v[120:121]
v_pk_add_f32 v[40:41], v[40:41], v[118:119]
v_mfma_f32_32x32x16_f16 v[118:133], v[224:227], a[240:243], 0
v_mad_u32_u16 v102, v102, 2, s85 op_sel:[1,0,0,0]
v_mad_u32_u16 v103, v103, 2, s85 op_sel:[1,0,0,0]
v_mad_u32_u16 v104, v104, 2, s85 op_sel:[1,0,0,0]
v_exp_f16 v64, v80
v_mad_u32_u16 v105, v105, 2, s85 op_sel:[1,0,0,0]
v_mad_u32_u16 v106, v106, 2, s85 op_sel:[1,0,0,0]
v_mad_u32_u16 v107, v107, 2, s85 op_sel:[1,0,0,0]
v_mfma_f32_32x32x16_bf16 v[134:149], a[200:203], a[176:179], v[134:149]
ds_read_u16_d16_hi v102, v102
ds_read_u16_d16_hi v103, v103
ds_read_u16_d16_hi v104, v104
ds_read_u16_d16_hi v105, v105
v_mad_u32_u16 v108, v108, 2, s85 op_sel:[1,0,0,0]
v_mad_u32_u16 v109, v109, 2, s85 op_sel:[1,0,0,0]
v_mad_u32_u16 v110, v110, 2, s85 op_sel:[1,0,0,0]
v_mfma_f32_32x32x16_f16 v[118:133], v[228:231], a[244:247], v[118:133]
ds_read_u16_d16_hi v106, v106
ds_read_u16_d16_hi v107, v107
ds_read_u16_d16_hi v108, v108
ds_read_u16_d16_hi v109, v109
v_mad_u32_u16 v111, v111, 2, s85 op_sel:[1,0,0,0]
v_exp_f16_sdwa v62, v78 dst_sel:WORD_1 dst_unused:UNUSED_PRESERVE src0_sel:WORD_1
v_mfma_f32_32x32x16_bf16 v[134:149], a[204:207], a[180:183], v[134:149]
ds_read_u16_d16_hi v110, v110
ds_read_u16_d16_hi v111, v111
v_pk_add_f16 v78, v62, 1.0 op_sel_hi:[1,0]
v_mad_u32_u16 v112, v112, 2, s85 op_sel:[1,0,0,0]
v_exp_f16 v65, v81
v_exp_f16_sdwa v63, v79 dst_sel:WORD_1 dst_unused:UNUSED_PRESERVE src0_sel:WORD_1
v_pk_fma_f32 v[38:39], v[118:119], v[118:119], v[38:39]
v_pk_fma_f32 v[38:39], v[120:121], v[120:121], v[38:39]
v_pk_fma_f32 v[38:39], v[122:123], v[122:123], v[38:39]
v_exp_f16 v66, v82
v_pk_fma_f32 v[38:39], v[124:125], v[124:125], v[38:39]
v_pk_fma_f32 v[38:39], v[126:127], v[126:127], v[38:39]
v_pk_fma_f32 v[38:39], v[128:129], v[128:129], v[38:39]
v_pk_fma_f32 v[38:39], v[130:131], v[130:131], v[38:39]
v_pk_fma_f32 v[38:39], v[132:133], v[132:133], v[38:39]
v_mfma_f32_32x32x16_bf16 v[134:149], a[208:211], a[184:187], v[134:149]
ds_read_u16_d16_hi v112, v112
v_pk_add_f16 v79, v63, 1.0 op_sel_hi:[1,0]
v_mad_u32_u16 v113, v113, 2, s85 op_sel:[1,0,0,0]
v_exp_f16_sdwa v64, v80 dst_sel:WORD_1 dst_unused:UNUSED_PRESERVE src0_sel:WORD_1
v_exp_f16 v67, v83
v_pk_add_f16 v80, v64, 1.0 op_sel_hi:[1,0]
v_mfma_f32_32x32x16_bf16 v[134:149], a[212:215], a[188:191], v[134:149]
ds_read_u16_d16_hi v113, v113
v_mad_u32_u16 v114, v114, 2, s85 op_sel:[1,0,0,0]
v_exp_f16_sdwa v65, v81 dst_sel:WORD_1 dst_unused:UNUSED_PRESERVE src0_sel:WORD_1
v_exp_f16 v68, v84
v_pk_add_f16 v81, v65, 1.0 op_sel_hi:[1,0]
v_exp_f16_sdwa v66, v82 dst_sel:WORD_1 dst_unused:UNUSED_PRESERVE src0_sel:WORD_1
v_mfma_f32_32x32x16_bf16 v[118:133], a[144:147], a[216:219], 0
ds_read_u16_d16_hi v114, v114
v_pk_add_f16 v82, v66, 1.0 op_sel_hi:[1,0]
v_mad_u32_u16 v115, v115, 2, s85 op_sel:[1,0,0,0]
v_exp_f16 v69, v85
v_exp_f16_sdwa v67, v83 dst_sel:WORD_1 dst_unused:UNUSED_PRESERVE src0_sel:WORD_1
v_exp_f16_sdwa v68, v84 dst_sel:WORD_1 dst_unused:UNUSED_PRESERVE src0_sel:WORD_1
v_mfma_f32_32x32x16_bf16 v[118:133], a[148:151], a[220:223], v[118:133]
ds_read_u16_d16_hi v115, v115
v_pk_add_f16 v83, v67, 1.0 op_sel_hi:[1,0]
v_mad_u32_u16 v116, v116, 2, s85 op_sel:[1,0,0,0]
v_pk_add_f16 v84, v68, 1.0 op_sel_hi:[1,0]
v_mad_u32_u16 v117, v117, 2, s85 op_sel:[1,0,0,0]
v_exp_f16_sdwa v69, v85 dst_sel:WORD_1 dst_unused:UNUSED_PRESERVE src0_sel:WORD_1
v_rcp_f16 v62, v78
v_mfma_f32_32x32x16_bf16 v[118:133], a[152:155], a[224:227], v[118:133]
ds_read_u16_d16_hi v116, v116
ds_read_u16_d16_hi v117, v117
v_pk_add_f16 v85, v69, 1.0 op_sel_hi:[1,0]
v_cvt_pk_f16_f32 v240, v134, v135
v_cvt_pk_f16_f32 v241, v136, v137
v_pk_fma_f16 v70, v240, v240, s84
v_cvt_pk_f16_f32 v242, v138, v139
v_rcp_f16 v63, v79
v_mfma_f32_32x32x16_bf16 v[118:133], a[156:159], a[228:231], v[118:133]
v_pk_fma_f16 v71, v241, v241, s84
v_pk_mul_f16 v70, v240, v70
v_cvt_pk_f16_f32 v243, v140, v141
v_pk_fma_f16 v72, v242, v242, s84
v_pk_mul_f16 v71, v241, v71
v_cvt_pk_f16_f32 v244, v142, v143
v_rcp_f16 v64, v80
v_mfma_f32_32x32x16_bf16 v[118:133], a[160:163], a[232:235], v[118:133]
v_rcp_f16_sdwa v62, v78 dst_sel:WORD_1 dst_unused:UNUSED_PRESERVE src0_sel:WORD_1
v_rcp_f16 v65, v81
v_pk_mul_f16 v232, v232, v62
v_pk_fma_f16 v73, v243, v243, s84
v_pk_mul_f16 v72, v242, v72
v_rcp_f16_sdwa v63, v79 dst_sel:WORD_1 dst_unused:UNUSED_PRESERVE src0_sel:WORD_1
v_mfma_f32_32x32x16_bf16 v[118:133], a[164:167], a[236:239], v[118:133]
v_pk_mul_f16 v233, v233, v63
v_cvt_pk_f16_f32 v245, v144, v145
v_pk_fma_f16 v74, v244, v244, s84
v_rcp_f16 v66, v82
v_rcp_f16_sdwa v64, v80 dst_sel:WORD_1 dst_unused:UNUSED_PRESERVE src0_sel:WORD_1
v_rcp_f16 v67, v83
v_pk_mul_f16 v234, v234, v64
v_pk_mul_f16 v73, v243, v73
v_cvt_pk_f16_f32 v246, v146, v147
v_rcp_f16_sdwa v65, v81 dst_sel:WORD_1 dst_unused:UNUSED_PRESERVE src0_sel:WORD_1
v_rcp_f16 v68, v84
v_pk_mul_f16 v235, v235, v65
v_pk_fma_f16 v75, v245, v245, s84
v_pk_mul_f16 v74, v244, v74
v_rcp_f16_sdwa v66, v82 dst_sel:WORD_1 dst_unused:UNUSED_PRESERVE src0_sel:WORD_1
v_rcp_f16 v69, v85
v_pk_mul_f16 v236, v236, v66
v_cvt_pk_f16_f32 v247, v148, v149
v_mfma_f32_32x32x16_bf16 v[134:149], a[216:219], a[168:171], 0
v_pk_fma_f16 v76, v246, v246, s84
v_rcp_f16_sdwa v67, v83 dst_sel:WORD_1 dst_unused:UNUSED_PRESERVE src0_sel:WORD_1
v_rcp_f16_sdwa v68, v84 dst_sel:WORD_1 dst_unused:UNUSED_PRESERVE src0_sel:WORD_1
v_pk_mul_f16 v237, v237, v67
v_pk_mul_f16 v75, v245, v75
v_pk_fma_f16 v77, v247, v247, s84
s_waitcnt lgkmcnt(0)
v_pk_add_f32 v[42:43], v[42:43], v[116:117]
v_pk_add_f32 v[42:43], v[42:43], v[114:115]
v_pk_add_f32 v[42:43], v[42:43], v[112:113]
v_pk_add_f32 v[42:43], v[42:43], v[110:111]
v_pk_add_f32 v[42:43], v[42:43], v[108:109]
v_pk_add_f32 v[42:43], v[42:43], v[106:107]
v_pk_add_f32 v[42:43], v[42:43], v[104:105]
v_pk_add_f32 v[42:43], v[42:43], v[102:103]
v_mfma_f32_32x32x16_f16 v[102:117], v[232:235], a[240:243], 0
v_pk_mul_f16 v238, v238, v68
v_pk_mul_f16 v76, v246, v76
v_pk_mul_f16 v77, v247, v77
v_rcp_f16_sdwa v69, v85 dst_sel:WORD_1 dst_unused:UNUSED_PRESERVE src0_sel:WORD_1
v_exp_f16 v62, v70
v_pk_mul_f16 v239, v239, v69
v_mfma_f32_32x32x16_bf16 v[134:149], a[220:223], a[172:175], v[134:149]
v_mad_u32_u16 v118, v118, 2, s85 op_sel:[1,0,0,0]
v_mad_u32_u16 v119, v119, 2, s85 op_sel:[1,0,0,0]
v_mad_u32_u16 v120, v120, 2, s85 op_sel:[1,0,0,0]
v_mad_u32_u16 v121, v121, 2, s85 op_sel:[1,0,0,0]
v_mad_u32_u16 v122, v122, 2, s85 op_sel:[1,0,0,0]
v_exp_f16 v63, v71
v_mad_u32_u16 v123, v123, 2, s85 op_sel:[1,0,0,0]
v_mfma_f32_32x32x16_f16 v[102:117], v[236:239], a[244:247], v[102:117]
ds_read_u16_d16_hi v118, v118
ds_read_u16_d16_hi v119, v119
ds_read_u16_d16_hi v120, v120
ds_read_u16_d16_hi v121, v121
v_mad_u32_u16 v124, v124, 2, s85 op_sel:[1,0,0,0]
v_mad_u32_u16 v125, v125, 2, s85 op_sel:[1,0,0,0]
v_exp_f16 v64, v72
v_mfma_f32_32x32x16_bf16 v[134:149], a[224:227], a[176:179], v[134:149]
ds_read_u16_d16_hi v122, v122
ds_read_u16_d16_hi v123, v123
ds_read_u16_d16_hi v124, v124
ds_read_u16_d16_hi v125, v125
v_mad_u32_u16 v126, v126, 2, s85 op_sel:[1,0,0,0]
v_mad_u32_u16 v127, v127, 2, s85 op_sel:[1,0,0,0]
v_exp_f16_sdwa v62, v70 dst_sel:WORD_1 dst_unused:UNUSED_PRESERVE src0_sel:WORD_1
v_pk_fma_f32 v[40:41], v[102:103], v[102:103], v[40:41]
v_pk_fma_f32 v[40:41], v[104:105], v[104:105], v[40:41]
v_pk_fma_f32 v[40:41], v[106:107], v[106:107], v[40:41]
v_exp_f16 v65, v73
v_pk_fma_f32 v[40:41], v[108:109], v[108:109], v[40:41]
v_pk_fma_f32 v[40:41], v[110:111], v[110:111], v[40:41]
v_pk_fma_f32 v[40:41], v[112:113], v[112:113], v[40:41]
v_pk_fma_f32 v[40:41], v[114:115], v[114:115], v[40:41]
v_pk_fma_f32 v[40:41], v[116:117], v[116:117], v[40:41]
v_mfma_f32_32x32x16_bf16 v[134:149], a[228:231], a[180:183], v[134:149]
ds_read_u16_d16_hi v126, v126
ds_read_u16_d16_hi v127, v127
v_pk_add_f16 v70, v62, 1.0 op_sel_hi:[1,0]
v_mad_u32_u16 v128, v128, 2, s85 op_sel:[1,0,0,0]
v_exp_f16_sdwa v63, v71 dst_sel:WORD_1 dst_unused:UNUSED_PRESERVE src0_sel:WORD_1
v_exp_f16 v66, v74
v_mfma_f32_32x32x16_bf16 v[134:149], a[232:235], a[184:187], v[134:149]
ds_read_u16_d16_hi v128, v128
v_pk_add_f16 v71, v63, 1.0 op_sel_hi:[1,0]
v_mad_u32_u16 v129, v129, 2, s85 op_sel:[1,0,0,0]
v_exp_f16_sdwa v64, v72 dst_sel:WORD_1 dst_unused:UNUSED_PRESERVE src0_sel:WORD_1
v_exp_f16 v67, v75
v_pk_add_f16 v72, v64, 1.0 op_sel_hi:[1,0]
v_mfma_f32_32x32x16_bf16 v[134:149], a[236:239], a[188:191], v[134:149]
ds_read_u16_d16_hi v129, v129
v_mad_u32_u16 v130, v130, 2, s85 op_sel:[1,0,0,0]
v_exp_f16_sdwa v65, v73 dst_sel:WORD_1 dst_unused:UNUSED_PRESERVE src0_sel:WORD_1
v_exp_f16 v68, v76
v_pk_add_f16 v73, v65, 1.0 op_sel_hi:[1,0]
v_exp_f16_sdwa v66, v74 dst_sel:WORD_1 dst_unused:UNUSED_PRESERVE src0_sel:WORD_1
v_exp_f16 v69, v77
v_pk_add_f16 v74, v66, 1.0 op_sel_hi:[1,0]
v_mad_u32_u16 v131, v131, 2, s85 op_sel:[1,0,0,0]
v_exp_f16_sdwa v67, v75 dst_sel:WORD_1 dst_unused:UNUSED_PRESERVE src0_sel:WORD_1
v_exp_f16_sdwa v68, v76 dst_sel:WORD_1 dst_unused:UNUSED_PRESERVE src0_sel:WORD_1
v_pk_add_f16 v75, v67, 1.0 op_sel_hi:[1,0]
v_mad_u32_u16 v132, v132, 2, s85 op_sel:[1,0,0,0]
v_pk_add_f16 v76, v68, 1.0 op_sel_hi:[1,0]
v_mad_u32_u16 v133, v133, 2, s85 op_sel:[1,0,0,0]
v_exp_f16_sdwa v69, v77 dst_sel:WORD_1 dst_unused:UNUSED_PRESERVE src0_sel:WORD_1
v_rcp_f16 v62, v70
v_pk_add_f16 v77, v69, 1.0 op_sel_hi:[1,0]
v_cvt_pk_f16_f32 v248, v134, v135
v_cvt_pk_f16_f32 v249, v136, v137
v_pk_fma_f16 v78, v248, v248, s84
v_cvt_pk_f16_f32 v250, v138, v139
v_rcp_f16 v63, v71
v_pk_fma_f16 v79, v249, v249, s84
v_pk_mul_f16 v78, v248, v78
v_cvt_pk_f16_f32 v251, v140, v141
v_pk_fma_f16 v80, v250, v250, s84
v_rcp_f16 v64, v72
v_pk_mul_f16 v79, v249, v79
v_cvt_pk_f16_f32 v252, v142, v143
v_rcp_f16_sdwa v62, v70 dst_sel:WORD_1 dst_unused:UNUSED_PRESERVE src0_sel:WORD_1
v_rcp_f16 v65, v73
v_pk_mul_f16 v240, v240, v62
v_pk_fma_f16 v81, v251, v251, s84
v_pk_mul_f16 v80, v250, v80
v_rcp_f16_sdwa v63, v71 dst_sel:WORD_1 dst_unused:UNUSED_PRESERVE src0_sel:WORD_1
v_rcp_f16 v66, v74
v_pk_mul_f16 v241, v241, v63
v_cvt_pk_f16_f32 v253, v144, v145
v_pk_fma_f16 v82, v252, v252, s84
v_rcp_f16_sdwa v64, v72 dst_sel:WORD_1 dst_unused:UNUSED_PRESERVE src0_sel:WORD_1
v_rcp_f16 v67, v75
v_pk_mul_f16 v242, v242, v64
v_pk_mul_f16 v81, v251, v81
v_cvt_pk_f16_f32 v254, v146, v147
v_rcp_f16_sdwa v65, v73 dst_sel:WORD_1 dst_unused:UNUSED_PRESERVE src0_sel:WORD_1
v_rcp_f16 v68, v76
v_pk_mul_f16 v243, v243, v65
v_pk_fma_f16 v83, v253, v253, s84
v_pk_mul_f16 v82, v252, v82
v_rcp_f16_sdwa v66, v74 dst_sel:WORD_1 dst_unused:UNUSED_PRESERVE src0_sel:WORD_1
v_rcp_f16 v69, v77
v_pk_mul_f16 v244, v244, v66
v_cvt_pk_f16_f32 v255, v148, v149
v_pk_fma_f16 v84, v254, v254, s84
v_rcp_f16_sdwa v67, v75 dst_sel:WORD_1 dst_unused:UNUSED_PRESERVE src0_sel:WORD_1
v_rcp_f16_sdwa v68, v76 dst_sel:WORD_1 dst_unused:UNUSED_PRESERVE src0_sel:WORD_1
v_pk_mul_f16 v245, v245, v67
v_pk_mul_f16 v83, v253, v83
v_pk_fma_f16 v85, v255, v255, s84
v_pk_mul_f16 v246, v246, v68
v_pk_mul_f16 v84, v254, v84
v_pk_mul_f16 v85, v255, v85
v_rcp_f16_sdwa v69, v77 dst_sel:WORD_1 dst_unused:UNUSED_PRESERVE src0_sel:WORD_1
v_exp_f16 v62, v78
v_pk_mul_f16 v247, v247, v69
v_exp_f16 v63, v79
v_exp_f16 v64, v80
v_exp_f16_sdwa v62, v78 dst_sel:WORD_1 dst_unused:UNUSED_PRESERVE src0_sel:WORD_1
v_exp_f16 v65, v81
v_pk_add_f16 v78, v62, 1.0 op_sel_hi:[1,0]
v_exp_f16_sdwa v63, v79 dst_sel:WORD_1 dst_unused:UNUSED_PRESERVE src0_sel:WORD_1
v_exp_f16 v66, v82
v_pk_add_f16 v79, v63, 1.0 op_sel_hi:[1,0]
v_exp_f16_sdwa v64, v80 dst_sel:WORD_1 dst_unused:UNUSED_PRESERVE src0_sel:WORD_1
v_exp_f16 v67, v83
v_pk_add_f16 v80, v64, 1.0 op_sel_hi:[1,0]
v_exp_f16_sdwa v65, v81 dst_sel:WORD_1 dst_unused:UNUSED_PRESERVE src0_sel:WORD_1
v_exp_f16 v68, v84
v_pk_add_f16 v81, v65, 1.0 op_sel_hi:[1,0]
v_exp_f16_sdwa v66, v82 dst_sel:WORD_1 dst_unused:UNUSED_PRESERVE src0_sel:WORD_1
v_exp_f16 v69, v85
v_pk_add_f16 v82, v66, 1.0 op_sel_hi:[1,0]
v_exp_f16_sdwa v67, v83 dst_sel:WORD_1 dst_unused:UNUSED_PRESERVE src0_sel:WORD_1
v_exp_f16_sdwa v68, v84 dst_sel:WORD_1 dst_unused:UNUSED_PRESERVE src0_sel:WORD_1
v_pk_add_f16 v83, v67, 1.0 op_sel_hi:[1,0]
v_pk_add_f16 v84, v68, 1.0 op_sel_hi:[1,0]
v_exp_f16_sdwa v69, v85 dst_sel:WORD_1 dst_unused:UNUSED_PRESERVE src0_sel:WORD_1
v_rcp_f16 v62, v78
v_pk_add_f16 v85, v69, 1.0 op_sel_hi:[1,0]
v_rcp_f16 v63, v79
v_rcp_f16 v64, v80
v_rcp_f16_sdwa v62, v78 dst_sel:WORD_1 dst_unused:UNUSED_PRESERVE src0_sel:WORD_1
v_rcp_f16 v65, v81
v_pk_mul_f16 v248, v248, v62
v_rcp_f16_sdwa v63, v79 dst_sel:WORD_1 dst_unused:UNUSED_PRESERVE src0_sel:WORD_1
v_rcp_f16 v66, v82
v_pk_mul_f16 v249, v249, v63
v_rcp_f16_sdwa v64, v80 dst_sel:WORD_1 dst_unused:UNUSED_PRESERVE src0_sel:WORD_1
v_rcp_f16 v67, v83
v_pk_mul_f16 v250, v250, v64
v_rcp_f16_sdwa v65, v81 dst_sel:WORD_1 dst_unused:UNUSED_PRESERVE src0_sel:WORD_1
v_rcp_f16 v68, v84
v_pk_mul_f16 v251, v251, v65
v_rcp_f16_sdwa v66, v82 dst_sel:WORD_1 dst_unused:UNUSED_PRESERVE src0_sel:WORD_1
v_rcp_f16 v69, v85
v_pk_mul_f16 v252, v252, v66
v_rcp_f16_sdwa v67, v83 dst_sel:WORD_1 dst_unused:UNUSED_PRESERVE src0_sel:WORD_1
v_rcp_f16_sdwa v68, v84 dst_sel:WORD_1 dst_unused:UNUSED_PRESERVE src0_sel:WORD_1
v_pk_mul_f16 v253, v253, v67
v_pk_mul_f16 v254, v254, v68
v_rcp_f16_sdwa v69, v85 dst_sel:WORD_1 dst_unused:UNUSED_PRESERVE src0_sel:WORD_1
ds_read_u16_d16_hi v130, v130
v_pk_mul_f16 v255, v255, v69
ds_read_u16_d16_hi v131, v131
ds_read_u16_d16_hi v132, v132
ds_read_u16_d16_hi v133, v133
s_waitcnt lgkmcnt(0)
v_pk_add_f32 v[44:45], v[44:45], v[132:133]
v_pk_add_f32 v[44:45], v[44:45], v[130:131]
v_pk_add_f32 v[44:45], v[44:45], v[128:129]
v_pk_add_f32 v[44:45], v[44:45], v[126:127]
v_pk_add_f32 v[44:45], v[44:45], v[124:125]
v_pk_add_f32 v[44:45], v[44:45], v[122:123]
v_pk_add_f32 v[44:45], v[44:45], v[120:121]
v_pk_add_f32 v[44:45], v[44:45], v[118:119]
v_mfma_f32_32x32x16_f16 v[118:133], v[240:243], a[240:243], 0
v_mfma_f32_32x32x16_f16 v[118:133], v[244:247], a[244:247], v[118:133]
s_nop 5
v_mfma_f32_32x32x16_f16 v[102:117], v[248:251], a[240:243], 0
s_nop 4
v_mfma_f32_32x32x16_f16 v[102:117], v[252:255], a[244:247], v[102:117]
v_pk_fma_f32 v[42:43], v[118:119], v[118:119], v[42:43]
v_pk_fma_f32 v[42:43], v[120:121], v[120:121], v[42:43]
v_pk_fma_f32 v[42:43], v[122:123], v[122:123], v[42:43]
v_pk_fma_f32 v[42:43], v[124:125], v[124:125], v[42:43]
v_pk_fma_f32 v[42:43], v[126:127], v[126:127], v[42:43]
v_pk_fma_f32 v[42:43], v[128:129], v[128:129], v[42:43]
v_pk_fma_f32 v[42:43], v[130:131], v[130:131], v[42:43]
v_pk_fma_f32 v[42:43], v[132:133], v[132:133], v[42:43]
s_nop 3
v_pk_fma_f32 v[44:45], v[102:103], v[102:103], v[44:45]
v_pk_fma_f32 v[44:45], v[104:105], v[104:105], v[44:45]
v_pk_fma_f32 v[44:45], v[106:107], v[106:107], v[44:45]
v_pk_fma_f32 v[44:45], v[108:109], v[108:109], v[44:45]
v_pk_fma_f32 v[44:45], v[110:111], v[110:111], v[44:45]
v_pk_fma_f32 v[44:45], v[112:113], v[112:113], v[44:45]
v_pk_fma_f32 v[44:45], v[114:115], v[114:115], v[44:45]
v_pk_fma_f32 v[44:45], v[116:117], v[116:117], v[44:45]
v_add_f32 v22, v22, v23
v_add_f32 v24, v24, v25
v_add_f32 v26, v26, v27
v_add_f32 v28, v28, v29
v_add_f32 v30, v30, v31
v_add_f32 v32, v32, v33
v_add_f32 v34, v34, v35
v_add_f32 v36, v36, v37
v_add_f32 v38, v38, v39
v_add_f32 v40, v40, v41
v_add_f32 v42, v42, v43
v_add_f32 v44, v44, v45
v_lshrrev_b32 v46, 1, v1
s_mul_i32 s65, s62, 1536
s_cmp_eq_u32 s62, 3
s_cselect_b32 s65, 0x40000000, s65
v_add_u32 v46, 152320, v46
v_add_u32 v47, s65, v46
v_permlane32_swap_b32 v22, v24
v_permlane32_swap_b32 v26, v28
v_permlane32_swap_b32 v30, v32
v_permlane32_swap_b32 v34, v36
v_permlane32_swap_b32 v38, v40
v_permlane32_swap_b32 v42, v44
v_add_f32 v8, v22, v24
v_add_f32 v9, v26, v28
v_add_f32 v10, v30, v32
v_add_f32 v11, v34, v36
v_add_f32 v12, v38, v40
v_add_f32 v13, v42, v44
ds_write_b64 v47, v[8:9] offset:0
ds_write_b64 v47, v[10:11] offset:512
ds_write_b64 v47, v[12:13] offset:1024
s_waitcnt vmcnt(0) lgkmcnt(0)
s_barrier
s_cmp_lg_u32 s62, 3
s_cbranch_scc1 L_nosum
ds_read_b64 v[22:23], v46 offset:0
ds_read_b64 v[24:25], v46 offset:512
ds_read_b64 v[26:27], v46 offset:1024
ds_read_b64 v[28:29], v46 offset:1536
ds_read_b64 v[30:31], v46 offset:2048
ds_read_b64 v[32:33], v46 offset:2560
ds_read_b64 v[34:35], v46 offset:3072
ds_read_b64 v[36:37], v46 offset:3584
ds_read_b64 v[38:39], v46 offset:4096
v_readfirstlane_b32 s65, v21
v_lshrrev_b32 v46, 2, v1
s_mov_b32 s97, 0
s_cmp_ge_u32 s65, 8
s_cbranch_scc1 L_flag_ok
L_flag_poll:
buffer_load_dword v21, v6, s[36:39], 0 offen sc1
s_add_u32 s97, s97, 1
s_waitcnt vmcnt(0)
v_readfirstlane_b32 s65, v21
s_cmp_gt_u32 s97, 0x40000
s_cbranch_scc1 L_flag_ok
s_cmp_ge_u32 s65, 8
s_cbranch_scc0 L_flag_poll
L_flag_ok:
s_lshr_b32 s65, s2, 3
s_and_b32 s65, s65, 7
s_lshl_b32 s65, s65, 11
s_waitcnt vmcnt(0) lgkmcnt(0)
v_pk_add_f32 v[8:9], v[8:9], v[22:23]
v_pk_add_f32 v[10:11], v[10:11], v[24:25]
v_pk_add_f32 v[12:13], v[12:13], v[26:27]
v_pk_add_f32 v[8:9], v[8:9], v[28:29]
v_pk_add_f32 v[10:11], v[10:11], v[30:31]
v_pk_add_f32 v[12:13], v[12:13], v[32:33]
v_pk_add_f32 v[8:9], v[8:9], v[34:35]
v_pk_add_f32 v[10:11], v[10:11], v[36:37]
v_pk_add_f32 v[12:13], v[12:13], v[38:39]
buffer_atomic_add_f32 v8, v46, s[12:15], s65 offen offset:0
buffer_atomic_add_f32 v9, v46, s[12:15], s65 offen offset:256
buffer_atomic_add_f32 v10, v46, s[12:15], s65 offen offset:512
buffer_atomic_add_f32 v11, v46, s[12:15], s65 offen offset:768
buffer_atomic_add_f32 v12, v46, s[12:15], s65 offen offset:1024
buffer_atomic_add_f32 v13, v46, s[12:15], s65 offen offset:1280
L_nosum:
v_lshrrev_b32 v46, 4, v1
v_lshrrev_b32 v47, 5, v46
v_bfe_u32 v48, v46, 2, 2
v_lshl_add_u32 v48, v47, 2, v48
v_mul_u32_u24 v48, 6, v48
v_bfe_u32 v49, v46, 4, 1
v_lshlrev_b32 v49, 4, v49
v_and_b32 v50, 1, v46
v_lshl_add_u32 v49, v50, 3, v49
v_bfe_u32 v50, v46, 1, 1
v_lshl_add_u32 v49, v50, 2, v49
v_lshlrev_b32 v49, 1, v49
s_mul_i32 s65, s62, 3
s_cmp_ge_u32 s62, 2
s_cselect_b32 s66, 186, 0
s_add_u32 s65, s65, s66
v_add_u32 v48, s65, v48
s_movk_i32 s67, 0xc0
s_cmp_ge_u32 s62, 2
v_mad_u32_u24 v49, v48, s67, v49
v_add_u32 v51, 78592, v49
v_add_u32 v52, 71680, v49
s_cselect_b64 vcc, -1, 0
v_cndmask_b32 v50, v52, v51, vcc
ds_read_b64_tr_b16 v[62:63], v50 offset:0
ds_read_b64_tr_b16 v[66:67], v50 offset:64
ds_read_b64_tr_b16 v[70:71], v50 offset:128
ds_read_b64_tr_b16 v[64:65], v50 offset:9216
ds_read_b64_tr_b16 v[68:69], v50 offset:9280
ds_read_b64_tr_b16 v[72:73], v50 offset:9344
v_cmp_gt_u32 vcc, 16, v48
s_nop 1
v_cndmask_b32 v53, v51, v52, vcc
ds_read_b64_tr_b16 v[74:75], v53 offset:18432
ds_read_b64_tr_b16 v[78:79], v53 offset:18496
ds_read_b64_tr_b16 v[82:83], v53 offset:18560
ds_read_b64_tr_b16 v[76:77], v51 offset:27648
ds_read_b64_tr_b16 v[80:81], v51 offset:27712
ds_read_b64_tr_b16 v[84:85], v51 offset:27776
ds_read_b64_tr_b16 v[86:87], v50 offset:192
ds_read_b64_tr_b16 v[90:91], v50 offset:256
ds_read_b64_tr_b16 v[94:95], v50 offset:320
ds_read_b64_tr_b16 v[88:89], v50 offset:9408
ds_read_b64_tr_b16 v[92:93], v50 offset:9472
ds_read_b64_tr_b16 v[96:97], v50 offset:9536
v_cmp_gt_u32 vcc, 15, v48
s_nop 1
v_cndmask_b32 v54, v51, v52, vcc
ds_read_b64_tr_b16 v[98:99], v54 offset:18624
ds_read_b64_tr_b16 v[102:103], v54 offset:18688
ds_read_b64_tr_b16 v[106:107], v54 offset:18752
ds_read_b64_tr_b16 v[100:101], v51 offset:27840
ds_read_b64_tr_b16 v[104:105], v51 offset:27904
ds_read_b64_tr_b16 v[108:109], v51 offset:27968
ds_read_b64_tr_b16 v[110:111], v50 offset:384
ds_read_b64_tr_b16 v[114:115], v50 offset:448
ds_read_b64_tr_b16 v[118:119], v50 offset:512
ds_read_b64_tr_b16 v[112:113], v50 offset:9600
ds_read_b64_tr_b16 v[116:117], v50 offset:9664
ds_read_b64_tr_b16 v[120:121], v50 offset:9728
v_cmp_gt_u32 vcc, 14, v48
s_nop 1
v_cndmask_b32 v55, v51, v52, vcc
ds_read_b64_tr_b16 v[122:123], v55 offset:18816
ds_read_b64_tr_b16 v[126:127], v55 offset:18880
ds_read_b64_tr_b16 v[130:131], v55 offset:18944
ds_read_b64_tr_b16 v[124:125], v51 offset:28032
ds_read_b64_tr_b16 v[128:129], v51 offset:28096
ds_read_b64_tr_b16 v[132:133], v51 offset:28160
s_mul_i32 s65, s62, 192
v_lshlrev_b32 v50, 3, v47
v_add_u32 v50, s65, v50
v_add_u32 v51, 153856, v50
v_add_u32 v50, 93184, v50
v_and_b32 v53, 31, v46
v_mul_u32_u24 v54, 192, v53
v_lshl_add_u32 v5, v47, 5, v54
v_lshl_add_u32 v6, v47, 4, v54
v_and_b32 v54, 15, v46
v_mul_u32_u24 v54, 192, v54
v_lshl_add_u32 v54, v47, 4, v54
v_bfe_u32 v55, v46, 4, 1
v_lshl_add_u32 v6, v55, 5, v54
ds_read_b64 v[134:135], v50 offset:0
ds_read_b64 v[136:137], v50 offset:16
ds_read_b64 v[138:139], v50 offset:32
ds_read_b64 v[140:141], v50 offset:48
ds_read_b64 v[142:143], v50 offset:64
ds_read_b64 v[144:145], v50 offset:80
ds_read_b64 v[146:147], v50 offset:96
ds_read_b64 v[148:149], v50 offset:112
ds_read_b64 v[150:151], v50 offset:128
ds_read_b64 v[152:153], v50 offset:144
ds_read_b64 v[154:155], v50 offset:160
ds_read_b64 v[156:157], v50 offset:176
ds_read_b128 a[192:195], v1 offset:0
ds_read_b128 a[196:199], v1 offset:1024
ds_read_b128 a[200:203], v1 offset:2048
ds_read_b128 a[204:207], v1 offset:3072
ds_read_b128 a[208:211], v1 offset:4096
ds_read_b128 a[212:215], v1 offset:5120
v_bfe_u32 v54, v53, 2, 1
v_lshrrev_b32 v55, 3, v53
v_cmp_eq_u32 vcc, v54, v47
v_mov_b32 v54, 7
s_nop 0
v_cndmask_b32 v55, v54, v55, vcc
v_mov_b32 v56, 0x3f80
v_cmp_eq_u32 vcc, 0, v55
s_nop 1
v_cndmask_b32 v57, 0, v56, vcc
v_accvgpr_write_b32 a250, v57
v_cmp_eq_u32 vcc, 1, v55
s_nop 1
v_cndmask_b32 v57, 0, v56, vcc
v_accvgpr_write_b32 a251, v57
v_cmp_eq_u32 vcc, 2, v55
s_nop 1
v_cndmask_b32 v57, 0, v56, vcc
v_accvgpr_write_b32 a252, v57
v_cmp_eq_u32 vcc, 3, v55
s_nop 1
v_cndmask_b32 v57, 0, v56, vcc
v_accvgpr_write_b32 a253, v57
v_mov_b32 v56, 0x3f803f80
v_cmp_eq_u32 vcc, 0, v47
s_nop 1
v_cndmask_b32 v57, 0, v56, vcc
v_accvgpr_write_b32 a246, v57
v_accvgpr_write_b32 a247, 0
v_accvgpr_write_b32 a248, 0
v_accvgpr_write_b32 a249, 0
v_mov_b32 v58, 0xffff0000
v_mov_b32 v47, v18
v_mov_b32 v49, v19
s_waitcnt lgkmcnt(13)
v_mfma_f32_32x32x16_bf16 v[24:39], v[134:137], v[62:65], 0
v_lshlrev_b32 v54, 16, v62
v_and_b32 v55, v58, v62
v_cvt_pk_f16_f32 v62, v54, v55
v_lshlrev_b32 v56, 16, v63
v_and_b32 v57, v58, v63
v_cvt_pk_f16_f32 v63, v56, v57
v_lshlrev_b32 v54, 16, v64
v_and_b32 v55, v58, v64
v_cvt_pk_f16_f32 v64, v54, v55
v_lshlrev_b32 v56, 16, v65
v_and_b32 v57, v58, v65
v_cvt_pk_f16_f32 v65, v56, v57
v_mfma_f32_32x32x16_bf16 v[24:39], v[138:141], v[74:77], v[24:39]
v_lshlrev_b32 v54, 16, v74
v_and_b32 v55, v58, v74
v_cvt_pk_f16_f32 v74, v54, v55
v_lshlrev_b32 v56, 16, v75
v_and_b32 v57, v58, v75
v_cvt_pk_f16_f32 v75, v56, v57
v_lshlrev_b32 v54, 16, v76
v_and_b32 v55, v58, v76
v_cvt_pk_f16_f32 v76, v54, v55
v_lshlrev_b32 v56, 16, v77
v_and_b32 v57, v58, v77
v_cvt_pk_f16_f32 v77, v56, v57
s_waitcnt lgkmcnt(6)
v_mfma_f32_32x32x16_bf16 v[24:39], v[142:145], v[86:89], v[24:39]
v_lshlrev_b32 v54, 16, v86
v_and_b32 v55, v58, v86
v_cvt_pk_f16_f32 v86, v54, v55
v_lshlrev_b32 v56, 16, v87
v_and_b32 v57, v58, v87
v_cvt_pk_f16_f32 v87, v56, v57
v_lshlrev_b32 v54, 16, v88
v_and_b32 v55, v58, v88
v_cvt_pk_f16_f32 v88, v54, v55
v_lshlrev_b32 v56, 16, v89
v_and_b32 v57, v58, v89
v_cvt_pk_f16_f32 v89, v56, v57
v_mfma_f32_32x32x16_bf16 v[24:39], v[146:149], v[98:101], v[24:39]
v_lshlrev_b32 v54, 16, v98
v_and_b32 v55, v58, v98
v_cvt_pk_f16_f32 v98, v54, v55
v_lshlrev_b32 v56, 16, v99
v_and_b32 v57, v58, v99
v_cvt_pk_f16_f32 v99, v56, v57
v_lshlrev_b32 v54, 16, v100
v_and_b32 v55, v58, v100
v_cvt_pk_f16_f32 v100, v54, v55
v_lshlrev_b32 v56, 16, v101
v_and_b32 v57, v58, v101
v_cvt_pk_f16_f32 v101, v56, v57
v_mfma_f32_32x32x16_bf16 v[24:39], v[150:153], v[110:113], v[24:39]
v_lshlrev_b32 v54, 16, v110
v_and_b32 v55, v58, v110
v_cvt_pk_f16_f32 v110, v54, v55
v_lshlrev_b32 v56, 16, v111
v_and_b32 v57, v58, v111
v_cvt_pk_f16_f32 v111, v56, v57
v_lshlrev_b32 v54, 16, v112
v_and_b32 v55, v58, v112
v_cvt_pk_f16_f32 v112, v54, v55
v_lshlrev_b32 v56, 16, v113
v_and_b32 v57, v58, v113
v_cvt_pk_f16_f32 v113, v56, v57
v_mfma_f32_32x32x16_bf16 v[24:39], v[154:157], v[122:125], v[24:39]
v_lshlrev_b32 v54, 16, v122
v_and_b32 v55, v58, v122
v_cvt_pk_f16_f32 v122, v54, v55
v_lshlrev_b32 v56, 16, v123
v_and_b32 v57, v58, v123
v_cvt_pk_f16_f32 v123, v56, v57
v_lshlrev_b32 v54, 16, v124
v_and_b32 v55, v58, v124
v_cvt_pk_f16_f32 v124, v54, v55
v_lshlrev_b32 v56, 16, v125
v_and_b32 v57, v58, v125
v_cvt_pk_f16_f32 v125, v56, v57
v_mov_b32 v40, v24
s_cmp_lg_u32 s62, 3
s_cbranch_scc1 L_arrived
v_lshlrev_b32 v60, 7, v1
s_lshr_b32 s65, s2, 3
s_and_b32 s65, s65, 7
s_lshl_b32 s65, s65, 8
s_add_u32 s65, s65, 0x10000
v_mov_b32 v61, 1
s_waitcnt vmcnt(0)
s_mov_b64 exec, 0xff
buffer_atomic_add v61, v60, s[12:15], s65 offen
s_mov_b64 exec, -1
L_arrived:
v_mfma_f32_32x32x16_bf16 v[24:39], v[134:137], v[66:69], 0
v_lshlrev_b32 v54, 16, v66
v_and_b32 v55, v58, v66
v_cvt_pk_f16_f32 v66, v54, v55
v_lshlrev_b32 v56, 16, v67
v_and_b32 v57, v58, v67
v_cvt_pk_f16_f32 v67, v56, v57
s_waitcnt lgkmcnt(0)
v_mfma_f32_32x32x16_bf16 v[8:23], a[192:195], a[144:147], 0
ds_read_b128 a[192:195], v1 offset:6144
v_lshlrev_b32 v54, 16, v68
v_and_b32 v55, v58, v68
v_cvt_pk_f16_f32 v68, v54, v55
v_lshlrev_b32 v56, 16, v69
v_and_b32 v57, v58, v69
v_cvt_pk_f16_f32 v69, v56, v57
v_mfma_f32_32x32x16_bf16 v[24:39], v[138:141], v[78:81], v[24:39]
v_lshlrev_b32 v54, 16, v78
v_and_b32 v55, v58, v78
v_cvt_pk_f16_f32 v78, v54, v55
v_lshlrev_b32 v56, 16, v79
v_and_b32 v57, v58, v79
v_cvt_pk_f16_f32 v79, v56, v57
v_mfma_f32_32x32x16_bf16 v[8:23], a[196:199], a[148:151], v[8:23]
ds_read_b128 a[196:199], v1 offset:7168
v_lshlrev_b32 v54, 16, v80
v_and_b32 v55, v58, v80
v_cvt_pk_f16_f32 v80, v54, v55
v_lshlrev_b32 v56, 16, v81
v_and_b32 v57, v58, v81
v_cvt_pk_f16_f32 v81, v56, v57
v_mfma_f32_32x32x16_bf16 v[24:39], v[142:145], v[90:93], v[24:39]
v_lshlrev_b32 v54, 16, v90
v_and_b32 v55, v58, v90
v_cvt_pk_f16_f32 v90, v54, v55
v_lshlrev_b32 v56, 16, v91
v_and_b32 v57, v58, v91
v_cvt_pk_f16_f32 v91, v56, v57
v_mfma_f32_32x32x16_bf16 v[8:23], a[200:203], a[152:155], v[8:23]
ds_read_b128 a[200:203], v1 offset:8192
v_lshlrev_b32 v54, 16, v92
v_and_b32 v55, v58, v92
v_cvt_pk_f16_f32 v92, v54, v55
v_lshlrev_b32 v56, 16, v93
v_and_b32 v57, v58, v93
v_cvt_pk_f16_f32 v93, v56, v57
v_mfma_f32_32x32x16_bf16 v[24:39], v[146:149], v[102:105], v[24:39]
v_lshlrev_b32 v54, 16, v102
v_and_b32 v55, v58, v102
v_cvt_pk_f16_f32 v102, v54, v55
v_lshlrev_b32 v56, 16, v103
v_and_b32 v57, v58, v103
v_cvt_pk_f16_f32 v103, v56, v57
v_mfma_f32_32x32x16_bf16 v[8:23], a[204:207], a[156:159], v[8:23]
ds_read_b128 a[204:207], v1 offset:9216
v_lshlrev_b32 v54, 16, v104
v_and_b32 v55, v58, v104
v_cvt_pk_f16_f32 v104, v54, v55
v_lshlrev_b32 v56, 16, v105
v_and_b32 v57, v58, v105
v_cvt_pk_f16_f32 v105, v56, v57
v_mfma_f32_32x32x16_bf16 v[24:39], v[150:153], v[114:117], v[24:39]
v_lshlrev_b32 v54, 16, v114
v_and_b32 v55, v58, v114
v_cvt_pk_f16_f32 v114, v54, v55
v_lshlrev_b32 v56, 16, v115
v_and_b32 v57, v58, v115
v_cvt_pk_f16_f32 v115, v56, v57
v_mfma_f32_32x32x16_bf16 v[8:23], a[208:211], a[160:163], v[8:23]
ds_read_b128 a[208:211], v1 offset:10240
v_lshlrev_b32 v54, 16, v116
v_and_b32 v55, v58, v116
v_cvt_pk_f16_f32 v116, v54, v55
v_lshlrev_b32 v56, 16, v117
v_and_b32 v57, v58, v117
v_cvt_pk_f16_f32 v117, v56, v57
v_mfma_f32_32x32x16_bf16 v[24:39], v[154:157], v[126:129], v[24:39]
v_lshlrev_b32 v54, 16, v126
v_and_b32 v55, v58, v126
v_cvt_pk_f16_f32 v126, v54, v55
v_lshlrev_b32 v56, 16, v127
v_and_b32 v57, v58, v127
v_cvt_pk_f16_f32 v127, v56, v57
v_mfma_f32_32x32x16_bf16 v[8:23], a[212:215], a[164:167], v[8:23]
ds_read_b128 a[212:215], v1 offset:11264
v_lshlrev_b32 v54, 16, v128
v_and_b32 v55, v58, v128
v_cvt_pk_f16_f32 v128, v54, v55
v_lshlrev_b32 v56, 16, v129
v_and_b32 v57, v58, v129
v_cvt_pk_f16_f32 v129, v56, v57
v_mov_b32 v41, v24
v_mfma_f32_32x32x16_bf16 v[24:39], v[134:137], v[70:73], 0
v_lshlrev_b32 v54, 16, v70
v_and_b32 v55, v58, v70
v_cvt_pk_f16_f32 v70, v54, v55
v_lshlrev_b32 v56, 16, v71
v_and_b32 v57, v58, v71
v_cvt_pk_f16_f32 v71, v56, v57
v_lshlrev_b32 v54, 16, v72
v_and_b32 v55, v58, v72
v_cvt_pk_f16_f32 v72, v54, v55
v_lshlrev_b32 v56, 16, v73
v_and_b32 v57, v58, v73
v_cvt_pk_f16_f32 v73, v56, v57
v_mfma_f32_32x32x16_bf16 v[24:39], v[138:141], v[82:85], v[24:39]
v_lshlrev_b32 v54, 16, v82
v_and_b32 v55, v58, v82
v_cvt_pk_f16_f32 v82, v54, v55
v_lshlrev_b32 v56, 16, v83
v_and_b32 v57, v58, v83
v_cvt_pk_f16_f32 v83, v56, v57
v_lshlrev_b32 v54, 16, v84
v_and_b32 v55, v58, v84
v_cvt_pk_f16_f32 v84, v54, v55
v_lshlrev_b32 v56, 16, v85
v_and_b32 v57, v58, v85
v_cvt_pk_f16_f32 v85, v56, v57
v_mfma_f32_32x32x16_bf16 v[24:39], v[142:145], v[94:97], v[24:39]
v_lshlrev_b32 v54, 16, v94
v_and_b32 v55, v58, v94
v_cvt_pk_f16_f32 v94, v54, v55
v_lshlrev_b32 v56, 16, v95
v_and_b32 v57, v58, v95
v_cvt_pk_f16_f32 v95, v56, v57
v_lshlrev_b32 v54, 16, v96
v_and_b32 v55, v58, v96
v_cvt_pk_f16_f32 v96, v54, v55
v_lshlrev_b32 v56, 16, v97
v_and_b32 v57, v58, v97
v_cvt_pk_f16_f32 v97, v56, v57
v_mfma_f32_32x32x16_bf16 v[24:39], v[146:149], v[106:109], v[24:39]
v_lshlrev_b32 v54, 16, v106
v_and_b32 v55, v58, v106
v_cvt_pk_f16_f32 v106, v54, v55
v_lshlrev_b32 v56, 16, v107
v_and_b32 v57, v58, v107
v_cvt_pk_f16_f32 v107, v56, v57
v_lshlrev_b32 v54, 16, v108
v_and_b32 v55, v58, v108
v_cvt_pk_f16_f32 v108, v54, v55
v_lshlrev_b32 v56, 16, v109
v_and_b32 v57, v58, v109
v_cvt_pk_f16_f32 v109, v56, v57
v_mfma_f32_32x32x16_bf16 v[24:39], v[150:153], v[118:121], v[24:39]
v_lshlrev_b32 v54, 16, v118
v_and_b32 v55, v58, v118
v_cvt_pk_f16_f32 v118, v54, v55
v_lshlrev_b32 v56, 16, v119
v_and_b32 v57, v58, v119
v_cvt_pk_f16_f32 v119, v56, v57
v_lshlrev_b32 v54, 16, v120
v_and_b32 v55, v58, v120
v_cvt_pk_f16_f32 v120, v54, v55
v_lshlrev_b32 v56, 16, v121
v_and_b32 v57, v58, v121
v_cvt_pk_f16_f32 v121, v56, v57
v_mfma_f32_32x32x16_bf16 v[24:39], v[154:157], v[130:133], v[24:39]
v_lshlrev_b32 v54, 16, v130
v_and_b32 v55, v58, v130
v_cvt_pk_f16_f32 v130, v54, v55
v_lshlrev_b32 v56, 16, v131
v_and_b32 v57, v58, v131
v_cvt_pk_f16_f32 v131, v56, v57
v_lshlrev_b32 v54, 16, v132
v_and_b32 v55, v58, v132
v_cvt_pk_f16_f32 v132, v54, v55
v_lshlrev_b32 v56, 16, v133
v_and_b32 v57, v58, v133
v_cvt_pk_f16_f32 v133, v56, v57
v_mov_b32 v42, v24
v_mad_u32_u16 v8, v8, 2, s85 op_sel:[1,0,0,0]
v_mad_u32_u16 v9, v9, 2, s85 op_sel:[1,0,0,0]
v_mad_u32_u16 v10, v10, 2, s85 op_sel:[1,0,0,0]
v_mad_u32_u16 v11, v11, 2, s85 op_sel:[1,0,0,0]
v_mad_u32_u16 v12, v12, 2, s85 op_sel:[1,0,0,0]
v_mad_u32_u16 v13, v13, 2, s85 op_sel:[1,0,0,0]
v_mad_u32_u16 v14, v14, 2, s85 op_sel:[1,0,0,0]
v_mad_u32_u16 v15, v15, 2, s85 op_sel:[1,0,0,0]
v_mad_u32_u16 v16, v16, 2, s85 op_sel:[1,0,0,0]
v_mad_u32_u16 v17, v17, 2, s85 op_sel:[1,0,0,0]
v_mad_u32_u16 v18, v18, 2, s85 op_sel:[1,0,0,0]
v_mad_u32_u16 v19, v19, 2, s85 op_sel:[1,0,0,0]
v_mad_u32_u16 v20, v20, 2, s85 op_sel:[1,0,0,0]
v_mad_u32_u16 v21, v21, 2, s85 op_sel:[1,0,0,0]
v_mad_u32_u16 v22, v22, 2, s85 op_sel:[1,0,0,0]
v_mad_u32_u16 v23, v23, 2, s85 op_sel:[1,0,0,0]
v_mov_b32 v43, v46
v_mov_b32 v44, v51
v_mov_b32 v45, v53
v_lshlrev_b32 v46, 17, v0
v_or_b32 v46, 0x8000, v46
v_mov_b32 v48, 0x409d30fc
v_lshlrev_b32 v60, 2, v0
v_add_u32 v61, 159488, v60
v_add_u32 v60, 93952, v60
v_add_u32 v50, 0, v46
v_add_u32 v51, 0x10000, v46
v_pk_mul_f32 v[50:51], v[50:51], s[86:87] op_sel:[0,1] op_sel_hi:[1,1] neg_lo:[1,0] neg_hi:[1,0]
v_pk_fma_f32 v[52:53], v[50:51], v[50:51], v[48:49] op_sel_hi:[1,1,0]
v_add_u32 v54, 0x2000000, v46
v_pk_mul_f32 v[52:53], v[50:51], v[52:53]
v_add_u32 v55, 0x2010000, v46
v_exp_f32 v52, v52
v_pk_mul_f32 v[54:55], v[54:55], s[86:87] op_sel:[0,1] op_sel_hi:[1,1] neg_lo:[1,0] neg_hi:[1,0]
v_exp_f32 v53, v53
v_pk_fma_f32 v[56:57], v[54:55], v[54:55], v[48:49] op_sel_hi:[1,1,0]
v_pk_add_f32 v[52:53], v[52:53], 1.0 op_sel_hi:[1,0]
v_pk_mul_f32 v[56:57], v[54:55], v[56:57]
v_rcp_f32 v52, v52
v_exp_f32 v56, v56
v_rcp_f32 v53, v53
v_exp_f32 v57, v57
v_pk_mul_f32 v[50:51], v[50:51], v[52:53]
v_pk_add_f32 v[56:57], v[56:57], 1.0 op_sel_hi:[1,0]
v_cvt_pk_f16_f32 v58, v50, v51
v_rcp_f32 v56, v56
v_add_u32 v58, 0x20002, v58
v_rcp_f32 v57, v57
v_and_b32 v58, 0xfffcfffc, v58
v_pk_mul_f32 v[54:55], v[54:55], v[56:57]
v_cvt_pk_f16_f32 v59, v54, v55
v_add_u32 v59, 0x20002, v59
v_and_b32 v59, 0xfffcfffc, v59
ds_write_b32 v60, v58 offset:0
ds_write_b32 v60, v59 offset:1024
v_add_u32 v50, 0x4000000, v46
v_add_u32 v51, 0x4010000, v46
v_pk_mul_f32 v[50:51], v[50:51], s[86:87] op_sel:[0,1] op_sel_hi:[1,1] neg_lo:[1,0] neg_hi:[1,0]
v_pk_fma_f32 v[52:53], v[50:51], v[50:51], v[48:49] op_sel_hi:[1,1,0]
v_add_u32 v54, 0x6000000, v46
v_pk_mul_f32 v[52:53], v[50:51], v[52:53]
v_add_u32 v55, 0x6010000, v46
v_exp_f32 v52, v52
v_pk_mul_f32 v[54:55], v[54:55], s[86:87] op_sel:[0,1] op_sel_hi:[1,1] neg_lo:[1,0] neg_hi:[1,0]
v_exp_f32 v53, v53
v_pk_fma_f32 v[56:57], v[54:55], v[54:55], v[48:49] op_sel_hi:[1,1,0]
v_pk_add_f32 v[52:53], v[52:53], 1.0 op_sel_hi:[1,0]
v_pk_mul_f32 v[56:57], v[54:55], v[56:57]
v_rcp_f32 v52, v52
v_exp_f32 v56, v56
v_rcp_f32 v53, v53
v_exp_f32 v57, v57
v_pk_mul_f32 v[50:51], v[50:51], v[52:53]
v_pk_add_f32 v[56:57], v[56:57], 1.0 op_sel_hi:[1,0]
v_cvt_pk_f16_f32 v58, v50, v51
v_rcp_f32 v56, v56
v_add_u32 v58, 0x20002, v58
v_rcp_f32 v57, v57
v_and_b32 v58, 0xfffcfffc, v58
v_pk_mul_f32 v[54:55], v[54:55], v[56:57]
v_cvt_pk_f16_f32 v59, v54, v55
v_add_u32 v59, 0x20002, v59
v_and_b32 v59, 0xfffcfffc, v59
ds_write_b32 v60, v58 offset:2048
ds_write_b32 v60, v59 offset:3072
v_add_u32 v50, 0x8000000, v46
v_add_u32 v51, 0x8010000, v46
v_pk_mul_f32 v[50:51], v[50:51], s[86:87] op_sel:[0,1] op_sel_hi:[1,1] neg_lo:[1,0] neg_hi:[1,0]
v_pk_fma_f32 v[52:53], v[50:51], v[50:51], v[48:49] op_sel_hi:[1,1,0]
v_add_u32 v54, 0xa000000, v46
v_pk_mul_f32 v[52:53], v[50:51], v[52:53]
v_add_u32 v55, 0xa010000, v46
v_exp_f32 v52, v52
v_pk_mul_f32 v[54:55], v[54:55], s[86:87] op_sel:[0,1] op_sel_hi:[1,1] neg_lo:[1,0] neg_hi:[1,0]
v_exp_f32 v53, v53
v_pk_fma_f32 v[56:57], v[54:55], v[54:55], v[48:49] op_sel_hi:[1,1,0]
v_pk_add_f32 v[52:53], v[52:53], 1.0 op_sel_hi:[1,0]
v_pk_mul_f32 v[56:57], v[54:55], v[56:57]
v_rcp_f32 v52, v52
v_exp_f32 v56, v56
v_rcp_f32 v53, v53
v_exp_f32 v57, v57
v_pk_mul_f32 v[50:51], v[50:51], v[52:53]
v_pk_add_f32 v[56:57], v[56:57], 1.0 op_sel_hi:[1,0]
v_cvt_pk_f16_f32 v58, v50, v51
v_rcp_f32 v56, v56
v_add_u32 v58, 0x20002, v58
v_rcp_f32 v57, v57
v_and_b32 v58, 0xfffcfffc, v58
v_pk_mul_f32 v[54:55], v[54:55], v[56:57]
v_cvt_pk_f16_f32 v59, v54, v55
v_add_u32 v59, 0x20002, v59
v_and_b32 v59, 0xfffcfffc, v59
ds_write_b32 v60, v58 offset:4096
ds_write_b32 v60, v59 offset:5120
v_add_u32 v50, 0, v46
v_add_u32 v51, 0x10000, v46
v_pk_mul_f32 v[50:51], v[50:51], s[86:87] op_sel:[0,1] op_sel_hi:[1,1]
v_pk_fma_f32 v[52:53], v[50:51], v[50:51], v[48:49] op_sel_hi:[1,1,0]
v_add_u32 v54, 0x2000000, v46
v_pk_mul_f32 v[52:53], v[50:51], v[52:53]
v_add_u32 v55, 0x2010000, v46
v_exp_f32 v52, v52
v_pk_mul_f32 v[54:55], v[54:55], s[86:87] op_sel:[0,1] op_sel_hi:[1,1]
v_exp_f32 v53, v53
v_pk_fma_f32 v[56:57], v[54:55], v[54:55], v[48:49] op_sel_hi:[1,1,0]
v_pk_add_f32 v[52:53], v[52:53], 1.0 op_sel_hi:[1,0]
v_pk_mul_f32 v[56:57], v[54:55], v[56:57]
v_rcp_f32 v52, v52
v_exp_f32 v56, v56
v_rcp_f32 v53, v53
v_exp_f32 v57, v57
v_pk_mul_f32 v[50:51], v[50:51], v[52:53]
v_pk_add_f32 v[56:57], v[56:57], 1.0 op_sel_hi:[1,0]
v_cvt_pk_f16_f32 v58, v50, v51
v_rcp_f32 v56, v56
v_add_u32 v58, 0x20002, v58
v_rcp_f32 v57, v57
v_and_b32 v58, 0xfffcfffc, v58
v_pk_mul_f32 v[54:55], v[54:55], v[56:57]
v_cvt_pk_f16_f32 v59, v54, v55
v_add_u32 v59, 0x20002, v59
v_and_b32 v59, 0xfffcfffc, v59
ds_write_b32 v61, v58 offset:0
ds_write_b32 v61, v59 offset:1024
v_add_u32 v50, 0x4000000, v46
v_add_u32 v51, 0x4010000, v46
v_pk_mul_f32 v[50:51], v[50:51], s[86:87] op_sel:[0,1] op_sel_hi:[1,1]
v_pk_fma_f32 v[52:53], v[50:51], v[50:51], v[48:49] op_sel_hi:[1,1,0]
v_add_u32 v54, 0x6000000, v46
v_pk_mul_f32 v[52:53], v[50:51], v[52:53]
v_add_u32 v55, 0x6010000, v46
v_exp_f32 v52, v52
v_pk_mul_f32 v[54:55], v[54:55], s[86:87] op_sel:[0,1] op_sel_hi:[1,1]
v_exp_f32 v53, v53
v_pk_fma_f32 v[56:57], v[54:55], v[54:55], v[48:49] op_sel_hi:[1,1,0]
v_pk_add_f32 v[52:53], v[52:53], 1.0 op_sel_hi:[1,0]
v_pk_mul_f32 v[56:57], v[54:55], v[56:57]
v_rcp_f32 v52, v52
v_exp_f32 v56, v56
v_rcp_f32 v53, v53
v_exp_f32 v57, v57
v_pk_mul_f32 v[50:51], v[50:51], v[52:53]
v_pk_add_f32 v[56:57], v[56:57], 1.0 op_sel_hi:[1,0]
v_cvt_pk_f16_f32 v58, v50, v51
v_rcp_f32 v56, v56
v_add_u32 v58, 0x20002, v58
v_rcp_f32 v57, v57
v_and_b32 v58, 0xfffcfffc, v58
v_pk_mul_f32 v[54:55], v[54:55], v[56:57]
v_cvt_pk_f16_f32 v59, v54, v55
v_add_u32 v59, 0x20002, v59
v_and_b32 v59, 0xfffcfffc, v59
ds_write_b32 v61, v58 offset:2048
ds_write_b32 v61, v59 offset:3072
v_add_u32 v50, 0x8000000, v46
v_add_u32 v51, 0x8010000, v46
v_pk_mul_f32 v[50:51], v[50:51], s[86:87] op_sel:[0,1] op_sel_hi:[1,1]
v_pk_fma_f32 v[52:53], v[50:51], v[50:51], v[48:49] op_sel_hi:[1,1,0]
v_pk_mul_f32 v[52:53], v[50:51], v[52:53]
v_exp_f32 v52, v52
v_exp_f32 v53, v53
s_nop 0
v_pk_add_f32 v[52:53], v[52:53], 1.0 op_sel_hi:[1,0]
v_rcp_f32 v52, v52
v_rcp_f32 v53, v53
s_nop 0
v_pk_mul_f32 v[50:51], v[50:51], v[52:53]
v_cvt_pk_f16_f32 v58, v50, v51
v_add_u32 v58, 0x20002, v58
v_and_b32 v58, 0xfffcfffc, v58
ds_write_b32 v61, v58 offset:4096
v_mov_b32 v46, v43
v_mov_b32 v51, v44
v_min_u32 v53, 47, v46
s_mul_i32 s65, s62, 384
v_lshlrev_b32 v52, 2, v45
v_add_u32 v52, 152320, v52
v_add_u32 v50, s65, v52
s_mul_i32 s66, s62, 192
s_add_u32 s66, s66, 153856
v_lshl_add_u32 v43, v53, 2, s66
v_lshl_add_u32 v53, v53, 3, s65
s_lshl_b32 s65, s62, 2
s_add_u32 s65, s65, 156928
v_mov_b32 v59, s65
v_mov_b32 v60, 156928
s_mul_i32 s65, s62, 18
s_add_u32 s65, s65, 70
s_lshl_b32 s65, s65, 10
v_add_u32 v44, s65, v1
s_cmp_ge_u32 s62, 1
s_cselect_b32 s66, 6912, 0
v_add_u32 v45, s66, v44
s_cmp_ge_u32 s62, 2
s_cselect_b32 s66, 6912, 0
v_add_u32 v44, s66, v44
s_cmp_lg_u32 s62, 0
s_cbranch_scc1 L_released
s_lshr_b32 s65, s2, 0
s_and_b32 s65, s65, 7
s_lshl_b32 s65, s65, 11
s_add_u32 s65, s65, 0x10000
v_and_b32 v54, 7, v46
v_lshlrev_b32 v54, 8, v54
s_mov_b32 s97, 0
L_poll:
buffer_load_dword v55, v54, s[12:15], s65 offen sc1
s_add_u32 s97, s97, 1
s_waitcnt vmcnt(0)
v_cmp_gt_u32 vcc, 32, v55
s_cmp_gt_u32 s97, 0x40000
s_cbranch_scc1 L_released
s_cbranch_vccnz L_poll
L_released:
s_waitcnt lgkmcnt(0)
s_barrier
s_movk_i32 s66, 0
buffer_load_dwordx2 v[24:25], v53, s[12:15], s66 offen offset:0 sc1
buffer_load_dwordx2 v[26:27], v53, s[12:15], s66 offen offset:2048 sc1
s_movk_i32 s66, 4096
buffer_load_dwordx2 v[28:29], v53, s[12:15], s66 offen offset:0 sc1
buffer_load_dwordx2 v[30:31], v53, s[12:15], s66 offen offset:2048 sc1
s_movk_i32 s66, 8192
buffer_load_dwordx2 v[32:33], v53, s[12:15], s66 offen offset:0 sc1
buffer_load_dwordx2 v[34:35], v53, s[12:15], s66 offen offset:2048 sc1
s_movk_i32 s66, 12288
buffer_load_dwordx2 v[36:37], v53, s[12:15], s66 offen offset:0 sc1
buffer_load_dwordx2 v[38:39], v53, s[12:15], s66 offen offset:2048 sc1
ds_read_u16 v8, v8
ds_read_u16_d16_hi v9, v9
ds_read_u16 v10, v10
ds_read_u16_d16_hi v11, v11
ds_read_u16 v12, v12
ds_read_u16_d16_hi v13, v13
ds_read_u16 v14, v14
ds_read_u16_d16_hi v15, v15
ds_read_u16 v16, v16
ds_read_u16_d16_hi v17, v17
ds_read_u16 v18, v18
ds_read_u16_d16_hi v19, v19
ds_read_u16 v20, v20
ds_read_u16_d16_hi v21, v21
ds_read_u16 v22, v22
ds_read_u16_d16_hi v23, v23
buffer_load_dwordx4 a[168:171], v5, s[4:7], s82 offen offset:0
buffer_load_dwordx4 a[172:175], v5, s[4:7], s82 offen offset:16
buffer_load_dwordx4 a[176:179], v5, s[4:7], s83 offen offset:0
buffer_load_dwordx4 a[180:183], v5, s[4:7], s83 offen offset:16
ds_write_b32 v50, v40 offset:0
ds_write_b32 v50, v41 offset:128
ds_write_b32 v50, v42 offset:256
s_waitcnt vmcnt(4)
v_pk_add_f32 v[36:37], v[36:37], v[38:39]
v_pk_add_f32 v[24:25], v[24:25], v[26:27]
v_pk_add_f32 v[28:29], v[28:29], v[30:31]
v_pk_add_f32 v[32:33], v[32:33], v[34:35]
v_pk_add_f32 v[24:25], v[24:25], v[28:29]
v_pk_add_f32 v[32:33], v[32:33], v[36:37]
v_pk_add_f32 v[24:25], v[24:25], v[32:33]
v_mov_b32 v56, 0x358637bd
v_fmac_f32 v56, 0x4091afa4, v24
v_mov_b32 v57, 0x358637bd
v_fmac_f32 v57, 0x4091afa4, v25
v_sqrt_f32 v56, v56
v_sqrt_f32 v57, v57
v_cmp_gt_u32 vcc, 48, v46
v_add_f32 v58, v56, v57
s_nop 0
v_cndmask_b32 v58, 0, v58, vcc
s_nop 1
v_add_f32_dpp v58, v58, v58 row_shr:1 row_mask:0xf bank_mask:0xf bound_ctrl:1
s_nop 1
v_add_f32_dpp v58, v58, v58 row_shr:2 row_mask:0xf bank_mask:0xf bound_ctrl:1
s_nop 1
v_add_f32_dpp v58, v58, v58 row_shr:4 row_mask:0xf bank_mask:0xf bound_ctrl:1
s_nop 1
v_add_f32_dpp v58, v58, v58 row_shr:8 row_mask:0xf bank_mask:0xf bound_ctrl:1
s_nop 1
v_readlane_b32 s65, v58, 15
v_readlane_b32 s66, v58, 31
v_readlane_b32 s67, v58, 47
v_mov_b32 v58, s65
v_add_f32 v58, s66, v58
v_add_f32 v58, s67, v58
ds_write_b32 v59, v58
s_waitcnt lgkmcnt(0)
s_barrier
ds_read_b128 v[24:27], v60
ds_read_b32 v28, v52 offset:0
ds_read_b32 v29, v52 offset:128
ds_read_b32 v30, v52 offset:256
ds_read_b32 v31, v52 offset:384
ds_read_b32 v32, v52 offset:512
ds_read_b32 v33, v52 offset:640
ds_read_b32 v34, v52 offset:768
ds_read_b32 v35, v52 offset:896
ds_read_b32 v36, v52 offset:1024
ds_read_b32 v37, v52 offset:1152
ds_read_b32 v38, v52 offset:1280
ds_read_b32 v39, v52 offset:1408
v_mul_f32 v56, v56, v47
v_mul_f32 v57, v57, v49
s_waitcnt lgkmcnt(9)
v_add_f32 v24, v24, v25
v_add_f32 v26, v26, v27
v_add_f32 v24, v24, v26
v_mov_b32 v58, 0x358637bd
v_fmac_f32 v58, 0x3b2aaaab, v24
v_rcp_f32 v58, v58
s_nop 0
v_fma_f32 v56, v56, v58, 1.0
v_fma_f32 v57, v57, v58, 1.0
v_mul_f32 v56, 0xc0088e99, v56
v_mul_f32 v57, 0xc0088e99, v57
v_cvt_pk_f16_f32 v56, v56, v57
ds_write_b32 v43, v56
ds_read_b64 v[134:135], v51 offset:0
ds_read_b64 v[136:137], v51 offset:16
ds_read_b64 v[138:139], v51 offset:32
ds_read_b64 v[140:141], v51 offset:48
ds_read_b64 v[142:143], v51 offset:64
ds_read_b64 v[144:145], v51 offset:80
ds_read_b64 v[146:147], v51 offset:96
ds_read_b64 v[148:149], v51 offset:112
ds_read_b64 v[150:151], v51 offset:128
ds_read_b64 v[152:153], v51 offset:144
ds_read_b64 v[154:155], v51 offset:160
ds_read_b64 v[156:157], v51 offset:176
s_waitcnt lgkmcnt(14)
v_add_f32 v28, v28, v31
v_add_f32 v34, v34, v37
v_add_f32 v28, v28, v34
v_cvt_pk_bf16_f32 v59, v28, v28
v_lshlrev_b32 v59, 16, v59
v_sub_f32 v59, v28, v59
v_cvt_pk_bf16_f32 v59, v28, v59
v_accvgpr_write_b32 a240, v59
v_accvgpr_write_b32 a241, 0
v_add_f32 v29, v29, v32
v_add_f32 v35, v35, v38
v_add_f32 v29, v29, v35
v_cvt_pk_bf16_f32 v59, v29, v29
v_lshlrev_b32 v59, 16, v59
v_sub_f32 v59, v29, v59
v_cvt_pk_bf16_f32 v59, v29, v59
v_accvgpr_write_b32 a242, v59
v_accvgpr_write_b32 a243, 0
v_add_f32 v30, v30, v33
s_waitcnt lgkmcnt(10)
v_add_f32 v36, v36, v39
v_add_f32 v30, v30, v36
v_cvt_pk_bf16_f32 v59, v30, v30
v_lshlrev_b32 v59, 16, v59
v_sub_f32 v59, v30, v59
v_cvt_pk_bf16_f32 v59, v30, v59
v_accvgpr_write_b32 a244, v59
v_accvgpr_write_b32 a245, 0
s_xor_b32 s87, s87, 0x80000000
v_mfma_f32_32x32x16_bf16 v[24:39], a[192:195], a[144:147], 0
ds_read_b128 a[192:195], v1 offset:12288
v_pk_mul_f16 v62, v62, v134
v_pk_mul_f16 v63, v63, v135
v_pk_mul_f16 v64, v64, v136
v_pk_mul_f16 v65, v65, v137
v_pk_mul_f16 v66, v66, v134
v_pk_mul_f16 v67, v67, v135
v_pk_mul_f16 v68, v68, v136
v_pk_mul_f16 v69, v69, v137
v_pk_mul_f16 v70, v70, v134
v_pk_mul_f16 v71, v71, v135
v_pk_mul_f16 v72, v72, v136
v_pk_mul_f16 v73, v73, v137
v_mfma_f32_32x32x16_bf16 v[24:39], a[196:199], a[148:151], v[24:39]
ds_read_b128 a[196:199], v1 offset:13312
ds_write_b128 v44, v[62:65] offset:0
ds_write_b128 v44, v[66:69] offset:1024
ds_write_b128 v44, v[70:73] offset:2048
s_waitcnt lgkmcnt(4)
v_pk_mul_f16 v74, v74, v138
v_pk_mul_f16 v75, v75, v139
v_pk_mul_f16 v76, v76, v140
v_pk_mul_f16 v77, v77, v141
v_pk_mul_f16 v78, v78, v138
v_pk_mul_f16 v79, v79, v139
v_pk_mul_f16 v80, v80, v140
v_pk_mul_f16 v81, v81, v141
v_pk_mul_f16 v82, v82, v138
v_pk_mul_f16 v83, v83, v139
v_pk_mul_f16 v84, v84, v140
v_pk_mul_f16 v85, v85, v141
v_mfma_f32_32x32x16_bf16 v[24:39], a[200:203], a[152:155], v[24:39]
ds_read_b128 a[200:203], v1 offset:14336
ds_write_b128 v45, v[74:77] offset:3072
ds_write_b128 v45, v[78:81] offset:4096
ds_write_b128 v45, v[82:85] offset:5120
v_pk_mul_f16 v86, v86, v142
v_pk_mul_f16 v87, v87, v143
v_pk_mul_f16 v88, v88, v144
v_pk_mul_f16 v89, v89, v145
v_pk_mul_f16 v90, v90, v142
v_pk_mul_f16 v91, v91, v143
v_pk_mul_f16 v92, v92, v144
v_pk_mul_f16 v93, v93, v145
v_pk_mul_f16 v94, v94, v142
v_pk_mul_f16 v95, v95, v143
v_pk_mul_f16 v96, v96, v144
v_pk_mul_f16 v97, v97, v145
v_mfma_f32_32x32x16_bf16 v[24:39], a[204:207], a[156:159], v[24:39]
ds_read_b128 a[204:207], v1 offset:15360
ds_write_b128 v45, v[86:89] offset:6144
ds_write_b128 v45, v[90:93] offset:7168
ds_write_b128 v45, v[94:97] offset:8192
v_pk_mul_f16 v98, v98, v146
v_pk_mul_f16 v99, v99, v147
v_pk_mul_f16 v100, v100, v148
v_pk_mul_f16 v101, v101, v149
v_pk_mul_f16 v102, v102, v146
v_pk_mul_f16 v103, v103, v147
v_pk_mul_f16 v104, v104, v148
v_pk_mul_f16 v105, v105, v149
v_pk_mul_f16 v106, v106, v146
v_pk_mul_f16 v107, v107, v147
v_pk_mul_f16 v108, v108, v148
v_pk_mul_f16 v109, v109, v149
v_mfma_f32_32x32x16_bf16 v[24:39], a[208:211], a[160:163], v[24:39]
ds_read_b128 a[208:211], v1 offset:16384
ds_write_b128 v45, v[98:101] offset:9216
ds_write_b128 v45, v[102:105] offset:10240
ds_write_b128 v45, v[106:109] offset:11264
v_pk_mul_f16 v110, v110, v150
v_pk_mul_f16 v111, v111, v151
v_pk_mul_f16 v112, v112, v152
v_pk_mul_f16 v113, v113, v153
v_pk_mul_f16 v114, v114, v150
v_pk_mul_f16 v115, v115, v151
v_pk_mul_f16 v116, v116, v152
v_pk_mul_f16 v117, v117, v153
v_pk_mul_f16 v118, v118, v150
v_pk_mul_f16 v119, v119, v151
v_pk_mul_f16 v120, v120, v152
v_pk_mul_f16 v121, v121, v153
v_mfma_f32_32x32x16_bf16 v[24:39], a[212:215], a[164:167], v[24:39]
ds_read_b128 a[212:215], v1 offset:17408
ds_write_b128 v45, v[110:113] offset:12288
ds_write_b128 v45, v[114:117] offset:13312
ds_write_b128 v45, v[118:121] offset:14336
v_pk_mul_f16 v122, v122, v154
v_pk_mul_f16 v123, v123, v155
v_pk_mul_f16 v124, v124, v156
v_pk_mul_f16 v125, v125, v157
v_pk_mul_f16 v126, v126, v154
v_pk_mul_f16 v127, v127, v155
v_pk_mul_f16 v128, v128, v156
v_pk_mul_f16 v129, v129, v157
v_pk_mul_f16 v130, v130, v154
v_pk_mul_f16 v131, v131, v155
v_pk_mul_f16 v132, v132, v156
v_pk_mul_f16 v133, v133, v157
ds_write_b128 v45, v[122:125] offset:15360
ds_write_b128 v45, v[126:129] offset:16384
ds_write_b128 v45, v[130:133] offset:17408
s_waitcnt lgkmcnt(0)
s_barrier
v_mfma_f32_32x32x16_bf16 v[110:125], a[240:243], a[246:249], 0
global_load_dword a255, v[158:159], off
ds_read_b128 a[216:219], v2 offset:6144
ds_read_b128 a[220:223], v2 offset:7168
ds_read_b128 a[224:227], v2 offset:8192
ds_read_b128 a[228:231], v2 offset:9216
v_mfma_f32_32x32x16_bf16 v[126:141], a[242:245], a[246:249], 0
ds_read_b128 a[232:235], v2 offset:10240
ds_read_b128 a[236:239], v2 offset:11264
v_or_b32 v40, v8, v9
v_or_b32 v41, v10, v11
v_or_b32 v42, v12, v13
v_or_b32 v43, v14, v15
v_mfma_f32_32x32x16_bf16 v[142:157], a[244:247], a[246:249], 0
v_or_b32 v44, v16, v17
v_or_b32 v45, v18, v19
v_or_b32 v46, v20, v21
v_or_b32 v47, v22, v23
v_mad_u32_u16 v24, v24, 2, s85 op_sel:[1,0,0,0]
v_mad_u32_u16 v25, v25, 2, s85 op_sel:[1,0,0,0]
v_mad_u32_u16 v26, v26, 2, s85 op_sel:[1,0,0,0]
v_mad_u32_u16 v27, v27, 2, s85 op_sel:[1,0,0,0]
v_mad_u32_u16 v28, v28, 2, s85 op_sel:[1,0,0,0]
v_mad_u32_u16 v29, v29, 2, s85 op_sel:[1,0,0,0]
v_mad_u32_u16 v30, v30, 2, s85 op_sel:[1,0,0,0]
v_mad_u32_u16 v31, v31, 2, s85 op_sel:[1,0,0,0]
v_mad_u32_u16 v32, v32, 2, s85 op_sel:[1,0,0,0]
v_mad_u32_u16 v33, v33, 2, s85 op_sel:[1,0,0,0]
v_mad_u32_u16 v34, v34, 2, s85 op_sel:[1,0,0,0]
s_waitcnt lgkmcnt(2)
v_mfma_f32_32x32x16_f16 v[110:125], a[216:219], v[160:163], v[110:125]
ds_read_u16 v24, v24
ds_read_u16_d16_hi v25, v25
ds_read_u16 v26, v26
ds_read_u16_d16_hi v27, v27
v_mad_u32_u16 v35, v35, 2, s85 op_sel:[1,0,0,0]
v_mad_u32_u16 v36, v36, 2, s85 op_sel:[1,0,0,0]
v_mfma_f32_32x32x16_f16 v[126:141], a[220:223], v[160:163], v[126:141]
ds_read_u16 v28, v28
ds_read_u16_d16_hi v29, v29
ds_read_u16 v30, v30
v_mad_u32_u16 v37, v37, 2, s85 op_sel:[1,0,0,0]
v_mad_u32_u16 v38, v38, 2, s85 op_sel:[1,0,0,0]
v_mfma_f32_32x32x16_f16 v[142:157], a[224:227], v[160:163], v[142:157]
ds_read_u16_d16_hi v31, v31
ds_read_u16 v32, v32
ds_read_u16_d16_hi v33, v33
ds_read_u16 v34, v34
v_mad_u32_u16 v39, v39, 2, s85 op_sel:[1,0,0,0]
v_mfma_f32_32x32x16_f16 v[110:125], a[228:231], v[164:167], v[110:125]
ds_read_u16_d16_hi v35, v35
ds_read_u16 v36, v36
ds_read_u16_d16_hi v37, v37
ds_read_u16 v38, v38
s_waitcnt lgkmcnt(13)
v_mfma_f32_32x32x16_f16 v[126:141], a[232:235], v[164:167], v[126:141]
ds_read_u16_d16_hi v39, v39
v_mfma_f32_32x32x16_f16 v[142:157], a[236:239], v[164:167], v[142:157]
v_or_b32 v48, v24, v25
v_mfma_f32_32x32x16_bf16 v[62:77], a[240:243], a[246:249], 0
v_mfma_f32_32x32x16_bf16 v[78:93], a[242:245], a[246:249], 0
s_waitcnt lgkmcnt(10)
v_or_b32 v49, v26, v27
v_mfma_f32_32x32x16_bf16 v[94:109], a[244:247], a[246:249], 0
v_or_b32 v50, v28, v29
v_mfma_f32_32x32x16_f16 v[62:77], a[216:219], v[40:43], v[62:77]
ds_read_b128 a[216:219], v2 offset:12288
v_mfma_f32_32x32x16_f16 v[78:93], a[220:223], v[40:43], v[78:93]
ds_read_b128 a[220:223], v2 offset:13312
s_waitcnt lgkmcnt(8)
v_or_b32 v51, v30, v31
v_mfma_f32_32x32x16_f16 v[94:109], a[224:227], v[40:43], v[94:109]
ds_read_b128 a[224:227], v2 offset:14336
v_mfma_f32_32x32x16_f16 v[62:77], a[228:231], v[44:47], v[62:77]
ds_read_b128 a[228:231], v2 offset:15360
v_or_b32 v52, v32, v33
v_mfma_f32_32x32x16_f16 v[78:93], a[232:235], v[44:47], v[78:93]
ds_read_b128 a[232:235], v2 offset:16384
s_waitcnt lgkmcnt(7)
v_or_b32 v53, v34, v35
v_mfma_f32_32x32x16_f16 v[94:109], a[236:239], v[44:47], v[94:109]
ds_read_b128 a[236:239], v2 offset:17408
v_mfma_f32_32x32x16_bf16 v[8:23], a[192:195], a[144:147], 0
ds_read_b128 a[192:195], v1 offset:18432
v_or_b32 v54, v36, v37
v_mfma_f32_32x32x16_bf16 v[8:23], a[196:199], a[148:151], v[8:23]
ds_read_b128 a[196:199], v1 offset:19456
v_mfma_f32_32x32x16_bf16 v[8:23], a[200:203], a[152:155], v[8:23]
ds_read_b128 a[200:203], v1 offset:20480
s_waitcnt lgkmcnt(5)
v_or_b32 v55, v38, v39
v_mfma_f32_32x32x16_bf16 v[8:23], a[204:207], a[156:159], v[8:23]
ds_read_b128 a[204:207], v1 offset:21504
v_mfma_f32_32x32x16_bf16 v[8:23], a[208:211], a[160:163], v[8:23]
ds_read_b128 a[208:211], v1 offset:22528
v_mfma_f32_32x32x16_bf16 v[8:23], a[212:215], a[164:167], v[8:23]
ds_read_b128 a[212:215], v1 offset:23552
s_nop 4
v_mfma_f32_32x32x16_f16 v[110:125], a[216:219], v[168:171], v[110:125]
s_nop 4
v_mad_u32_u16 v8, v8, 2, s85 op_sel:[1,0,0,0]
v_mfma_f32_32x32x16_f16 v[126:141], a[220:223], v[168:171], v[126:141]
ds_read_u16 v8, v8
v_mad_u32_u16 v9, v9, 2, s85 op_sel:[1,0,0,0]
v_mad_u32_u16 v10, v10, 2, s85 op_sel:[1,0,0,0]
v_mad_u32_u16 v11, v11, 2, s85 op_sel:[1,0,0,0]
v_mad_u32_u16 v12, v12, 2, s85 op_sel:[1,0,0,0]
v_mad_u32_u16 v13, v13, 2, s85 op_sel:[1,0,0,0]
v_mfma_f32_32x32x16_f16 v[142:157], a[224:227], v[168:171], v[142:157]
ds_read_u16_d16_hi v9, v9
ds_read_u16 v10, v10
ds_read_u16_d16_hi v11, v11
ds_read_u16 v12, v12
v_mad_u32_u16 v14, v14, 2, s85 op_sel:[1,0,0,0]
v_mfma_f32_32x32x16_f16 v[110:125], a[228:231], v[172:175], v[110:125]
ds_read_u16_d16_hi v13, v13
ds_read_u16 v14, v14
v_mad_u32_u16 v15, v15, 2, s85 op_sel:[1,0,0,0]
v_mad_u32_u16 v16, v16, 2, s85 op_sel:[1,0,0,0]
v_mad_u32_u16 v17, v17, 2, s85 op_sel:[1,0,0,0]
v_mad_u32_u16 v18, v18, 2, s85 op_sel:[1,0,0,0]
s_waitcnt lgkmcnt(6)
v_mfma_f32_32x32x16_f16 v[126:141], a[232:235], v[172:175], v[126:141]
ds_read_u16_d16_hi v15, v15
ds_read_u16 v16, v16
ds_read_u16_d16_hi v17, v17
ds_read_u16 v18, v18
v_mad_u32_u16 v19, v19, 2, s85 op_sel:[1,0,0,0]
v_mad_u32_u16 v20, v20, 2, s85 op_sel:[1,0,0,0]
v_mfma_f32_32x32x16_f16 v[142:157], a[236:239], v[172:175], v[142:157]
ds_read_u16_d16_hi v19, v19
v_mad_u32_u16 v21, v21, 2, s85 op_sel:[1,0,0,0]
v_mad_u32_u16 v22, v22, 2, s85 op_sel:[1,0,0,0]
v_mad_u32_u16 v23, v23, 2, s85 op_sel:[1,0,0,0]
ds_read_u16 v20, v20
v_mfma_f32_32x32x16_f16 v[62:77], a[216:219], v[48:51], v[62:77]
s_waitcnt lgkmcnt(9)
v_or_b32 v40, v8, v9
ds_read_b128 a[216:219], v2 offset:18432
ds_read_u16_d16_hi v21, v21
v_mfma_f32_32x32x16_f16 v[78:93], a[220:223], v[48:51], v[78:93]
ds_read_u16 v22, v22
ds_read_u16_d16_hi v23, v23
ds_read_b128 a[220:223], v2 offset:19456
v_or_b32 v41, v10, v11
v_mfma_f32_32x32x16_f16 v[94:109], a[224:227], v[48:51], v[94:109]
ds_read_b128 a[224:227], v2 offset:20480
v_mfma_f32_32x32x16_f16 v[62:77], a[228:231], v[52:55], v[62:77]
ds_read_b128 a[228:231], v2 offset:21504
s_waitcnt lgkmcnt(12)
v_or_b32 v42, v12, v13
v_mfma_f32_32x32x16_f16 v[78:93], a[232:235], v[52:55], v[78:93]
ds_read_b128 a[232:235], v2 offset:22528
v_mfma_f32_32x32x16_f16 v[94:109], a[236:239], v[52:55], v[94:109]
v_or_b32 v43, v14, v15
ds_read_b128 a[236:239], v2 offset:23552
s_waitcnt vmcnt(3)
v_smfmac_f32_32x32x32_bf16 v[62:77], a[250:253], a[168:175], v4
buffer_load_dwordx4 a[168:171], v5, s[4:7], s82 offen offset:64
buffer_load_dwordx4 a[172:175], v5, s[4:7], s82 offen offset:80
v_mfma_f32_32x32x16_bf16 v[24:39], a[192:195], a[144:147], 0
s_waitcnt lgkmcnt(10)
v_or_b32 v44, v16, v17
ds_read_b128 a[192:195], v1 offset:24576
v_mfma_f32_32x32x16_bf16 v[24:39], a[196:199], a[148:151], v[24:39]
ds_read_b128 a[196:199], v1 offset:25600
v_or_b32 v45, v18, v19
v_mfma_f32_32x32x16_bf16 v[24:39], a[200:203], a[152:155], v[24:39]
ds_read_b128 a[200:203], v1 offset:26624
v_mfma_f32_32x32x16_bf16 v[24:39], a[204:207], a[156:159], v[24:39]
ds_read_b128 a[204:207], v1 offset:27648
s_waitcnt lgkmcnt(9)
v_or_b32 v46, v20, v21
v_mfma_f32_32x32x16_bf16 v[24:39], a[208:211], a[160:163], v[24:39]
ds_read_b128 a[208:211], v1 offset:28672
v_mfma_f32_32x32x16_bf16 v[24:39], a[212:215], a[164:167], v[24:39]
ds_read_b128 a[212:215], v1 offset:29696
v_or_b32 v47, v22, v23
s_nop 3
v_mfma_f32_32x32x16_f16 v[110:125], a[216:219], v[176:179], v[110:125]
s_nop 4
v_mad_u32_u16 v24, v24, 2, s85 op_sel:[1,0,0,0]
s_waitcnt lgkmcnt(4)
v_mfma_f32_32x32x16_f16 v[126:141], a[220:223], v[176:179], v[126:141]
ds_read_u16 v24, v24
v_mad_u32_u16 v25, v25, 2, s85 op_sel:[1,0,0,0]
v_mad_u32_u16 v26, v26, 2, s85 op_sel:[1,0,0,0]
v_mad_u32_u16 v27, v27, 2, s85 op_sel:[1,0,0,0]
v_mad_u32_u16 v28, v28, 2, s85 op_sel:[1,0,0,0]
v_mad_u32_u16 v29, v29, 2, s85 op_sel:[1,0,0,0]
v_mfma_f32_32x32x16_f16 v[142:157], a[224:227], v[176:179], v[142:157]
ds_read_u16_d16_hi v25, v25
ds_read_u16 v26, v26
ds_read_u16_d16_hi v27, v27
ds_read_u16 v28, v28
v_mad_u32_u16 v30, v30, 2, s85 op_sel:[1,0,0,0]
v_mad_u32_u16 v31, v31, 2, s85 op_sel:[1,0,0,0]
v_mfma_f32_32x32x16_f16 v[110:125], a[228:231], v[180:183], v[110:125]
ds_read_u16_d16_hi v29, v29
ds_read_u16 v30, v30
ds_read_u16_d16_hi v31, v31
v_mad_u32_u16 v32, v32, 2, s85 op_sel:[1,0,0,0]
v_mad_u32_u16 v33, v33, 2, s85 op_sel:[1,0,0,0]
v_mfma_f32_32x32x16_f16 v[126:141], a[232:235], v[180:183], v[126:141]
ds_read_u16 v32, v32
ds_read_u16_d16_hi v33, v33
v_mad_u32_u16 v34, v34, 2, s85 op_sel:[1,0,0,0]
v_mad_u32_u16 v35, v35, 2, s85 op_sel:[1,0,0,0]
v_mad_u32_u16 v36, v36, 2, s85 op_sel:[1,0,0,0]
v_mad_u32_u16 v37, v37, 2, s85 op_sel:[1,0,0,0]
v_mfma_f32_32x32x16_f16 v[142:157], a[236:239], v[180:183], v[142:157]
ds_read_u16 v34, v34
ds_read_u16_d16_hi v35, v35
ds_read_u16 v36, v36
v_mad_u32_u16 v38, v38, 2, s85 op_sel:[1,0,0,0]
v_mad_u32_u16 v39, v39, 2, s85 op_sel:[1,0,0,0]
s_waitcnt vmcnt(3)
v_smfmac_f32_32x32x32_bf16 v[110:125], a[250:253], a[176:183], v4
buffer_load_dwordx4 a[176:179], v5, s[4:7], s83 offen offset:64
s_waitcnt lgkmcnt(9)
v_or_b32 v48, v24, v25
v_mfma_f32_32x32x16_f16 v[62:77], a[216:219], v[40:43], v[62:77]
ds_read_b128 a[216:219], v2 offset:24576
ds_read_u16_d16_hi v37, v37
buffer_load_dwordx4 a[180:183], v5, s[4:7], s83 offen offset:80
ds_read_u16 v38, v38
v_mfma_f32_32x32x16_f16 v[78:93], a[220:223], v[40:43], v[78:93]
v_or_b32 v49, v26, v27
ds_read_u16_d16_hi v39, v39
ds_read_b128 a[220:223], v2 offset:25600
v_mfma_f32_32x32x16_f16 v[94:109], a[224:227], v[40:43], v[94:109]
ds_read_b128 a[224:227], v2 offset:26624
s_waitcnt lgkmcnt(11)
v_or_b32 v50, v28, v29
v_mfma_f32_32x32x16_f16 v[62:77], a[228:231], v[44:47], v[62:77]
ds_read_b128 a[228:231], v2 offset:34560
v_mfma_f32_32x32x16_f16 v[78:93], a[232:235], v[44:47], v[78:93]
ds_read_b128 a[232:235], v2 offset:35584
v_or_b32 v51, v30, v31
v_mfma_f32_32x32x16_f16 v[94:109], a[236:239], v[44:47], v[94:109]
ds_read_b128 a[236:239], v2 offset:36608
v_mfma_f32_32x32x16_bf16 v[8:23], a[192:195], a[144:147], 0
s_waitcnt lgkmcnt(10)
v_or_b32 v52, v32, v33
ds_read_b128 a[192:195], v1 offset:30720
v_mfma_f32_32x32x16_bf16 v[8:23], a[196:199], a[148:151], v[8:23]
ds_read_b128 a[196:199], v1 offset:31744
v_or_b32 v53, v34, v35
v_mfma_f32_32x32x16_bf16 v[8:23], a[200:203], a[152:155], v[8:23]
ds_read_b128 a[200:203], v1 offset:32768
v_mfma_f32_32x32x16_bf16 v[8:23], a[204:207], a[156:159], v[8:23]
ds_read_b128 a[204:207], v1 offset:33792
v_mfma_f32_32x32x16_bf16 v[8:23], a[208:211], a[160:163], v[8:23]
ds_read_b128 a[208:211], v1 offset:34816
s_waitcnt lgkmcnt(9)
v_or_b32 v54, v36, v37
v_mfma_f32_32x32x16_bf16 v[8:23], a[212:215], a[164:167], v[8:23]
ds_read_b128 a[212:215], v1 offset:35840
v_or_b32 v55, v38, v39
v_mfma_f32_32x32x16_f16 v[110:125], a[216:219], v[184:187], v[110:125]
s_nop 5
v_mfma_f32_32x32x16_f16 v[126:141], a[220:223], v[184:187], v[126:141]
s_nop 1
v_mad_u32_u16 v8, v8, 2, s85 op_sel:[1,0,0,0]
v_mad_u32_u16 v9, v9, 2, s85 op_sel:[1,0,0,0]
v_mad_u32_u16 v10, v10, 2, s85 op_sel:[1,0,0,0]
v_mad_u32_u16 v11, v11, 2, s85 op_sel:[1,0,0,0]
s_waitcnt lgkmcnt(3)
v_mfma_f32_32x32x16_f16 v[142:157], a[224:227], v[184:187], v[142:157]
ds_read_u16 v8, v8
ds_read_u16_d16_hi v9, v9
ds_read_u16 v10, v10
ds_read_u16_d16_hi v11, v11
v_mad_u32_u16 v12, v12, 2, s85 op_sel:[1,0,0,0]
v_mad_u32_u16 v13, v13, 2, s85 op_sel:[1,0,0,0]
v_mfma_f32_32x32x16_f16 v[110:125], a[228:231], v[188:191], v[110:125]
ds_read_u16 v12, v12
ds_read_u16_d16_hi v13, v13
v_mad_u32_u16 v14, v14, 2, s85 op_sel:[1,0,0,0]
v_mad_u32_u16 v15, v15, 2, s85 op_sel:[1,0,0,0]
v_mad_u32_u16 v16, v16, 2, s85 op_sel:[1,0,0,0]
v_mad_u32_u16 v17, v17, 2, s85 op_sel:[1,0,0,0]
v_mfma_f32_32x32x16_f16 v[126:141], a[232:235], v[188:191], v[126:141]
ds_read_u16 v14, v14
ds_read_u16_d16_hi v15, v15
ds_read_u16 v16, v16
ds_read_u16_d16_hi v17, v17
v_mad_u32_u16 v18, v18, 2, s85 op_sel:[1,0,0,0]
v_mad_u32_u16 v19, v19, 2, s85 op_sel:[1,0,0,0]
v_mfma_f32_32x32x16_f16 v[142:157], a[236:239], v[188:191], v[142:157]
ds_read_u16 v18, v18
ds_read_u16_d16_hi v19, v19
v_mad_u32_u16 v20, v20, 2, s85 op_sel:[1,0,0,0]
v_mad_u32_u16 v21, v21, 2, s85 op_sel:[1,0,0,0]
v_mad_u32_u16 v22, v22, 2, s85 op_sel:[1,0,0,0]
v_mfma_f32_32x32x16_f16 v[62:77], a[216:219], v[48:51], v[62:77]
v_mad_u32_u16 v23, v23, 2, s85 op_sel:[1,0,0,0]
ds_read_b128 a[216:219], v2 offset:37632
ds_read_u16 v20, v20
ds_read_u16_d16_hi v21, v21
v_mfma_f32_32x32x16_f16 v[78:93], a[220:223], v[48:51], v[78:93]
s_waitcnt lgkmcnt(11)
v_or_b32 v40, v8, v9
ds_read_u16 v22, v22
ds_read_u16_d16_hi v23, v23
v_mfma_f32_32x32x16_f16 v[94:109], a[224:227], v[48:51], v[94:109]
ds_read_b128 a[220:223], v2 offset:38656
ds_read_b128 a[224:227], v2 offset:39680
v_mfma_f32_32x32x16_f16 v[62:77], a[228:231], v[52:55], v[62:77]
v_or_b32 v41, v10, v11
ds_read_b128 a[228:231], v2 offset:40704
v_mfma_f32_32x32x16_f16 v[78:93], a[232:235], v[52:55], v[78:93]
ds_read_b128 a[232:235], v2 offset:41728
s_waitcnt lgkmcnt(13)
v_or_b32 v42, v12, v13
v_mfma_f32_32x32x16_f16 v[94:109], a[236:239], v[52:55], v[94:109]
ds_read_b128 a[236:239], v2 offset:42752
v_mfma_f32_32x32x16_bf16 v[24:39], a[192:195], a[144:147], 0
v_or_b32 v43, v14, v15
ds_read_b128 a[192:195], v1 offset:36864
v_mfma_f32_32x32x16_bf16 v[24:39], a[196:199], a[148:151], v[24:39]
ds_read_b128 a[196:199], v1 offset:37888
s_waitcnt lgkmcnt(12)
v_or_b32 v44, v16, v17
v_mfma_f32_32x32x16_bf16 v[24:39], a[200:203], a[152:155], v[24:39]
ds_read_b128 a[200:203], v1 offset:38912
v_mfma_f32_32x32x16_bf16 v[24:39], a[204:207], a[156:159], v[24:39]
ds_read_b128 a[204:207], v1 offset:39936
v_or_b32 v45, v18, v19
v_mfma_f32_32x32x16_bf16 v[24:39], a[208:211], a[160:163], v[24:39]
ds_read_b128 a[208:211], v1 offset:40960
v_mfma_f32_32x32x16_bf16 v[24:39], a[212:215], a[164:167], v[24:39]
ds_read_b128 a[212:215], v1 offset:41984
s_waitcnt lgkmcnt(11)
v_or_b32 v46, v20, v21
v_mfma_f32_32x32x16_f16 v[110:125], a[216:219], v[192:195], v[110:125]
s_nop 7
v_mad_u32_u16 v24, v24, 2, s85 op_sel:[1,0,0,0]
v_or_b32 v47, v22, v23
v_mad_u32_u16 v25, v25, 2, s85 op_sel:[1,0,0,0]
v_mad_u32_u16 v26, v26, 2, s85 op_sel:[1,0,0,0]
v_mad_u32_u16 v27, v27, 2, s85 op_sel:[1,0,0,0]
s_waitcnt lgkmcnt(7)
v_mfma_f32_32x32x16_f16 v[126:141], a[220:223], v[192:195], v[126:141]
ds_read_u16 v24, v24
ds_read_u16_d16_hi v25, v25
ds_read_u16 v26, v26
v_mad_u32_u16 v28, v28, 2, s85 op_sel:[1,0,0,0]
v_mad_u32_u16 v29, v29, 2, s85 op_sel:[1,0,0,0]
v_mad_u32_u16 v30, v30, 2, s85 op_sel:[1,0,0,0]
v_mfma_f32_32x32x16_f16 v[142:157], a[224:227], v[192:195], v[142:157]
ds_read_u16_d16_hi v27, v27
ds_read_u16 v28, v28
v_mad_u32_u16 v31, v31, 2, s85 op_sel:[1,0,0,0]
v_mad_u32_u16 v32, v32, 2, s85 op_sel:[1,0,0,0]
v_mad_u32_u16 v33, v33, 2, s85 op_sel:[1,0,0,0]
v_mad_u32_u16 v34, v34, 2, s85 op_sel:[1,0,0,0]
v_mfma_f32_32x32x16_f16 v[110:125], a[228:231], v[196:199], v[110:125]
ds_read_u16_d16_hi v29, v29
ds_read_u16 v30, v30
v_mad_u32_u16 v35, v35, 2, s85 op_sel:[1,0,0,0]
v_mad_u32_u16 v36, v36, 2, s85 op_sel:[1,0,0,0]
v_mad_u32_u16 v37, v37, 2, s85 op_sel:[1,0,0,0]
v_mad_u32_u16 v38, v38, 2, s85 op_sel:[1,0,0,0]
v_mfma_f32_32x32x16_f16 v[126:141], a[232:235], v[196:199], v[126:141]
ds_read_u16_d16_hi v31, v31
ds_read_u16 v32, v32
v_mad_u32_u16 v39, v39, 2, s85 op_sel:[1,0,0,0]
ds_read_u16_d16_hi v33, v33
s_waitcnt lgkmcnt(9)
v_mfma_f32_32x32x16_f16 v[142:157], a[236:239], v[196:199], v[142:157]
ds_read_u16 v34, v34
ds_read_u16_d16_hi v35, v35
ds_read_u16 v36, v36
ds_read_u16_d16_hi v37, v37
ds_read_u16 v38, v38
v_mfma_f32_32x32x16_f16 v[62:77], a[216:219], v[40:43], v[62:77]
ds_read_u16_d16_hi v39, v39
v_mfma_f32_32x32x16_f16 v[78:93], a[220:223], v[40:43], v[78:93]
s_waitcnt lgkmcnt(12)
v_or_b32 v48, v24, v25
ds_read_b128 a[216:219], v2 offset:43776
v_mfma_f32_32x32x16_f16 v[94:109], a[224:227], v[40:43], v[94:109]
ds_read_b128 a[220:223], v2 offset:44800
ds_read_b128 a[224:227], v2 offset:45824
v_mfma_f32_32x32x16_f16 v[62:77], a[228:231], v[44:47], v[62:77]
v_or_b32 v49, v26, v27
ds_read_b128 a[228:231], v2 offset:46848
v_mfma_f32_32x32x16_f16 v[78:93], a[232:235], v[44:47], v[78:93]
ds_read_b128 a[232:235], v2 offset:47872
s_waitcnt lgkmcnt(13)
v_or_b32 v50, v28, v29
v_mfma_f32_32x32x16_f16 v[94:109], a[236:239], v[44:47], v[94:109]
ds_read_b128 a[236:239], v2 offset:48896
v_mfma_f32_32x32x16_bf16 v[8:23], a[192:195], a[144:147], 0
v_or_b32 v51, v30, v31
ds_read_b128 a[192:195], v1 offset:43008
v_mfma_f32_32x32x16_bf16 v[8:23], a[196:199], a[148:151], v[8:23]
ds_read_b128 a[196:199], v1 offset:44032
s_waitcnt lgkmcnt(12)
v_or_b32 v52, v32, v33
v_mfma_f32_32x32x16_bf16 v[8:23], a[200:203], a[152:155], v[8:23]
ds_read_b128 a[200:203], v1 offset:45056
v_mfma_f32_32x32x16_bf16 v[8:23], a[204:207], a[156:159], v[8:23]
ds_read_b128 a[204:207], v1 offset:46080
v_or_b32 v53, v34, v35
v_mfma_f32_32x32x16_bf16 v[8:23], a[208:211], a[160:163], v[8:23]
ds_read_b128 a[208:211], v1 offset:47104
v_mfma_f32_32x32x16_bf16 v[8:23], a[212:215], a[164:167], v[8:23]
s_waitcnt lgkmcnt(11)
v_or_b32 v54, v36, v37
ds_read_b128 a[212:215], v1 offset:48128
v_or_b32 v55, v38, v39
s_nop 2
s_waitcnt lgkmcnt(8)
v_mfma_f32_32x32x16_f16 v[110:125], a[216:219], v[200:203], v[110:125]
s_nop 2
v_mad_u32_u16 v8, v8, 2, s85 op_sel:[1,0,0,0]
v_mad_u32_u16 v9, v9, 2, s85 op_sel:[1,0,0,0]
v_mad_u32_u16 v10, v10, 2, s85 op_sel:[1,0,0,0]
v_mfma_f32_32x32x16_f16 v[126:141], a[220:223], v[200:203], v[126:141]
ds_read_u16 v8, v8
ds_read_u16_d16_hi v9, v9
ds_read_u16 v10, v10
v_mad_u32_u16 v11, v11, 2, s85 op_sel:[1,0,0,0]
v_mad_u32_u16 v12, v12, 2, s85 op_sel:[1,0,0,0]
v_mfma_f32_32x32x16_f16 v[142:157], a[224:227], v[200:203], v[142:157]
ds_read_u16_d16_hi v11, v11
ds_read_u16 v12, v12
v_mad_u32_u16 v13, v13, 2, s85 op_sel:[1,0,0,0]
v_mad_u32_u16 v14, v14, 2, s85 op_sel:[1,0,0,0]
v_mad_u32_u16 v15, v15, 2, s85 op_sel:[1,0,0,0]
v_mad_u32_u16 v16, v16, 2, s85 op_sel:[1,0,0,0]
v_mfma_f32_32x32x16_f16 v[110:125], a[228:231], v[204:207], v[110:125]
ds_read_u16_d16_hi v13, v13
ds_read_u16 v14, v14
ds_read_u16_d16_hi v15, v15
v_mad_u32_u16 v17, v17, 2, s85 op_sel:[1,0,0,0]
v_mad_u32_u16 v18, v18, 2, s85 op_sel:[1,0,0,0]
v_mad_u32_u16 v19, v19, 2, s85 op_sel:[1,0,0,0]
s_waitcnt lgkmcnt(8)
v_mfma_f32_32x32x16_f16 v[126:141], a[232:235], v[204:207], v[126:141]
ds_read_u16 v16, v16
ds_read_u16_d16_hi v17, v17
ds_read_u16 v18, v18
v_mad_u32_u16 v20, v20, 2, s85 op_sel:[1,0,0,0]
v_mad_u32_u16 v21, v21, 2, s85 op_sel:[1,0,0,0]
v_mad_u32_u16 v22, v22, 2, s85 op_sel:[1,0,0,0]
v_mfma_f32_32x32x16_f16 v[142:157], a[236:239], v[204:207], v[142:157]
ds_read_u16_d16_hi v19, v19
v_mad_u32_u16 v23, v23, 2, s85 op_sel:[1,0,0,0]
ds_read_u16 v20, v20
ds_read_u16_d16_hi v21, v21
v_mfma_f32_32x32x16_f16 v[62:77], a[216:219], v[48:51], v[62:77]
ds_read_u16 v22, v22
ds_read_u16_d16_hi v23, v23
ds_read_b128 a[216:219], v2 offset:49920
s_waitcnt lgkmcnt(13)
v_or_b32 v40, v8, v9
v_mfma_f32_32x32x16_f16 v[78:93], a[220:223], v[48:51], v[78:93]
ds_read_b128 a[220:223], v2 offset:50944
v_mfma_f32_32x32x16_f16 v[94:109], a[224:227], v[48:51], v[94:109]
v_or_b32 v41, v10, v11
ds_read_b128 a[224:227], v2 offset:51968
v_mfma_f32_32x32x16_f16 v[62:77], a[228:231], v[52:55], v[62:77]
ds_read_b128 a[228:231], v2 offset:52992
v_mfma_f32_32x32x16_f16 v[78:93], a[232:235], v[52:55], v[78:93]
s_waitcnt lgkmcnt(12)
v_or_b32 v42, v12, v13
ds_read_b128 a[232:235], v2 offset:54016
v_mfma_f32_32x32x16_f16 v[94:109], a[236:239], v[52:55], v[94:109]
ds_read_b128 a[236:239], v2 offset:55040
v_or_b32 v43, v14, v15
v_mfma_f32_32x32x16_bf16 v[24:39], a[192:195], a[144:147], 0
ds_read_b128 a[192:195], v1 offset:49152
s_waitcnt vmcnt(2)
v_smfmac_f32_32x32x32_bf16 v[78:93], a[250:253], a[168:175], v4
buffer_load_dwordx4 a[168:171], v5, s[4:7], s82 offen offset:128
s_waitcnt lgkmcnt(11)
v_or_b32 v44, v16, v17
v_mfma_f32_32x32x16_bf16 v[24:39], a[196:199], a[148:151], v[24:39]
buffer_load_dwordx4 a[172:175], v5, s[4:7], s82 offen offset:144
ds_read_b128 a[196:199], v1 offset:50176
v_mfma_f32_32x32x16_bf16 v[24:39], a[200:203], a[152:155], v[24:39]
v_or_b32 v45, v18, v19
ds_read_b128 a[200:203], v1 offset:51200
v_mfma_f32_32x32x16_bf16 v[24:39], a[204:207], a[156:159], v[24:39]
ds_read_b128 a[204:207], v1 offset:52224
s_waitcnt lgkmcnt(10)
v_or_b32 v46, v20, v21
v_mfma_f32_32x32x16_bf16 v[24:39], a[208:211], a[160:163], v[24:39]
ds_read_b128 a[208:211], v1 offset:53248
v_mfma_f32_32x32x16_bf16 v[24:39], a[212:215], a[164:167], v[24:39]
ds_read_b128 a[212:215], v1 offset:54272
v_or_b32 v47, v22, v23
s_nop 3
s_waitcnt lgkmcnt(8)
v_mfma_f32_32x32x16_f16 v[110:125], a[216:219], v[208:211], v[110:125]
s_nop 3
v_mad_u32_u16 v24, v24, 2, s85 op_sel:[1,0,0,0]
v_mad_u32_u16 v25, v25, 2, s85 op_sel:[1,0,0,0]
v_mfma_f32_32x32x16_f16 v[126:141], a[220:223], v[208:211], v[126:141]
ds_read_u16 v24, v24
ds_read_u16_d16_hi v25, v25
v_mad_u32_u16 v26, v26, 2, s85 op_sel:[1,0,0,0]
v_mad_u32_u16 v27, v27, 2, s85 op_sel:[1,0,0,0]
v_mad_u32_u16 v28, v28, 2, s85 op_sel:[1,0,0,0]
v_mad_u32_u16 v29, v29, 2, s85 op_sel:[1,0,0,0]
v_mfma_f32_32x32x16_f16 v[142:157], a[224:227], v[208:211], v[142:157]
ds_read_u16 v26, v26
ds_read_u16_d16_hi v27, v27
ds_read_u16 v28, v28
ds_read_u16_d16_hi v29, v29
v_mad_u32_u16 v30, v30, 2, s85 op_sel:[1,0,0,0]
v_mfma_f32_32x32x16_f16 v[110:125], a[228:231], v[212:215], v[110:125]
ds_read_u16 v30, v30
s_add_u32 s101, s3, 53248
buffer_load_dwordx4 a[184:187], v1, s[12:15], s101 offen offset:0
v_mad_u32_u16 v31, v31, 2, s85 op_sel:[1,0,0,0]
s_waitcnt lgkmcnt(7)
v_mfma_f32_32x32x16_f16 v[126:141], a[232:235], v[212:215], v[126:141]
ds_read_u16_d16_hi v31, v31
v_mad_u32_u16 v32, v32, 2, s85 op_sel:[1,0,0,0]
v_mad_u32_u16 v33, v33, 2, s85 op_sel:[1,0,0,0]
v_mad_u32_u16 v34, v34, 2, s85 op_sel:[1,0,0,0]
v_mad_u32_u16 v35, v35, 2, s85 op_sel:[1,0,0,0]
v_mad_u32_u16 v36, v36, 2, s85 op_sel:[1,0,0,0]
v_mfma_f32_32x32x16_f16 v[142:157], a[236:239], v[212:215], v[142:157]
ds_read_u16 v32, v32
ds_read_u16_d16_hi v33, v33
ds_read_u16 v34, v34
ds_read_u16_d16_hi v35, v35
v_mad_u32_u16 v37, v37, 2, s85 op_sel:[1,0,0,0]
v_mad_u32_u16 v38, v38, 2, s85 op_sel:[1,0,0,0]
v_mad_u32_u16 v39, v39, 2, s85 op_sel:[1,0,0,0]
ds_read_u16 v36, v36
s_waitcnt lgkmcnt(9)
v_or_b32 v48, v24, v25
ds_read_u16_d16_hi v37, v37
s_waitcnt vmcnt(3)
v_smfmac_f32_32x32x32_bf16 v[126:141], a[250:253], a[176:183], v4
ds_read_u16 v38, v38
buffer_load_dwordx4 a[188:191], v1, s[12:15], s101 offen offset:1024
buffer_load_dwordx4 a[176:179], v5, s[4:7], s83 offen offset:128
v_mfma_f32_32x32x16_f16 v[62:77], a[216:219], v[40:43], v[62:77]
ds_read_b128 a[216:219], v2 offset:56064
v_or_b32 v49, v26, v27
buffer_load_dwordx4 a[180:183], v5, s[4:7], s83 offen offset:144
v_mfma_f32_32x32x16_f16 v[78:93], a[220:223], v[40:43], v[78:93]
ds_read_b128 a[220:223], v2 offset:57088
ds_read_u16_d16_hi v39, v39
s_waitcnt lgkmcnt(10)
v_or_b32 v50, v28, v29
v_mfma_f32_32x32x16_f16 v[94:109], a[224:227], v[40:43], v[94:109]
ds_read_b128 a[224:227], v2 offset:58112
v_mfma_f32_32x32x16_f16 v[62:77], a[228:231], v[44:47], v[62:77]
ds_read_b128 a[228:231], v2 offset:59136
v_or_b32 v51, v30, v31
v_mfma_f32_32x32x16_f16 v[78:93], a[232:235], v[44:47], v[78:93]
ds_read_b128 a[232:235], v2 offset:60160
s_waitcnt lgkmcnt(9)
v_or_b32 v52, v32, v33
v_mfma_f32_32x32x16_f16 v[94:109], a[236:239], v[44:47], v[94:109]
ds_read_b128 a[236:239], v2 offset:61184
v_mfma_f32_32x32x16_bf16 v[8:23], a[192:195], a[144:147], 0
ds_read_b128 a[192:195], v1 offset:55296
v_or_b32 v53, v34, v35
v_mfma_f32_32x32x16_bf16 v[8:23], a[196:199], a[148:151], v[8:23]
ds_read_b128 a[196:199], v1 offset:56320
v_mfma_f32_32x32x16_bf16 v[8:23], a[200:203], a[152:155], v[8:23]
ds_read_b128 a[200:203], v1 offset:57344
s_waitcnt lgkmcnt(8)
v_or_b32 v54, v36, v37
v_mfma_f32_32x32x16_bf16 v[8:23], a[204:207], a[156:159], v[8:23]
ds_read_b128 a[204:207], v1 offset:58368
v_mfma_f32_32x32x16_bf16 v[8:23], a[208:211], a[160:163], v[8:23]
ds_read_b128 a[208:211], v1 offset:59392
s_waitcnt lgkmcnt(6)
v_or_b32 v55, v38, v39
v_mfma_f32_32x32x16_bf16 v[8:23], a[212:215], a[164:167], v[8:23]
ds_read_b128 a[212:215], v1 offset:60416
s_nop 4
v_mfma_f32_32x32x16_f16 v[110:125], a[216:219], v[216:219], v[110:125]
s_nop 4
v_mad_u32_u16 v8, v8, 2, s85 op_sel:[1,0,0,0]
v_mfma_f32_32x32x16_f16 v[126:141], a[220:223], v[216:219], v[126:141]
ds_read_u16 v8, v8
v_mad_u32_u16 v9, v9, 2, s85 op_sel:[1,0,0,0]
v_mad_u32_u16 v10, v10, 2, s85 op_sel:[1,0,0,0]
v_mad_u32_u16 v11, v11, 2, s85 op_sel:[1,0,0,0]
v_mad_u32_u16 v12, v12, 2, s85 op_sel:[1,0,0,0]
v_mfma_f32_32x32x16_f16 v[142:157], a[224:227], v[216:219], v[142:157]
ds_read_u16_d16_hi v9, v9
ds_read_u16 v10, v10
ds_read_u16_d16_hi v11, v11
ds_read_u16 v12, v12
v_mad_u32_u16 v13, v13, 2, s85 op_sel:[1,0,0,0]
v_mad_u32_u16 v14, v14, 2, s85 op_sel:[1,0,0,0]
v_mfma_f32_32x32x16_f16 v[110:125], a[228:231], v[220:223], v[110:125]
ds_read_u16_d16_hi v13, v13
ds_read_u16 v14, v14
v_mad_u32_u16 v15, v15, 2, s85 op_sel:[1,0,0,0]
v_mad_u32_u16 v16, v16, 2, s85 op_sel:[1,0,0,0]
v_mad_u32_u16 v17, v17, 2, s85 op_sel:[1,0,0,0]
v_mad_u32_u16 v18, v18, 2, s85 op_sel:[1,0,0,0]
v_mfma_f32_32x32x16_f16 v[126:141], a[232:235], v[220:223], v[126:141]
ds_read_u16_d16_hi v15, v15
ds_read_u16 v16, v16
ds_read_u16_d16_hi v17, v17
v_mad_u32_u16 v19, v19, 2, s85 op_sel:[1,0,0,0]
v_mad_u32_u16 v20, v20, 2, s85 op_sel:[1,0,0,0]
s_waitcnt lgkmcnt(8)
v_mfma_f32_32x32x16_f16 v[142:157], a[236:239], v[220:223], v[142:157]
ds_read_u16 v18, v18
ds_read_u16_d16_hi v19, v19
ds_read_u16 v20, v20
v_mad_u32_u16 v21, v21, 2, s85 op_sel:[1,0,0,0]
v_mad_u32_u16 v22, v22, 2, s85 op_sel:[1,0,0,0]
v_mad_u32_u16 v23, v23, 2, s85 op_sel:[1,0,0,0]
v_mfma_f32_32x32x16_f16 v[62:77], a[216:219], v[48:51], v[62:77]
ds_read_b128 a[216:219], v2 offset:62208
v_or_b32 v40, v8, v9
ds_read_u16_d16_hi v21, v21
ds_read_u16 v22, v22
v_mfma_f32_32x32x16_f16 v[78:93], a[220:223], v[48:51], v[78:93]
ds_read_u16_d16_hi v23, v23
ds_read_b128 a[220:223], v2 offset:63232
s_waitcnt lgkmcnt(12)
v_or_b32 v41, v10, v11
v_mfma_f32_32x32x16_f16 v[94:109], a[224:227], v[48:51], v[94:109]
ds_read_b128 a[224:227], v2 offset:64256
v_mfma_f32_32x32x16_f16 v[62:77], a[228:231], v[52:55], v[62:77]
ds_read_b128 a[228:231], v2 offset:65280
v_or_b32 v42, v12, v13
v_mfma_f32_32x32x16_f16 v[78:93], a[232:235], v[52:55], v[78:93]
ds_read_b128 a[232:235], v3 offset:768
v_mfma_f32_32x32x16_f16 v[94:109], a[236:239], v[52:55], v[94:109]
s_waitcnt lgkmcnt(11)
v_or_b32 v43, v14, v15
ds_read_b128 a[236:239], v3 offset:1792
v_mfma_f32_32x32x16_bf16 v[24:39], a[192:195], a[144:147], 0
ds_read_b128 a[192:195], v1 offset:61440
v_or_b32 v44, v16, v17
v_mfma_f32_32x32x16_bf16 v[24:39], a[196:199], a[148:151], v[24:39]
ds_read_b128 a[196:199], v1 offset:62464
v_mfma_f32_32x32x16_bf16 v[24:39], a[200:203], a[152:155], v[24:39]
ds_read_b128 a[200:203], v1 offset:63488
s_waitcnt lgkmcnt(11)
v_or_b32 v45, v18, v19
v_mfma_f32_32x32x16_bf16 v[24:39], a[204:207], a[156:159], v[24:39]
ds_read_b128 a[204:207], v1 offset:64512
v_mfma_f32_32x32x16_bf16 v[24:39], a[208:211], a[160:163], v[24:39]
ds_read_b128 a[208:211], v2 offset:0
s_waitcnt lgkmcnt(10)
v_or_b32 v46, v20, v21
v_mfma_f32_32x32x16_bf16 v[24:39], a[212:215], a[164:167], v[24:39]
ds_read_b128 a[212:215], v2 offset:1024
s_nop 4
v_mfma_f32_32x32x16_f16 v[110:125], a[216:219], v[224:227], v[110:125]
v_or_b32 v47, v22, v23
s_nop 2
s_waitcnt lgkmcnt(7)
v_mfma_f32_32x32x16_f16 v[126:141], a[220:223], v[224:227], v[126:141]
v_mad_u32_u16 v24, v24, 2, s85 op_sel:[1,0,0,0]
v_mad_u32_u16 v25, v25, 2, s85 op_sel:[1,0,0,0]
v_mad_u32_u16 v26, v26, 2, s85 op_sel:[1,0,0,0]
v_mad_u32_u16 v27, v27, 2, s85 op_sel:[1,0,0,0]
v_mad_u32_u16 v28, v28, 2, s85 op_sel:[1,0,0,0]
v_mad_u32_u16 v29, v29, 2, s85 op_sel:[1,0,0,0]
v_mfma_f32_32x32x16_f16 v[142:157], a[224:227], v[224:227], v[142:157]
ds_read_u16 v24, v24
ds_read_u16_d16_hi v25, v25
ds_read_u16 v26, v26
v_mad_u32_u16 v30, v30, 2, s85 op_sel:[1,0,0,0]
v_mad_u32_u16 v31, v31, 2, s85 op_sel:[1,0,0,0]
v_mfma_f32_32x32x16_f16 v[110:125], a[228:231], v[228:231], v[110:125]
ds_read_u16_d16_hi v27, v27
ds_read_u16 v28, v28
ds_read_u16_d16_hi v29, v29
ds_read_u16 v30, v30
v_mad_u32_u16 v32, v32, 2, s85 op_sel:[1,0,0,0]
v_mad_u32_u16 v33, v33, 2, s85 op_sel:[1,0,0,0]
v_mfma_f32_32x32x16_f16 v[126:141], a[232:235], v[228:231], v[126:141]
ds_read_u16_d16_hi v31, v31
ds_read_u16 v32, v32
v_mad_u32_u16 v34, v34, 2, s85 op_sel:[1,0,0,0]
v_mad_u32_u16 v35, v35, 2, s85 op_sel:[1,0,0,0]
v_mad_u32_u16 v36, v36, 2, s85 op_sel:[1,0,0,0]
v_mad_u32_u16 v37, v37, 2, s85 op_sel:[1,0,0,0]
s_waitcnt lgkmcnt(8)
v_mfma_f32_32x32x16_f16 v[142:157], a[236:239], v[228:231], v[142:157]
ds_read_u16_d16_hi v33, v33
ds_read_u16 v34, v34
ds_read_u16_d16_hi v35, v35
v_mad_u32_u16 v38, v38, 2, s85 op_sel:[1,0,0,0]
v_mad_u32_u16 v39, v39, 2, s85 op_sel:[1,0,0,0]
v_mfma_f32_32x32x16_f16 v[62:77], a[216:219], v[40:43], v[62:77]
ds_read_u16 v36, v36
ds_read_u16_d16_hi v37, v37
ds_read_u16 v38, v38
ds_read_u16_d16_hi v39, v39
v_mfma_f32_32x32x16_f16 v[78:93], a[220:223], v[40:43], v[78:93]
v_lshl_add_u64 v[158:159], v[158:159], 0, s[42:43]
global_load_dword a255, v[158:159], off
s_waitcnt lgkmcnt(11)
v_or_b32 v48, v24, v25
v_mfma_f32_32x32x16_f16 v[94:109], a[224:227], v[40:43], v[94:109]
ds_read_b128 a[216:219], v3 offset:2816
ds_read_b128 a[220:223], v3 offset:3840
v_or_b32 v49, v26, v27
ds_read_b128 a[224:227], v3 offset:4864
v_mfma_f32_32x32x16_f16 v[62:77], a[228:231], v[44:47], v[62:77]
ds_read_b128 a[228:231], v3 offset:5888
v_mfma_f32_32x32x16_f16 v[78:93], a[232:235], v[44:47], v[78:93]
s_waitcnt lgkmcnt(12)
v_or_b32 v50, v28, v29
ds_read_b128 a[232:235], v3 offset:6912
v_mfma_f32_32x32x16_f16 v[94:109], a[236:239], v[44:47], v[94:109]
ds_read_b128 a[236:239], v3 offset:7936
v_mfma_f32_32x32x16_bf16 v[8:23], a[192:195], a[144:147], 0
v_or_b32 v51, v30, v31
ds_read_b128 a[192:195], v2 offset:2048
v_mfma_f32_32x32x16_bf16 v[8:23], a[196:199], a[148:151], v[8:23]
ds_read_b128 a[196:199], v2 offset:3072
s_waitcnt lgkmcnt(12)
v_or_b32 v52, v32, v33
v_mfma_f32_32x32x16_bf16 v[8:23], a[200:203], a[152:155], v[8:23]
ds_read_b128 a[200:203], v2 offset:4096
v_mfma_f32_32x32x16_bf16 v[8:23], a[204:207], a[156:159], v[8:23]
v_or_b32 v53, v34, v35
ds_read_b128 a[204:207], v2 offset:5120
v_mfma_f32_32x32x16_bf16 v[8:23], a[208:211], a[160:163], v[8:23]
ds_read_b128 a[208:211], v3 offset:26368
v_mfma_f32_32x32x16_bf16 v[8:23], a[212:215], a[164:167], v[8:23]
s_waitcnt lgkmcnt(11)
v_or_b32 v54, v36, v37
ds_read_b128 a[212:215], v3 offset:27392
v_or_b32 v55, v38, v39
s_nop 2
s_waitcnt lgkmcnt(8)
v_mfma_f32_32x32x16_f16 v[110:125], a[216:219], v[232:235], v[110:125]
s_nop 2
v_mad_u32_u16 v8, v8, 2, s85 op_sel:[1,0,0,0]
v_mad_u32_u16 v9, v9, 2, s85 op_sel:[1,0,0,0]
v_mad_u32_u16 v10, v10, 2, s85 op_sel:[1,0,0,0]
v_mfma_f32_32x32x16_f16 v[126:141], a[220:223], v[232:235], v[126:141]
ds_read_u16 v8, v8
ds_read_u16_d16_hi v9, v9
ds_read_u16 v10, v10
v_mad_u32_u16 v11, v11, 2, s85 op_sel:[1,0,0,0]
v_mad_u32_u16 v12, v12, 2, s85 op_sel:[1,0,0,0]
v_mfma_f32_32x32x16_f16 v[142:157], a[224:227], v[232:235], v[142:157]
ds_read_u16_d16_hi v11, v11
ds_read_u16 v12, v12
v_mad_u32_u16 v13, v13, 2, s85 op_sel:[1,0,0,0]
v_mad_u32_u16 v14, v14, 2, s85 op_sel:[1,0,0,0]
v_mad_u32_u16 v15, v15, 2, s85 op_sel:[1,0,0,0]
v_mad_u32_u16 v16, v16, 2, s85 op_sel:[1,0,0,0]
v_mfma_f32_32x32x16_f16 v[110:125], a[228:231], v[236:239], v[110:125]
ds_read_u16_d16_hi v13, v13
ds_read_u16 v14, v14
ds_read_u16_d16_hi v15, v15
v_mad_u32_u16 v17, v17, 2, s85 op_sel:[1,0,0,0]
v_mad_u32_u16 v18, v18, 2, s85 op_sel:[1,0,0,0]
v_mad_u32_u16 v19, v19, 2, s85 op_sel:[1,0,0,0]
s_waitcnt lgkmcnt(8)
v_mfma_f32_32x32x16_f16 v[126:141], a[232:235], v[236:239], v[126:141]
ds_read_u16 v16, v16
ds_read_u16_d16_hi v17, v17
ds_read_u16 v18, v18
v_mad_u32_u16 v20, v20, 2, s85 op_sel:[1,0,0,0]
v_mad_u32_u16 v21, v21, 2, s85 op_sel:[1,0,0,0]
v_mad_u32_u16 v22, v22, 2, s85 op_sel:[1,0,0,0]
v_mfma_f32_32x32x16_f16 v[142:157], a[236:239], v[236:239], v[142:157]
ds_read_u16_d16_hi v19, v19
v_mad_u32_u16 v23, v23, 2, s85 op_sel:[1,0,0,0]
ds_read_u16 v20, v20
ds_read_u16_d16_hi v21, v21
v_mfma_f32_32x32x16_f16 v[62:77], a[216:219], v[48:51], v[62:77]
ds_read_u16 v22, v22
ds_read_u16_d16_hi v23, v23
ds_read_b128 a[216:219], v3 offset:8960
s_waitcnt lgkmcnt(13)
v_or_b32 v40, v8, v9
v_mfma_f32_32x32x16_f16 v[78:93], a[220:223], v[48:51], v[78:93]
ds_read_b128 a[220:223], v3 offset:9984
v_mfma_f32_32x32x16_f16 v[94:109], a[224:227], v[48:51], v[94:109]
v_or_b32 v41, v10, v11
ds_read_b128 a[224:227], v3 offset:11008
v_mfma_f32_32x32x16_f16 v[62:77], a[228:231], v[52:55], v[62:77]
ds_read_b128 a[228:231], v3 offset:12032
v_mfma_f32_32x32x16_f16 v[78:93], a[232:235], v[52:55], v[78:93]
s_waitcnt lgkmcnt(12)
v_or_b32 v42, v12, v13
ds_read_b128 a[232:235], v3 offset:13056
v_mfma_f32_32x32x16_f16 v[94:109], a[236:239], v[52:55], v[94:109]
ds_read_b128 a[236:239], v3 offset:14080
v_or_b32 v43, v14, v15
v_mfma_f32_32x32x16_bf16 v[24:39], a[192:195], a[144:147], 0
ds_read_b128 a[192:195], v1 offset:0
v_mfma_f32_32x32x16_bf16 v[24:39], a[196:199], a[148:151], v[24:39]
s_waitcnt lgkmcnt(11)
v_or_b32 v44, v16, v17
ds_read_b128 a[196:199], v1 offset:1024
s_waitcnt vmcnt(5)
v_smfmac_f32_32x32x32_bf16 v[94:109], a[250:253], a[168:175], v4
buffer_load_dwordx4 a[168:171], v5, s[4:7], s80 offen offset:0
buffer_load_dwordx4 a[172:175], v5, s[4:7], s80 offen offset:16
v_mfma_f32_32x32x16_bf16 v[24:39], a[200:203], a[152:155], v[24:39]
v_or_b32 v45, v18, v19
ds_read_b128 a[200:203], v1 offset:2048
v_mfma_f32_32x32x16_bf16 v[24:39], a[204:207], a[156:159], v[24:39]
ds_read_b128 a[204:207], v1 offset:3072
s_waitcnt lgkmcnt(10)
v_or_b32 v46, v20, v21
v_mfma_f32_32x32x16_bf16 v[24:39], a[208:211], a[160:163], v[24:39]
ds_read_b128 a[208:211], v1 offset:4096
v_mfma_f32_32x32x16_bf16 v[24:39], a[212:215], a[164:167], v[24:39]
v_or_b32 v47, v22, v23
ds_read_b128 a[212:215], v1 offset:5120
s_nop 1
s_waitcnt lgkmcnt(7)
v_mfma_f32_32x32x16_f16 v[110:125], a[216:219], v[240:243], v[110:125]
s_nop 5
v_mfma_f32_32x32x16_f16 v[126:141], a[220:223], v[240:243], v[126:141]
v_mad_u32_u16 v24, v24, 2, s85 op_sel:[1,0,0,0]
v_mad_u32_u16 v25, v25, 2, s85 op_sel:[1,0,0,0]
v_mad_u32_u16 v26, v26, 2, s85 op_sel:[1,0,0,0]
v_mad_u32_u16 v27, v27, 2, s85 op_sel:[1,0,0,0]
v_mad_u32_u16 v28, v28, 2, s85 op_sel:[1,0,0,0]
v_mad_u32_u16 v29, v29, 2, s85 op_sel:[1,0,0,0]
v_mfma_f32_32x32x16_f16 v[142:157], a[224:227], v[240:243], v[142:157]
ds_read_u16 v24, v24
ds_read_u16_d16_hi v25, v25
ds_read_u16 v26, v26
ds_read_u16_d16_hi v27, v27
v_mad_u32_u16 v30, v30, 2, s85 op_sel:[1,0,0,0]
v_mad_u32_u16 v31, v31, 2, s85 op_sel:[1,0,0,0]
s_waitcnt lgkmcnt(5)
v_mfma_f32_32x32x16_bf16 v[8:23], a[192:195], a[96:99], 0
ds_read_u16 v28, v28
ds_read_u16_d16_hi v29, v29
ds_read_u16 v30, v30
ds_read_u16_d16_hi v31, v31
v_mad_u32_u16 v32, v32, 2, s85 op_sel:[1,0,0,0]
v_mad_u32_u16 v33, v33, 2, s85 op_sel:[1,0,0,0]
v_mfma_f32_32x32x16_f16 v[110:125], a[228:231], v[244:247], v[110:125]
ds_read_u16 v32, v32
ds_read_u16_d16_hi v33, v33
s_add_u32 s101, s3, 59392
buffer_load_dwordx4 a[144:147], v1, s[12:15], s101 offen offset:0
v_mfma_f32_32x32x16_bf16 v[8:23], a[196:199], a[100:103], v[8:23]
v_mad_u32_u16 v34, v34, 2, s85 op_sel:[1,0,0,0]
v_mad_u32_u16 v35, v35, 2, s85 op_sel:[1,0,0,0]
v_mad_u32_u16 v36, v36, 2, s85 op_sel:[1,0,0,0]
v_mad_u32_u16 v37, v37, 2, s85 op_sel:[1,0,0,0]
v_mad_u32_u16 v38, v38, 2, s85 op_sel:[1,0,0,0]
v_mad_u32_u16 v39, v39, 2, s85 op_sel:[1,0,0,0]
v_mfma_f32_32x32x16_f16 v[126:141], a[232:235], v[244:247], v[126:141]
ds_read_u16 v34, v34
ds_read_u16_d16_hi v35, v35
ds_read_u16 v36, v36
buffer_load_dwordx4 a[148:151], v1, s[12:15], s101 offen offset:1024
v_mfma_f32_32x32x16_bf16 v[8:23], a[200:203], a[104:107], v[8:23]
ds_read_u16_d16_hi v37, v37
s_waitcnt lgkmcnt(10)
v_or_b32 v48, v24, v25
ds_read_u16 v38, v38
v_mfma_f32_32x32x16_f16 v[142:157], a[236:239], v[244:247], v[142:157]
ds_read_u16_d16_hi v39, v39
v_or_b32 v49, v26, v27
v_mfma_f32_32x32x16_bf16 v[8:23], a[204:207], a[108:111], v[8:23]
s_waitcnt vmcnt(5)
v_smfmac_f32_32x32x32_bf16 v[142:157], a[250:253], a[176:183], v4
buffer_load_dwordx4 a[176:179], v5, s[4:7], s81 offen offset:0
s_waitcnt lgkmcnt(8)
v_or_b32 v50, v28, v29
v_mfma_f32_32x32x16_f16 v[62:77], a[216:219], v[40:43], v[62:77]
ds_read_b128 a[216:219], v3 offset:15104
buffer_load_dwordx4 a[180:183], v5, s[4:7], s81 offen offset:16
v_mfma_f32_32x32x16_f16 v[78:93], a[220:223], v[40:43], v[78:93]
ds_read_b128 a[220:223], v3 offset:16128
v_or_b32 v51, v30, v31
v_mfma_f32_32x32x16_f16 v[94:109], a[224:227], v[40:43], v[94:109]
ds_read_b128 a[224:227], v3 offset:17152
s_waitcnt lgkmcnt(7)
v_or_b32 v52, v32, v33
v_mfma_f32_32x32x16_bf16 v[8:23], a[208:211], a[112:115], v[8:23]
v_mfma_f32_32x32x16_f16 v[62:77], a[228:231], v[44:47], v[62:77]
ds_read_b128 a[228:231], v3 offset:18176
v_or_b32 v53, v34, v35
v_mfma_f32_32x32x16_f16 v[78:93], a[232:235], v[44:47], v[78:93]
ds_read_b128 a[232:235], v3 offset:19200
v_mfma_f32_32x32x16_f16 v[94:109], a[236:239], v[44:47], v[94:109]
ds_read_b128 a[236:239], v3 offset:20224
s_waitcnt lgkmcnt(6)
v_or_b32 v54, v36, v37
v_mfma_f32_32x32x16_bf16 v[8:23], a[212:215], a[116:119], v[8:23]
v_or_b32 v55, v38, v39
v_mfma_f32_32x32x16_bf16 v[208:223], a[192:195], a[120:123], 0
ds_read_b128 a[192:195], v1 offset:6144
s_nop 4
s_waitcnt lgkmcnt(1)
v_mfma_f32_32x32x16_f16 v[110:125], a[216:219], v[248:251], v[110:125]
s_nop 1
v_mad_u32_u16 v8, v8, 2, s85 op_sel:[1,0,0,0]
v_mad_u32_u16 v9, v9, 2, s85 op_sel:[1,0,0,0]
v_mad_u32_u16 v10, v10, 2, s85 op_sel:[1,0,0,0]
v_mad_u32_u16 v11, v11, 2, s85 op_sel:[1,0,0,0]
v_mfma_f32_32x32x16_bf16 v[208:223], a[196:199], a[124:127], v[208:223]
ds_read_b128 a[196:199], v1 offset:7168
ds_read_u16 v8, v8
ds_read_u16_d16_hi v9, v9
ds_read_u16 v10, v10
v_mad_u32_u16 v12, v12, 2, s85 op_sel:[1,0,0,0]
v_mad_u32_u16 v13, v13, 2, s85 op_sel:[1,0,0,0]
v_mfma_f32_32x32x16_f16 v[126:141], a[220:223], v[248:251], v[126:141]
ds_read_u16_d16_hi v11, v11
ds_read_u16 v12, v12
ds_read_u16_d16_hi v13, v13
v_mad_u32_u16 v14, v14, 2, s85 op_sel:[1,0,0,0]
v_mad_u32_u16 v15, v15, 2, s85 op_sel:[1,0,0,0]
v_mad_u32_u16 v16, v16, 2, s85 op_sel:[1,0,0,0]
v_mfma_f32_32x32x16_bf16 v[208:223], a[200:203], a[128:131], v[208:223]
ds_read_b128 a[200:203], v1 offset:8192
ds_read_u16 v14, v14
ds_read_u16_d16_hi v15, v15
ds_read_u16 v16, v16
v_mad_u32_u16 v17, v17, 2, s85 op_sel:[1,0,0,0]
v_mad_u32_u16 v18, v18, 2, s85 op_sel:[1,0,0,0]
v_mfma_f32_32x32x16_f16 v[142:157], a[224:227], v[248:251], v[142:157]
ds_read_u16_d16_hi v17, v17
v_mad_u32_u16 v19, v19, 2, s85 op_sel:[1,0,0,0]
v_mad_u32_u16 v20, v20, 2, s85 op_sel:[1,0,0,0]
v_mad_u32_u16 v21, v21, 2, s85 op_sel:[1,0,0,0]
v_mad_u32_u16 v22, v22, 2, s85 op_sel:[1,0,0,0]
v_mfma_f32_32x32x16_bf16 v[208:223], a[204:207], a[132:135], v[208:223]
ds_read_b128 a[204:207], v1 offset:9216
v_mad_u32_u16 v23, v23, 2, s85 op_sel:[1,0,0,0]
ds_read_u16 v18, v18
ds_read_u16_d16_hi v19, v19
v_mfma_f32_32x32x16_f16 v[110:125], a[228:231], v[252:255], v[110:125]
ds_read_u16 v20, v20
ds_read_u16_d16_hi v21, v21
s_waitcnt lgkmcnt(12)
v_or_b32 v40, v8, v9
s_nop 1
v_mfma_f32_32x32x16_bf16 v[208:223], a[208:211], a[136:139], v[208:223]
ds_read_u16 v22, v22
ds_read_u16_d16_hi v23, v23
s_nop 2
v_cvt_pk_bf16_f32 v184, v110, v111
v_mfma_f32_32x32x16_f16 v[126:141], a[232:235], v[252:255], v[126:141]
v_or_b32 v41, v10, v11
v_cvt_pk_bf16_f32 v185, v112, v113
v_cvt_pk_bf16_f32 v186, v114, v115
v_cvt_pk_bf16_f32 v187, v116, v117
v_cvt_pk_bf16_f32 v188, v118, v119
v_mfma_f32_32x32x16_bf16 v[208:223], a[212:215], a[140:143], v[208:223]
v_cvt_pk_bf16_f32 v189, v120, v121
v_cvt_pk_bf16_f32 v190, v122, v123
v_cvt_pk_bf16_f32 v191, v124, v125
v_permlane16_swap_b32 v184, v188
s_waitcnt lgkmcnt(10)
v_or_b32 v42, v12, v13
v_mfma_f32_32x32x16_f16 v[142:157], a[236:239], v[252:255], v[142:157]
v_permlane16_swap_b32 v185, v189
v_permlane16_swap_b32 v186, v190
v_permlane16_swap_b32 v187, v191
v_mfma_f32_32x32x16_bf16 v[24:39], a[192:195], a[96:99], 0
ds_read_b128 a[208:211], v1 offset:10240
ds_read_b128 a[212:215], v1 offset:11264
v_cvt_pk_bf16_f32 v192, v126, v127
v_mul_f32 v56, s60, v216
v_cvt_pk_bf16_f32 v193, v128, v129
s_waitcnt lgkmcnt(9)
v_or_b32 v43, v14, v15
v_mfma_f32_32x32x16_f16 v[62:77], a[216:219], v[48:51], v[62:77]
ds_read_b128 a[216:219], v2 offset:6144
v_cvt_pk_bf16_f32 v194, v130, v131
v_mul_f32 v57, s60, v217
v_cvt_pk_bf16_f32 v195, v132, v133
v_mul_f32 v58, s60, v218
v_cvt_pk_bf16_f32 v196, v134, v135
v_mfma_f32_32x32x16_bf16 v[24:39], a[196:199], a[100:103], v[24:39]
v_cvt_pk_bf16_f32 v197, v136, v137
v_mul_f32 v59, s60, v219
v_or_b32 v44, v16, v17
v_cvt_pk_bf16_f32 v198, v138, v139
v_mul_f32 v60, s60, v220
v_cvt_pk_bf16_f32 v199, v140, v141
v_mfma_f32_32x32x16_f16 v[78:93], a[220:223], v[48:51], v[78:93]
ds_read_b128 a[220:223], v2 offset:7168
v_permlane16_swap_b32 v192, v196
v_mul_f32 v61, s60, v221
v_permlane16_swap_b32 v193, v197
v_mfma_f32_32x32x16_bf16 v[24:39], a[200:203], a[104:107], v[24:39]
v_permlane16_swap_b32 v194, v198
v_mul_f32 v7, s60, v222
s_waitcnt lgkmcnt(6)
v_or_b32 v45, v18, v19
v_permlane16_swap_b32 v195, v199
v_mfma_f32_32x32x16_f16 v[94:109], a[224:227], v[48:51], v[94:109]
ds_read_b128 a[224:227], v2 offset:8192
v_cvt_pk_bf16_f32 v200, v142, v143
v_mul_f32 v0, s60, v223
v_cvt_pk_bf16_f32 v201, v144, v145
v_mad_u32_u16 v56, v56, 2, s85 op_sel:[1,0,0,0]
v_cvt_pk_bf16_f32 v202, v146, v147
v_mfma_f32_32x32x16_bf16 v[24:39], a[204:207], a[108:111], v[24:39]
ds_read_u16 v56, v56
v_or_b32 v46, v20, v21
v_cvt_pk_bf16_f32 v203, v148, v149
v_mad_u32_u16 v57, v57, 2, s85 op_sel:[1,0,0,0]
v_cvt_pk_bf16_f32 v204, v150, v151
v_mad_u32_u16 v58, v58, 2, s85 op_sel:[1,0,0,0]
v_mfma_f32_32x32x16_f16 v[62:77], a[228:231], v[52:55], v[62:77]
ds_read_b128 a[228:231], v2 offset:9216
ds_read_u16_d16_hi v57, v57
ds_read_u16 v58, v58
v_cvt_pk_bf16_f32 v205, v152, v153
v_mad_u32_u16 v59, v59, 2, s85 op_sel:[1,0,0,0]
v_mfma_f32_32x32x16_f16 v[78:93], a[232:235], v[52:55], v[78:93]
ds_read_b128 a[232:235], v2 offset:10240
ds_read_u16_d16_hi v59, v59
s_waitcnt lgkmcnt(7)
v_or_b32 v47, v22, v23
v_cvt_pk_bf16_f32 v206, v154, v155
v_mad_u32_u16 v60, v60, 2, s85 op_sel:[1,0,0,0]
v_mfma_f32_32x32x16_bf16 v[24:39], a[208:211], a[112:115], v[24:39]
ds_read_u16 v60, v60
v_cvt_pk_bf16_f32 v207, v156, v157
v_mad_u32_u16 v61, v61, 2, s85 op_sel:[1,0,0,0]
v_permlane16_swap_b32 v200, v204
v_mad_u32_u16 v7, v7, 2, s85 op_sel:[1,0,0,0]
v_mfma_f32_32x32x16_f16 v[94:109], a[236:239], v[52:55], v[94:109]
ds_read_b128 a[236:239], v2 offset:11264
ds_read_u16_d16_hi v61, v61
ds_read_u16 v7, v7
v_permlane16_swap_b32 v201, v205
v_mad_u32_u16 v0, v0, 2, s85 op_sel:[1,0,0,0]
v_mfma_f32_32x32x16_bf16 v[24:39], a[212:215], a[116:119], v[24:39]
ds_read_u16_d16_hi v0, v0
v_permlane16_swap_b32 v202, v206
v_cvt_pk_f16_f32 v224, v208, v209
v_permlane16_swap_b32 v203, v207
v_cvt_pk_f16_f32 v225, v210, v211
v_cvt_pk_bf16_f32 v160, v62, v63
v_pk_fma_f16 v240, v224, v224, s84
v_cvt_pk_bf16_f32 v161, v64, v65
v_cvt_pk_f16_f32 v226, v212, v213
v_cvt_pk_bf16_f32 v162, v66, v67
v_pk_fma_f16 v241, v225, v225, s84
v_cvt_pk_bf16_f32 v163, v68, v69
v_pk_mul_f16 v240, v224, v240
v_cvt_pk_bf16_f32 v164, v70, v71
v_exp_f16 v248, v240
v_lshl_add_u64 v[158:159], v[158:159], 0, s[42:43]
v_cvt_pk_bf16_f32 v165, v72, v73
v_cvt_pk_f16_f32 v227, v214, v215
v_mfma_f32_32x32x16_bf16 v[208:223], a[192:195], a[120:123], 0
ds_read_b128 a[192:195], v1 offset:12288
v_cvt_pk_bf16_f32 v166, v74, v75
v_pk_fma_f16 v242, v226, v226, s84
v_cvt_pk_bf16_f32 v167, v76, v77
v_pk_mul_f16 v241, v225, v241
v_mfma_f32_32x32x16_bf16 v[62:77], a[240:243], a[246:249], 0
v_permlane16_swap_b32 v160, v164
v_pk_fma_f16 v243, v227, v227, s84
v_permlane16_swap_b32 v161, v165
v_pk_mul_f16 v242, v226, v242
v_mfma_f32_32x32x16_bf16 v[208:223], a[196:199], a[124:127], v[208:223]
ds_read_b128 a[196:199], v1 offset:13312
v_permlane16_swap_b32 v162, v166
v_pk_mul_f16 v243, v227, v243
v_permlane16_swap_b32 v163, v167
v_mfma_f32_32x32x16_bf16 v[208:223], a[200:203], a[128:131], v[208:223]
ds_read_b128 a[200:203], v1 offset:14336
buffer_store_dwordx4 v[184:187], v6, s[8:11], s83 offen offset:0 sc1 nt
v_mfma_f32_32x32x16_bf16 v[208:223], a[204:207], a[132:135], v[208:223]
ds_read_b128 a[204:207], v1 offset:15360
v_cvt_pk_bf16_f32 v168, v78, v79
v_mad_u32_u16 v24, v24, 2, s85 op_sel:[1,0,0,0]
v_cvt_pk_bf16_f32 v169, v80, v81
v_mad_u32_u16 v25, v25, 2, s85 op_sel:[1,0,0,0]
v_cvt_pk_bf16_f32 v170, v82, v83
v_mfma_f32_32x32x16_bf16 v[208:223], a[208:211], a[136:139], v[208:223]
ds_read_b128 a[208:211], v1 offset:16384
ds_read_u16 v24, v24
ds_read_u16_d16_hi v25, v25
v_exp_f16 v249, v241
v_cvt_pk_bf16_f32 v171, v84, v85
v_mfma_f32_32x32x16_bf16 v[208:223], a[212:215], a[140:143], v[208:223]
ds_read_b128 a[212:215], v1 offset:17408
v_cvt_pk_bf16_f32 v172, v86, v87
v_mad_u32_u16 v26, v26, 2, s85 op_sel:[1,0,0,0]
v_cvt_pk_bf16_f32 v173, v88, v89
v_mad_u32_u16 v27, v27, 2, s85 op_sel:[1,0,0,0]
v_cvt_pk_bf16_f32 v174, v90, v91
s_waitcnt lgkmcnt(4)
v_mfma_f32_32x32x16_bf16 v[8:23], a[192:195], a[96:99], 0
ds_read_b128 a[192:195], v1 offset:18432
ds_read_u16 v26, v26
ds_read_u16_d16_hi v27, v27
v_cvt_pk_bf16_f32 v175, v92, v93
v_mad_u32_u16 v28, v28, 2, s85 op_sel:[1,0,0,0]
v_permlane16_swap_b32 v168, v172
v_mfma_f32_32x32x16_bf16 v[78:93], a[242:245], a[246:249], 0
ds_read_u16 v28, v28
v_permlane16_swap_b32 v169, v173
v_mad_u32_u16 v29, v29, 2, s85 op_sel:[1,0,0,0]
v_permlane16_swap_b32 v170, v174
v_mfma_f32_32x32x16_bf16 v[8:23], a[196:199], a[100:103], v[8:23]
ds_read_b128 a[196:199], v1 offset:19456
ds_read_u16_d16_hi v29, v29
v_permlane16_swap_b32 v171, v175
v_mad_u32_u16 v30, v30, 2, s85 op_sel:[1,0,0,0]
v_cvt_pk_bf16_f32 v176, v94, v95
v_mfma_f32_32x32x16_bf16 v[8:23], a[200:203], a[104:107], v[8:23]
ds_read_b128 a[200:203], v1 offset:20480
ds_read_u16 v30, v30
s_waitcnt lgkmcnt(6)
v_or_b32 v48, v24, v25
v_cvt_pk_bf16_f32 v177, v96, v97
v_mad_u32_u16 v31, v31, 2, s85 op_sel:[1,0,0,0]
v_mfma_f32_32x32x16_bf16 v[8:23], a[204:207], a[108:111], v[8:23]
ds_read_b128 a[204:207], v1 offset:21504
ds_read_u16_d16_hi v31, v31
v_cvt_pk_bf16_f32 v178, v98, v99
v_mad_u32_u16 v32, v32, 2, s85 op_sel:[1,0,0,0]
v_exp_f16 v250, v242
v_mfma_f32_32x32x16_bf16 v[8:23], a[208:211], a[112:115], v[8:23]
ds_read_b128 a[208:211], v1 offset:22528
ds_read_u16 v32, v32
v_cvt_pk_bf16_f32 v179, v100, v101
v_mad_u32_u16 v33, v33, 2, s85 op_sel:[1,0,0,0]
v_cvt_pk_bf16_f32 v180, v102, v103
v_mad_u32_u16 v34, v34, 2, s85 op_sel:[1,0,0,0]
v_mfma_f32_32x32x16_bf16 v[8:23], a[212:215], a[116:119], v[8:23]
ds_read_b128 a[212:215], v1 offset:23552
ds_read_u16_d16_hi v33, v33
ds_read_u16 v34, v34
s_waitcnt lgkmcnt(9)
v_or_b32 v49, v26, v27
v_cvt_pk_bf16_f32 v181, v104, v105
v_exp_f16_sdwa v248, v240 dst_sel:WORD_1 dst_unused:UNUSED_PRESERVE src0_sel:WORD_1
v_cvt_pk_bf16_f32 v182, v106, v107
v_pk_add_f16 v240, v248, 1.0 op_sel_hi:[1,0]
v_cvt_pk_bf16_f32 v183, v108, v109
v_mfma_f32_32x32x16_bf16 v[94:109], a[244:247], a[246:249], 0
v_permlane16_swap_b32 v176, v180
v_mad_u32_u16 v35, v35, 2, s85 op_sel:[1,0,0,0]
v_permlane16_swap_b32 v177, v181
v_or_b32 v50, v28, v29
v_mfma_f32_32x32x16_f16 v[62:77], a[216:219], v[40:43], v[62:77]
ds_read_u16_d16_hi v35, v35
v_permlane16_swap_b32 v178, v182
v_mad_u32_u16 v36, v36, 2, s85 op_sel:[1,0,0,0]
v_permlane16_swap_b32 v179, v183
v_mfma_f32_32x32x16_f16 v[78:93], a[220:223], v[40:43], v[78:93]
ds_read_u16 v36, v36
v_exp_f16 v251, v243
v_exp_f16_sdwa v249, v241 dst_sel:WORD_1 dst_unused:UNUSED_PRESERVE src0_sel:WORD_1
v_exp_f16_sdwa v250, v242 dst_sel:WORD_1 dst_unused:UNUSED_PRESERVE src0_sel:WORD_1
v_mfma_f32_32x32x16_f16 v[94:109], a[224:227], v[40:43], v[94:109]
v_pk_add_f16 v241, v249, 1.0 op_sel_hi:[1,0]
s_waitcnt lgkmcnt(4)
v_or_b32 v51, v30, v31
v_mad_u32_u16 v37, v37, 2, s85 op_sel:[1,0,0,0]
v_pk_add_f16 v242, v250, 1.0 op_sel_hi:[1,0]
v_mad_u32_u16 v38, v38, 2, s85 op_sel:[1,0,0,0]
v_mfma_f32_32x32x16_f16 v[62:77], a[228:231], v[44:47], v[62:77]
ds_read_u16_d16_hi v37, v37
ds_read_u16 v38, v38
v_mad_u32_u16 v39, v39, 2, s85 op_sel:[1,0,0,0]
v_exp_f16_sdwa v251, v243 dst_sel:WORD_1 dst_unused:UNUSED_PRESERVE src0_sel:WORD_1
v_rcp_f16 v248, v240
v_mfma_f32_32x32x16_f16 v[78:93], a[232:235], v[44:47], v[78:93]
ds_read_u16_d16_hi v39, v39
v_pk_add_f16 v243, v251, 1.0 op_sel_hi:[1,0]
v_or_b32 v228, v56, v57
v_or_b32 v229, v58, v59
v_or_b32 v230, v60, v61
s_waitcnt lgkmcnt(4)
v_or_b32 v52, v32, v33
v_mfma_f32_32x32x16_f16 v[94:109], a[236:239], v[44:47], v[94:109]
v_or_b32 v231, v7, v0
v_mul_f32 v56, s60, v216
v_mul_f32 v57, s60, v217
v_mul_f32 v58, s60, v218
v_mul_f32 v59, s60, v219
v_mul_f32 v60, s60, v220
v_mfma_f32_32x32x16_bf16 v[110:125], a[240:243], a[246:249], 0
v_mul_f32 v61, s60, v221
v_mul_f32 v7, s60, v222
v_or_b32 v53, v34, v35
v_mul_f32 v0, s60, v223
v_mad_u32_u16 v56, v56, 2, s85 op_sel:[1,0,0,0]
v_mad_u32_u16 v57, v57, 2, s85 op_sel:[1,0,0,0]
v_mfma_f32_32x32x16_bf16 v[126:141], a[242:245], a[246:249], 0
ds_read_u16 v56, v56
ds_read_u16_d16_hi v57, v57
v_mad_u32_u16 v58, v58, 2, s85 op_sel:[1,0,0,0]
v_mad_u32_u16 v59, v59, 2, s85 op_sel:[1,0,0,0]
v_rcp_f16 v249, v241
v_mfma_f32_32x32x16_bf16 v[142:157], a[244:247], a[246:249], 0
ds_read_u16 v58, v58
ds_read_u16_d16_hi v59, v59
s_add_u32 s101, s3, 65536
buffer_load_dwordx4 a[152:155], v1, s[12:15], s101 offen offset:0
s_waitcnt lgkmcnt(4)
v_or_b32 v54, v36, v37
v_mad_u32_u16 v60, v60, 2, s85 op_sel:[1,0,0,0]
v_rcp_f16 v250, v242
v_rcp_f16_sdwa v248, v240 dst_sel:WORD_1 dst_unused:UNUSED_PRESERVE src0_sel:WORD_1
v_or_b32 v55, v38, v39
v_mfma_f32_32x32x16_bf16 v[24:39], a[192:195], a[96:99], 0
ds_read_u16 v60, v60
v_pk_mul_f16 v224, v224, v248
v_mad_u32_u16 v61, v61, 2, s85 op_sel:[1,0,0,0]
v_mad_u32_u16 v7, v7, 2, s85 op_sel:[1,0,0,0]
v_mad_u32_u16 v0, v0, 2, s85 op_sel:[1,0,0,0]
v_rcp_f16 v251, v243
v_mfma_f32_32x32x16_bf16 v[24:39], a[196:199], a[100:103], v[24:39]
ds_read_u16_d16_hi v61, v61
ds_read_u16 v7, v7
ds_read_u16_d16_hi v0, v0
v_cvt_pk_f16_f32 v232, v208, v209
v_cvt_pk_f16_f32 v233, v210, v211
v_rcp_f16_sdwa v249, v241 dst_sel:WORD_1 dst_unused:UNUSED_PRESERVE src0_sel:WORD_1
v_mfma_f32_32x32x16_bf16 v[24:39], a[200:203], a[104:107], v[24:39]
v_pk_mul_f16 v225, v225, v249
v_pk_fma_f16 v244, v232, v232, s84
v_cvt_pk_f16_f32 v234, v212, v213
v_pk_fma_f16 v245, v233, v233, s84
v_pk_mul_f16 v244, v232, v244
v_mfma_f32_32x32x16_bf16 v[24:39], a[204:207], a[108:111], v[24:39]
v_cvt_pk_f16_f32 v235, v214, v215
v_rcp_f16_sdwa v250, v242 dst_sel:WORD_1 dst_unused:UNUSED_PRESERVE src0_sel:WORD_1
v_rcp_f16_sdwa v251, v243 dst_sel:WORD_1 dst_unused:UNUSED_PRESERVE src0_sel:WORD_1
v_pk_mul_f16 v226, v226, v250
v_mfma_f32_32x32x16_bf16 v[24:39], a[208:211], a[112:115], v[24:39]
buffer_load_dwordx4 a[156:159], v1, s[12:15], s101 offen offset:1024
v_pk_fma_f16 v246, v234, v234, s84
v_pk_mul_f16 v245, v233, v245
v_pk_fma_f16 v247, v235, v235, s84
v_mfma_f32_32x32x16_bf16 v[24:39], a[212:215], a[116:119], v[24:39]
v_pk_mul_f16 v246, v234, v246
v_pk_mul_f16 v247, v235, v247
v_pk_mul_f16 v227, v227, v251
v_mad_u32_u16 v8, v8, 2, s85 op_sel:[1,0,0,0]
v_exp_f16 v248, v244
v_mfma_f32_32x32x16_f16 v[110:125], a[216:219], v[224:227], v[110:125]
ds_read_b128 a[216:219], v2 offset:12288
ds_read_u16 v8, v8
v_mad_u32_u16 v9, v9, 2, s85 op_sel:[1,0,0,0]
v_mad_u32_u16 v10, v10, 2, s85 op_sel:[1,0,0,0]
v_mad_u32_u16 v11, v11, 2, s85 op_sel:[1,0,0,0]
v_mad_u32_u16 v12, v12, 2, s85 op_sel:[1,0,0,0]
v_mfma_f32_32x32x16_bf16 v[208:223], a[192:195], a[120:123], 0
ds_read_b128 a[192:195], v1 offset:24576
ds_read_u16_d16_hi v9, v9
ds_read_u16 v10, v10
v_exp_f16 v249, v245
v_mad_u32_u16 v13, v13, 2, s85 op_sel:[1,0,0,0]
v_mfma_f32_32x32x16_f16 v[126:141], a[220:223], v[224:227], v[126:141]
ds_read_b128 a[220:223], v2 offset:13312
ds_read_u16_d16_hi v11, v11
ds_read_u16 v12, v12
ds_read_u16_d16_hi v13, v13
v_mad_u32_u16 v14, v14, 2, s85 op_sel:[1,0,0,0]
v_mad_u32_u16 v15, v15, 2, s85 op_sel:[1,0,0,0]
v_mfma_f32_32x32x16_bf16 v[208:223], a[196:199], a[124:127], v[208:223]
ds_read_b128 a[196:199], v1 offset:25600
ds_read_u16 v14, v14
ds_read_u16_d16_hi v15, v15
v_mad_u32_u16 v16, v16, 2, s85 op_sel:[1,0,0,0]
v_mad_u32_u16 v17, v17, 2, s85 op_sel:[1,0,0,0]
v_mad_u32_u16 v18, v18, 2, s85 op_sel:[1,0,0,0]
v_mfma_f32_32x32x16_f16 v[142:157], a[224:227], v[224:227], v[142:157]
ds_read_b128 a[224:227], v2 offset:14336
v_exp_f16 v250, v246
v_exp_f16_sdwa v248, v244 dst_sel:WORD_1 dst_unused:UNUSED_PRESERVE src0_sel:WORD_1
v_exp_f16 v251, v247
v_mfma_f32_32x32x16_bf16 v[208:223], a[200:203], a[128:131], v[208:223]
ds_read_b128 a[200:203], v1 offset:26624
ds_read_u16 v16, v16
v_pk_add_f16 v244, v248, 1.0 op_sel_hi:[1,0]
v_mad_u32_u16 v19, v19, 2, s85 op_sel:[1,0,0,0]
v_mad_u32_u16 v20, v20, 2, s85 op_sel:[1,0,0,0]
v_mfma_f32_32x32x16_f16 v[110:125], a[228:231], v[228:231], v[110:125]
ds_read_b128 a[228:231], v2 offset:15360
s_waitcnt lgkmcnt(10)
v_or_b32 v40, v8, v9
v_exp_f16_sdwa v249, v245 dst_sel:WORD_1 dst_unused:UNUSED_PRESERVE src0_sel:WORD_1
v_exp_f16_sdwa v250, v246 dst_sel:WORD_1 dst_unused:UNUSED_PRESERVE src0_sel:WORD_1
v_mfma_f32_32x32x16_bf16 v[208:223], a[204:207], a[132:135], v[208:223]
ds_read_b128 a[204:207], v1 offset:27648
ds_read_u16_d16_hi v17, v17
v_pk_add_f16 v245, v249, 1.0 op_sel_hi:[1,0]
v_mad_u32_u16 v21, v21, 2, s85 op_sel:[1,0,0,0]
v_pk_add_f16 v246, v250, 1.0 op_sel_hi:[1,0]
v_mad_u32_u16 v22, v22, 2, s85 op_sel:[1,0,0,0]
v_mfma_f32_32x32x16_f16 v[126:141], a[232:235], v[228:231], v[126:141]
ds_read_b128 a[232:235], v2 offset:16384
s_waitcnt lgkmcnt(9)
v_or_b32 v41, v10, v11
v_mad_u32_u16 v23, v23, 2, s85 op_sel:[1,0,0,0]
v_exp_f16_sdwa v251, v247 dst_sel:WORD_1 dst_unused:UNUSED_PRESERVE src0_sel:WORD_1
v_mfma_f32_32x32x16_bf16 v[208:223], a[208:211], a[136:139], v[208:223]
ds_read_b128 a[208:211], v1 offset:28672
v_pk_add_f16 v247, v251, 1.0 op_sel_hi:[1,0]
v_or_b32 v236, v56, v57
v_or_b32 v42, v12, v13
v_or_b32 v237, v58, v59
v_or_b32 v238, v60, v61
v_mfma_f32_32x32x16_f16 v[142:157], a[236:239], v[228:231], v[142:157]
ds_read_b128 a[236:239], v2 offset:17408
ds_read_u16 v18, v18
v_or_b32 v239, v7, v0
v_rcp_f16 v248, v244
v_rcp_f16 v249, v245
v_mfma_f32_32x32x16_bf16 v[208:223], a[212:215], a[140:143], v[208:223]
ds_read_b128 a[212:215], v1 offset:29696
v_rcp_f16 v250, v246
v_rcp_f16_sdwa v248, v244 dst_sel:WORD_1 dst_unused:UNUSED_PRESERVE src0_sel:WORD_1
s_waitcnt lgkmcnt(8)
v_or_b32 v43, v14, v15
v_mfma_f32_32x32x16_f16 v[62:77], a[216:219], v[48:51], v[62:77]
ds_read_u16_d16_hi v19, v19
ds_read_u16 v20, v20
v_pk_mul_f16 v232, v232, v248
v_rcp_f16 v251, v247
v_rcp_f16_sdwa v249, v245 dst_sel:WORD_1 dst_unused:UNUSED_PRESERVE src0_sel:WORD_1
v_mfma_f32_32x32x16_f16 v[78:93], a[220:223], v[48:51], v[78:93]
ds_read_u16_d16_hi v21, v21
v_pk_mul_f16 v233, v233, v249
v_rcp_f16_sdwa v250, v246 dst_sel:WORD_1 dst_unused:UNUSED_PRESERVE src0_sel:WORD_1
v_rcp_f16_sdwa v251, v247 dst_sel:WORD_1 dst_unused:UNUSED_PRESERVE src0_sel:WORD_1
v_mfma_f32_32x32x16_f16 v[94:109], a[224:227], v[48:51], v[94:109]
ds_read_u16 v22, v22
ds_read_u16_d16_hi v23, v23
v_pk_mul_f16 v234, v234, v250
v_pk_mul_f16 v235, v235, v251
v_mad_u32_u16 v24, v24, 2, s85 op_sel:[1,0,0,0]
v_mad_u32_u16 v25, v25, 2, s85 op_sel:[1,0,0,0]
s_waitcnt lgkmcnt(7)
v_mfma_f32_32x32x16_f16 v[62:77], a[228:231], v[52:55], v[62:77]
ds_read_u16 v24, v24
ds_read_u16_d16_hi v25, v25
v_or_b32 v44, v16, v17
v_mad_u32_u16 v26, v26, 2, s85 op_sel:[1,0,0,0]
v_mad_u32_u16 v27, v27, 2, s85 op_sel:[1,0,0,0]
v_mad_u32_u16 v28, v28, 2, s85 op_sel:[1,0,0,0]
v_mfma_f32_32x32x16_f16 v[78:93], a[232:235], v[52:55], v[78:93]
ds_read_u16 v26, v26
ds_read_u16_d16_hi v27, v27
ds_read_u16 v28, v28
v_mad_u32_u16 v29, v29, 2, s85 op_sel:[1,0,0,0]
v_mad_u32_u16 v30, v30, 2, s85 op_sel:[1,0,0,0]
v_mad_u32_u16 v31, v31, 2, s85 op_sel:[1,0,0,0]
v_mfma_f32_32x32x16_f16 v[94:109], a[236:239], v[52:55], v[94:109]
v_mad_u32_u16 v32, v32, 2, s85 op_sel:[1,0,0,0]
v_mad_u32_u16 v33, v33, 2, s85 op_sel:[1,0,0,0]
v_mad_u32_u16 v34, v34, 2, s85 op_sel:[1,0,0,0]
v_mad_u32_u16 v35, v35, 2, s85 op_sel:[1,0,0,0]
v_mad_u32_u16 v36, v36, 2, s85 op_sel:[1,0,0,0]
s_waitcnt vmcnt(7)
v_smfmac_f32_32x32x32_bf16 v[62:77], a[250:253], a[168:175], v4
ds_read_u16_d16_hi v29, v29
s_waitcnt lgkmcnt(8)
v_or_b32 v45, v18, v19
v_mad_u32_u16 v37, v37, 2, s85 op_sel:[1,0,0,0]
v_mad_u32_u16 v38, v38, 2, s85 op_sel:[1,0,0,0]
v_mfma_f32_32x32x16_f16 v[110:125], a[216:219], v[232:235], v[110:125]
ds_read_b128 a[216:219], v2 offset:18432
ds_read_u16 v30, v30
ds_read_u16_d16_hi v31, v31
buffer_load_dwordx4 a[168:171], v5, s[4:7], s80 offen offset:64
v_mfma_f32_32x32x16_f16 v[126:141], a[220:223], v[232:235], v[126:141]
ds_read_b128 a[220:223], v2 offset:19456
v_or_b32 v46, v20, v21
v_mad_u32_u16 v39, v39, 2, s85 op_sel:[1,0,0,0]
v_mul_f32 v56, s60, v216
v_mul_f32 v57, s60, v217
v_mul_f32 v58, s60, v218
v_mfma_f32_32x32x16_f16 v[142:157], a[224:227], v[232:235], v[142:157]
ds_read_b128 a[224:227], v2 offset:20480
v_mul_f32 v59, s60, v219
v_mul_f32 v60, s60, v220
v_mul_f32 v61, s60, v221
v_mul_f32 v7, s60, v222
s_waitcnt lgkmcnt(9)
v_or_b32 v47, v22, v23
v_mfma_f32_32x32x16_bf16 v[8:23], a[192:195], a[96:99], 0
ds_read_u16 v32, v32
v_mul_f32 v0, s60, v223
v_mad_u32_u16 v56, v56, 2, s85 op_sel:[1,0,0,0]
v_mad_u32_u16 v57, v57, 2, s85 op_sel:[1,0,0,0]
v_mad_u32_u16 v58, v58, 2, s85 op_sel:[1,0,0,0]
v_mad_u32_u16 v59, v59, 2, s85 op_sel:[1,0,0,0]
v_mfma_f32_32x32x16_f16 v[110:125], a[228:231], v[236:239], v[110:125]
ds_read_b128 a[228:231], v2 offset:21504
ds_read_u16_d16_hi v33, v33
v_or_b32 v48, v24, v25
v_mad_u32_u16 v60, v60, 2, s85 op_sel:[1,0,0,0]
v_mad_u32_u16 v61, v61, 2, s85 op_sel:[1,0,0,0]
v_mad_u32_u16 v7, v7, 2, s85 op_sel:[1,0,0,0]
v_mfma_f32_32x32x16_bf16 v[8:23], a[196:199], a[100:103], v[8:23]
ds_read_u16 v34, v34
v_mad_u32_u16 v0, v0, 2, s85 op_sel:[1,0,0,0]
v_cvt_pk_f16_f32 v224, v208, v209
v_cvt_pk_f16_f32 v225, v210, v211
v_pk_fma_f16 v240, v224, v224, s84
v_mfma_f32_32x32x16_f16 v[126:141], a[232:235], v[236:239], v[126:141]
ds_read_b128 a[232:235], v2 offset:22528
buffer_store_dwordx4 v[188:191], v6, s[8:11], s83 offen offset:3072 sc1 nt
ds_read_u16_d16_hi v35, v35
v_mfma_f32_32x32x16_bf16 v[8:23], a[200:203], a[104:107], v[8:23]
s_waitcnt lgkmcnt(9)
v_or_b32 v49, v26, v27
v_or_b32 v50, v28, v29
v_cvt_pk_f16_f32 v226, v212, v213
v_pk_fma_f16 v241, v225, v225, s84
v_pk_mul_f16 v240, v224, v240
v_mfma_f32_32x32x16_f16 v[142:157], a[236:239], v[236:239], v[142:157]
ds_read_b128 a[236:239], v2 offset:23552
ds_read_u16 v36, v36
v_cvt_pk_f16_f32 v227, v214, v215
v_pk_fma_f16 v242, v226, v226, s84
v_exp_f16 v248, v240
v_mfma_f32_32x32x16_bf16 v[8:23], a[204:207], a[108:111], v[8:23]
ds_read_u16_d16_hi v37, v37
v_pk_mul_f16 v241, v225, v241
v_pk_fma_f16 v243, v227, v227, s84
s_waitcnt lgkmcnt(8)
v_or_b32 v51, v30, v31
v_pk_mul_f16 v242, v226, v242
v_mfma_f32_32x32x16_f16 v[62:77], a[216:219], v[40:43], v[62:77]
ds_read_u16 v38, v38
ds_read_u16_d16_hi v39, v39
v_pk_mul_f16 v243, v227, v243
v_exp_f16 v249, v241
v_exp_f16 v250, v242
v_mfma_f32_32x32x16_bf16 v[8:23], a[208:211], a[112:115], v[8:23]
ds_read_u16 v56, v56
v_exp_f16_sdwa v248, v240 dst_sel:WORD_1 dst_unused:UNUSED_PRESERVE src0_sel:WORD_1
v_exp_f16 v251, v243
v_exp_f16_sdwa v249, v241 dst_sel:WORD_1 dst_unused:UNUSED_PRESERVE src0_sel:WORD_1
v_mfma_f32_32x32x16_f16 v[78:93], a[220:223], v[40:43], v[78:93]
ds_read_u16_d16_hi v57, v57
ds_read_u16 v58, v58
buffer_load_dwordx4 a[172:175], v5, s[4:7], s80 offen offset:80
ds_read_u16_d16_hi v59, v59
v_mfma_f32_32x32x16_bf16 v[8:23], a[212:215], a[116:119], v[8:23]
s_waitcnt lgkmcnt(9)
v_or_b32 v52, v32, v33
v_exp_f16_sdwa v250, v242 dst_sel:WORD_1 dst_unused:UNUSED_PRESERVE src0_sel:WORD_1
v_exp_f16_sdwa v251, v243 dst_sel:WORD_1 dst_unused:UNUSED_PRESERVE src0_sel:WORD_1
v_mfma_f32_32x32x16_f16 v[94:109], a[224:227], v[40:43], v[94:109]
ds_read_u16 v60, v60
ds_read_u16_d16_hi v61, v61
ds_read_u16 v7, v7
ds_read_u16_d16_hi v0, v0
v_or_b32 v53, v34, v35
v_mfma_f32_32x32x16_f16 v[62:77], a[228:231], v[44:47], v[62:77]
s_nop 0
v_mad_u32_u16 v8, v8, 2, s85 op_sel:[1,0,0,0]
v_mad_u32_u16 v9, v9, 2, s85 op_sel:[1,0,0,0]
v_mad_u32_u16 v10, v10, 2, s85 op_sel:[1,0,0,0]
v_mad_u32_u16 v11, v11, 2, s85 op_sel:[1,0,0,0]
v_mad_u32_u16 v12, v12, 2, s85 op_sel:[1,0,0,0]
v_mfma_f32_32x32x16_bf16 v[208:223], a[192:195], a[120:123], 0
ds_read_b128 a[192:195], v1 offset:30720
v_mad_u32_u16 v13, v13, 2, s85 op_sel:[1,0,0,0]
v_mad_u32_u16 v14, v14, 2, s85 op_sel:[1,0,0,0]
v_mad_u32_u16 v15, v15, 2, s85 op_sel:[1,0,0,0]
s_waitcnt lgkmcnt(9)
v_or_b32 v54, v36, v37
v_mfma_f32_32x32x16_f16 v[78:93], a[232:235], v[44:47], v[78:93]
ds_read_u16 v8, v8
v_mad_u32_u16 v16, v16, 2, s85 op_sel:[1,0,0,0]
v_mad_u32_u16 v17, v17, 2, s85 op_sel:[1,0,0,0]
v_mad_u32_u16 v18, v18, 2, s85 op_sel:[1,0,0,0]
v_pk_add_f16 v240, v248, 1.0 op_sel_hi:[1,0]
v_mad_u32_u16 v19, v19, 2, s85 op_sel:[1,0,0,0]
v_mfma_f32_32x32x16_bf16 v[208:223], a[196:199], a[124:127], v[208:223]
ds_read_b128 a[196:199], v1 offset:31744
v_or_b32 v55, v38, v39
v_mad_u32_u16 v20, v20, 2, s85 op_sel:[1,0,0,0]
v_pk_add_f16 v241, v249, 1.0 op_sel_hi:[1,0]
v_mad_u32_u16 v21, v21, 2, s85 op_sel:[1,0,0,0]
v_pk_add_f16 v242, v250, 1.0 op_sel_hi:[1,0]
v_mfma_f32_32x32x16_f16 v[94:109], a[236:239], v[44:47], v[94:109]
ds_read_u16_d16_hi v9, v9
ds_read_u16 v10, v10
v_mad_u32_u16 v22, v22, 2, s85 op_sel:[1,0,0,0]
v_mad_u32_u16 v23, v23, 2, s85 op_sel:[1,0,0,0]
v_pk_add_f16 v243, v251, 1.0 op_sel_hi:[1,0]
s_waitcnt lgkmcnt(9)
v_or_b32 v228, v56, v57
v_mfma_f32_32x32x16_bf16 v[208:223], a[200:203], a[128:131], v[208:223]
ds_read_b128 a[200:203], v1 offset:32768
v_rcp_f16 v248, v240
v_rcp_f16 v249, v241
v_rcp_f16 v250, v242
v_mfma_f32_32x32x16_f16 v[110:125], a[216:219], a[184:187], v[110:125]
ds_read_b128 a[216:219], v2 offset:24576
v_or_b32 v229, v58, v59
v_rcp_f16_sdwa v248, v240 dst_sel:WORD_1 dst_unused:UNUSED_PRESERVE src0_sel:WORD_1
v_rcp_f16 v251, v243
v_mfma_f32_32x32x16_bf16 v[208:223], a[204:207], a[132:135], v[208:223]
ds_read_b128 a[204:207], v1 offset:33792
ds_read_u16_d16_hi v11, v11
v_rcp_f16_sdwa v249, v241 dst_sel:WORD_1 dst_unused:UNUSED_PRESERVE src0_sel:WORD_1
v_rcp_f16_sdwa v250, v242 dst_sel:WORD_1 dst_unused:UNUSED_PRESERVE src0_sel:WORD_1
v_mfma_f32_32x32x16_f16 v[126:141], a[220:223], a[184:187], v[126:141]
ds_read_b128 a[220:223], v2 offset:25600
buffer_store_dwordx4 v[192:195], v6, s[8:11], s83 offen offset:64 sc1 nt
ds_read_u16 v12, v12
v_mfma_f32_32x32x16_bf16 v[208:223], a[208:211], a[136:139], v[208:223]
s_waitcnt lgkmcnt(9)
v_or_b32 v230, v60, v61
v_or_b32 v231, v7, v0
v_rcp_f16_sdwa v251, v243 dst_sel:WORD_1 dst_unused:UNUSED_PRESERVE src0_sel:WORD_1
ds_read_b128 a[208:211], v1 offset:34816
v_mfma_f32_32x32x16_f16 v[142:157], a[224:227], a[184:187], v[142:157]
ds_read_b128 a[224:227], v2 offset:26624
ds_read_u16_d16_hi v13, v13
ds_read_u16 v14, v14
ds_read_u16_d16_hi v15, v15
ds_read_u16 v16, v16
v_mfma_f32_32x32x16_f16 v[110:125], a[228:231], a[188:191], v[110:125]
ds_read_b128 a[228:231], v2 offset:34560
v_mfma_f32_32x32x16_f16 v[126:141], a[232:235], a[188:191], v[126:141]
s_waitcnt lgkmcnt(11)
v_or_b32 v40, v8, v9
ds_read_b128 a[232:235], v2 offset:35584
ds_read_u16_d16_hi v17, v17
v_mfma_f32_32x32x16_bf16 v[208:223], a[212:215], a[140:143], v[208:223]
ds_read_u16 v18, v18
ds_read_u16_d16_hi v19, v19
v_mfma_f32_32x32x16_f16 v[142:157], a[236:239], a[188:191], v[142:157]
ds_read_b128 a[236:239], v2 offset:36608
s_nop 3
v_mfma_f32_32x32x16_bf16 v[24:39], a[192:195], a[96:99], 0
s_waitcnt lgkmcnt(11)
v_or_b32 v41, v10, v11
s_nop 0
v_mul_f32 v56, s60, v216
v_mul_f32 v57, s60, v217
v_mul_f32 v58, s60, v218
s_waitcnt vmcnt(7)
v_smfmac_f32_32x32x32_bf16 v[110:125], a[250:253], a[176:183], v4
buffer_load_dwordx4 a[176:179], v5, s[4:7], s81 offen offset:64
v_mul_f32 v59, s60, v219
v_mul_f32 v60, s60, v220
v_mfma_f32_32x32x16_bf16 v[24:39], a[196:199], a[100:103], v[24:39]
ds_read_b128 a[212:215], v1 offset:35840
v_mul_f32 v61, s60, v221
v_mul_f32 v7, s60, v222
v_mul_f32 v0, s60, v223
v_mad_u32_u16 v56, v56, 2, s85 op_sel:[1,0,0,0]
v_mad_u32_u16 v57, v57, 2, s85 op_sel:[1,0,0,0]
v_mfma_f32_32x32x16_f16 v[62:77], a[216:219], v[48:51], v[62:77]
ds_read_b128 a[192:195], v1 offset:36864
ds_read_b128 a[196:199], v1 offset:37888
s_waitcnt lgkmcnt(10)
v_or_b32 v42, v12, v13
v_mad_u32_u16 v58, v58, 2, s85 op_sel:[1,0,0,0]
v_mad_u32_u16 v59, v59, 2, s85 op_sel:[1,0,0,0]
v_mfma_f32_32x32x16_bf16 v[24:39], a[200:203], a[104:107], v[24:39]
ds_read_b128 a[200:203], v1 offset:38912
v_mad_u32_u16 v60, v60, 2, s85 op_sel:[1,0,0,0]
v_pk_mul_f16 v224, v224, v248
v_mad_u32_u16 v61, v61, 2, s85 op_sel:[1,0,0,0]
v_mad_u32_u16 v7, v7, 2, s85 op_sel:[1,0,0,0]
v_or_b32 v43, v14, v15
v_mfma_f32_32x32x16_f16 v[78:93], a[220:223], v[48:51], v[78:93]
ds_read_u16 v20, v20
v_mad_u32_u16 v0, v0, 2, s85 op_sel:[1,0,0,0]
v_cvt_pk_f16_f32 v232, v208, v209
v_cvt_pk_f16_f32 v233, v210, v211
v_pk_mul_f16 v225, v225, v249
v_mfma_f32_32x32x16_bf16 v[24:39], a[204:207], a[108:111], v[24:39]
ds_read_b128 a[204:207], v1 offset:39936
ds_read_u16_d16_hi v21, v21
buffer_load_dwordx4 a[180:183], v5, s[4:7], s81 offen offset:80
ds_read_u16 v22, v22
v_mfma_f32_32x32x16_f16 v[94:109], a[224:227], v[48:51], v[94:109]
v_pk_fma_f16 v244, v232, v232, s84
v_cvt_pk_f16_f32 v234, v212, v213
s_waitcnt lgkmcnt(9)
v_or_b32 v44, v16, v17
v_pk_fma_f16 v245, v233, v233, s84
v_pk_mul_f16 v244, v232, v244
v_mfma_f32_32x32x16_bf16 v[24:39], a[208:211], a[112:115], v[24:39]
ds_read_b128 a[208:211], v1 offset:40960
v_cvt_pk_f16_f32 v235, v214, v215
v_pk_mul_f16 v226, v226, v250
v_pk_fma_f16 v246, v234, v234, s84
v_pk_mul_f16 v245, v233, v245
v_pk_fma_f16 v247, v235, v235, s84
v_mfma_f32_32x32x16_f16 v[62:77], a[228:231], v[52:55], v[62:77]
ds_read_u16_d16_hi v23, v23
ds_read_u16 v56, v56
v_or_b32 v45, v18, v19
v_pk_mul_f16 v246, v234, v246
v_pk_mul_f16 v247, v235, v247
v_pk_mul_f16 v227, v227, v251
v_mfma_f32_32x32x16_f16 v[78:93], a[232:235], v[52:55], v[78:93]
ds_read_u16_d16_hi v57, v57
ds_read_u16 v58, v58
v_exp_f16 v248, v244
v_exp_f16 v249, v245
s_waitcnt lgkmcnt(8)
v_mfma_f32_32x32x16_bf16 v[24:39], a[212:215], a[116:119], v[24:39]
ds_read_b128 a[212:215], v1 offset:41984
ds_read_u16_d16_hi v59, v59
v_exp_f16 v250, v246
v_exp_f16_sdwa v248, v244 dst_sel:WORD_1 dst_unused:UNUSED_PRESERVE src0_sel:WORD_1
v_mfma_f32_32x32x16_f16 v[94:109], a[236:239], v[52:55], v[94:109]
ds_read_u16 v60, v60
v_exp_f16 v251, v247
v_exp_f16_sdwa v249, v245 dst_sel:WORD_1 dst_unused:UNUSED_PRESERVE src0_sel:WORD_1
v_exp_f16_sdwa v250, v246 dst_sel:WORD_1 dst_unused:UNUSED_PRESERVE src0_sel:WORD_1
v_mfma_f32_32x32x16_f16 v[110:125], a[216:219], v[224:227], v[110:125]
ds_read_b128 a[216:219], v2 offset:37632
ds_read_u16_d16_hi v61, v61
v_mad_u32_u16 v24, v24, 2, s85 op_sel:[1,0,0,0]
s_waitcnt lgkmcnt(9)
v_or_b32 v46, v20, v21
v_mad_u32_u16 v25, v25, 2, s85 op_sel:[1,0,0,0]
v_mfma_f32_32x32x16_f16 v[126:141], a[220:223], v[224:227], v[126:141]
ds_read_b128 a[220:223], v2 offset:38656
v_mad_u32_u16 v26, v26, 2, s85 op_sel:[1,0,0,0]
v_mad_u32_u16 v27, v27, 2, s85 op_sel:[1,0,0,0]
v_mad_u32_u16 v28, v28, 2, s85 op_sel:[1,0,0,0]
v_mad_u32_u16 v29, v29, 2, s85 op_sel:[1,0,0,0]
v_mad_u32_u16 v30, v30, 2, s85 op_sel:[1,0,0,0]
v_mfma_f32_32x32x16_f16 v[142:157], a[224:227], v[224:227], v[142:157]
ds_read_b128 a[224:227], v2 offset:39680
ds_read_u16 v7, v7
s_add_u32 s101, s3, 71680
buffer_load_dwordx4 a[160:163], v1, s[12:15], s101 offen offset:0
ds_read_u16_d16_hi v0, v0
v_mfma_f32_32x32x16_f16 v[110:125], a[228:231], v[228:231], v[110:125]
s_waitcnt lgkmcnt(10)
v_or_b32 v47, v22, v23
v_mad_u32_u16 v31, v31, 2, s85 op_sel:[1,0,0,0]
v_mad_u32_u16 v32, v32, 2, s85 op_sel:[1,0,0,0]
v_mad_u32_u16 v33, v33, 2, s85 op_sel:[1,0,0,0]
v_mad_u32_u16 v34, v34, 2, s85 op_sel:[1,0,0,0]
v_mfma_f32_32x32x16_bf16 v[8:23], a[192:195], a[96:99], 0
ds_read_b128 a[228:231], v2 offset:40704
ds_read_u16 v24, v24
v_pk_add_f16 v244, v248, 1.0 op_sel_hi:[1,0]
v_mad_u32_u16 v35, v35, 2, s85 op_sel:[1,0,0,0]
v_mad_u32_u16 v36, v36, 2, s85 op_sel:[1,0,0,0]
v_pk_add_f16 v245, v249, 1.0 op_sel_hi:[1,0]
v_mfma_f32_32x32x16_f16 v[126:141], a[232:235], v[228:231], v[126:141]
ds_read_b128 a[232:235], v2 offset:41728
v_mad_u32_u16 v37, v37, 2, s85 op_sel:[1,0,0,0]
v_pk_add_f16 v246, v250, 1.0 op_sel_hi:[1,0]
v_mad_u32_u16 v38, v38, 2, s85 op_sel:[1,0,0,0]
v_mad_u32_u16 v39, v39, 2, s85 op_sel:[1,0,0,0]
v_mfma_f32_32x32x16_bf16 v[8:23], a[196:199], a[100:103], v[8:23]
ds_read_u16_d16_hi v25, v25
v_exp_f16_sdwa v251, v247 dst_sel:WORD_1 dst_unused:UNUSED_PRESERVE src0_sel:WORD_1
v_rcp_f16 v248, v244
v_pk_add_f16 v247, v251, 1.0 op_sel_hi:[1,0]
v_mfma_f32_32x32x16_f16 v[142:157], a[236:239], v[228:231], v[142:157]
ds_read_b128 a[236:239], v2 offset:42752
ds_read_u16 v26, v26
buffer_load_dwordx4 a[164:167], v1, s[12:15], s101 offen offset:1024
ds_read_u16_d16_hi v27, v27
v_mfma_f32_32x32x16_bf16 v[8:23], a[200:203], a[104:107], v[8:23]
v_or_b32 v236, v56, v57
s_waitcnt lgkmcnt(9)
v_or_b32 v237, v58, v59
v_or_b32 v238, v60, v61
v_rcp_f16 v249, v245
v_mfma_f32_32x32x16_f16 v[62:77], a[216:219], v[40:43], v[62:77]
ds_read_u16 v28, v28
ds_read_u16_d16_hi v29, v29
v_rcp_f16 v250, v246
v_rcp_f16_sdwa v248, v244 dst_sel:WORD_1 dst_unused:UNUSED_PRESERVE src0_sel:WORD_1
v_mfma_f32_32x32x16_bf16 v[8:23], a[204:207], a[108:111], v[8:23]
ds_read_u16 v30, v30
v_rcp_f16 v251, v247
v_rcp_f16_sdwa v249, v245 dst_sel:WORD_1 dst_unused:UNUSED_PRESERVE src0_sel:WORD_1
v_rcp_f16_sdwa v250, v246 dst_sel:WORD_1 dst_unused:UNUSED_PRESERVE src0_sel:WORD_1
v_mfma_f32_32x32x16_f16 v[78:93], a[220:223], v[40:43], v[78:93]
ds_read_u16_d16_hi v31, v31
ds_read_u16 v32, v32
s_waitcnt lgkmcnt(9)
v_or_b32 v239, v7, v0
v_pk_mul_f16 v232, v232, v248
v_pk_mul_f16 v233, v233, v249
v_mfma_f32_32x32x16_bf16 v[8:23], a[208:211], a[112:115], v[8:23]
ds_read_u16_d16_hi v33, v33
v_pk_mul_f16 v234, v234, v250
v_rcp_f16_sdwa v251, v247 dst_sel:WORD_1 dst_unused:UNUSED_PRESERVE src0_sel:WORD_1
ds_read_u16 v34, v34
v_mfma_f32_32x32x16_f16 v[94:109], a[224:227], v[40:43], v[94:109]
ds_read_u16_d16_hi v35, v35
buffer_store_dwordx4 v[196:199], v6, s[8:11], s83 offen offset:3136 sc1 nt
ds_read_u16 v36, v36
ds_read_u16_d16_hi v37, v37
v_mfma_f32_32x32x16_bf16 v[8:23], a[212:215], a[116:119], v[8:23]
s_waitcnt lgkmcnt(10)
v_or_b32 v48, v24, v25
v_pk_mul_f16 v235, v235, v251
ds_read_u16 v38, v38
v_mfma_f32_32x32x16_f16 v[62:77], a[228:231], v[44:47], v[62:77]
ds_read_u16_d16_hi v39, v39
v_or_b32 v49, v26, v27
s_nop 1
v_mfma_f32_32x32x16_bf16 v[208:223], a[192:195], a[120:123], 0
ds_read_b128 a[192:195], v1 offset:43008
s_nop 0
v_mad_u32_u16 v8, v8, 2, s85 op_sel:[1,0,0,0]
v_mad_u32_u16 v9, v9, 2, s85 op_sel:[1,0,0,0]
v_mad_u32_u16 v10, v10, 2, s85 op_sel:[1,0,0,0]
v_mad_u32_u16 v11, v11, 2, s85 op_sel:[1,0,0,0]
v_mfma_f32_32x32x16_f16 v[78:93], a[232:235], v[44:47], v[78:93]
ds_read_u16 v8, v8
s_waitcnt lgkmcnt(10)
v_or_b32 v50, v28, v29
v_mad_u32_u16 v12, v12, 2, s85 op_sel:[1,0,0,0]
v_mad_u32_u16 v13, v13, 2, s85 op_sel:[1,0,0,0]
v_mad_u32_u16 v14, v14, 2, s85 op_sel:[1,0,0,0]
v_mfma_f32_32x32x16_bf16 v[208:223], a[196:199], a[124:127], v[208:223]
ds_read_b128 a[196:199], v1 offset:44032
v_mad_u32_u16 v15, v15, 2, s85 op_sel:[1,0,0,0]
v_mad_u32_u16 v16, v16, 2, s85 op_sel:[1,0,0,0]
v_mad_u32_u16 v17, v17, 2, s85 op_sel:[1,0,0,0]
v_or_b32 v51, v30, v31
v_mad_u32_u16 v18, v18, 2, s85 op_sel:[1,0,0,0]
v_mfma_f32_32x32x16_f16 v[94:109], a[236:239], v[44:47], v[94:109]
ds_read_u16_d16_hi v9, v9
v_mad_u32_u16 v19, v19, 2, s85 op_sel:[1,0,0,0]
v_mad_u32_u16 v20, v20, 2, s85 op_sel:[1,0,0,0]
v_mad_u32_u16 v21, v21, 2, s85 op_sel:[1,0,0,0]
v_mad_u32_u16 v22, v22, 2, s85 op_sel:[1,0,0,0]
v_mad_u32_u16 v23, v23, 2, s85 op_sel:[1,0,0,0]
v_mfma_f32_32x32x16_bf16 v[208:223], a[200:203], a[128:131], v[208:223]
ds_read_b128 a[200:203], v1 offset:45056
ds_read_u16 v10, v10
s_waitcnt lgkmcnt(10)
v_or_b32 v52, v32, v33
v_mfma_f32_32x32x16_f16 v[110:125], a[216:219], v[232:235], v[110:125]
ds_read_b128 a[216:219], v2 offset:43776
ds_read_u16_d16_hi v11, v11
ds_read_u16 v12, v12
ds_read_u16_d16_hi v13, v13
v_or_b32 v53, v34, v35
v_mfma_f32_32x32x16_f16 v[126:141], a[220:223], v[232:235], v[126:141]
ds_read_b128 a[220:223], v2 offset:44800
buffer_store_dwordx4 v[200:203], v6, s[8:11], s83 offen offset:128 sc1 nt
v_mfma_f32_32x32x16_bf16 v[208:223], a[204:207], a[132:135], v[208:223]
s_waitcnt lgkmcnt(11)
v_or_b32 v54, v36, v37
ds_read_u16 v14, v14
ds_read_u16_d16_hi v15, v15
v_mfma_f32_32x32x16_f16 v[142:157], a[224:227], v[232:235], v[142:157]
ds_read_b128 a[224:227], v2 offset:45824
v_or_b32 v55, v38, v39
v_mfma_f32_32x32x16_bf16 v[208:223], a[208:211], a[136:139], v[208:223]
ds_read_u16 v16, v16
ds_read_u16_d16_hi v17, v17
v_mfma_f32_32x32x16_f16 v[110:125], a[228:231], v[236:239], v[110:125]
ds_read_b128 a[228:231], v2 offset:46848
ds_read_u16 v18, v18
v_mfma_f32_32x32x16_f16 v[126:141], a[232:235], v[236:239], v[126:141]
ds_read_b128 a[232:235], v2 offset:47872
s_waitcnt lgkmcnt(12)
v_or_b32 v40, v8, v9
v_mfma_f32_32x32x16_f16 v[142:157], a[236:239], v[236:239], v[142:157]
ds_read_b128 a[236:239], v2 offset:48896
ds_read_u16_d16_hi v19, v19
v_mfma_f32_32x32x16_bf16 v[208:223], a[212:215], a[140:143], v[208:223]
ds_read_u16 v20, v20
s_nop 3
v_mfma_f32_32x32x16_f16 v[62:77], a[216:219], v[48:51], v[62:77]
s_waitcnt lgkmcnt(12)
v_or_b32 v41, v10, v11
ds_read_u16_d16_hi v21, v21
v_mfma_f32_32x32x16_bf16 v[24:39], a[192:195], a[96:99], 0
ds_read_u16 v22, v22
s_nop 0
v_mul_f32 v56, s60, v216
v_mul_f32 v57, s60, v217
v_or_b32 v42, v12, v13
v_mul_f32 v58, s60, v218
v_mfma_f32_32x32x16_bf16 v[24:39], a[196:199], a[100:103], v[24:39]
buffer_store_dwordx4 v[204:207], v6, s[8:11], s83 offen offset:3200 sc1 nt
s_waitcnt lgkmcnt(10)
v_mfma_f32_32x32x16_f16 v[78:93], a[220:223], v[48:51], v[78:93]
v_mul_f32 v59, s60, v219
v_mul_f32 v60, s60, v220
v_mul_f32 v61, s60, v221
v_mul_f32 v7, s60, v222
v_mul_f32 v0, s60, v223
v_or_b32 v43, v14, v15
v_mfma_f32_32x32x16_bf16 v[24:39], a[200:203], a[104:107], v[24:39]
ds_read_b128 a[204:207], v1 offset:46080
v_mad_u32_u16 v56, v56, 2, s85 op_sel:[1,0,0,0]
v_mad_u32_u16 v57, v57, 2, s85 op_sel:[1,0,0,0]
v_mad_u32_u16 v58, v58, 2, s85 op_sel:[1,0,0,0]
v_mad_u32_u16 v59, v59, 2, s85 op_sel:[1,0,0,0]
v_mfma_f32_32x32x16_f16 v[94:109], a[224:227], v[48:51], v[94:109]
ds_read_b128 a[208:211], v1 offset:47104
ds_read_b128 a[212:215], v1 offset:48128
v_mad_u32_u16 v60, v60, 2, s85 op_sel:[1,0,0,0]
v_mad_u32_u16 v61, v61, 2, s85 op_sel:[1,0,0,0]
v_mad_u32_u16 v7, v7, 2, s85 op_sel:[1,0,0,0]
v_mad_u32_u16 v0, v0, 2, s85 op_sel:[1,0,0,0]
s_waitcnt lgkmcnt(8)
v_or_b32 v44, v16, v17
v_cvt_pk_f16_f32 v224, v208, v209
v_mfma_f32_32x32x16_f16 v[62:77], a[228:231], v[52:55], v[62:77]
ds_read_u16_d16_hi v23, v23
ds_read_u16 v56, v56
v_cvt_pk_f16_f32 v225, v210, v211
v_pk_fma_f16 v240, v224, v224, s84
v_cvt_pk_f16_f32 v226, v212, v213
v_pk_fma_f16 v241, v225, v225, s84
v_pk_mul_f16 v240, v224, v240
v_cvt_pk_f16_f32 v227, v214, v215
v_mfma_f32_32x32x16_f16 v[78:93], a[232:235], v[52:55], v[78:93]
ds_read_u16_d16_hi v57, v57
ds_read_u16 v58, v58
v_pk_fma_f16 v242, v226, v226, s84
v_exp_f16 v248, v240
v_pk_mul_f16 v241, v225, v241
s_waitcnt lgkmcnt(9)
v_mfma_f32_32x32x16_f16 v[94:109], a[236:239], v[52:55], v[94:109]
ds_read_u16_d16_hi v59, v59
ds_read_u16 v60, v60
v_or_b32 v45, v18, v19
v_pk_fma_f16 v243, v227, v227, s84
v_pk_mul_f16 v242, v226, v242
v_pk_mul_f16 v243, v227, v243
v_exp_f16 v249, v241
v_exp_f16 v250, v242
v_exp_f16_sdwa v248, v240 dst_sel:WORD_1 dst_unused:UNUSED_PRESERVE src0_sel:WORD_1
v_exp_f16 v251, v243
s_waitcnt lgkmcnt(7)
v_or_b32 v46, v20, v21
v_exp_f16_sdwa v249, v241 dst_sel:WORD_1 dst_unused:UNUSED_PRESERVE src0_sel:WORD_1
v_exp_f16_sdwa v250, v242 dst_sel:WORD_1 dst_unused:UNUSED_PRESERVE src0_sel:WORD_1
v_exp_f16_sdwa v251, v243 dst_sel:WORD_1 dst_unused:UNUSED_PRESERVE src0_sel:WORD_1
ds_read_u16_d16_hi v61, v61
v_mfma_f32_32x32x16_bf16 v[24:39], a[204:207], a[108:111], v[24:39]
ds_read_u16 v7, v7
ds_read_u16_d16_hi v0, v0
v_mfma_f32_32x32x16_bf16 v[24:39], a[208:211], a[112:115], v[24:39]
s_waitcnt lgkmcnt(6)
v_or_b32 v47, v22, v23
s_waitcnt vmcnt(8)
v_smfmac_f32_32x32x32_bf16 v[78:93], a[250:253], a[168:175], v4
global_load_dword a255, v[158:159], off
buffer_load_dwordx4 a[168:171], v5, s[4:7], s80 offen offset:128
v_mfma_f32_32x32x16_bf16 v[24:39], a[212:215], a[116:119], v[24:39]
buffer_load_dwordx4 a[172:175], v5, s[4:7], s80 offen offset:144
s_nop 2
v_mfma_f32_32x32x16_f16 v[110:125], a[216:219], a[144:147], v[110:125]
ds_read_b128 a[216:219], v2 offset:49920
s_nop 4
v_mfma_f32_32x32x16_bf16 v[208:223], a[192:195], a[120:123], 0
ds_read_b128 a[192:195], v1 offset:49152
v_mad_u32_u16 v24, v24, 2, s85 op_sel:[1,0,0,0]
v_mad_u32_u16 v25, v25, 2, s85 op_sel:[1,0,0,0]
v_mad_u32_u16 v26, v26, 2, s85 op_sel:[1,0,0,0]
v_mad_u32_u16 v27, v27, 2, s85 op_sel:[1,0,0,0]
v_mad_u32_u16 v28, v28, 2, s85 op_sel:[1,0,0,0]
v_mfma_f32_32x32x16_f16 v[126:141], a[220:223], a[144:147], v[126:141]
ds_read_b128 a[220:223], v2 offset:50944
ds_read_u16 v24, v24
ds_read_u16_d16_hi v25, v25
ds_read_u16 v26, v26
v_mad_u32_u16 v29, v29, 2, s85 op_sel:[1,0,0,0]
v_mad_u32_u16 v30, v30, 2, s85 op_sel:[1,0,0,0]
v_mfma_f32_32x32x16_bf16 v[208:223], a[196:199], a[124:127], v[208:223]
ds_read_b128 a[196:199], v1 offset:50176
ds_read_u16_d16_hi v27, v27
ds_read_u16 v28, v28
ds_read_u16_d16_hi v29, v29
v_mad_u32_u16 v31, v31, 2, s85 op_sel:[1,0,0,0]
v_mfma_f32_32x32x16_f16 v[142:157], a[224:227], a[144:147], v[142:157]
ds_read_b128 a[224:227], v2 offset:51968
ds_read_u16 v30, v30
buffer_store_dwordx4 v[160:163], v6, s[8:11], s82 offen offset:0 sc1 nt
ds_read_u16_d16_hi v31, v31
v_mfma_f32_32x32x16_bf16 v[208:223], a[200:203], a[128:131], v[208:223]
ds_read_b128 a[200:203], v1 offset:51200
v_mad_u32_u16 v32, v32, 2, s85 op_sel:[1,0,0,0]
v_mad_u32_u16 v33, v33, 2, s85 op_sel:[1,0,0,0]
v_mad_u32_u16 v34, v34, 2, s85 op_sel:[1,0,0,0]
v_pk_add_f16 v240, v248, 1.0 op_sel_hi:[1,0]
v_rcp_f16 v248, v240
v_lshl_add_u64 v[158:159], v[158:159], 0, s[42:43]
v_mfma_f32_32x32x16_f16 v[110:125], a[228:231], a[148:151], v[110:125]
ds_read_b128 a[228:231], v2 offset:52992
v_mad_u32_u16 v35, v35, 2, s85 op_sel:[1,0,0,0]
v_mad_u32_u16 v36, v36, 2, s85 op_sel:[1,0,0,0]
v_pk_add_f16 v241, v249, 1.0 op_sel_hi:[1,0]
v_mad_u32_u16 v37, v37, 2, s85 op_sel:[1,0,0,0]
v_rcp_f16 v249, v241
v_mfma_f32_32x32x16_bf16 v[208:223], a[204:207], a[132:135], v[208:223]
ds_read_b128 a[204:207], v1 offset:52224
ds_read_u16 v32, v32
s_waitcnt lgkmcnt(9)
v_or_b32 v48, v24, v25
v_pk_add_f16 v242, v250, 1.0 op_sel_hi:[1,0]
v_mad_u32_u16 v38, v38, 2, s85 op_sel:[1,0,0,0]
v_mfma_f32_32x32x16_f16 v[126:141], a[232:235], a[148:151], v[126:141]
ds_read_b128 a[232:235], v2 offset:54016
v_mad_u32_u16 v39, v39, 2, s85 op_sel:[1,0,0,0]
v_pk_add_f16 v243, v251, 1.0 op_sel_hi:[1,0]
v_or_b32 v228, v56, v57
v_or_b32 v229, v58, v59
v_or_b32 v230, v60, v61
v_mfma_f32_32x32x16_bf16 v[208:223], a[208:211], a[136:139], v[208:223]
ds_read_b128 a[208:211], v1 offset:53248
ds_read_u16_d16_hi v33, v33
v_or_b32 v49, v26, v27
v_or_b32 v231, v7, v0
v_rcp_f16 v250, v242
v_mfma_f32_32x32x16_f16 v[142:157], a[236:239], a[148:151], v[142:157]
ds_read_b128 a[236:239], v2 offset:55040
v_rcp_f16_sdwa v248, v240 dst_sel:WORD_1 dst_unused:UNUSED_PRESERVE src0_sel:WORD_1
v_rcp_f16 v251, v243
s_waitcnt lgkmcnt(9)
v_or_b32 v50, v28, v29
v_mfma_f32_32x32x16_bf16 v[208:223], a[212:215], a[140:143], v[208:223]
ds_read_b128 a[212:215], v1 offset:54272
ds_read_u16 v34, v34
v_rcp_f16_sdwa v249, v241 dst_sel:WORD_1 dst_unused:UNUSED_PRESERVE src0_sel:WORD_1
v_rcp_f16_sdwa v250, v242 dst_sel:WORD_1 dst_unused:UNUSED_PRESERVE src0_sel:WORD_1
v_mfma_f32_32x32x16_f16 v[62:77], a[216:219], v[40:43], v[62:77]
ds_read_u16_d16_hi v35, v35
v_rcp_f16_sdwa v251, v243 dst_sel:WORD_1 dst_unused:UNUSED_PRESERVE src0_sel:WORD_1
ds_read_u16 v36, v36
v_mfma_f32_32x32x16_bf16 v[8:23], a[192:195], a[96:99], 0
s_waitcnt lgkmcnt(9)
v_or_b32 v51, v30, v31
s_nop 0
v_mul_f32 v56, s60, v216
v_mul_f32 v57, s60, v217
v_mul_f32 v58, s60, v218
v_mfma_f32_32x32x16_f16 v[78:93], a[220:223], v[40:43], v[78:93]
ds_read_b128 a[192:195], v1 offset:55296
ds_read_u16_d16_hi v37, v37
v_mul_f32 v59, s60, v219
v_mul_f32 v60, s60, v220
v_mul_f32 v61, s60, v221
v_mul_f32 v7, s60, v222
v_mfma_f32_32x32x16_bf16 v[8:23], a[196:199], a[100:103], v[8:23]
ds_read_b128 a[196:199], v1 offset:56320
v_mul_f32 v0, s60, v223
v_mad_u32_u16 v56, v56, 2, s85 op_sel:[1,0,0,0]
v_mad_u32_u16 v57, v57, 2, s85 op_sel:[1,0,0,0]
v_mad_u32_u16 v58, v58, 2, s85 op_sel:[1,0,0,0]
v_mad_u32_u16 v59, v59, 2, s85 op_sel:[1,0,0,0]
v_mfma_f32_32x32x16_f16 v[94:109], a[224:227], v[40:43], v[94:109]
ds_read_u16 v38, v38
ds_read_u16_d16_hi v39, v39
ds_read_u16 v56, v56
v_mad_u32_u16 v60, v60, 2, s85 op_sel:[1,0,0,0]
v_pk_mul_f16 v224, v224, v248
v_mad_u32_u16 v61, v61, 2, s85 op_sel:[1,0,0,0]
v_mfma_f32_32x32x16_bf16 v[8:23], a[200:203], a[104:107], v[8:23]
ds_read_b128 a[200:203], v1 offset:57344
s_waitcnt lgkmcnt(9)
v_or_b32 v52, v32, v33
v_mad_u32_u16 v7, v7, 2, s85 op_sel:[1,0,0,0]
v_mad_u32_u16 v0, v0, 2, s85 op_sel:[1,0,0,0]
v_cvt_pk_f16_f32 v232, v208, v209
v_mfma_f32_32x32x16_f16 v[62:77], a[228:231], v[44:47], v[62:77]
ds_read_u16_d16_hi v57, v57
ds_read_u16 v58, v58
v_cvt_pk_f16_f32 v233, v210, v211
v_pk_mul_f16 v225, v225, v249
v_pk_fma_f16 v244, v232, v232, s84
v_cvt_pk_f16_f32 v234, v212, v213
v_mfma_f32_32x32x16_bf16 v[8:23], a[204:207], a[108:111], v[8:23]
ds_read_b128 a[204:207], v1 offset:58368
v_pk_fma_f16 v245, v233, v233, s84
s_waitcnt lgkmcnt(9)
v_or_b32 v53, v34, v35
v_pk_mul_f16 v244, v232, v244
v_cvt_pk_f16_f32 v235, v214, v215
v_mfma_f32_32x32x16_f16 v[78:93], a[232:235], v[44:47], v[78:93]
ds_read_u16_d16_hi v59, v59
v_pk_mul_f16 v226, v226, v250
v_pk_fma_f16 v246, v234, v234, s84
v_pk_mul_f16 v245, v233, v245
v_exp_f16 v248, v244
v_mfma_f32_32x32x16_bf16 v[8:23], a[208:211], a[112:115], v[8:23]
ds_read_b128 a[208:211], v1 offset:59392
ds_read_u16 v60, v60
v_pk_fma_f16 v247, v235, v235, s84
s_waitcnt lgkmcnt(9)
v_or_b32 v54, v36, v37
v_pk_mul_f16 v246, v234, v246
v_mfma_f32_32x32x16_f16 v[94:109], a[236:239], v[44:47], v[94:109]
ds_read_u16_d16_hi v61, v61
ds_read_u16 v7, v7
v_pk_mul_f16 v247, v235, v247
v_pk_mul_f16 v227, v227, v251
v_exp_f16 v249, v245
v_mfma_f32_32x32x16_bf16 v[8:23], a[212:215], a[116:119], v[8:23]
ds_read_b128 a[212:215], v1 offset:60416
v_exp_f16 v250, v246
v_exp_f16_sdwa v248, v244 dst_sel:WORD_1 dst_unused:UNUSED_PRESERVE src0_sel:WORD_1
s_waitcnt lgkmcnt(9)
v_or_b32 v55, v38, v39
v_mfma_f32_32x32x16_f16 v[110:125], a[216:219], v[224:227], v[110:125]
ds_read_b128 a[216:219], v2 offset:56064
v_exp_f16 v251, v247
v_exp_f16_sdwa v249, v245 dst_sel:WORD_1 dst_unused:UNUSED_PRESERVE src0_sel:WORD_1
v_exp_f16_sdwa v250, v246 dst_sel:WORD_1 dst_unused:UNUSED_PRESERVE src0_sel:WORD_1
v_mfma_f32_32x32x16_bf16 v[24:39], a[192:195], a[96:99], 0
ds_read_u16_d16_hi v0, v0
v_mad_u32_u16 v8, v8, 2, s85 op_sel:[1,0,0,0]
v_mad_u32_u16 v9, v9, 2, s85 op_sel:[1,0,0,0]
v_mad_u32_u16 v10, v10, 2, s85 op_sel:[1,0,0,0]
v_mad_u32_u16 v11, v11, 2, s85 op_sel:[1,0,0,0]
v_mad_u32_u16 v12, v12, 2, s85 op_sel:[1,0,0,0]
v_mfma_f32_32x32x16_f16 v[126:141], a[220:223], v[224:227], v[126:141]
ds_read_b128 a[220:223], v2 offset:57088
ds_read_u16 v8, v8
s_add_u32 s101, s3, 28672
ds_read_u16_d16_hi v9, v9
buffer_load_dwordx4 a[184:187], v1, s[12:15], s101 offen offset:0
v_mfma_f32_32x32x16_bf16 v[24:39], a[196:199], a[100:103], v[24:39]
ds_read_u16 v10, v10
v_mad_u32_u16 v13, v13, 2, s85 op_sel:[1,0,0,0]
v_mad_u32_u16 v14, v14, 2, s85 op_sel:[1,0,0,0]
v_mad_u32_u16 v15, v15, 2, s85 op_sel:[1,0,0,0]
v_mad_u32_u16 v16, v16, 2, s85 op_sel:[1,0,0,0]
v_mad_u32_u16 v17, v17, 2, s85 op_sel:[1,0,0,0]
v_mfma_f32_32x32x16_f16 v[142:157], a[224:227], v[224:227], v[142:157]
ds_read_b128 a[224:227], v2 offset:58112
ds_read_u16_d16_hi v11, v11
v_mad_u32_u16 v18, v18, 2, s85 op_sel:[1,0,0,0]
v_pk_add_f16 v244, v248, 1.0 op_sel_hi:[1,0]
v_mad_u32_u16 v19, v19, 2, s85 op_sel:[1,0,0,0]
v_mad_u32_u16 v20, v20, 2, s85 op_sel:[1,0,0,0]
v_mfma_f32_32x32x16_bf16 v[24:39], a[200:203], a[104:107], v[24:39]
ds_read_u16 v12, v12
v_pk_add_f16 v245, v249, 1.0 op_sel_hi:[1,0]
v_mad_u32_u16 v21, v21, 2, s85 op_sel:[1,0,0,0]
v_pk_add_f16 v246, v250, 1.0 op_sel_hi:[1,0]
v_mad_u32_u16 v22, v22, 2, s85 op_sel:[1,0,0,0]
v_mad_u32_u16 v23, v23, 2, s85 op_sel:[1,0,0,0]
v_mfma_f32_32x32x16_f16 v[110:125], a[228:231], v[228:231], v[110:125]
ds_read_b128 a[228:231], v2 offset:59136
v_exp_f16_sdwa v251, v247 dst_sel:WORD_1 dst_unused:UNUSED_PRESERVE src0_sel:WORD_1
v_rcp_f16 v248, v244
v_pk_add_f16 v247, v251, 1.0 op_sel_hi:[1,0]
s_waitcnt lgkmcnt(8)
v_mfma_f32_32x32x16_bf16 v[24:39], a[204:207], a[108:111], v[24:39]
ds_read_u16_d16_hi v13, v13
ds_read_u16 v14, v14
ds_read_u16_d16_hi v15, v15
buffer_load_dwordx4 a[188:191], v1, s[12:15], s101 offen offset:1024
v_mfma_f32_32x32x16_f16 v[126:141], a[232:235], v[228:231], v[126:141]
v_or_b32 v236, v56, v57
v_or_b32 v237, v58, v59
v_or_b32 v238, v60, v61
v_or_b32 v239, v7, v0
v_rcp_f16 v249, v245
v_mfma_f32_32x32x16_bf16 v[24:39], a[208:211], a[112:115], v[24:39]
ds_read_b128 a[232:235], v2 offset:60160
ds_read_u16 v16, v16
v_rcp_f16 v250, v246
v_rcp_f16_sdwa v248, v244 dst_sel:WORD_1 dst_unused:UNUSED_PRESERVE src0_sel:WORD_1
v_mfma_f32_32x32x16_f16 v[142:157], a[236:239], v[228:231], v[142:157]
ds_read_b128 a[236:239], v2 offset:61184
s_waitcnt lgkmcnt(9)
v_or_b32 v40, v8, v9
v_pk_mul_f16 v232, v232, v248
v_rcp_f16 v251, v247
v_mfma_f32_32x32x16_bf16 v[24:39], a[212:215], a[116:119], v[24:39]
ds_read_u16_d16_hi v17, v17
ds_read_u16 v18, v18
v_rcp_f16_sdwa v249, v245 dst_sel:WORD_1 dst_unused:UNUSED_PRESERVE src0_sel:WORD_1
v_rcp_f16_sdwa v250, v246 dst_sel:WORD_1 dst_unused:UNUSED_PRESERVE src0_sel:WORD_1
s_waitcnt vmcnt(11)
v_smfmac_f32_32x32x32_bf16 v[126:141], a[250:253], a[176:183], v4
ds_read_u16_d16_hi v19, v19
s_waitcnt lgkmcnt(9)
v_or_b32 v41, v10, v11
v_pk_mul_f16 v233, v233, v249
v_pk_mul_f16 v234, v234, v250
v_mfma_f32_32x32x16_bf16 v[208:223], a[192:195], a[120:123], 0
ds_read_b128 a[192:195], v1 offset:61440
buffer_store_dwordx4 v[164:167], v6, s[8:11], s82 offen offset:3072 sc1 nt
ds_read_u16 v20, v20
ds_read_u16_d16_hi v21, v21
v_mfma_f32_32x32x16_f16 v[62:77], a[216:219], v[48:51], v[62:77]
s_waitcnt lgkmcnt(9)
v_or_b32 v42, v12, v13
v_rcp_f16_sdwa v251, v247 dst_sel:WORD_1 dst_unused:UNUSED_PRESERVE src0_sel:WORD_1
ds_read_u16 v22, v22
v_mfma_f32_32x32x16_bf16 v[208:223], a[196:199], a[124:127], v[208:223]
ds_read_b128 a[196:199], v1 offset:62464
v_pk_mul_f16 v235, v235, v251
v_mad_u32_u16 v24, v24, 2, s85 op_sel:[1,0,0,0]
v_mad_u32_u16 v25, v25, 2, s85 op_sel:[1,0,0,0]
v_mad_u32_u16 v26, v26, 2, s85 op_sel:[1,0,0,0]
v_or_b32 v43, v14, v15
v_mfma_f32_32x32x16_f16 v[78:93], a[220:223], v[48:51], v[78:93]
ds_read_u16_d16_hi v23, v23
v_mad_u32_u16 v27, v27, 2, s85 op_sel:[1,0,0,0]
v_mad_u32_u16 v28, v28, 2, s85 op_sel:[1,0,0,0]
v_mad_u32_u16 v29, v29, 2, s85 op_sel:[1,0,0,0]
v_mad_u32_u16 v30, v30, 2, s85 op_sel:[1,0,0,0]
v_mfma_f32_32x32x16_bf16 v[208:223], a[200:203], a[128:131], v[208:223]
ds_read_b128 a[200:203], v1 offset:63488
ds_read_u16 v24, v24
v_mad_u32_u16 v31, v31, 2, s85 op_sel:[1,0,0,0]
v_mad_u32_u16 v32, v32, 2, s85 op_sel:[1,0,0,0]
v_mad_u32_u16 v33, v33, 2, s85 op_sel:[1,0,0,0]
v_mad_u32_u16 v34, v34, 2, s85 op_sel:[1,0,0,0]
v_mfma_f32_32x32x16_f16 v[94:109], a[224:227], v[48:51], v[94:109]
ds_read_u16_d16_hi v25, v25
buffer_load_dwordx4 a[176:179], v5, s[4:7], s81 offen offset:128
ds_read_u16 v26, v26
s_waitcnt lgkmcnt(9)
v_or_b32 v44, v16, v17
v_mfma_f32_32x32x16_bf16 v[208:223], a[204:207], a[132:135], v[208:223]
ds_read_b128 a[204:207], v1 offset:64512
v_mad_u32_u16 v35, v35, 2, s85 op_sel:[1,0,0,0]
v_mad_u32_u16 v36, v36, 2, s85 op_sel:[1,0,0,0]
v_mad_u32_u16 v37, v37, 2, s85 op_sel:[1,0,0,0]
v_mad_u32_u16 v38, v38, 2, s85 op_sel:[1,0,0,0]
v_mad_u32_u16 v39, v39, 2, s85 op_sel:[1,0,0,0]
v_mfma_f32_32x32x16_f16 v[62:77], a[228:231], v[52:55], v[62:77]
ds_read_u16_d16_hi v27, v27
v_or_b32 v45, v18, v19
ds_read_u16 v28, v28
buffer_load_dwordx4 a[180:183], v5, s[4:7], s81 offen offset:144
v_mfma_f32_32x32x16_bf16 v[208:223], a[208:211], a[136:139], v[208:223]
ds_read_b128 a[208:211], v2 offset:0
ds_read_u16_d16_hi v29, v29
ds_read_u16 v30, v30
ds_read_u16_d16_hi v31, v31
s_waitcnt lgkmcnt(12)
v_or_b32 v46, v20, v21
v_mfma_f32_32x32x16_f16 v[78:93], a[232:235], v[52:55], v[78:93]
ds_read_u16 v32, v32
ds_read_u16_d16_hi v33, v33
v_mfma_f32_32x32x16_f16 v[94:109], a[236:239], v[52:55], v[94:109]
ds_read_u16 v34, v34
v_mfma_f32_32x32x16_f16 v[110:125], a[216:219], v[232:235], v[110:125]
s_waitcnt lgkmcnt(12)
v_or_b32 v47, v22, v23
ds_read_b128 a[216:219], v2 offset:62208
ds_read_u16_d16_hi v35, v35
v_mfma_f32_32x32x16_bf16 v[208:223], a[212:215], a[140:143], v[208:223]
ds_read_u16 v36, v36
buffer_store_dwordx4 v[168:171], v6, s[8:11], s82 offen offset:64 sc1 nt
v_mfma_f32_32x32x16_f16 v[126:141], a[220:223], v[232:235], v[126:141]
s_waitcnt lgkmcnt(11)
v_or_b32 v48, v24, v25
ds_read_b128 a[220:223], v2 offset:63232
ds_read_u16_d16_hi v37, v37
v_mfma_f32_32x32x16_bf16 v[8:23], a[192:195], a[96:99], 0
ds_read_u16 v38, v38
s_nop 2
v_mul_f32 v56, s60, v216
v_or_b32 v49, v26, v27
v_mfma_f32_32x32x16_f16 v[142:157], a[224:227], v[232:235], v[142:157]
v_mul_f32 v57, s60, v217
v_mul_f32 v58, s60, v218
v_mul_f32 v59, s60, v219
v_mul_f32 v60, s60, v220
v_mul_f32 v61, s60, v221
v_mul_f32 v7, s60, v222
v_mfma_f32_32x32x16_bf16 v[8:23], a[196:199], a[100:103], v[8:23]
v_mul_f32 v0, s60, v223
v_mad_u32_u16 v56, v56, 2, s85 op_sel:[1,0,0,0]
v_mad_u32_u16 v57, v57, 2, s85 op_sel:[1,0,0,0]
v_mad_u32_u16 v58, v58, 2, s85 op_sel:[1,0,0,0]
v_mad_u32_u16 v59, v59, 2, s85 op_sel:[1,0,0,0]
v_mad_u32_u16 v60, v60, 2, s85 op_sel:[1,0,0,0]
v_mfma_f32_32x32x16_f16 v[110:125], a[228:231], v[236:239], v[110:125]
ds_read_b128 a[212:215], v2 offset:1024
s_waitcnt lgkmcnt(10)
v_or_b32 v50, v28, v29
v_mad_u32_u16 v61, v61, 2, s85 op_sel:[1,0,0,0]
v_mad_u32_u16 v7, v7, 2, s85 op_sel:[1,0,0,0]
v_mad_u32_u16 v0, v0, 2, s85 op_sel:[1,0,0,0]
v_mfma_f32_32x32x16_bf16 v[8:23], a[200:203], a[104:107], v[8:23]
ds_read_b128 a[224:227], v2 offset:64256
v_cvt_pk_f16_f32 v224, v208, v209
v_cvt_pk_f16_f32 v225, v210, v211
v_or_b32 v51, v30, v31
v_pk_fma_f16 v240, v224, v224, s84
v_cvt_pk_f16_f32 v226, v212, v213
v_mfma_f32_32x32x16_f16 v[126:141], a[232:235], v[236:239], v[126:141]
ds_read_b128 a[228:231], v2 offset:65280
v_pk_fma_f16 v241, v225, v225, s84
v_pk_mul_f16 v240, v224, v240
v_cvt_pk_f16_f32 v227, v214, v215
v_pk_fma_f16 v242, v226, v226, s84
v_exp_f16 v248, v240
v_mfma_f32_32x32x16_bf16 v[8:23], a[204:207], a[108:111], v[8:23]
ds_read_b128 a[232:235], v3 offset:768
ds_read_u16_d16_hi v39, v39
s_waitcnt lgkmcnt(10)
v_or_b32 v52, v32, v33
v_pk_mul_f16 v241, v225, v241
v_pk_fma_f16 v243, v227, v227, s84
v_mfma_f32_32x32x16_f16 v[142:157], a[236:239], v[236:239], v[142:157]
ds_read_b128 a[236:239], v3 offset:1792
v_pk_mul_f16 v242, v226, v242
v_pk_mul_f16 v243, v227, v243
v_exp_f16 v249, v241
v_exp_f16 v250, v242
v_mfma_f32_32x32x16_bf16 v[8:23], a[208:211], a[112:115], v[8:23]
ds_read_u16 v56, v56
ds_read_u16_d16_hi v57, v57
s_waitcnt lgkmcnt(10)
v_or_b32 v53, v34, v35
v_exp_f16_sdwa v248, v240 dst_sel:WORD_1 dst_unused:UNUSED_PRESERVE src0_sel:WORD_1
v_mfma_f32_32x32x16_f16 v[62:77], a[216:219], v[40:43], v[62:77]
ds_read_u16 v58, v58
v_exp_f16 v251, v243
v_exp_f16_sdwa v249, v241 dst_sel:WORD_1 dst_unused:UNUSED_PRESERVE src0_sel:WORD_1
v_exp_f16_sdwa v250, v242 dst_sel:WORD_1 dst_unused:UNUSED_PRESERVE src0_sel:WORD_1
v_mfma_f32_32x32x16_f16 v[78:93], a[220:223], v[40:43], v[78:93]
ds_read_u16_d16_hi v59, v59
ds_read_u16 v60, v60
s_waitcnt lgkmcnt(9)
v_or_b32 v54, v36, v37
v_exp_f16_sdwa v251, v243 dst_sel:WORD_1 dst_unused:UNUSED_PRESERVE src0_sel:WORD_1
ds_read_u16_d16_hi v61, v61
ds_read_u16 v7, v7
ds_read_u16_d16_hi v0, v0
v_mfma_f32_32x32x16_bf16 v[8:23], a[212:215], a[116:119], v[8:23]
s_nop 5
v_mfma_f32_32x32x16_f16 v[94:109], a[224:227], v[40:43], v[94:109]
s_nop 4
v_mad_u32_u16 v8, v8, 2, s85 op_sel:[1,0,0,0]
v_mfma_f32_32x32x16_bf16 v[208:223], a[192:195], a[120:123], 0
ds_read_b128 a[192:195], v2 offset:2048
ds_read_u16 v8, v8
s_waitcnt lgkmcnt(9)
v_or_b32 v55, v38, v39
v_mad_u32_u16 v9, v9, 2, s85 op_sel:[1,0,0,0]
v_mad_u32_u16 v10, v10, 2, s85 op_sel:[1,0,0,0]
v_mfma_f32_32x32x16_f16 v[62:77], a[228:231], v[44:47], v[62:77]
ds_read_u16_d16_hi v9, v9
ds_read_u16 v10, v10
v_mad_u32_u16 v11, v11, 2, s85 op_sel:[1,0,0,0]
v_mad_u32_u16 v12, v12, 2, s85 op_sel:[1,0,0,0]
v_mad_u32_u16 v13, v13, 2, s85 op_sel:[1,0,0,0]
v_mad_u32_u16 v14, v14, 2, s85 op_sel:[1,0,0,0]
v_mfma_f32_32x32x16_bf16 v[208:223], a[196:199], a[124:127], v[208:223]
ds_read_b128 a[196:199], v2 offset:3072
v_mad_u32_u16 v15, v15, 2, s85 op_sel:[1,0,0,0]
v_mad_u32_u16 v16, v16, 2, s85 op_sel:[1,0,0,0]
v_mad_u32_u16 v17, v17, 2, s85 op_sel:[1,0,0,0]
v_mad_u32_u16 v18, v18, 2, s85 op_sel:[1,0,0,0]
v_pk_add_f16 v240, v248, 1.0 op_sel_hi:[1,0]
v_mfma_f32_32x32x16_f16 v[78:93], a[232:235], v[44:47], v[78:93]
ds_read_u16_d16_hi v11, v11
ds_read_u16 v12, v12
v_mad_u32_u16 v19, v19, 2, s85 op_sel:[1,0,0,0]
v_mad_u32_u16 v20, v20, 2, s85 op_sel:[1,0,0,0]
v_pk_add_f16 v241, v249, 1.0 op_sel_hi:[1,0]
v_mad_u32_u16 v21, v21, 2, s85 op_sel:[1,0,0,0]
v_mfma_f32_32x32x16_bf16 v[208:223], a[200:203], a[128:131], v[208:223]
ds_read_b128 a[200:203], v2 offset:4096
v_pk_add_f16 v242, v250, 1.0 op_sel_hi:[1,0]
v_mad_u32_u16 v22, v22, 2, s85 op_sel:[1,0,0,0]
v_rcp_f16 v248, v240
v_mad_u32_u16 v23, v23, 2, s85 op_sel:[1,0,0,0]
v_mfma_f32_32x32x16_f16 v[94:109], a[236:239], v[44:47], v[94:109]
ds_read_u16_d16_hi v13, v13
v_pk_add_f16 v243, v251, 1.0 op_sel_hi:[1,0]
s_waitcnt lgkmcnt(10)
v_or_b32 v228, v56, v57
v_or_b32 v229, v58, v59
v_or_b32 v230, v60, v61
v_mfma_f32_32x32x16_bf16 v[208:223], a[204:207], a[132:135], v[208:223]
ds_read_b128 a[204:207], v2 offset:5120
v_rcp_f16 v249, v241
v_rcp_f16 v250, v242
v_rcp_f16_sdwa v248, v240 dst_sel:WORD_1 dst_unused:UNUSED_PRESERVE src0_sel:WORD_1
v_mfma_f32_32x32x16_f16 v[110:125], a[216:219], a[152:155], v[110:125]
ds_read_b128 a[216:219], v3 offset:2816
ds_read_u16 v14, v14
s_waitcnt lgkmcnt(10)
v_or_b32 v231, v7, v0
v_rcp_f16 v251, v243
v_mfma_f32_32x32x16_bf16 v[208:223], a[208:211], a[136:139], v[208:223]
ds_read_b128 a[208:211], v3 offset:26368
v_rcp_f16_sdwa v249, v241 dst_sel:WORD_1 dst_unused:UNUSED_PRESERVE src0_sel:WORD_1
v_rcp_f16_sdwa v250, v242 dst_sel:WORD_1 dst_unused:UNUSED_PRESERVE src0_sel:WORD_1
v_rcp_f16_sdwa v251, v243 dst_sel:WORD_1 dst_unused:UNUSED_PRESERVE src0_sel:WORD_1
v_mfma_f32_32x32x16_f16 v[126:141], a[220:223], a[152:155], v[126:141]
ds_read_b128 a[220:223], v3 offset:3840
ds_read_u16_d16_hi v15, v15
buffer_store_dwordx4 v[172:175], v6, s[8:11], s82 offen offset:3136 sc1 nt
ds_read_u16 v16, v16
v_mfma_f32_32x32x16_bf16 v[208:223], a[212:215], a[140:143], v[208:223]
s_waitcnt lgkmcnt(9)
v_or_b32 v40, v8, v9
ds_read_b128 a[212:215], v3 offset:27392
ds_read_u16_d16_hi v17, v17
v_mfma_f32_32x32x16_f16 v[142:157], a[224:227], a[152:155], v[142:157]
v_or_b32 v41, v10, v11
ds_read_b128 a[224:227], v3 offset:4864
ds_read_u16 v18, v18
ds_read_u16_d16_hi v19, v19
v_mfma_f32_32x32x16_bf16 v[24:39], a[192:195], a[96:99], 0
ds_read_u16 v20, v20
s_nop 0
v_mul_f32 v56, s60, v216
v_mul_f32 v57, s60, v217
v_mul_f32 v58, s60, v218
v_mul_f32 v59, s60, v219
v_mfma_f32_32x32x16_f16 v[110:125], a[228:231], a[156:159], v[110:125]
s_waitcnt lgkmcnt(10)
v_or_b32 v42, v12, v13
v_mul_f32 v60, s60, v220
v_mul_f32 v61, s60, v221
v_mul_f32 v7, s60, v222
v_mul_f32 v0, s60, v223
v_mfma_f32_32x32x16_bf16 v[24:39], a[196:199], a[100:103], v[24:39]
v_mad_u32_u16 v56, v56, 2, s85 op_sel:[1,0,0,0]
v_mad_u32_u16 v57, v57, 2, s85 op_sel:[1,0,0,0]
v_mad_u32_u16 v58, v58, 2, s85 op_sel:[1,0,0,0]
v_mad_u32_u16 v59, v59, 2, s85 op_sel:[1,0,0,0]
v_mad_u32_u16 v60, v60, 2, s85 op_sel:[1,0,0,0]
v_pk_mul_f16 v224, v224, v248
v_mfma_f32_32x32x16_f16 v[126:141], a[232:235], a[156:159], v[126:141]
ds_read_b128 a[192:195], v1 offset:0
ds_read_b128 a[196:199], v1 offset:1024
v_mad_u32_u16 v61, v61, 2, s85 op_sel:[1,0,0,0]
v_mad_u32_u16 v7, v7, 2, s85 op_sel:[1,0,0,0]
v_mad_u32_u16 v0, v0, 2, s85 op_sel:[1,0,0,0]
v_cvt_pk_f16_f32 v232, v208, v209
v_mfma_f32_32x32x16_bf16 v[24:39], a[200:203], a[104:107], v[24:39]
ds_read_b128 a[200:203], v1 offset:2048
ds_read_b128 a[228:231], v3 offset:5888
v_cvt_pk_f16_f32 v233, v210, v211
v_pk_mul_f16 v225, v225, v249
v_pk_fma_f16 v244, v232, v232, s84
v_mfma_f32_32x32x16_f16 v[142:157], a[236:239], a[156:159], v[142:157]
ds_read_b128 a[232:235], v3 offset:6912
s_waitcnt lgkmcnt(9)
v_or_b32 v43, v14, v15
v_cvt_pk_f16_f32 v234, v212, v213
v_pk_fma_f16 v245, v233, v233, s84
v_pk_mul_f16 v244, v232, v244
v_mfma_f32_32x32x16_bf16 v[24:39], a[204:207], a[108:111], v[24:39]
ds_read_b128 a[204:207], v1 offset:3072
ds_read_b128 a[236:239], v3 offset:7936
v_cvt_pk_f16_f32 v235, v214, v215
v_exp_f16 v248, v244
v_pk_mul_f16 v226, v226, v250
v_mfma_f32_32x32x16_f16 v[62:77], a[216:219], v[48:51], v[62:77]
ds_read_u16_d16_hi v21, v21
v_or_b32 v44, v16, v17
v_pk_fma_f16 v246, v234, v234, s84
v_pk_mul_f16 v245, v233, v245
v_pk_fma_f16 v247, v235, v235, s84
v_pk_mul_f16 v246, v234, v246
v_mfma_f32_32x32x16_bf16 v[24:39], a[208:211], a[112:115], v[24:39]
ds_read_b128 a[208:211], v1 offset:4096
v_pk_mul_f16 v247, v235, v247
v_pk_mul_f16 v227, v227, v251
v_exp_f16 v249, v245
v_exp_f16 v250, v246
v_mfma_f32_32x32x16_f16 v[78:93], a[220:223], v[48:51], v[78:93]
ds_read_u16 v22, v22
ds_read_u16_d16_hi v23, v23
s_waitcnt lgkmcnt(9)
v_or_b32 v45, v18, v19
v_exp_f16_sdwa v248, v244 dst_sel:WORD_1 dst_unused:UNUSED_PRESERVE src0_sel:WORD_1
v_mfma_f32_32x32x16_bf16 v[24:39], a[212:215], a[116:119], v[24:39]
ds_read_b128 a[212:215], v1 offset:5120
v_exp_f16 v251, v247
v_exp_f16_sdwa v249, v245 dst_sel:WORD_1 dst_unused:UNUSED_PRESERVE src0_sel:WORD_1
v_exp_f16_sdwa v250, v246 dst_sel:WORD_1 dst_unused:UNUSED_PRESERVE src0_sel:WORD_1
v_mfma_f32_32x32x16_f16 v[94:109], a[224:227], v[48:51], v[94:109]
ds_read_u16 v56, v56
ds_read_u16_d16_hi v57, v57
ds_read_u16 v58, v58
v_exp_f16_sdwa v251, v247 dst_sel:WORD_1 dst_unused:UNUSED_PRESERVE src0_sel:WORD_1
s_waitcnt lgkmcnt(8)
v_mfma_f32_32x32x16_f16 v[62:77], a[228:231], v[52:55], v[62:77]
ds_read_u16_d16_hi v59, v59
v_mad_u32_u16 v24, v24, 2, s85 op_sel:[1,0,0,0]
v_mad_u32_u16 v25, v25, 2, s85 op_sel:[1,0,0,0]
v_mad_u32_u16 v26, v26, 2, s85 op_sel:[1,0,0,0]
v_mad_u32_u16 v27, v27, 2, s85 op_sel:[1,0,0,0]
v_mfma_f32_32x32x16_f16 v[78:93], a[232:235], v[52:55], v[78:93]
ds_read_u16 v60, v60
ds_read_u16_d16_hi v61, v61
ds_read_u16 v7, v7
v_mad_u32_u16 v28, v28, 2, s85 op_sel:[1,0,0,0]
v_mad_u32_u16 v29, v29, 2, s85 op_sel:[1,0,0,0]
v_mad_u32_u16 v30, v30, 2, s85 op_sel:[1,0,0,0]
v_mfma_f32_32x32x16_f16 v[94:109], a[236:239], v[52:55], v[94:109]
ds_read_u16_d16_hi v0, v0
s_waitcnt lgkmcnt(10)
v_or_b32 v46, v20, v21
v_mad_u32_u16 v31, v31, 2, s85 op_sel:[1,0,0,0]
v_mad_u32_u16 v32, v32, 2, s85 op_sel:[1,0,0,0]
v_mad_u32_u16 v33, v33, 2, s85 op_sel:[1,0,0,0]
s_waitcnt vmcnt(8)
v_smfmac_f32_32x32x32_bf16 v[94:109], a[250:253], a[168:175], v4
ds_read_u16 v24, v24
v_mad_u32_u16 v34, v34, 2, s85 op_sel:[1,0,0,0]
v_pk_add_f16 v244, v248, 1.0 op_sel_hi:[1,0]
v_mad_u32_u16 v35, v35, 2, s85 op_sel:[1,0,0,0]
v_rcp_f16 v248, v244
v_mfma_f32_32x32x16_f16 v[110:125], a[216:219], v[224:227], v[110:125]
ds_read_b128 a[216:219], v3 offset:8960
ds_read_u16_d16_hi v25, v25
buffer_load_dwordx4 a[168:171], v5, s[4:7], s78 offen offset:0
ds_read_u16 v26, v26
v_mfma_f32_32x32x16_f16 v[126:141], a[220:223], v[224:227], v[126:141]
s_waitcnt lgkmcnt(9)
v_or_b32 v47, v22, v23
v_mad_u32_u16 v36, v36, 2, s85 op_sel:[1,0,0,0]
v_pk_add_f16 v245, v249, 1.0 op_sel_hi:[1,0]
v_mad_u32_u16 v37, v37, 2, s85 op_sel:[1,0,0,0]
v_pk_add_f16 v246, v250, 1.0 op_sel_hi:[1,0]
v_mfma_f32_32x32x16_bf16 v[8:23], a[192:195], a[48:51], 0
ds_read_b128 a[220:223], v3 offset:9984
ds_read_u16_d16_hi v27, v27
v_mad_u32_u16 v38, v38, 2, s85 op_sel:[1,0,0,0]
v_rcp_f16 v249, v245
v_mad_u32_u16 v39, v39, 2, s85 op_sel:[1,0,0,0]
v_mfma_f32_32x32x16_f16 v[142:157], a[224:227], v[224:227], v[142:157]
ds_read_b128 a[224:227], v3 offset:11008
v_pk_add_f16 v247, v251, 1.0 op_sel_hi:[1,0]
v_or_b32 v236, v56, v57
v_rcp_f16 v250, v246
s_waitcnt lgkmcnt(9)
v_or_b32 v237, v58, v59
v_mfma_f32_32x32x16_bf16 v[8:23], a[196:199], a[52:55], v[8:23]
ds_read_u16 v28, v28
v_rcp_f16_sdwa v248, v244 dst_sel:WORD_1 dst_unused:UNUSED_PRESERVE src0_sel:WORD_1
v_rcp_f16 v251, v247
v_rcp_f16_sdwa v249, v245 dst_sel:WORD_1 dst_unused:UNUSED_PRESERVE src0_sel:WORD_1
v_mfma_f32_32x32x16_f16 v[110:125], a[228:231], v[228:231], v[110:125]
ds_read_b128 a[228:231], v3 offset:12032
ds_read_u16_d16_hi v29, v29
s_add_u32 s101, s3, 34816
buffer_load_dwordx4 a[144:147], v1, s[12:15], s101 offen offset:0
v_mfma_f32_32x32x16_bf16 v[8:23], a[200:203], a[56:59], v[8:23]
ds_read_u16 v30, v30
v_or_b32 v238, v60, v61
v_rcp_f16_sdwa v250, v246 dst_sel:WORD_1 dst_unused:UNUSED_PRESERVE src0_sel:WORD_1
v_rcp_f16_sdwa v251, v247 dst_sel:WORD_1 dst_unused:UNUSED_PRESERVE src0_sel:WORD_1
v_mfma_f32_32x32x16_f16 v[126:141], a[232:235], v[228:231], v[126:141]
ds_read_b128 a[232:235], v3 offset:13056
s_waitcnt lgkmcnt(9)
v_or_b32 v239, v7, v0
v_pk_mul_f16 v232, v232, v248
v_pk_mul_f16 v233, v233, v249
v_pk_mul_f16 v234, v234, v250
v_mfma_f32_32x32x16_bf16 v[8:23], a[204:207], a[60:63], v[8:23]
ds_read_u16_d16_hi v31, v31
v_pk_mul_f16 v235, v235, v251
ds_read_u16 v32, v32
buffer_load_dwordx4 a[172:175], v5, s[4:7], s78 offen offset:16
v_mfma_f32_32x32x16_f16 v[142:157], a[236:239], v[228:231], v[142:157]
ds_read_b128 a[236:239], v3 offset:14080
v_or_b32 v48, v24, v25
buffer_load_dwordx4 a[148:151], v1, s[12:15], s101 offen offset:1024
v_mfma_f32_32x32x16_bf16 v[8:23], a[208:211], a[64:67], v[8:23]
ds_read_u16_d16_hi v33, v33
ds_read_u16 v34, v34
buffer_store_dwordx4 v[176:179], v6, s[8:11], s82 offen offset:128 sc1 nt
v_mfma_f32_32x32x16_f16 v[62:77], a[216:219], v[40:43], v[62:77]
ds_read_u16_d16_hi v35, v35
ds_read_u16 v36, v36
s_waitcnt lgkmcnt(10)
v_or_b32 v49, v26, v27
v_mfma_f32_32x32x16_f16 v[78:93], a[220:223], v[40:43], v[78:93]
ds_read_u16_d16_hi v37, v37
ds_read_u16 v38, v38
ds_read_u16_d16_hi v39, v39
v_mfma_f32_32x32x16_f16 v[94:109], a[224:227], v[40:43], v[94:109]
s_waitcnt lgkmcnt(10)
v_or_b32 v50, v28, v29
v_mfma_f32_32x32x16_f16 v[62:77], a[228:231], v[44:47], v[62:77]
v_mfma_f32_32x32x16_f16 v[78:93], a[232:235], v[44:47], v[78:93]
s_waitcnt lgkmcnt(7)
v_or_b32 v51, v30, v31
v_mfma_f32_32x32x16_bf16 v[8:23], a[212:215], a[68:71], v[8:23]
s_nop 5
v_mfma_f32_32x32x16_bf16 v[208:223], a[192:195], a[72:75], 0
ds_read_b128 a[192:195], v1 offset:6144
s_waitcnt lgkmcnt(5)
v_or_b32 v52, v32, v33
v_mfma_f32_32x32x16_f16 v[94:109], a[236:239], v[44:47], v[94:109]
s_nop 0
v_mad_u32_u16 v8, v8, 2, s85 op_sel:[1,0,0,0]
v_mad_u32_u16 v9, v9, 2, s85 op_sel:[1,0,0,0]
v_mad_u32_u16 v10, v10, 2, s85 op_sel:[1,0,0,0]
v_mad_u32_u16 v11, v11, 2, s85 op_sel:[1,0,0,0]
v_mad_u32_u16 v12, v12, 2, s85 op_sel:[1,0,0,0]
v_mfma_f32_32x32x16_bf16 v[208:223], a[196:199], a[76:79], v[208:223]
ds_read_b128 a[196:199], v1 offset:7168
ds_read_u16 v8, v8
ds_read_u16_d16_hi v9, v9
ds_read_u16 v10, v10
v_or_b32 v53, v34, v35
v_mad_u32_u16 v13, v13, 2, s85 op_sel:[1,0,0,0]
v_mfma_f32_32x32x16_f16 v[110:125], a[216:219], v[232:235], v[110:125]
ds_read_b128 a[216:219], v3 offset:15104
ds_read_u16_d16_hi v11, v11
ds_read_u16 v12, v12
ds_read_u16_d16_hi v13, v13
v_mad_u32_u16 v14, v14, 2, s85 op_sel:[1,0,0,0]
v_mad_u32_u16 v15, v15, 2, s85 op_sel:[1,0,0,0]
v_mfma_f32_32x32x16_bf16 v[208:223], a[200:203], a[80:83], v[208:223]
ds_read_b128 a[200:203], v1 offset:8192
s_waitcnt lgkmcnt(9)
v_or_b32 v54, v36, v37
v_mad_u32_u16 v16, v16, 2, s85 op_sel:[1,0,0,0]
v_mad_u32_u16 v17, v17, 2, s85 op_sel:[1,0,0,0]
v_mad_u32_u16 v18, v18, 2, s85 op_sel:[1,0,0,0]
v_mfma_f32_32x32x16_f16 v[126:141], a[220:223], v[232:235], v[126:141]
ds_read_b128 a[220:223], v3 offset:16128
buffer_store_dwordx4 v[180:183], v6, s[8:11], s82 offen offset:3200 sc1 nt
ds_read_u16 v14, v14
ds_read_u16_d16_hi v15, v15
v_mfma_f32_32x32x16_bf16 v[208:223], a[204:207], a[84:87], v[208:223]
v_or_b32 v55, v38, v39
v_mad_u32_u16 v19, v19, 2, s85 op_sel:[1,0,0,0]
v_mad_u32_u16 v20, v20, 2, s85 op_sel:[1,0,0,0]
v_mad_u32_u16 v21, v21, 2, s85 op_sel:[1,0,0,0]
v_mad_u32_u16 v22, v22, 2, s85 op_sel:[1,0,0,0]
v_mad_u32_u16 v23, v23, 2, s85 op_sel:[1,0,0,0]
v_mfma_f32_32x32x16_f16 v[142:157], a[224:227], v[232:235], v[142:157]
ds_read_b128 a[204:207], v1 offset:9216
ds_read_b128 a[224:227], v3 offset:17152
ds_read_u16 v16, v16
ds_read_u16_d16_hi v17, v17
s_waitcnt lgkmcnt(11)
v_or_b32 v40, v8, v9
v_mfma_f32_32x32x16_bf16 v[208:223], a[208:211], a[88:91], v[208:223]
ds_read_u16 v18, v18
ds_read_u16_d16_hi v19, v19
ds_read_u16 v20, v20
v_mfma_f32_32x32x16_f16 v[110:125], a[228:231], v[236:239], v[110:125]
ds_read_b128 a[228:231], v3 offset:18176
v_mfma_f32_32x32x16_f16 v[126:141], a[232:235], v[236:239], v[126:141]
s_waitcnt lgkmcnt(12)
v_or_b32 v41, v10, v11
ds_read_b128 a[232:235], v3 offset:19200
ds_read_u16_d16_hi v21, v21
v_mfma_f32_32x32x16_f16 v[142:157], a[236:239], v[236:239], v[142:157]
ds_read_b128 a[236:239], v3 offset:20224
v_or_b32 v42, v12, v13
v_mfma_f32_32x32x16_bf16 v[208:223], a[212:215], a[92:95], v[208:223]
ds_read_u16 v22, v22
ds_read_u16_d16_hi v23, v23
s_waitcnt vmcnt(8)
v_smfmac_f32_32x32x32_bf16 v[142:157], a[250:253], a[176:183], v4
buffer_load_dwordx4 a[176:179], v5, s[4:7], s79 offen offset:0
buffer_load_dwordx4 a[180:183], v5, s[4:7], s79 offen offset:16
v_mfma_f32_32x32x16_f16 v[62:77], a[216:219], v[48:51], v[62:77]
s_waitcnt lgkmcnt(10)
v_or_b32 v43, v14, v15
ds_read_b128 a[208:211], v1 offset:10240
ds_read_b128 a[212:215], v1 offset:11264
v_mfma_f32_32x32x16_bf16 v[24:39], a[192:195], a[48:51], 0
v_mul_f32 v56, s60, v216
v_mul_f32 v57, s60, v217
v_mul_f32 v58, s60, v218
v_mul_f32 v59, s60, v219
v_mul_f32 v60, s60, v220
v_mul_f32 v61, s60, v221
v_mfma_f32_32x32x16_f16 v[78:93], a[220:223], v[48:51], v[78:93]
v_mul_f32 v7, s60, v222
v_mul_f32 v0, s60, v223
v_mad_u32_u16 v56, v56, 2, s85 op_sel:[1,0,0,0]
v_mad_u32_u16 v57, v57, 2, s85 op_sel:[1,0,0,0]
v_mad_u32_u16 v58, v58, 2, s85 op_sel:[1,0,0,0]
s_waitcnt lgkmcnt(9)
v_or_b32 v44, v16, v17
v_mfma_f32_32x32x16_bf16 v[24:39], a[196:199], a[52:55], v[24:39]
ds_read_u16 v56, v56
v_mad_u32_u16 v59, v59, 2, s85 op_sel:[1,0,0,0]
v_mad_u32_u16 v60, v60, 2, s85 op_sel:[1,0,0,0]
v_mad_u32_u16 v61, v61, 2, s85 op_sel:[1,0,0,0]
v_mad_u32_u16 v7, v7, 2, s85 op_sel:[1,0,0,0]
v_mad_u32_u16 v0, v0, 2, s85 op_sel:[1,0,0,0]
v_mfma_f32_32x32x16_f16 v[94:109], a[224:227], v[48:51], v[94:109]
ds_read_u16_d16_hi v57, v57
v_cvt_pk_f16_f32 v224, v208, v209
v_or_b32 v45, v18, v19
v_cvt_pk_f16_f32 v225, v210, v211
v_pk_fma_f16 v240, v224, v224, s84
v_mfma_f32_32x32x16_bf16 v[24:39], a[200:203], a[56:59], v[24:39]
ds_read_u16 v58, v58
ds_read_u16_d16_hi v59, v59
v_cvt_pk_f16_f32 v226, v212, v213
v_pk_fma_f16 v241, v225, v225, s84
v_pk_mul_f16 v240, v224, v240
v_cvt_pk_f16_f32 v227, v214, v215
s_waitcnt lgkmcnt(8)
v_mfma_f32_32x32x16_f16 v[62:77], a[228:231], v[52:55], v[62:77]
ds_read_u16 v60, v60
ds_read_u16_d16_hi v61, v61
v_pk_fma_f16 v242, v226, v226, s84
v_pk_mul_f16 v241, v225, v241
v_pk_fma_f16 v243, v227, v227, s84
v_pk_mul_f16 v242, v226, v242
v_mfma_f32_32x32x16_bf16 v[24:39], a[204:207], a[60:63], v[24:39]
ds_read_u16 v7, v7
v_or_b32 v46, v20, v21
v_pk_mul_f16 v243, v227, v243
v_exp_f16 v248, v240
v_exp_f16 v249, v241
v_mfma_f32_32x32x16_f16 v[78:93], a[232:235], v[52:55], v[78:93]
ds_read_u16_d16_hi v0, v0
v_cvt_pk_bf16_f32 v160, v62, v63
v_exp_f16 v250, v242
v_cvt_pk_bf16_f32 v161, v64, v65
v_exp_f16_sdwa v248, v240 dst_sel:WORD_1 dst_unused:UNUSED_PRESERVE src0_sel:WORD_1
v_mfma_f32_32x32x16_f16 v[94:109], a[236:239], v[52:55], v[94:109]
s_waitcnt lgkmcnt(7)
v_or_b32 v47, v22, v23
v_cvt_pk_bf16_f32 v162, v66, v67
v_exp_f16 v251, v243
v_cvt_pk_bf16_f32 v163, v68, v69
v_mfma_f32_32x32x16_bf16 v[24:39], a[208:211], a[64:67], v[24:39]
v_cvt_pk_bf16_f32 v164, v70, v71
v_exp_f16_sdwa v249, v241 dst_sel:WORD_1 dst_unused:UNUSED_PRESERVE src0_sel:WORD_1
v_cvt_pk_bf16_f32 v165, v72, v73
v_exp_f16_sdwa v250, v242 dst_sel:WORD_1 dst_unused:UNUSED_PRESERVE src0_sel:WORD_1
v_mfma_f32_32x32x16_f16 v[110:125], a[216:219], a[160:163], v[110:125]
ds_read_b128 a[216:219], v2 offset:6144
v_cvt_pk_bf16_f32 v166, v74, v75
v_exp_f16_sdwa v251, v243 dst_sel:WORD_1 dst_unused:UNUSED_PRESERVE src0_sel:WORD_1
v_cvt_pk_bf16_f32 v167, v76, v77
v_permlane16_swap_b32 v160, v164
v_mfma_f32_32x32x16_bf16 v[24:39], a[212:215], a[68:71], v[24:39]
v_permlane16_swap_b32 v161, v165
v_permlane16_swap_b32 v162, v166
v_permlane16_swap_b32 v163, v167
v_mfma_f32_32x32x16_f16 v[126:141], a[220:223], a[160:163], v[126:141]
ds_read_b128 a[220:223], v2 offset:7168
v_cvt_pk_bf16_f32 v168, v78, v79
v_cvt_pk_bf16_f32 v169, v80, v81
v_cvt_pk_bf16_f32 v170, v82, v83
v_cvt_pk_bf16_f32 v171, v84, v85
v_mfma_f32_32x32x16_bf16 v[208:223], a[192:195], a[72:75], 0
ds_read_b128 a[192:195], v1 offset:12288
v_cvt_pk_bf16_f32 v172, v86, v87
v_mad_u32_u16 v24, v24, 2, s85 op_sel:[1,0,0,0]
v_cvt_pk_bf16_f32 v173, v88, v89
v_mad_u32_u16 v25, v25, 2, s85 op_sel:[1,0,0,0]
v_cvt_pk_bf16_f32 v174, v90, v91
v_mfma_f32_32x32x16_f16 v[142:157], a[224:227], a[160:163], v[142:157]
ds_read_b128 a[224:227], v2 offset:8192
ds_read_u16 v24, v24
ds_read_u16_d16_hi v25, v25
v_cvt_pk_bf16_f32 v175, v92, v93
v_mad_u32_u16 v26, v26, 2, s85 op_sel:[1,0,0,0]
v_permlane16_swap_b32 v168, v172
v_mfma_f32_32x32x16_bf16 v[208:223], a[196:199], a[76:79], v[208:223]
ds_read_b128 a[196:199], v1 offset:13312
ds_read_u16 v26, v26
v_permlane16_swap_b32 v169, v173
v_mad_u32_u16 v27, v27, 2, s85 op_sel:[1,0,0,0]
v_permlane16_swap_b32 v170, v174
v_mfma_f32_32x32x16_f16 v[110:125], a[228:231], a[164:167], v[110:125]
ds_read_b128 a[228:231], v2 offset:9216
ds_read_u16_d16_hi v27, v27
v_permlane16_swap_b32 v171, v175
v_mad_u32_u16 v28, v28, 2, s85 op_sel:[1,0,0,0]
v_cvt_pk_bf16_f32 v176, v94, v95
v_mfma_f32_32x32x16_bf16 v[208:223], a[200:203], a[80:83], v[208:223]
ds_read_b128 a[200:203], v1 offset:14336
ds_read_u16 v28, v28
v_cvt_pk_bf16_f32 v177, v96, v97
v_mad_u32_u16 v29, v29, 2, s85 op_sel:[1,0,0,0]
v_cvt_pk_bf16_f32 v178, v98, v99
v_mad_u32_u16 v30, v30, 2, s85 op_sel:[1,0,0,0]
v_mfma_f32_32x32x16_f16 v[126:141], a[232:235], a[164:167], v[126:141]
ds_read_b128 a[232:235], v2 offset:10240
ds_read_u16_d16_hi v29, v29
ds_read_u16 v30, v30
v_cvt_pk_bf16_f32 v179, v100, v101
v_mad_u32_u16 v31, v31, 2, s85 op_sel:[1,0,0,0]
v_cvt_pk_bf16_f32 v180, v102, v103
v_mfma_f32_32x32x16_bf16 v[208:223], a[204:207], a[84:87], v[208:223]
ds_read_b128 a[204:207], v1 offset:15360
ds_read_u16_d16_hi v31, v31
s_waitcnt lgkmcnt(8)
v_or_b32 v48, v24, v25
v_cvt_pk_bf16_f32 v181, v104, v105
v_mad_u32_u16 v32, v32, 2, s85 op_sel:[1,0,0,0]
v_mfma_f32_32x32x16_f16 v[142:157], a[236:239], a[164:167], v[142:157]
ds_read_b128 a[236:239], v2 offset:11264
ds_read_u16 v32, v32
v_cvt_pk_bf16_f32 v182, v106, v107
v_mad_u32_u16 v33, v33, 2, s85 op_sel:[1,0,0,0]
v_cvt_pk_bf16_f32 v183, v108, v109
v_mad_u32_u16 v34, v34, 2, s85 op_sel:[1,0,0,0]
v_mfma_f32_32x32x16_bf16 v[208:223], a[208:211], a[88:91], v[208:223]
ds_read_b128 a[208:211], v1 offset:16384
ds_read_u16_d16_hi v33, v33
v_permlane16_swap_b32 v176, v180
v_pk_add_f16 v240, v248, 1.0 op_sel_hi:[1,0]
v_permlane16_swap_b32 v177, v181
v_mfma_f32_32x32x16_bf16 v[62:77], a[240:243], a[246:249], 0
ds_read_u16 v34, v34
s_waitcnt lgkmcnt(9)
v_or_b32 v49, v26, v27
v_permlane16_swap_b32 v178, v182
v_mad_u32_u16 v35, v35, 2, s85 op_sel:[1,0,0,0]
v_mfma_f32_32x32x16_bf16 v[208:223], a[212:215], a[92:95], v[208:223]
ds_read_b128 a[212:215], v1 offset:17408
ds_read_u16_d16_hi v35, v35
v_permlane16_swap_b32 v179, v183
v_mad_u32_u16 v36, v36, 2, s85 op_sel:[1,0,0,0]
v_cvt_pk_bf16_f32 v184, v110, v111
v_mfma_f32_32x32x16_bf16 v[78:93], a[242:245], a[246:249], 0
ds_read_u16 v36, v36
buffer_store_dwordx4 v[160:163], v6, s[8:11], s80 offen offset:0 sc1 nt
v_mfma_f32_32x32x16_bf16 v[8:23], a[192:195], a[48:51], 0
ds_read_b128 a[192:195], v1 offset:18432
s_waitcnt lgkmcnt(8)
v_or_b32 v50, v28, v29
v_cvt_pk_bf16_f32 v185, v112, v113
v_pk_add_f16 v241, v249, 1.0 op_sel_hi:[1,0]
v_cvt_pk_bf16_f32 v186, v114, v115
v_mfma_f32_32x32x16_bf16 v[94:109], a[244:247], a[246:249], 0
v_cvt_pk_bf16_f32 v187, v116, v117
v_mad_u32_u16 v37, v37, 2, s85 op_sel:[1,0,0,0]
v_or_b32 v51, v30, v31
v_cvt_pk_bf16_f32 v188, v118, v119
v_pk_add_f16 v242, v250, 1.0 op_sel_hi:[1,0]
v_cvt_pk_bf16_f32 v189, v120, v121
v_mfma_f32_32x32x16_bf16 v[8:23], a[196:199], a[52:55], v[8:23]
ds_read_b128 a[196:199], v1 offset:19456
ds_read_u16_d16_hi v37, v37
v_cvt_pk_bf16_f32 v190, v122, v123
v_mad_u32_u16 v38, v38, 2, s85 op_sel:[1,0,0,0]
v_rcp_f16 v248, v240
v_mfma_f32_32x32x16_f16 v[62:77], a[216:219], v[40:43], v[62:77]
ds_read_u16 v38, v38
v_cvt_pk_bf16_f32 v191, v124, v125
v_mad_u32_u16 v39, v39, 2, s85 op_sel:[1,0,0,0]
v_permlane16_swap_b32 v184, v188
v_pk_add_f16 v243, v251, 1.0 op_sel_hi:[1,0]
v_mfma_f32_32x32x16_bf16 v[8:23], a[200:203], a[56:59], v[8:23]
ds_read_b128 a[200:203], v1 offset:20480
ds_read_u16_d16_hi v39, v39
s_waitcnt lgkmcnt(8)
v_or_b32 v52, v32, v33
v_permlane16_swap_b32 v185, v189
v_mfma_f32_32x32x16_f16 v[78:93], a[220:223], v[40:43], v[78:93]
v_permlane16_swap_b32 v186, v190
v_or_b32 v228, v56, v57
v_permlane16_swap_b32 v187, v191
v_or_b32 v229, v58, v59
v_mfma_f32_32x32x16_bf16 v[8:23], a[204:207], a[60:63], v[8:23]
ds_read_b128 a[204:207], v1 offset:21504
s_waitcnt lgkmcnt(5)
v_or_b32 v53, v34, v35
v_cvt_pk_bf16_f32 v192, v126, v127
v_or_b32 v230, v60, v61
v_cvt_pk_bf16_f32 v193, v128, v129
v_mfma_f32_32x32x16_f16 v[94:109], a[224:227], v[40:43], v[94:109]
v_cvt_pk_bf16_f32 v194, v130, v131
v_or_b32 v231, v7, v0
v_cvt_pk_bf16_f32 v195, v132, v133
v_mul_f32 v56, s60, v216
v_cvt_pk_bf16_f32 v196, v134, v135
v_mul_f32 v57, s60, v217
v_mfma_f32_32x32x16_bf16 v[8:23], a[208:211], a[64:67], v[8:23]
ds_read_b128 a[208:211], v1 offset:22528
v_cvt_pk_bf16_f32 v197, v136, v137
v_mul_f32 v58, s60, v218
v_cvt_pk_bf16_f32 v198, v138, v139
v_mul_f32 v59, s60, v219
v_cvt_pk_bf16_f32 v199, v140, v141
v_mfma_f32_32x32x16_f16 v[62:77], a[228:231], v[44:47], v[62:77]
s_waitcnt lgkmcnt(3)
v_or_b32 v54, v36, v37
v_permlane16_swap_b32 v192, v196
v_mul_f32 v60, s60, v220
v_permlane16_swap_b32 v193, v197
v_mfma_f32_32x32x16_bf16 v[8:23], a[212:215], a[68:71], v[8:23]
ds_read_b128 a[212:215], v1 offset:23552
v_permlane16_swap_b32 v194, v198
v_mul_f32 v61, s60, v221
v_permlane16_swap_b32 v195, v199
v_mfma_f32_32x32x16_f16 v[78:93], a[232:235], v[44:47], v[78:93]
s_waitcnt lgkmcnt(1)
v_or_b32 v55, v38, v39
v_cvt_pk_bf16_f32 v200, v142, v143
v_mul_f32 v7, s60, v222
v_cvt_pk_bf16_f32 v201, v144, v145
v_mul_f32 v0, s60, v223
v_mfma_f32_32x32x16_bf16 v[24:39], a[192:195], a[48:51], 0
v_cvt_pk_bf16_f32 v202, v146, v147
v_mad_u32_u16 v56, v56, 2, s85 op_sel:[1,0,0,0]
v_cvt_pk_bf16_f32 v203, v148, v149
v_mad_u32_u16 v57, v57, 2, s85 op_sel:[1,0,0,0]
v_cvt_pk_bf16_f32 v204, v150, v151
v_rcp_f16 v249, v241
v_mfma_f32_32x32x16_f16 v[94:109], a[236:239], v[44:47], v[94:109]
ds_read_u16 v56, v56
ds_read_u16_d16_hi v57, v57
v_cvt_pk_bf16_f32 v205, v152, v153
v_mad_u32_u16 v58, v58, 2, s85 op_sel:[1,0,0,0]
v_cvt_pk_bf16_f32 v206, v154, v155
v_mad_u32_u16 v59, v59, 2, s85 op_sel:[1,0,0,0]
v_mfma_f32_32x32x16_bf16 v[24:39], a[196:199], a[52:55], v[24:39]
ds_read_u16 v58, v58
ds_read_u16_d16_hi v59, v59
v_cvt_pk_bf16_f32 v207, v156, v157
v_rcp_f16 v250, v242
v_permlane16_swap_b32 v200, v204
v_mfma_f32_32x32x16_bf16 v[110:125], a[240:243], a[246:249], 0
v_permlane16_swap_b32 v201, v205
v_mad_u32_u16 v60, v60, 2, s85 op_sel:[1,0,0,0]
v_permlane16_swap_b32 v202, v206
v_rcp_f16_sdwa v248, v240 dst_sel:WORD_1 dst_unused:UNUSED_PRESERVE src0_sel:WORD_1
v_mfma_f32_32x32x16_bf16 v[24:39], a[200:203], a[56:59], v[24:39]
ds_read_u16 v60, v60
v_permlane16_swap_b32 v203, v207
v_pk_mul_f16 v224, v224, v248
v_mad_u32_u16 v61, v61, 2, s85 op_sel:[1,0,0,0]
v_mad_u32_u16 v7, v7, 2, s85 op_sel:[1,0,0,0]
v_mfma_f32_32x32x16_bf16 v[126:141], a[242:245], a[246:249], 0
ds_read_u16_d16_hi v61, v61
ds_read_u16 v7, v7
s_add_u32 s101, s3, 40960
buffer_load_dwordx4 a[152:155], v1, s[12:15], s101 offen offset:0
v_mfma_f32_32x32x16_bf16 v[24:39], a[204:207], a[60:63], v[24:39]
v_mad_u32_u16 v0, v0, 2, s85 op_sel:[1,0,0,0]
v_cvt_pk_f16_f32 v232, v208, v209
v_cvt_pk_f16_f32 v233, v210, v211
v_rcp_f16 v251, v243
v_rcp_f16_sdwa v249, v241 dst_sel:WORD_1 dst_unused:UNUSED_PRESERVE src0_sel:WORD_1
v_mfma_f32_32x32x16_bf16 v[142:157], a[244:247], a[246:249], 0
ds_read_u16_d16_hi v0, v0
v_pk_mul_f16 v225, v225, v249
v_pk_fma_f16 v244, v232, v232, s84
v_cvt_pk_f16_f32 v234, v212, v213
v_pk_fma_f16 v245, v233, v233, s84
v_pk_mul_f16 v244, v232, v244
v_mfma_f32_32x32x16_bf16 v[24:39], a[208:211], a[64:67], v[24:39]
v_cvt_pk_f16_f32 v235, v214, v215
v_rcp_f16_sdwa v250, v242 dst_sel:WORD_1 dst_unused:UNUSED_PRESERVE src0_sel:WORD_1
v_rcp_f16_sdwa v251, v243 dst_sel:WORD_1 dst_unused:UNUSED_PRESERVE src0_sel:WORD_1
v_pk_mul_f16 v226, v226, v250
s_waitcnt lgkmcnt(1)
v_mfma_f32_32x32x16_bf16 v[24:39], a[212:215], a[68:71], v[24:39]
v_pk_fma_f16 v246, v234, v234, s84
v_pk_mul_f16 v245, v233, v245
v_pk_fma_f16 v247, v235, v235, s84
v_pk_mul_f16 v246, v234, v246
v_pk_mul_f16 v247, v235, v247
v_pk_mul_f16 v227, v227, v251
v_mfma_f32_32x32x16_bf16 v[208:223], a[192:195], a[72:75], 0
ds_read_b128 a[192:195], v1 offset:24576
buffer_load_dwordx4 a[156:159], v1, s[12:15], s101 offen offset:1024
v_mad_u32_u16 v8, v8, 2, s85 op_sel:[1,0,0,0]
v_mad_u32_u16 v9, v9, 2, s85 op_sel:[1,0,0,0]
v_mfma_f32_32x32x16_f16 v[110:125], a[216:219], v[224:227], v[110:125]
ds_read_b128 a[216:219], v2 offset:12288
ds_read_u16 v8, v8
ds_read_u16_d16_hi v9, v9
v_mad_u32_u16 v10, v10, 2, s85 op_sel:[1,0,0,0]
v_mad_u32_u16 v11, v11, 2, s85 op_sel:[1,0,0,0]
v_mad_u32_u16 v12, v12, 2, s85 op_sel:[1,0,0,0]
v_mfma_f32_32x32x16_bf16 v[208:223], a[196:199], a[76:79], v[208:223]
ds_read_b128 a[196:199], v1 offset:25600
ds_read_u16 v10, v10
ds_read_u16_d16_hi v11, v11
ds_read_u16 v12, v12
v_mad_u32_u16 v13, v13, 2, s85 op_sel:[1,0,0,0]
v_mad_u32_u16 v14, v14, 2, s85 op_sel:[1,0,0,0]
v_mfma_f32_32x32x16_f16 v[126:141], a[220:223], v[224:227], v[126:141]
ds_read_b128 a[220:223], v2 offset:13312
ds_read_u16_d16_hi v13, v13
ds_read_u16 v14, v14
v_mad_u32_u16 v15, v15, 2, s85 op_sel:[1,0,0,0]
v_exp_f16 v248, v244
v_mfma_f32_32x32x16_bf16 v[208:223], a[200:203], a[80:83], v[208:223]
ds_read_b128 a[200:203], v1 offset:26624
ds_read_u16_d16_hi v15, v15
v_mad_u32_u16 v16, v16, 2, s85 op_sel:[1,0,0,0]
v_mad_u32_u16 v17, v17, 2, s85 op_sel:[1,0,0,0]
v_mad_u32_u16 v18, v18, 2, s85 op_sel:[1,0,0,0]
v_exp_f16 v249, v245
v_mfma_f32_32x32x16_f16 v[142:157], a[224:227], v[224:227], v[142:157]
ds_read_b128 a[224:227], v2 offset:14336
v_exp_f16 v250, v246
v_exp_f16_sdwa v248, v244 dst_sel:WORD_1 dst_unused:UNUSED_PRESERVE src0_sel:WORD_1
v_exp_f16 v251, v247
v_mfma_f32_32x32x16_bf16 v[208:223], a[204:207], a[84:87], v[208:223]
ds_read_b128 a[204:207], v1 offset:27648
s_waitcnt lgkmcnt(9)
v_or_b32 v40, v8, v9
v_pk_add_f16 v244, v248, 1.0 op_sel_hi:[1,0]
v_mad_u32_u16 v19, v19, 2, s85 op_sel:[1,0,0,0]
v_mad_u32_u16 v20, v20, 2, s85 op_sel:[1,0,0,0]
v_mfma_f32_32x32x16_f16 v[110:125], a[228:231], v[228:231], v[110:125]
ds_read_b128 a[228:231], v2 offset:15360
ds_read_u16 v16, v16
v_exp_f16_sdwa v249, v245 dst_sel:WORD_1 dst_unused:UNUSED_PRESERVE src0_sel:WORD_1
v_exp_f16_sdwa v250, v246 dst_sel:WORD_1 dst_unused:UNUSED_PRESERVE src0_sel:WORD_1
v_mfma_f32_32x32x16_bf16 v[208:223], a[208:211], a[88:91], v[208:223]
ds_read_b128 a[208:211], v1 offset:28672
v_pk_add_f16 v245, v249, 1.0 op_sel_hi:[1,0]
v_mad_u32_u16 v21, v21, 2, s85 op_sel:[1,0,0,0]
s_waitcnt lgkmcnt(9)
v_or_b32 v41, v10, v11
v_pk_add_f16 v246, v250, 1.0 op_sel_hi:[1,0]
v_mfma_f32_32x32x16_f16 v[126:141], a[232:235], v[228:231], v[126:141]
ds_read_b128 a[232:235], v2 offset:16384
v_mad_u32_u16 v22, v22, 2, s85 op_sel:[1,0,0,0]
v_mad_u32_u16 v23, v23, 2, s85 op_sel:[1,0,0,0]
v_exp_f16_sdwa v251, v247 dst_sel:WORD_1 dst_unused:UNUSED_PRESERVE src0_sel:WORD_1
v_rcp_f16 v248, v244
v_mfma_f32_32x32x16_bf16 v[208:223], a[212:215], a[92:95], v[208:223]
ds_read_b128 a[212:215], v1 offset:29696
ds_read_u16_d16_hi v17, v17
v_pk_add_f16 v247, v251, 1.0 op_sel_hi:[1,0]
s_waitcnt lgkmcnt(9)
v_or_b32 v42, v12, v13
v_or_b32 v236, v56, v57
v_mfma_f32_32x32x16_f16 v[142:157], a[236:239], v[228:231], v[142:157]
ds_read_b128 a[236:239], v2 offset:17408
v_or_b32 v237, v58, v59
v_or_b32 v238, v60, v61
v_or_b32 v239, v7, v0
v_rcp_f16 v249, v245
v_mfma_f32_32x32x16_f16 v[62:77], a[216:219], v[48:51], v[62:77]
ds_read_u16 v18, v18
ds_read_u16_d16_hi v19, v19
v_rcp_f16 v250, v246
v_rcp_f16_sdwa v248, v244 dst_sel:WORD_1 dst_unused:UNUSED_PRESERVE src0_sel:WORD_1
v_mfma_f32_32x32x16_f16 v[78:93], a[220:223], v[48:51], v[78:93]
ds_read_u16 v20, v20
s_waitcnt lgkmcnt(9)
v_or_b32 v43, v14, v15
v_pk_mul_f16 v232, v232, v248
v_rcp_f16 v251, v247
v_mfma_f32_32x32x16_f16 v[94:109], a[224:227], v[48:51], v[94:109]
ds_read_u16_d16_hi v21, v21
ds_read_u16 v22, v22
ds_read_u16_d16_hi v23, v23
v_rcp_f16_sdwa v249, v245 dst_sel:WORD_1 dst_unused:UNUSED_PRESERVE src0_sel:WORD_1
v_rcp_f16_sdwa v250, v246 dst_sel:WORD_1 dst_unused:UNUSED_PRESERVE src0_sel:WORD_1
v_mfma_f32_32x32x16_f16 v[62:77], a[228:231], v[52:55], v[62:77]
v_pk_mul_f16 v233, v233, v249
v_pk_mul_f16 v234, v234, v250
v_rcp_f16_sdwa v251, v247 dst_sel:WORD_1 dst_unused:UNUSED_PRESERVE src0_sel:WORD_1
s_nop 0
v_pk_mul_f16 v235, v235, v251
v_mad_u32_u16 v24, v24, 2, s85 op_sel:[1,0,0,0]
s_waitcnt lgkmcnt(6)
v_mfma_f32_32x32x16_f16 v[78:93], a[232:235], v[52:55], v[78:93]
ds_read_u16 v24, v24
v_mad_u32_u16 v25, v25, 2, s85 op_sel:[1,0,0,0]
v_mad_u32_u16 v26, v26, 2, s85 op_sel:[1,0,0,0]
v_mad_u32_u16 v27, v27, 2, s85 op_sel:[1,0,0,0]
v_mad_u32_u16 v28, v28, 2, s85 op_sel:[1,0,0,0]
v_mad_u32_u16 v29, v29, 2, s85 op_sel:[1,0,0,0]
v_mad_u32_u16 v30, v30, 2, s85 op_sel:[1,0,0,0]
v_or_b32 v44, v16, v17
v_mad_u32_u16 v31, v31, 2, s85 op_sel:[1,0,0,0]
v_mad_u32_u16 v32, v32, 2, s85 op_sel:[1,0,0,0]
v_mfma_f32_32x32x16_f16 v[94:109], a[236:239], v[52:55], v[94:109]
ds_read_u16_d16_hi v25, v25
ds_read_u16 v26, v26
ds_read_u16_d16_hi v27, v27
v_mad_u32_u16 v33, v33, 2, s85 op_sel:[1,0,0,0]
v_mad_u32_u16 v34, v34, 2, s85 op_sel:[1,0,0,0]
s_waitcnt vmcnt(8)
v_smfmac_f32_32x32x32_bf16 v[62:77], a[250:253], a[168:175], v4
ds_read_u16 v28, v28
v_mad_u32_u16 v35, v35, 2, s85 op_sel:[1,0,0,0]
s_waitcnt lgkmcnt(7)
v_or_b32 v45, v18, v19
v_mad_u32_u16 v36, v36, 2, s85 op_sel:[1,0,0,0]
v_mfma_f32_32x32x16_f16 v[110:125], a[216:219], v[232:235], v[110:125]
ds_read_b128 a[216:219], v2 offset:18432
ds_read_u16_d16_hi v29, v29
ds_read_u16 v30, v30
ds_read_u16_d16_hi v31, v31
v_mad_u32_u16 v37, v37, 2, s85 op_sel:[1,0,0,0]
v_mfma_f32_32x32x16_f16 v[126:141], a[220:223], v[232:235], v[126:141]
buffer_load_dwordx4 a[168:171], v5, s[4:7], s78 offen offset:64
ds_read_b128 a[220:223], v2 offset:19456
v_or_b32 v46, v20, v21
v_mad_u32_u16 v38, v38, 2, s85 op_sel:[1,0,0,0]
v_mfma_f32_32x32x16_f16 v[142:157], a[224:227], v[232:235], v[142:157]
ds_read_b128 a[224:227], v2 offset:20480
v_mad_u32_u16 v39, v39, 2, s85 op_sel:[1,0,0,0]
v_mul_f32 v56, s60, v216
v_mul_f32 v57, s60, v217
v_mul_f32 v58, s60, v218
v_mul_f32 v59, s60, v219
v_mfma_f32_32x32x16_f16 v[110:125], a[228:231], v[236:239], v[110:125]
ds_read_b128 a[228:231], v2 offset:21504
s_waitcnt lgkmcnt(10)
v_or_b32 v47, v22, v23
v_mul_f32 v60, s60, v220
v_mul_f32 v61, s60, v221
v_mul_f32 v7, s60, v222
v_mfma_f32_32x32x16_bf16 v[8:23], a[192:195], a[48:51], 0
global_load_dword a255, v[158:159], off
ds_read_u16 v32, v32
ds_read_u16_d16_hi v33, v33
v_or_b32 v48, v24, v25
v_mfma_f32_32x32x16_f16 v[126:141], a[232:235], v[236:239], v[126:141]
v_mul_f32 v0, s60, v223
v_mad_u32_u16 v56, v56, 2, s85 op_sel:[1,0,0,0]
v_mad_u32_u16 v57, v57, 2, s85 op_sel:[1,0,0,0]
v_mad_u32_u16 v58, v58, 2, s85 op_sel:[1,0,0,0]
v_mad_u32_u16 v59, v59, 2, s85 op_sel:[1,0,0,0]
v_mfma_f32_32x32x16_bf16 v[8:23], a[196:199], a[52:55], v[8:23]
ds_read_b128 a[232:235], v2 offset:22528
buffer_store_dwordx4 v[164:167], v6, s[8:11], s80 offen offset:3072 sc1 nt
ds_read_u16 v34, v34
v_mfma_f32_32x32x16_f16 v[142:157], a[236:239], v[236:239], v[142:157]
ds_read_b128 a[236:239], v2 offset:23552
s_waitcnt lgkmcnt(9)
v_or_b32 v49, v26, v27
v_mad_u32_u16 v60, v60, 2, s85 op_sel:[1,0,0,0]
v_mad_u32_u16 v61, v61, 2, s85 op_sel:[1,0,0,0]
v_mad_u32_u16 v7, v7, 2, s85 op_sel:[1,0,0,0]
v_mfma_f32_32x32x16_bf16 v[8:23], a[200:203], a[56:59], v[8:23]
ds_read_u16_d16_hi v35, v35
ds_read_u16 v36, v36
v_or_b32 v50, v28, v29
v_mad_u32_u16 v0, v0, 2, s85 op_sel:[1,0,0,0]
v_cvt_pk_f16_f32 v224, v208, v209
v_cvt_pk_f16_f32 v225, v210, v211
v_mfma_f32_32x32x16_f16 v[62:77], a[216:219], v[40:43], v[62:77]
ds_read_u16_d16_hi v37, v37
v_pk_fma_f16 v240, v224, v224, s84
v_cvt_pk_f16_f32 v226, v212, v213
v_pk_fma_f16 v241, v225, v225, s84
v_pk_mul_f16 v240, v224, v240
v_exp_f16 v248, v240
s_mov_b32 s42, 4992
v_lshl_add_u64 v[158:159], v[158:159], 0, s[42:43]
v_mfma_f32_32x32x16_bf16 v[8:23], a[204:207], a[60:63], v[8:23]
ds_read_u16 v38, v38
ds_read_u16_d16_hi v39, v39
s_waitcnt lgkmcnt(9)
v_or_b32 v51, v30, v31
v_cvt_pk_f16_f32 v227, v214, v215
v_pk_fma_f16 v242, v226, v226, s84
v_mfma_f32_32x32x16_f16 v[78:93], a[220:223], v[40:43], v[78:93]
ds_read_u16 v56, v56
ds_read_u16_d16_hi v57, v57
buffer_load_dwordx4 a[172:175], v5, s[4:7], s78 offen offset:80
v_pk_mul_f16 v241, v225, v241
v_mfma_f32_32x32x16_bf16 v[8:23], a[208:211], a[64:67], v[8:23]
ds_read_u16 v58, v58
v_pk_fma_f16 v243, v227, v227, s84
v_pk_mul_f16 v242, v226, v242
v_pk_mul_f16 v243, v227, v243
s_waitcnt lgkmcnt(8)
v_or_b32 v52, v32, v33
v_mfma_f32_32x32x16_f16 v[94:109], a[224:227], v[40:43], v[94:109]
ds_read_u16_d16_hi v59, v59
ds_read_u16 v60, v60
v_exp_f16 v249, v241
v_exp_f16 v250, v242
v_mfma_f32_32x32x16_bf16 v[8:23], a[212:215], a[68:71], v[8:23]
ds_read_u16_d16_hi v61, v61
v_exp_f16_sdwa v248, v240 dst_sel:WORD_1 dst_unused:UNUSED_PRESERVE src0_sel:WORD_1
v_exp_f16 v251, v243
v_exp_f16_sdwa v249, v241 dst_sel:WORD_1 dst_unused:UNUSED_PRESERVE src0_sel:WORD_1
v_mfma_f32_32x32x16_f16 v[62:77], a[228:231], v[44:47], v[62:77]
ds_read_u16 v7, v7
s_waitcnt lgkmcnt(9)
v_or_b32 v53, v34, v35
v_exp_f16_sdwa v250, v242 dst_sel:WORD_1 dst_unused:UNUSED_PRESERVE src0_sel:WORD_1
v_exp_f16_sdwa v251, v243 dst_sel:WORD_1 dst_unused:UNUSED_PRESERVE src0_sel:WORD_1
v_mfma_f32_32x32x16_bf16 v[208:223], a[192:195], a[72:75], 0
ds_read_b128 a[192:195], v1 offset:30720
ds_read_u16_d16_hi v0, v0
v_mad_u32_u16 v8, v8, 2, s85 op_sel:[1,0,0,0]
v_mad_u32_u16 v9, v9, 2, s85 op_sel:[1,0,0,0]
v_mad_u32_u16 v10, v10, 2, s85 op_sel:[1,0,0,0]
v_or_b32 v54, v36, v37
v_mfma_f32_32x32x16_f16 v[78:93], a[232:235], v[44:47], v[78:93]
ds_read_u16 v8, v8
v_mad_u32_u16 v11, v11, 2, s85 op_sel:[1,0,0,0]
v_mad_u32_u16 v12, v12, 2, s85 op_sel:[1,0,0,0]
v_mad_u32_u16 v13, v13, 2, s85 op_sel:[1,0,0,0]
v_mad_u32_u16 v14, v14, 2, s85 op_sel:[1,0,0,0]
v_mfma_f32_32x32x16_bf16 v[208:223], a[196:199], a[76:79], v[208:223]
ds_read_b128 a[196:199], v1 offset:31744
v_mad_u32_u16 v15, v15, 2, s85 op_sel:[1,0,0,0]
v_mad_u32_u16 v16, v16, 2, s85 op_sel:[1,0,0,0]
s_waitcnt lgkmcnt(9)
v_or_b32 v55, v38, v39
v_mad_u32_u16 v17, v17, 2, s85 op_sel:[1,0,0,0]
v_mfma_f32_32x32x16_f16 v[94:109], a[236:239], v[44:47], v[94:109]
ds_read_u16_d16_hi v9, v9
v_mad_u32_u16 v18, v18, 2, s85 op_sel:[1,0,0,0]
v_pk_add_f16 v240, v248, 1.0 op_sel_hi:[1,0]
v_mad_u32_u16 v19, v19, 2, s85 op_sel:[1,0,0,0]
v_rcp_f16 v248, v240
v_mfma_f32_32x32x16_bf16 v[208:223], a[200:203], a[80:83], v[208:223]
ds_read_b128 a[200:203], v1 offset:32768
ds_read_u16 v10, v10
v_mad_u32_u16 v20, v20, 2, s85 op_sel:[1,0,0,0]
v_pk_add_f16 v241, v249, 1.0 op_sel_hi:[1,0]
v_mad_u32_u16 v21, v21, 2, s85 op_sel:[1,0,0,0]
v_pk_add_f16 v242, v250, 1.0 op_sel_hi:[1,0]
v_mfma_f32_32x32x16_f16 v[110:125], a[216:219], a[184:187], v[110:125]
ds_read_b128 a[216:219], v2 offset:24576
v_mad_u32_u16 v22, v22, 2, s85 op_sel:[1,0,0,0]
v_mad_u32_u16 v23, v23, 2, s85 op_sel:[1,0,0,0]
v_rcp_f16 v249, v241
v_pk_add_f16 v243, v251, 1.0 op_sel_hi:[1,0]
v_mfma_f32_32x32x16_bf16 v[208:223], a[204:207], a[84:87], v[208:223]
ds_read_b128 a[204:207], v1 offset:33792
v_or_b32 v228, v56, v57
s_waitcnt lgkmcnt(10)
v_or_b32 v229, v58, v59
v_rcp_f16 v250, v242
v_mfma_f32_32x32x16_f16 v[126:141], a[220:223], a[184:187], v[126:141]
ds_read_b128 a[220:223], v2 offset:25600
buffer_store_dwordx4 v[168:171], v6, s[8:11], s80 offen offset:64 sc1 nt
ds_read_u16_d16_hi v11, v11
v_mfma_f32_32x32x16_bf16 v[208:223], a[208:211], a[88:91], v[208:223]
v_or_b32 v230, v60, v61
v_rcp_f16_sdwa v248, v240 dst_sel:WORD_1 dst_unused:UNUSED_PRESERVE src0_sel:WORD_1
v_rcp_f16 v251, v243
v_rcp_f16_sdwa v249, v241 dst_sel:WORD_1 dst_unused:UNUSED_PRESERVE src0_sel:WORD_1
v_mfma_f32_32x32x16_f16 v[142:157], a[224:227], a[184:187], v[142:157]
ds_read_b128 a[208:211], v1 offset:34816
ds_read_b128 a[224:227], v2 offset:26624
s_waitcnt lgkmcnt(9)
v_or_b32 v231, v7, v0
v_rcp_f16_sdwa v250, v242 dst_sel:WORD_1 dst_unused:UNUSED_PRESERVE src0_sel:WORD_1
v_mfma_f32_32x32x16_bf16 v[208:223], a[212:215], a[92:95], v[208:223]
ds_read_b128 a[212:215], v1 offset:35840
v_rcp_f16_sdwa v251, v243 dst_sel:WORD_1 dst_unused:UNUSED_PRESERVE src0_sel:WORD_1
ds_read_u16 v12, v12
v_mfma_f32_32x32x16_f16 v[110:125], a[228:231], a[188:191], v[110:125]
ds_read_b128 a[228:231], v2 offset:34560
ds_read_u16_d16_hi v13, v13
ds_read_u16 v14, v14
s_waitcnt lgkmcnt(10)
v_or_b32 v40, v8, v9
v_mfma_f32_32x32x16_f16 v[126:141], a[232:235], a[188:191], v[126:141]
ds_read_b128 a[232:235], v2 offset:35584
ds_read_u16_d16_hi v15, v15
v_mul_f32 v56, s60, v216
v_mul_f32 v57, s60, v217
v_mul_f32 v58, s60, v218
v_mul_f32 v59, s60, v219
v_mfma_f32_32x32x16_bf16 v[24:39], a[192:195], a[48:51], 0
v_mul_f32 v60, s60, v220
v_mul_f32 v61, s60, v221
v_mul_f32 v7, s60, v222
v_mul_f32 v0, s60, v223
v_mad_u32_u16 v56, v56, 2, s85 op_sel:[1,0,0,0]
v_mad_u32_u16 v57, v57, 2, s85 op_sel:[1,0,0,0]
v_mfma_f32_32x32x16_f16 v[142:157], a[236:239], a[188:191], v[142:157]
ds_read_b128 a[192:195], v1 offset:36864
v_mad_u32_u16 v58, v58, 2, s85 op_sel:[1,0,0,0]
v_mad_u32_u16 v59, v59, 2, s85 op_sel:[1,0,0,0]
v_mad_u32_u16 v60, v60, 2, s85 op_sel:[1,0,0,0]
v_pk_mul_f16 v224, v224, v248
v_mad_u32_u16 v61, v61, 2, s85 op_sel:[1,0,0,0]
v_mfma_f32_32x32x16_bf16 v[24:39], a[196:199], a[52:55], v[24:39]
ds_read_b128 a[196:199], v1 offset:37888
ds_read_b128 a[236:239], v2 offset:36608
s_waitcnt lgkmcnt(9)
v_or_b32 v41, v10, v11
v_mad_u32_u16 v7, v7, 2, s85 op_sel:[1,0,0,0]
v_mad_u32_u16 v0, v0, 2, s85 op_sel:[1,0,0,0]
s_waitcnt vmcnt(8)
v_smfmac_f32_32x32x32_bf16 v[110:125], a[250:253], a[176:183], v4
ds_read_u16 v16, v16
v_cvt_pk_f16_f32 v232, v208, v209
v_cvt_pk_f16_f32 v233, v210, v211
v_pk_mul_f16 v225, v225, v249
v_pk_fma_f16 v244, v232, v232, s84
v_mfma_f32_32x32x16_bf16 v[24:39], a[200:203], a[56:59], v[24:39]
ds_read_b128 a[200:203], v1 offset:38912
ds_read_u16_d16_hi v17, v17
ds_read_u16 v18, v18
buffer_load_dwordx4 a[176:179], v5, s[4:7], s79 offen offset:64
v_mfma_f32_32x32x16_f16 v[62:77], a[216:219], v[48:51], v[62:77]
ds_read_u16_d16_hi v19, v19
v_cvt_pk_f16_f32 v234, v212, v213
v_pk_fma_f16 v245, v233, v233, s84
s_waitcnt lgkmcnt(9)
v_or_b32 v42, v12, v13
v_pk_mul_f16 v244, v232, v244
v_mfma_f32_32x32x16_bf16 v[24:39], a[204:207], a[60:63], v[24:39]
ds_read_b128 a[204:207], v1 offset:39936
v_cvt_pk_f16_f32 v235, v214, v215
v_pk_mul_f16 v226, v226, v250
v_exp_f16 v248, v244
v_pk_fma_f16 v246, v234, v234, s84
v_mfma_f32_32x32x16_f16 v[78:93], a[220:223], v[48:51], v[78:93]
ds_read_u16 v20, v20
ds_read_u16_d16_hi v21, v21
v_pk_mul_f16 v245, v233, v245
v_pk_fma_f16 v247, v235, v235, s84
v_pk_mul_f16 v246, v234, v246
s_waitcnt lgkmcnt(8)
v_or_b32 v43, v14, v15
v_mfma_f32_32x32x16_bf16 v[24:39], a[208:211], a[64:67], v[24:39]
ds_read_b128 a[208:211], v1 offset:40960
ds_read_u16 v22, v22
v_pk_mul_f16 v247, v235, v247
v_pk_mul_f16 v227, v227, v251
v_exp_f16 v249, v245
v_mfma_f32_32x32x16_f16 v[94:109], a[224:227], v[48:51], v[94:109]
ds_read_u16_d16_hi v23, v23
ds_read_u16 v56, v56
v_exp_f16 v250, v246
v_exp_f16_sdwa v248, v244 dst_sel:WORD_1 dst_unused:UNUSED_PRESERVE src0_sel:WORD_1
v_mfma_f32_32x32x16_bf16 v[24:39], a[212:215], a[68:71], v[24:39]
ds_read_b128 a[212:215], v1 offset:41984
buffer_load_dwordx4 a[180:183], v5, s[4:7], s79 offen offset:80
ds_read_u16_d16_hi v57, v57
v_exp_f16 v251, v247
v_mfma_f32_32x32x16_f16 v[62:77], a[228:231], v[52:55], v[62:77]
s_waitcnt lgkmcnt(9)
v_or_b32 v44, v16, v17
v_exp_f16_sdwa v249, v245 dst_sel:WORD_1 dst_unused:UNUSED_PRESERVE src0_sel:WORD_1
v_exp_f16_sdwa v250, v246 dst_sel:WORD_1 dst_unused:UNUSED_PRESERVE src0_sel:WORD_1
v_mfma_f32_32x32x16_f16 v[78:93], a[232:235], v[52:55], v[78:93]
ds_read_u16 v58, v58
ds_read_u16_d16_hi v59, v59
v_mad_u32_u16 v24, v24, 2, s85 op_sel:[1,0,0,0]
v_mad_u32_u16 v25, v25, 2, s85 op_sel:[1,0,0,0]
v_exp_f16_sdwa v251, v247 dst_sel:WORD_1 dst_unused:UNUSED_PRESERVE src0_sel:WORD_1
v_mfma_f32_32x32x16_f16 v[94:109], a[236:239], v[52:55], v[94:109]
ds_read_u16 v60, v60
v_or_b32 v45, v18, v19
v_mad_u32_u16 v26, v26, 2, s85 op_sel:[1,0,0,0]
v_mad_u32_u16 v27, v27, 2, s85 op_sel:[1,0,0,0]
v_mad_u32_u16 v28, v28, 2, s85 op_sel:[1,0,0,0]
v_mad_u32_u16 v29, v29, 2, s85 op_sel:[1,0,0,0]
v_mfma_f32_32x32x16_f16 v[110:125], a[216:219], v[224:227], v[110:125]
ds_read_b128 a[216:219], v2 offset:37632
v_mad_u32_u16 v30, v30, 2, s85 op_sel:[1,0,0,0]
v_mad_u32_u16 v31, v31, 2, s85 op_sel:[1,0,0,0]
v_mad_u32_u16 v32, v32, 2, s85 op_sel:[1,0,0,0]
v_mad_u32_u16 v33, v33, 2, s85 op_sel:[1,0,0,0]
v_mfma_f32_32x32x16_f16 v[126:141], a[220:223], v[224:227], v[126:141]
ds_read_b128 a[220:223], v2 offset:38656
ds_read_u16_d16_hi v61, v61
s_waitcnt lgkmcnt(10)
v_or_b32 v46, v20, v21
v_mad_u32_u16 v34, v34, 2, s85 op_sel:[1,0,0,0]
v_pk_add_f16 v244, v248, 1.0 op_sel_hi:[1,0]
v_mfma_f32_32x32x16_f16 v[142:157], a[224:227], v[224:227], v[142:157]
ds_read_b128 a[224:227], v2 offset:39680
s_add_u32 s101, s3, 47104
buffer_load_dwordx4 a[96:99], v1, s[12:15], s101 offen offset:0
ds_read_u16 v7, v7
v_mfma_f32_32x32x16_f16 v[110:125], a[228:231], v[228:231], v[110:125]
v_mad_u32_u16 v35, v35, 2, s85 op_sel:[1,0,0,0]
s_waitcnt lgkmcnt(9)
v_or_b32 v47, v22, v23
v_mad_u32_u16 v36, v36, 2, s85 op_sel:[1,0,0,0]
v_pk_add_f16 v245, v249, 1.0 op_sel_hi:[1,0]
v_mad_u32_u16 v37, v37, 2, s85 op_sel:[1,0,0,0]
v_mfma_f32_32x32x16_bf16 v[8:23], a[192:195], a[48:51], 0
ds_read_b128 a[228:231], v2 offset:40704
ds_read_u16_d16_hi v0, v0
v_pk_add_f16 v246, v250, 1.0 op_sel_hi:[1,0]
v_mad_u32_u16 v38, v38, 2, s85 op_sel:[1,0,0,0]
v_mad_u32_u16 v39, v39, 2, s85 op_sel:[1,0,0,0]
v_rcp_f16 v248, v244
v_mfma_f32_32x32x16_f16 v[126:141], a[232:235], v[228:231], v[126:141]
ds_read_b128 a[232:235], v2 offset:41728
v_pk_add_f16 v247, v251, 1.0 op_sel_hi:[1,0]
s_waitcnt lgkmcnt(9)
v_or_b32 v236, v56, v57
v_rcp_f16 v249, v245
v_mfma_f32_32x32x16_bf16 v[8:23], a[196:199], a[52:55], v[8:23]
ds_read_u16 v24, v24
ds_read_u16_d16_hi v25, v25
v_rcp_f16 v250, v246
v_rcp_f16_sdwa v248, v244 dst_sel:WORD_1 dst_unused:UNUSED_PRESERVE src0_sel:WORD_1
v_mfma_f32_32x32x16_f16 v[142:157], a[236:239], v[228:231], v[142:157]
ds_read_b128 a[236:239], v2 offset:42752
v_or_b32 v237, v58, v59
v_rcp_f16 v251, v247
v_rcp_f16_sdwa v249, v245 dst_sel:WORD_1 dst_unused:UNUSED_PRESERVE src0_sel:WORD_1
v_mfma_f32_32x32x16_bf16 v[8:23], a[200:203], a[56:59], v[8:23]
ds_read_u16 v26, v26
buffer_load_dwordx4 a[100:103], v1, s[12:15], s101 offen offset:1024
ds_read_u16_d16_hi v27, v27
v_rcp_f16_sdwa v250, v246 dst_sel:WORD_1 dst_unused:UNUSED_PRESERVE src0_sel:WORD_1
s_waitcnt lgkmcnt(9)
v_mfma_f32_32x32x16_f16 v[62:77], a[216:219], v[40:43], v[62:77]
ds_read_u16 v28, v28
v_rcp_f16_sdwa v251, v247 dst_sel:WORD_1 dst_unused:UNUSED_PRESERVE src0_sel:WORD_1
v_or_b32 v238, v60, v61
ds_read_u16_d16_hi v29, v29
v_mfma_f32_32x32x16_bf16 v[8:23], a[204:207], a[60:63], v[8:23]
ds_read_u16 v30, v30
buffer_store_dwordx4 v[172:175], v6, s[8:11], s80 offen offset:3136 sc1 nt
v_mfma_f32_32x32x16_f16 v[78:93], a[220:223], v[40:43], v[78:93]
ds_read_u16_d16_hi v31, v31
ds_read_u16 v32, v32
ds_read_u16_d16_hi v33, v33
ds_read_u16 v34, v34
ds_read_u16_d16_hi v35, v35
v_mfma_f32_32x32x16_f16 v[94:109], a[224:227], v[40:43], v[94:109]
s_waitcnt lgkmcnt(12)
v_or_b32 v239, v7, v0
v_pk_mul_f16 v232, v232, v248
v_pk_mul_f16 v233, v233, v249
v_pk_mul_f16 v234, v234, v250
v_pk_mul_f16 v235, v235, v251
v_mfma_f32_32x32x16_bf16 v[8:23], a[208:211], a[64:67], v[8:23]
ds_read_u16 v36, v36
ds_read_u16_d16_hi v37, v37
ds_read_u16 v38, v38
v_mfma_f32_32x32x16_f16 v[62:77], a[228:231], v[44:47], v[62:77]
s_waitcnt lgkmcnt(12)
v_or_b32 v48, v24, v25
ds_read_u16_d16_hi v39, v39
v_mfma_f32_32x32x16_f16 v[78:93], a[232:235], v[44:47], v[78:93]
v_mfma_f32_32x32x16_f16 v[94:109], a[236:239], v[44:47], v[94:109]
s_waitcnt lgkmcnt(10)
v_or_b32 v49, v26, v27
v_mfma_f32_32x32x16_bf16 v[8:23], a[212:215], a[68:71], v[8:23]
s_nop 5
v_mfma_f32_32x32x16_f16 v[110:125], a[216:219], v[232:235], v[110:125]
ds_read_b128 a[216:219], v2 offset:43776
v_or_b32 v50, v28, v29
s_nop 2
v_mad_u32_u16 v8, v8, 2, s85 op_sel:[1,0,0,0]
v_mfma_f32_32x32x16_bf16 v[208:223], a[192:195], a[72:75], 0
ds_read_b128 a[192:195], v1 offset:43008
ds_read_u16 v8, v8
v_mad_u32_u16 v9, v9, 2, s85 op_sel:[1,0,0,0]
v_mad_u32_u16 v10, v10, 2, s85 op_sel:[1,0,0,0]
s_waitcnt lgkmcnt(9)
v_or_b32 v51, v30, v31
v_mfma_f32_32x32x16_f16 v[126:141], a[220:223], v[232:235], v[126:141]
ds_read_b128 a[220:223], v2 offset:44800
buffer_store_dwordx4 v[176:179], v6, s[8:11], s80 offen offset:128 sc1 nt
ds_read_u16_d16_hi v9, v9
v_mfma_f32_32x32x16_bf16 v[208:223], a[196:199], a[76:79], v[208:223]
ds_read_b128 a[196:199], v1 offset:44032
v_or_b32 v52, v32, v33
v_mad_u32_u16 v11, v11, 2, s85 op_sel:[1,0,0,0]
v_mad_u32_u16 v12, v12, 2, s85 op_sel:[1,0,0,0]
v_mad_u32_u16 v13, v13, 2, s85 op_sel:[1,0,0,0]
v_mad_u32_u16 v14, v14, 2, s85 op_sel:[1,0,0,0]
v_mfma_f32_32x32x16_f16 v[142:157], a[224:227], v[232:235], v[142:157]
ds_read_b128 a[224:227], v2 offset:45824
v_mad_u32_u16 v15, v15, 2, s85 op_sel:[1,0,0,0]
v_mad_u32_u16 v16, v16, 2, s85 op_sel:[1,0,0,0]
v_mad_u32_u16 v17, v17, 2, s85 op_sel:[1,0,0,0]
v_mad_u32_u16 v18, v18, 2, s85 op_sel:[1,0,0,0]
s_waitcnt lgkmcnt(9)
v_or_b32 v53, v34, v35
v_mfma_f32_32x32x16_bf16 v[208:223], a[200:203], a[80:83], v[208:223]
ds_read_b128 a[200:203], v1 offset:45056
v_mad_u32_u16 v19, v19, 2, s85 op_sel:[1,0,0,0]
v_mad_u32_u16 v20, v20, 2, s85 op_sel:[1,0,0,0]
v_mad_u32_u16 v21, v21, 2, s85 op_sel:[1,0,0,0]
v_mad_u32_u16 v22, v22, 2, s85 op_sel:[1,0,0,0]
v_mad_u32_u16 v23, v23, 2, s85 op_sel:[1,0,0,0]
v_mfma_f32_32x32x16_f16 v[110:125], a[228:231], v[236:239], v[110:125]
ds_read_b128 a[228:231], v2 offset:46848
ds_read_u16 v10, v10
v_or_b32 v54, v36, v37
ds_read_u16_d16_hi v11, v11
v_mfma_f32_32x32x16_bf16 v[208:223], a[204:207], a[84:87], v[208:223]
ds_read_u16 v12, v12
ds_read_u16_d16_hi v13, v13
ds_read_u16 v14, v14
s_waitcnt lgkmcnt(11)
v_or_b32 v55, v38, v39
v_mfma_f32_32x32x16_f16 v[126:141], a[232:235], v[236:239], v[126:141]
ds_read_b128 a[232:235], v2 offset:47872
ds_read_u16_d16_hi v15, v15
ds_read_u16 v16, v16
v_mfma_f32_32x32x16_bf16 v[208:223], a[208:211], a[88:91], v[208:223]
ds_read_u16_d16_hi v17, v17
v_mfma_f32_32x32x16_f16 v[142:157], a[236:239], v[236:239], v[142:157]
ds_read_b128 a[236:239], v2 offset:48896
v_mfma_f32_32x32x16_bf16 v[208:223], a[212:215], a[92:95], v[208:223]
s_waitcnt lgkmcnt(10)
v_or_b32 v40, v8, v9
ds_read_u16 v18, v18
ds_read_u16_d16_hi v19, v19
v_mfma_f32_32x32x16_f16 v[62:77], a[216:219], v[48:51], v[62:77]
ds_read_u16 v20, v20
ds_read_u16_d16_hi v21, v21
s_nop 1
v_mfma_f32_32x32x16_bf16 v[24:39], a[192:195], a[48:51], 0
ds_read_u16 v22, v22
s_nop 0
v_mul_f32 v56, s60, v216
v_mul_f32 v57, s60, v217
v_mul_f32 v58, s60, v218
v_mul_f32 v59, s60, v219
v_mfma_f32_32x32x16_f16 v[78:93], a[220:223], v[48:51], v[78:93]
buffer_store_dwordx4 v[180:183], v6, s[8:11], s80 offen offset:3200 sc1 nt
v_mfma_f32_32x32x16_bf16 v[24:39], a[196:199], a[52:55], v[24:39]
s_waitcnt lgkmcnt(11)
v_or_b32 v41, v10, v11
v_mul_f32 v60, s60, v220
v_mul_f32 v61, s60, v221
v_mul_f32 v7, s60, v222
v_mul_f32 v0, s60, v223
v_mfma_f32_32x32x16_f16 v[94:109], a[224:227], v[48:51], v[94:109]
v_mad_u32_u16 v56, v56, 2, s85 op_sel:[1,0,0,0]
v_or_b32 v42, v12, v13
v_mad_u32_u16 v57, v57, 2, s85 op_sel:[1,0,0,0]
v_mad_u32_u16 v58, v58, 2, s85 op_sel:[1,0,0,0]
v_mad_u32_u16 v59, v59, 2, s85 op_sel:[1,0,0,0]
v_mad_u32_u16 v60, v60, 2, s85 op_sel:[1,0,0,0]
v_mfma_f32_32x32x16_bf16 v[24:39], a[200:203], a[56:59], v[24:39]
ds_read_b128 a[204:207], v1 offset:46080
ds_read_b128 a[208:211], v1 offset:47104
v_mad_u32_u16 v61, v61, 2, s85 op_sel:[1,0,0,0]
v_mad_u32_u16 v7, v7, 2, s85 op_sel:[1,0,0,0]
v_mad_u32_u16 v0, v0, 2, s85 op_sel:[1,0,0,0]
v_cvt_pk_f16_f32 v224, v208, v209
v_mfma_f32_32x32x16_f16 v[62:77], a[228:231], v[52:55], v[62:77]
ds_read_b128 a[212:215], v1 offset:48128
s_waitcnt lgkmcnt(9)
v_or_b32 v43, v14, v15
v_cvt_pk_f16_f32 v225, v210, v211
v_pk_fma_f16 v240, v224, v224, s84
v_cvt_pk_f16_f32 v226, v212, v213
v_mfma_f32_32x32x16_f16 v[78:93], a[232:235], v[52:55], v[78:93]
ds_read_u16_d16_hi v23, v23
ds_read_u16 v56, v56
v_pk_fma_f16 v241, v225, v225, s84
v_pk_mul_f16 v240, v224, v240
v_cvt_pk_f16_f32 v227, v214, v215
v_pk_fma_f16 v242, v226, v226, s84
v_or_b32 v44, v16, v17
v_pk_mul_f16 v241, v225, v241
v_exp_f16 v248, v240
s_waitcnt lgkmcnt(8)
v_mfma_f32_32x32x16_f16 v[94:109], a[236:239], v[52:55], v[94:109]
ds_read_u16_d16_hi v57, v57
ds_read_u16 v58, v58
v_pk_fma_f16 v243, v227, v227, s84
v_pk_mul_f16 v242, v226, v242
v_pk_mul_f16 v243, v227, v243
v_exp_f16 v249, v241
v_exp_f16 v250, v242
v_exp_f16_sdwa v248, v240 dst_sel:WORD_1 dst_unused:UNUSED_PRESERVE src0_sel:WORD_1
v_or_b32 v45, v18, v19
v_exp_f16 v251, v243
v_exp_f16_sdwa v249, v241 dst_sel:WORD_1 dst_unused:UNUSED_PRESERVE src0_sel:WORD_1
v_exp_f16_sdwa v250, v242 dst_sel:WORD_1 dst_unused:UNUSED_PRESERVE src0_sel:WORD_1
v_exp_f16_sdwa v251, v243 dst_sel:WORD_1 dst_unused:UNUSED_PRESERVE src0_sel:WORD_1
ds_read_u16_d16_hi v59, v59
ds_read_u16 v60, v60
s_waitcnt lgkmcnt(7)
v_or_b32 v46, v20, v21
ds_read_u16_d16_hi v61, v61
ds_read_u16 v7, v7
ds_read_u16_d16_hi v0, v0
v_mfma_f32_32x32x16_bf16 v[24:39], a[204:207], a[60:63], v[24:39]
s_waitcnt vmcnt(8)
v_smfmac_f32_32x32x32_bf16 v[78:93], a[250:253], a[168:175], v4
buffer_load_dwordx4 a[168:171], v5, s[4:7], s78 offen offset:128
s_waitcnt lgkmcnt(6)
v_or_b32 v47, v22, v23
v_mfma_f32_32x32x16_bf16 v[24:39], a[208:211], a[64:67], v[24:39]
buffer_load_dwordx4 a[172:175], v5, s[4:7], s78 offen offset:144
v_mfma_f32_32x32x16_bf16 v[24:39], a[212:215], a[68:71], v[24:39]
s_nop 5
v_mfma_f32_32x32x16_f16 v[110:125], a[216:219], a[144:147], v[110:125]
ds_read_b128 a[216:219], v2 offset:49920
s_nop 3
v_mad_u32_u16 v24, v24, 2, s85 op_sel:[1,0,0,0]
v_mfma_f32_32x32x16_bf16 v[208:223], a[192:195], a[72:75], 0
ds_read_b128 a[192:195], v1 offset:49152
ds_read_u16 v24, v24
v_mad_u32_u16 v25, v25, 2, s85 op_sel:[1,0,0,0]
v_mad_u32_u16 v26, v26, 2, s85 op_sel:[1,0,0,0]
v_mad_u32_u16 v27, v27, 2, s85 op_sel:[1,0,0,0]
v_mad_u32_u16 v28, v28, 2, s85 op_sel:[1,0,0,0]
v_mfma_f32_32x32x16_f16 v[126:141], a[220:223], a[144:147], v[126:141]
ds_read_b128 a[220:223], v2 offset:50944
ds_read_u16_d16_hi v25, v25
ds_read_u16 v26, v26
ds_read_u16_d16_hi v27, v27
v_mad_u32_u16 v29, v29, 2, s85 op_sel:[1,0,0,0]
v_mad_u32_u16 v30, v30, 2, s85 op_sel:[1,0,0,0]
v_mfma_f32_32x32x16_bf16 v[208:223], a[196:199], a[76:79], v[208:223]
ds_read_b128 a[196:199], v1 offset:50176
ds_read_u16 v28, v28
ds_read_u16_d16_hi v29, v29
ds_read_u16 v30, v30
v_mad_u32_u16 v31, v31, 2, s85 op_sel:[1,0,0,0]
v_mad_u32_u16 v32, v32, 2, s85 op_sel:[1,0,0,0]
v_mfma_f32_32x32x16_f16 v[142:157], a[224:227], a[144:147], v[142:157]
buffer_store_dwordx4 v[184:187], v6, s[8:11], s81 offen offset:0 sc1 nt
ds_read_b128 a[224:227], v2 offset:51968
ds_read_u16_d16_hi v31, v31
v_mfma_f32_32x32x16_bf16 v[208:223], a[200:203], a[80:83], v[208:223]
ds_read_b128 a[200:203], v1 offset:51200
v_mad_u32_u16 v33, v33, 2, s85 op_sel:[1,0,0,0]
v_mad_u32_u16 v34, v34, 2, s85 op_sel:[1,0,0,0]
v_pk_add_f16 v240, v248, 1.0 op_sel_hi:[1,0]
v_mad_u32_u16 v35, v35, 2, s85 op_sel:[1,0,0,0]
v_mfma_f32_32x32x16_f16 v[110:125], a[228:231], a[148:151], v[110:125]
ds_read_b128 a[228:231], v2 offset:52992
v_mad_u32_u16 v36, v36, 2, s85 op_sel:[1,0,0,0]
v_pk_add_f16 v241, v249, 1.0 op_sel_hi:[1,0]
v_mad_u32_u16 v37, v37, 2, s85 op_sel:[1,0,0,0]
v_pk_add_f16 v242, v250, 1.0 op_sel_hi:[1,0]
v_rcp_f16 v248, v240
v_mfma_f32_32x32x16_bf16 v[208:223], a[204:207], a[84:87], v[208:223]
ds_read_b128 a[204:207], v1 offset:52224
ds_read_u16 v32, v32
s_waitcnt lgkmcnt(9)
v_or_b32 v48, v24, v25
v_mad_u32_u16 v38, v38, 2, s85 op_sel:[1,0,0,0]
v_mad_u32_u16 v39, v39, 2, s85 op_sel:[1,0,0,0]
v_mfma_f32_32x32x16_f16 v[126:141], a[232:235], a[148:151], v[126:141]
ds_read_b128 a[232:235], v2 offset:54016
v_pk_add_f16 v243, v251, 1.0 op_sel_hi:[1,0]
v_or_b32 v228, v56, v57
v_or_b32 v229, v58, v59
v_or_b32 v49, v26, v27
v_or_b32 v230, v60, v61
v_mfma_f32_32x32x16_bf16 v[208:223], a[208:211], a[88:91], v[208:223]
ds_read_b128 a[208:211], v1 offset:53248
ds_read_u16_d16_hi v33, v33
v_or_b32 v231, v7, v0
v_rcp_f16 v249, v241
v_rcp_f16 v250, v242
v_mfma_f32_32x32x16_f16 v[142:157], a[236:239], a[148:151], v[142:157]
ds_read_b128 a[236:239], v2 offset:55040
v_rcp_f16_sdwa v248, v240 dst_sel:WORD_1 dst_unused:UNUSED_PRESERVE src0_sel:WORD_1
v_rcp_f16 v251, v243
s_waitcnt lgkmcnt(9)
v_or_b32 v50, v28, v29
v_mfma_f32_32x32x16_bf16 v[208:223], a[212:215], a[92:95], v[208:223]
ds_read_b128 a[212:215], v1 offset:54272
v_rcp_f16_sdwa v249, v241 dst_sel:WORD_1 dst_unused:UNUSED_PRESERVE src0_sel:WORD_1
v_rcp_f16_sdwa v250, v242 dst_sel:WORD_1 dst_unused:UNUSED_PRESERVE src0_sel:WORD_1
v_rcp_f16_sdwa v251, v243 dst_sel:WORD_1 dst_unused:UNUSED_PRESERVE src0_sel:WORD_1
v_mfma_f32_32x32x16_f16 v[62:77], a[216:219], v[40:43], v[62:77]
ds_read_u16 v34, v34
ds_read_u16_d16_hi v35, v35
ds_read_u16 v36, v36
ds_read_u16_d16_hi v37, v37
s_waitcnt lgkmcnt(10)
v_or_b32 v51, v30, v31
v_mfma_f32_32x32x16_bf16 v[8:23], a[192:195], a[48:51], 0
v_mul_f32 v56, s60, v216
v_mul_f32 v57, s60, v217
v_mul_f32 v58, s60, v218
v_mul_f32 v59, s60, v219
v_mul_f32 v60, s60, v220
v_mul_f32 v61, s60, v221
v_mfma_f32_32x32x16_f16 v[78:93], a[220:223], v[40:43], v[78:93]
ds_read_b128 a[192:195], v1 offset:55296
ds_read_u16 v38, v38
v_mul_f32 v7, s60, v222
v_mul_f32 v0, s60, v223
v_mad_u32_u16 v56, v56, 2, s85 op_sel:[1,0,0,0]
v_mad_u32_u16 v57, v57, 2, s85 op_sel:[1,0,0,0]
v_mfma_f32_32x32x16_bf16 v[8:23], a[196:199], a[52:55], v[8:23]
ds_read_b128 a[196:199], v1 offset:56320
v_mad_u32_u16 v58, v58, 2, s85 op_sel:[1,0,0,0]
v_mad_u32_u16 v59, v59, 2, s85 op_sel:[1,0,0,0]
v_mad_u32_u16 v60, v60, 2, s85 op_sel:[1,0,0,0]
v_pk_mul_f16 v224, v224, v248
v_mad_u32_u16 v61, v61, 2, s85 op_sel:[1,0,0,0]
v_mfma_f32_32x32x16_f16 v[94:109], a[224:227], v[40:43], v[94:109]
ds_read_u16_d16_hi v39, v39
ds_read_u16 v56, v56
v_mad_u32_u16 v7, v7, 2, s85 op_sel:[1,0,0,0]
v_mad_u32_u16 v0, v0, 2, s85 op_sel:[1,0,0,0]
v_cvt_pk_f16_f32 v232, v208, v209
s_waitcnt lgkmcnt(8)
v_or_b32 v52, v32, v33
v_mfma_f32_32x32x16_bf16 v[8:23], a[200:203], a[56:59], v[8:23]
ds_read_b128 a[200:203], v1 offset:57344
ds_read_u16_d16_hi v57, v57
v_cvt_pk_f16_f32 v233, v210, v211
v_pk_mul_f16 v225, v225, v249
v_pk_fma_f16 v244, v232, v232, s84
v_mfma_f32_32x32x16_f16 v[62:77], a[228:231], v[44:47], v[62:77]
ds_read_u16 v58, v58
v_cvt_pk_f16_f32 v234, v212, v213
v_pk_fma_f16 v245, v233, v233, s84
v_pk_mul_f16 v244, v232, v244
v_cvt_pk_f16_f32 v235, v214, v215
v_pk_mul_f16 v226, v226, v250
v_mfma_f32_32x32x16_bf16 v[8:23], a[204:207], a[60:63], v[8:23]
ds_read_b128 a[204:207], v1 offset:58368
ds_read_u16_d16_hi v59, v59
s_waitcnt lgkmcnt(10)
v_or_b32 v53, v34, v35
v_pk_fma_f16 v246, v234, v234, s84
v_pk_mul_f16 v245, v233, v245
v_mfma_f32_32x32x16_f16 v[78:93], a[232:235], v[44:47], v[78:93]
ds_read_u16 v60, v60
v_pk_fma_f16 v247, v235, v235, s84
v_pk_mul_f16 v246, v234, v246
v_pk_mul_f16 v247, v235, v247
v_pk_mul_f16 v227, v227, v251
v_exp_f16 v248, v244
v_mfma_f32_32x32x16_bf16 v[8:23], a[208:211], a[64:67], v[8:23]
ds_read_b128 a[208:211], v1 offset:59392
v_or_b32 v54, v36, v37
v_exp_f16 v249, v245
v_exp_f16 v250, v246
v_mfma_f32_32x32x16_f16 v[94:109], a[236:239], v[44:47], v[94:109]
ds_read_u16_d16_hi v61, v61
ds_read_u16 v7, v7
v_exp_f16_sdwa v248, v244 dst_sel:WORD_1 dst_unused:UNUSED_PRESERVE src0_sel:WORD_1
v_exp_f16 v251, v247
v_mfma_f32_32x32x16_bf16 v[8:23], a[212:215], a[68:71], v[8:23]
ds_read_b128 a[212:215], v1 offset:60416
v_exp_f16_sdwa v249, v245 dst_sel:WORD_1 dst_unused:UNUSED_PRESERVE src0_sel:WORD_1
s_waitcnt lgkmcnt(9)
v_or_b32 v55, v38, v39
v_exp_f16_sdwa v250, v246 dst_sel:WORD_1 dst_unused:UNUSED_PRESERVE src0_sel:WORD_1
v_mfma_f32_32x32x16_f16 v[110:125], a[216:219], v[224:227], v[110:125]
ds_read_b128 a[216:219], v2 offset:56064
ds_read_u16_d16_hi v0, v0
v_exp_f16_sdwa v251, v247 dst_sel:WORD_1 dst_unused:UNUSED_PRESERVE src0_sel:WORD_1
s_nop 1
v_mfma_f32_32x32x16_bf16 v[24:39], a[192:195], a[48:51], 0
v_mad_u32_u16 v8, v8, 2, s85 op_sel:[1,0,0,0]
v_mad_u32_u16 v9, v9, 2, s85 op_sel:[1,0,0,0]
v_mad_u32_u16 v10, v10, 2, s85 op_sel:[1,0,0,0]
v_mad_u32_u16 v11, v11, 2, s85 op_sel:[1,0,0,0]
v_mad_u32_u16 v12, v12, 2, s85 op_sel:[1,0,0,0]
v_mad_u32_u16 v13, v13, 2, s85 op_sel:[1,0,0,0]
v_mfma_f32_32x32x16_f16 v[126:141], a[220:223], v[224:227], v[126:141]
ds_read_b128 a[220:223], v2 offset:57088
ds_read_u16 v8, v8
ds_read_u16_d16_hi v9, v9
s_add_u32 s101, s3, 4096
buffer_load_dwordx4 a[104:107], v1, s[12:15], s101 offen offset:0
v_mfma_f32_32x32x16_bf16 v[24:39], a[196:199], a[52:55], v[24:39]
ds_read_u16 v10, v10
v_mad_u32_u16 v14, v14, 2, s85 op_sel:[1,0,0,0]
v_mad_u32_u16 v15, v15, 2, s85 op_sel:[1,0,0,0]
v_mad_u32_u16 v16, v16, 2, s85 op_sel:[1,0,0,0]
v_mad_u32_u16 v17, v17, 2, s85 op_sel:[1,0,0,0]
v_mfma_f32_32x32x16_f16 v[142:157], a[224:227], v[224:227], v[142:157]
ds_read_b128 a[224:227], v2 offset:58112
v_mad_u32_u16 v18, v18, 2, s85 op_sel:[1,0,0,0]
v_pk_add_f16 v244, v248, 1.0 op_sel_hi:[1,0]
v_mad_u32_u16 v19, v19, 2, s85 op_sel:[1,0,0,0]
v_mad_u32_u16 v20, v20, 2, s85 op_sel:[1,0,0,0]
v_pk_add_f16 v245, v249, 1.0 op_sel_hi:[1,0]
v_mfma_f32_32x32x16_bf16 v[24:39], a[200:203], a[56:59], v[24:39]
ds_read_u16_d16_hi v11, v11
ds_read_u16 v12, v12
v_mad_u32_u16 v21, v21, 2, s85 op_sel:[1,0,0,0]
v_pk_add_f16 v246, v250, 1.0 op_sel_hi:[1,0]
v_mad_u32_u16 v22, v22, 2, s85 op_sel:[1,0,0,0]
v_mad_u32_u16 v23, v23, 2, s85 op_sel:[1,0,0,0]
v_mfma_f32_32x32x16_f16 v[110:125], a[228:231], v[228:231], v[110:125]
ds_read_b128 a[228:231], v2 offset:59136
v_pk_add_f16 v247, v251, 1.0 op_sel_hi:[1,0]
s_waitcnt lgkmcnt(8)
v_or_b32 v236, v56, v57
v_or_b32 v237, v58, v59
v_or_b32 v238, v60, v61
v_mfma_f32_32x32x16_bf16 v[24:39], a[204:207], a[60:63], v[24:39]
ds_read_u16_d16_hi v13, v13
ds_read_u16 v14, v14
ds_read_u16_d16_hi v15, v15
buffer_load_dwordx4 a[108:111], v1, s[12:15], s101 offen offset:1024
v_mfma_f32_32x32x16_f16 v[126:141], a[232:235], v[228:231], v[126:141]
v_or_b32 v239, v7, v0
v_rcp_f16 v248, v244
v_rcp_f16 v249, v245
v_rcp_f16 v250, v246
v_mfma_f32_32x32x16_bf16 v[24:39], a[208:211], a[64:67], v[24:39]
ds_read_b128 a[232:235], v2 offset:60160
ds_read_u16 v16, v16
v_rcp_f16_sdwa v248, v244 dst_sel:WORD_1 dst_unused:UNUSED_PRESERVE src0_sel:WORD_1
v_rcp_f16 v251, v247
v_mfma_f32_32x32x16_f16 v[142:157], a[236:239], v[228:231], v[142:157]
ds_read_b128 a[236:239], v2 offset:61184
s_waitcnt lgkmcnt(9)
v_or_b32 v40, v8, v9
v_pk_mul_f16 v232, v232, v248
v_rcp_f16_sdwa v249, v245 dst_sel:WORD_1 dst_unused:UNUSED_PRESERVE src0_sel:WORD_1
v_mfma_f32_32x32x16_bf16 v[24:39], a[212:215], a[68:71], v[24:39]
ds_read_u16_d16_hi v17, v17
ds_read_u16 v18, v18
v_pk_mul_f16 v233, v233, v249
v_rcp_f16_sdwa v250, v246 dst_sel:WORD_1 dst_unused:UNUSED_PRESERVE src0_sel:WORD_1
v_rcp_f16_sdwa v251, v247 dst_sel:WORD_1 dst_unused:UNUSED_PRESERVE src0_sel:WORD_1
s_waitcnt vmcnt(10)
v_smfmac_f32_32x32x32_bf16 v[126:141], a[250:253], a[176:183], v4
ds_read_u16_d16_hi v19, v19
s_waitcnt lgkmcnt(9)
v_or_b32 v41, v10, v11
v_pk_mul_f16 v234, v234, v250
v_pk_mul_f16 v235, v235, v251
v_mfma_f32_32x32x16_bf16 v[208:223], a[192:195], a[72:75], 0
ds_read_b128 a[192:195], v1 offset:61440
ds_read_u16 v20, v20
buffer_store_dwordx4 v[188:191], v6, s[8:11], s81 offen offset:3072 sc1 nt
ds_read_u16_d16_hi v21, v21
v_mfma_f32_32x32x16_f16 v[62:77], a[216:219], v[48:51], v[62:77]
ds_read_u16 v22, v22
s_waitcnt lgkmcnt(10)
v_or_b32 v42, v12, v13
v_mad_u32_u16 v24, v24, 2, s85 op_sel:[1,0,0,0]
v_mad_u32_u16 v25, v25, 2, s85 op_sel:[1,0,0,0]
v_mad_u32_u16 v26, v26, 2, s85 op_sel:[1,0,0,0]
v_mfma_f32_32x32x16_bf16 v[208:223], a[196:199], a[76:79], v[208:223]
ds_read_b128 a[196:199], v1 offset:62464
v_mad_u32_u16 v27, v27, 2, s85 op_sel:[1,0,0,0]
v_mad_u32_u16 v28, v28, 2, s85 op_sel:[1,0,0,0]
v_or_b32 v43, v14, v15
v_mad_u32_u16 v29, v29, 2, s85 op_sel:[1,0,0,0]
v_mad_u32_u16 v30, v30, 2, s85 op_sel:[1,0,0,0]
v_mfma_f32_32x32x16_f16 v[78:93], a[220:223], v[48:51], v[78:93]
ds_read_u16_d16_hi v23, v23
ds_read_u16 v24, v24
v_mad_u32_u16 v31, v31, 2, s85 op_sel:[1,0,0,0]
v_mad_u32_u16 v32, v32, 2, s85 op_sel:[1,0,0,0]
v_mad_u32_u16 v33, v33, 2, s85 op_sel:[1,0,0,0]
v_mad_u32_u16 v34, v34, 2, s85 op_sel:[1,0,0,0]
v_mfma_f32_32x32x16_bf16 v[208:223], a[200:203], a[80:83], v[208:223]
ds_read_b128 a[200:203], v1 offset:63488
v_mad_u32_u16 v35, v35, 2, s85 op_sel:[1,0,0,0]
v_mad_u32_u16 v36, v36, 2, s85 op_sel:[1,0,0,0]
v_mad_u32_u16 v37, v37, 2, s85 op_sel:[1,0,0,0]
v_mad_u32_u16 v38, v38, 2, s85 op_sel:[1,0,0,0]
v_mad_u32_u16 v39, v39, 2, s85 op_sel:[1,0,0,0]
v_mfma_f32_32x32x16_f16 v[94:109], a[224:227], v[48:51], v[94:109]
ds_read_u16_d16_hi v25, v25
ds_read_u16 v26, v26
buffer_load_dwordx4 a[176:179], v5, s[4:7], s79 offen offset:128
s_waitcnt lgkmcnt(9)
v_or_b32 v44, v16, v17
v_mfma_f32_32x32x16_bf16 v[208:223], a[204:207], a[84:87], v[208:223]
ds_read_b128 a[204:207], v1 offset:64512
buffer_load_dwordx4 a[180:183], v5, s[4:7], s79 offen offset:144
v_or_b32 v45, v18, v19
ds_read_u16_d16_hi v27, v27
v_mfma_f32_32x32x16_f16 v[62:77], a[228:231], v[52:55], v[62:77]
ds_read_u16 v28, v28
ds_read_u16_d16_hi v29, v29
ds_read_u16 v30, v30
ds_read_u16_d16_hi v31, v31
ds_read_u16 v32, v32
v_mfma_f32_32x32x16_bf16 v[208:223], a[208:211], a[88:91], v[208:223]
s_waitcnt lgkmcnt(12)
v_or_b32 v46, v20, v21
ds_read_u16_d16_hi v33, v33
v_mfma_f32_32x32x16_f16 v[78:93], a[232:235], v[52:55], v[78:93]
ds_read_u16 v34, v34
ds_read_u16_d16_hi v35, v35
v_mfma_f32_32x32x16_bf16 v[208:223], a[212:215], a[92:95], v[208:223]
s_waitcnt lgkmcnt(12)
v_or_b32 v47, v22, v23
v_mfma_f32_32x32x16_f16 v[94:109], a[236:239], v[52:55], v[94:109]
ds_read_u16 v36, v36
ds_read_u16_d16_hi v37, v37
s_nop 1
v_mfma_f32_32x32x16_f16 v[110:125], a[216:219], v[232:235], v[110:125]
ds_read_b128 a[216:219], v2 offset:62208
s_nop 2
v_mul_f32 v56, s60, v216
s_waitcnt lgkmcnt(12)
v_or_b32 v48, v24, v25
v_mfma_f32_32x32x16_f16 v[126:141], a[220:223], v[232:235], v[126:141]
v_mul_f32 v57, s60, v217
v_mul_f32 v58, s60, v218
v_mul_f32 v59, s60, v219
v_mul_f32 v60, s60, v220
v_mul_f32 v61, s60, v221
v_mul_f32 v7, s60, v222
v_mfma_f32_32x32x16_bf16 v[8:23], a[192:195], a[48:51], 0
buffer_store_dwordx4 v[192:195], v6, s[8:11], s81 offen offset:64 sc1 nt
ds_read_b128 a[208:211], v2 offset:0
v_mfma_f32_32x32x16_f16 v[142:157], a[224:227], v[232:235], v[142:157]
s_waitcnt lgkmcnt(10)
v_or_b32 v49, v26, v27
v_mul_f32 v0, s60, v223
v_mad_u32_u16 v56, v56, 2, s85 op_sel:[1,0,0,0]
v_mad_u32_u16 v57, v57, 2, s85 op_sel:[1,0,0,0]
v_mad_u32_u16 v58, v58, 2, s85 op_sel:[1,0,0,0]
v_mfma_f32_32x32x16_bf16 v[8:23], a[196:199], a[52:55], v[8:23]
ds_read_b128 a[212:215], v2 offset:1024
ds_read_b128 a[220:223], v2 offset:63232
v_or_b32 v50, v28, v29
v_mad_u32_u16 v59, v59, 2, s85 op_sel:[1,0,0,0]
v_mad_u32_u16 v60, v60, 2, s85 op_sel:[1,0,0,0]
v_mad_u32_u16 v61, v61, 2, s85 op_sel:[1,0,0,0]
v_mfma_f32_32x32x16_f16 v[110:125], a[228:231], v[236:239], v[110:125]
ds_read_b128 a[224:227], v2 offset:64256
v_mad_u32_u16 v7, v7, 2, s85 op_sel:[1,0,0,0]
v_mad_u32_u16 v0, v0, 2, s85 op_sel:[1,0,0,0]
v_cvt_pk_f16_f32 v224, v208, v209
v_cvt_pk_f16_f32 v225, v210, v211
v_pk_fma_f16 v240, v224, v224, s84
v_mfma_f32_32x32x16_bf16 v[8:23], a[200:203], a[56:59], v[8:23]
ds_read_b128 a[228:231], v2 offset:65280
s_waitcnt lgkmcnt(10)
v_or_b32 v51, v30, v31
v_cvt_pk_f16_f32 v226, v212, v213
v_pk_fma_f16 v241, v225, v225, s84
v_pk_mul_f16 v240, v224, v240
v_mfma_f32_32x32x16_f16 v[126:141], a[232:235], v[236:239], v[126:141]
ds_read_b128 a[232:235], v3 offset:768
v_cvt_pk_f16_f32 v227, v214, v215
v_or_b32 v52, v32, v33
v_pk_fma_f16 v242, v226, v226, s84
v_exp_f16 v248, v240
v_mfma_f32_32x32x16_bf16 v[8:23], a[204:207], a[60:63], v[8:23]
ds_read_u16 v38, v38
v_pk_mul_f16 v241, v225, v241
v_pk_fma_f16 v243, v227, v227, s84
v_pk_mul_f16 v242, v226, v242
v_pk_mul_f16 v243, v227, v243
v_exp_f16 v249, v241
v_mfma_f32_32x32x16_f16 v[142:157], a[236:239], v[236:239], v[142:157]
ds_read_b128 a[236:239], v3 offset:1792
ds_read_u16_d16_hi v39, v39
s_waitcnt lgkmcnt(9)
v_or_b32 v53, v34, v35
v_exp_f16 v250, v242
v_exp_f16_sdwa v248, v240 dst_sel:WORD_1 dst_unused:UNUSED_PRESERVE src0_sel:WORD_1
v_exp_f16 v251, v243
v_exp_f16_sdwa v249, v241 dst_sel:WORD_1 dst_unused:UNUSED_PRESERVE src0_sel:WORD_1
v_or_b32 v54, v36, v37
v_exp_f16_sdwa v250, v242 dst_sel:WORD_1 dst_unused:UNUSED_PRESERVE src0_sel:WORD_1
v_exp_f16_sdwa v251, v243 dst_sel:WORD_1 dst_unused:UNUSED_PRESERVE src0_sel:WORD_1
v_mfma_f32_32x32x16_f16 v[62:77], a[216:219], v[40:43], v[62:77]
ds_read_u16 v56, v56
ds_read_u16_d16_hi v57, v57
ds_read_u16 v58, v58
ds_read_u16_d16_hi v59, v59
ds_read_u16 v60, v60
ds_read_u16_d16_hi v61, v61
s_waitcnt lgkmcnt(10)
v_mfma_f32_32x32x16_bf16 v[8:23], a[208:211], a[64:67], v[8:23]
ds_read_u16 v7, v7
ds_read_u16_d16_hi v0, v0
v_mfma_f32_32x32x16_f16 v[78:93], a[220:223], v[40:43], v[78:93]
v_mfma_f32_32x32x16_f16 v[94:109], a[224:227], v[40:43], v[94:109]
v_mfma_f32_32x32x16_f16 v[62:77], a[228:231], v[44:47], v[62:77]
s_waitcnt lgkmcnt(6)
v_or_b32 v55, v38, v39
v_mfma_f32_32x32x16_f16 v[78:93], a[232:235], v[44:47], v[78:93]
v_mfma_f32_32x32x16_f16 v[94:109], a[236:239], v[44:47], v[94:109]
v_mfma_f32_32x32x16_bf16 v[8:23], a[212:215], a[68:71], v[8:23]
s_nop 5
v_mfma_f32_32x32x16_bf16 v[208:223], a[192:195], a[72:75], 0
ds_read_b128 a[192:195], v2 offset:2048
s_nop 3
v_mad_u32_u16 v8, v8, 2, s85 op_sel:[1,0,0,0]
v_mfma_f32_32x32x16_f16 v[110:125], a[216:219], a[152:155], v[110:125]
ds_read_b128 a[216:219], v3 offset:2816
ds_read_u16 v8, v8
v_mad_u32_u16 v9, v9, 2, s85 op_sel:[1,0,0,0]
v_mad_u32_u16 v10, v10, 2, s85 op_sel:[1,0,0,0]
v_mad_u32_u16 v11, v11, 2, s85 op_sel:[1,0,0,0]
v_mad_u32_u16 v12, v12, 2, s85 op_sel:[1,0,0,0]
v_mfma_f32_32x32x16_bf16 v[208:223], a[196:199], a[76:79], v[208:223]
ds_read_b128 a[196:199], v2 offset:3072
ds_read_u16_d16_hi v9, v9
ds_read_u16 v10, v10
ds_read_u16_d16_hi v11, v11
v_mad_u32_u16 v13, v13, 2, s85 op_sel:[1,0,0,0]
v_mad_u32_u16 v14, v14, 2, s85 op_sel:[1,0,0,0]
v_mfma_f32_32x32x16_f16 v[126:141], a[220:223], a[152:155], v[126:141]
ds_read_b128 a[220:223], v3 offset:3840
ds_read_u16 v12, v12
ds_read_u16_d16_hi v13, v13
ds_read_u16 v14, v14
v_mad_u32_u16 v15, v15, 2, s85 op_sel:[1,0,0,0]
v_mad_u32_u16 v16, v16, 2, s85 op_sel:[1,0,0,0]
v_mfma_f32_32x32x16_bf16 v[208:223], a[200:203], a[80:83], v[208:223]
ds_read_b128 a[200:203], v2 offset:4096
ds_read_u16_d16_hi v15, v15
buffer_store_dwordx4 v[196:199], v6, s[8:11], s81 offen offset:3136 sc1 nt
ds_read_u16 v16, v16
v_mfma_f32_32x32x16_f16 v[142:157], a[224:227], a[152:155], v[142:157]
v_mad_u32_u16 v17, v17, 2, s85 op_sel:[1,0,0,0]
v_mad_u32_u16 v18, v18, 2, s85 op_sel:[1,0,0,0]
v_pk_add_f16 v240, v248, 1.0 op_sel_hi:[1,0]
v_mad_u32_u16 v19, v19, 2, s85 op_sel:[1,0,0,0]
v_mad_u32_u16 v20, v20, 2, s85 op_sel:[1,0,0,0]
v_pk_add_f16 v241, v249, 1.0 op_sel_hi:[1,0]
v_mfma_f32_32x32x16_bf16 v[208:223], a[204:207], a[84:87], v[208:223]
ds_read_b128 a[204:207], v2 offset:5120
ds_read_b128 a[224:227], v3 offset:4864
v_mad_u32_u16 v21, v21, 2, s85 op_sel:[1,0,0,0]
s_waitcnt lgkmcnt(9)
v_or_b32 v40, v8, v9
v_pk_add_f16 v242, v250, 1.0 op_sel_hi:[1,0]
v_mfma_f32_32x32x16_f16 v[110:125], a[228:231], a[156:159], v[110:125]
ds_read_b128 a[228:231], v3 offset:5888
v_mad_u32_u16 v22, v22, 2, s85 op_sel:[1,0,0,0]
v_mad_u32_u16 v23, v23, 2, s85 op_sel:[1,0,0,0]
v_pk_add_f16 v243, v251, 1.0 op_sel_hi:[1,0]
v_or_b32 v228, v56, v57
v_or_b32 v229, v58, v59
v_mfma_f32_32x32x16_bf16 v[208:223], a[208:211], a[88:91], v[208:223]
ds_read_b128 a[208:211], v3 offset:26368
v_or_b32 v41, v10, v11
v_or_b32 v230, v60, v61
v_or_b32 v231, v7, v0
v_rcp_f16 v248, v240
v_mfma_f32_32x32x16_f16 v[126:141], a[232:235], a[156:159], v[126:141]
ds_read_b128 a[232:235], v3 offset:6912
ds_read_u16_d16_hi v17, v17
v_rcp_f16 v249, v241
v_rcp_f16 v250, v242
v_mfma_f32_32x32x16_bf16 v[208:223], a[212:215], a[92:95], v[208:223]
ds_read_b128 a[212:215], v3 offset:27392
v_rcp_f16_sdwa v248, v240 dst_sel:WORD_1 dst_unused:UNUSED_PRESERVE src0_sel:WORD_1
s_waitcnt lgkmcnt(9)
v_or_b32 v42, v12, v13
v_rcp_f16 v251, v243
v_mfma_f32_32x32x16_f16 v[142:157], a[236:239], a[156:159], v[142:157]
ds_read_b128 a[236:239], v3 offset:7936
ds_read_u16 v18, v18
v_rcp_f16_sdwa v249, v241 dst_sel:WORD_1 dst_unused:UNUSED_PRESERVE src0_sel:WORD_1
v_rcp_f16_sdwa v250, v242 dst_sel:WORD_1 dst_unused:UNUSED_PRESERVE src0_sel:WORD_1
v_mfma_f32_32x32x16_bf16 v[24:39], a[192:195], a[48:51], 0
ds_read_b128 a[192:195], v1 offset:0
v_mul_f32 v56, s60, v216
v_mul_f32 v57, s60, v217
s_waitcnt lgkmcnt(8)
v_or_b32 v43, v14, v15
v_mul_f32 v58, s60, v218
v_mfma_f32_32x32x16_f16 v[62:77], a[216:219], v[48:51], v[62:77]
ds_read_u16_d16_hi v19, v19
v_mul_f32 v59, s60, v219
v_mul_f32 v60, s60, v220
v_mul_f32 v61, s60, v221
v_mul_f32 v7, s60, v222
v_mul_f32 v0, s60, v223
v_mfma_f32_32x32x16_bf16 v[24:39], a[196:199], a[52:55], v[24:39]
ds_read_b128 a[196:199], v1 offset:1024
ds_read_u16 v20, v20
v_mad_u32_u16 v56, v56, 2, s85 op_sel:[1,0,0,0]
v_mad_u32_u16 v57, v57, 2, s85 op_sel:[1,0,0,0]
v_mad_u32_u16 v58, v58, 2, s85 op_sel:[1,0,0,0]
v_rcp_f16_sdwa v251, v243 dst_sel:WORD_1 dst_unused:UNUSED_PRESERVE src0_sel:WORD_1
v_mfma_f32_32x32x16_f16 v[78:93], a[220:223], v[48:51], v[78:93]
ds_read_u16_d16_hi v21, v21
ds_read_u16 v22, v22
ds_read_u16_d16_hi v23, v23
v_mad_u32_u16 v59, v59, 2, s85 op_sel:[1,0,0,0]
v_mad_u32_u16 v60, v60, 2, s85 op_sel:[1,0,0,0]
v_pk_mul_f16 v224, v224, v248
v_mfma_f32_32x32x16_bf16 v[24:39], a[200:203], a[56:59], v[24:39]
ds_read_b128 a[200:203], v1 offset:2048
v_mad_u32_u16 v61, v61, 2, s85 op_sel:[1,0,0,0]
v_mad_u32_u16 v7, v7, 2, s85 op_sel:[1,0,0,0]
s_waitcnt lgkmcnt(8)
v_or_b32 v44, v16, v17
v_mad_u32_u16 v0, v0, 2, s85 op_sel:[1,0,0,0]
v_mfma_f32_32x32x16_f16 v[94:109], a[224:227], v[48:51], v[94:109]
ds_read_u16 v56, v56
ds_read_u16_d16_hi v57, v57
v_cvt_pk_f16_f32 v232, v208, v209
v_cvt_pk_f16_f32 v233, v210, v211
v_pk_mul_f16 v225, v225, v249
v_pk_fma_f16 v244, v232, v232, s84
v_mfma_f32_32x32x16_bf16 v[24:39], a[204:207], a[60:63], v[24:39]
ds_read_b128 a[204:207], v1 offset:3072
v_cvt_pk_f16_f32 v234, v212, v213
v_pk_fma_f16 v245, v233, v233, s84
v_pk_mul_f16 v244, v232, v244
v_cvt_pk_f16_f32 v235, v214, v215
v_pk_mul_f16 v226, v226, v250
v_mfma_f32_32x32x16_f16 v[62:77], a[228:231], v[52:55], v[62:77]
ds_read_u16 v58, v58
ds_read_u16_d16_hi v59, v59
v_pk_fma_f16 v246, v234, v234, s84
v_exp_f16 v248, v244
s_waitcnt lgkmcnt(9)
v_or_b32 v45, v18, v19
v_mfma_f32_32x32x16_bf16 v[24:39], a[208:211], a[64:67], v[24:39]
ds_read_b128 a[208:211], v1 offset:4096
ds_read_u16 v60, v60
v_pk_mul_f16 v245, v233, v245
v_pk_fma_f16 v247, v235, v235, s84
v_pk_mul_f16 v246, v234, v246
v_pk_mul_f16 v247, v235, v247
v_mfma_f32_32x32x16_f16 v[78:93], a[232:235], v[52:55], v[78:93]
ds_read_u16_d16_hi v61, v61
v_pk_mul_f16 v227, v227, v251
v_exp_f16 v249, v245
s_waitcnt lgkmcnt(9)
v_or_b32 v46, v20, v21
v_mfma_f32_32x32x16_bf16 v[24:39], a[212:215], a[68:71], v[24:39]
ds_read_b128 a[212:215], v1 offset:5120
v_exp_f16 v250, v246
v_exp_f16_sdwa v248, v244 dst_sel:WORD_1 dst_unused:UNUSED_PRESERVE src0_sel:WORD_1
v_exp_f16 v251, v247
v_mfma_f32_32x32x16_f16 v[94:109], a[236:239], v[52:55], v[94:109]
ds_read_u16 v7, v7
ds_read_u16_d16_hi v0, v0
v_or_b32 v47, v22, v23
v_exp_f16_sdwa v249, v245 dst_sel:WORD_1 dst_unused:UNUSED_PRESERVE src0_sel:WORD_1
v_exp_f16_sdwa v250, v246 dst_sel:WORD_1 dst_unused:UNUSED_PRESERVE src0_sel:WORD_1
v_mfma_f32_32x32x16_bf16 v[8:23], a[192:195], a[0:3], 0
v_exp_f16_sdwa v251, v247 dst_sel:WORD_1 dst_unused:UNUSED_PRESERVE src0_sel:WORD_1
v_mad_u32_u16 v24, v24, 2, s85 op_sel:[1,0,0,0]
v_mad_u32_u16 v25, v25, 2, s85 op_sel:[1,0,0,0]
v_mad_u32_u16 v26, v26, 2, s85 op_sel:[1,0,0,0]
v_mad_u32_u16 v27, v27, 2, s85 op_sel:[1,0,0,0]
s_waitcnt vmcnt(8)
v_smfmac_f32_32x32x32_bf16 v[94:109], a[250:253], a[168:175], v4
ds_read_u16 v24, v24
v_mad_u32_u16 v28, v28, 2, s85 op_sel:[1,0,0,0]
v_mad_u32_u16 v29, v29, 2, s85 op_sel:[1,0,0,0]
v_mad_u32_u16 v30, v30, 2, s85 op_sel:[1,0,0,0]
v_mad_u32_u16 v31, v31, 2, s85 op_sel:[1,0,0,0]
v_mfma_f32_32x32x16_bf16 v[8:23], a[196:199], a[4:7], v[8:23]
ds_read_u16_d16_hi v25, v25
ds_read_u16 v26, v26
ds_read_u16_d16_hi v27, v27
ds_read_u16 v28, v28
v_mad_u32_u16 v32, v32, 2, s85 op_sel:[1,0,0,0]
v_mad_u32_u16 v33, v33, 2, s85 op_sel:[1,0,0,0]
v_mfma_f32_32x32x16_f16 v[110:125], a[216:219], v[224:227], v[110:125]
buffer_load_dwordx4 a[168:171], v5, s[4:7], s76 offen offset:0
ds_read_b128 a[216:219], v3 offset:8960
v_mad_u32_u16 v34, v34, 2, s85 op_sel:[1,0,0,0]
v_pk_add_f16 v244, v248, 1.0 op_sel_hi:[1,0]
s_waitcnt lgkmcnt(9)
v_mfma_f32_32x32x16_bf16 v[8:23], a[200:203], a[8:11], v[8:23]
ds_read_u16_d16_hi v29, v29
v_mad_u32_u16 v35, v35, 2, s85 op_sel:[1,0,0,0]
v_mad_u32_u16 v36, v36, 2, s85 op_sel:[1,0,0,0]
v_pk_add_f16 v245, v249, 1.0 op_sel_hi:[1,0]
v_rcp_f16 v248, v244
v_mfma_f32_32x32x16_f16 v[126:141], a[220:223], v[224:227], v[126:141]
ds_read_b128 a[220:223], v3 offset:9984
ds_read_u16 v30, v30
v_mad_u32_u16 v37, v37, 2, s85 op_sel:[1,0,0,0]
v_pk_add_f16 v246, v250, 1.0 op_sel_hi:[1,0]
v_mad_u32_u16 v38, v38, 2, s85 op_sel:[1,0,0,0]
v_mad_u32_u16 v39, v39, 2, s85 op_sel:[1,0,0,0]
v_mfma_f32_32x32x16_bf16 v[8:23], a[204:207], a[12:15], v[8:23]
ds_read_u16_d16_hi v31, v31
v_pk_add_f16 v247, v251, 1.0 op_sel_hi:[1,0]
v_or_b32 v236, v56, v57
v_or_b32 v237, v58, v59
v_or_b32 v238, v60, v61
v_rcp_f16 v249, v245
v_mfma_f32_32x32x16_f16 v[142:157], a[224:227], v[224:227], v[142:157]
ds_read_b128 a[224:227], v3 offset:11008
s_waitcnt lgkmcnt(9)
v_or_b32 v239, v7, v0
v_rcp_f16 v250, v246
v_rcp_f16_sdwa v248, v244 dst_sel:WORD_1 dst_unused:UNUSED_PRESERVE src0_sel:WORD_1
v_mfma_f32_32x32x16_bf16 v[8:23], a[208:211], a[16:19], v[8:23]
ds_read_u16 v32, v32
ds_read_u16_d16_hi v33, v33
s_add_u32 s101, s3, 10240
buffer_load_dwordx4 a[112:115], v1, s[12:15], s101 offen offset:0
ds_read_u16 v34, v34
v_mfma_f32_32x32x16_f16 v[110:125], a[228:231], v[228:231], v[110:125]
v_or_b32 v48, v24, v25
v_pk_mul_f16 v232, v232, v248
v_rcp_f16 v251, v247
v_rcp_f16_sdwa v249, v245 dst_sel:WORD_1 dst_unused:UNUSED_PRESERVE src0_sel:WORD_1
v_mfma_f32_32x32x16_bf16 v[8:23], a[212:215], a[20:23], v[8:23]
ds_read_b128 a[228:231], v3 offset:12032
v_pk_mul_f16 v233, v233, v249
s_waitcnt lgkmcnt(9)
v_or_b32 v49, v26, v27
v_rcp_f16_sdwa v250, v246 dst_sel:WORD_1 dst_unused:UNUSED_PRESERVE src0_sel:WORD_1
v_mfma_f32_32x32x16_f16 v[126:141], a[232:235], v[228:231], v[126:141]
ds_read_b128 a[232:235], v3 offset:13056
v_pk_mul_f16 v234, v234, v250
v_rcp_f16_sdwa v251, v247 dst_sel:WORD_1 dst_unused:UNUSED_PRESERVE src0_sel:WORD_1
ds_read_u16_d16_hi v35, v35
v_mfma_f32_32x32x16_bf16 v[208:223], a[192:195], a[24:27], 0
ds_read_b128 a[192:195], v1 offset:6144
v_pk_mul_f16 v235, v235, v251
s_waitcnt lgkmcnt(9)
v_or_b32 v50, v28, v29
v_mad_u32_u16 v8, v8, 2, s85 op_sel:[1,0,0,0]
v_mad_u32_u16 v9, v9, 2, s85 op_sel:[1,0,0,0]
v_mfma_f32_32x32x16_f16 v[142:157], a[236:239], v[228:231], v[142:157]
ds_read_b128 a[236:239], v3 offset:14080
ds_read_u16 v36, v36
buffer_load_dwordx4 a[116:119], v1, s[12:15], s101 offen offset:1024
v_mad_u32_u16 v10, v10, 2, s85 op_sel:[1,0,0,0]
v_mfma_f32_32x32x16_bf16 v[208:223], a[196:199], a[28:31], v[208:223]
ds_read_b128 a[196:199], v1 offset:7168
v_mad_u32_u16 v11, v11, 2, s85 op_sel:[1,0,0,0]
v_mad_u32_u16 v12, v12, 2, s85 op_sel:[1,0,0,0]
v_mad_u32_u16 v13, v13, 2, s85 op_sel:[1,0,0,0]
s_waitcnt lgkmcnt(9)
v_or_b32 v51, v30, v31
v_mfma_f32_32x32x16_f16 v[62:77], a[216:219], v[40:43], v[62:77]
ds_read_u16_d16_hi v37, v37
ds_read_u16 v38, v38
v_mad_u32_u16 v14, v14, 2, s85 op_sel:[1,0,0,0]
v_mad_u32_u16 v15, v15, 2, s85 op_sel:[1,0,0,0]
v_mad_u32_u16 v16, v16, 2, s85 op_sel:[1,0,0,0]
v_mad_u32_u16 v17, v17, 2, s85 op_sel:[1,0,0,0]
v_mfma_f32_32x32x16_bf16 v[208:223], a[200:203], a[32:35], v[208:223]
ds_read_b128 a[200:203], v1 offset:8192
v_mad_u32_u16 v18, v18, 2, s85 op_sel:[1,0,0,0]
v_mad_u32_u16 v19, v19, 2, s85 op_sel:[1,0,0,0]
v_mad_u32_u16 v20, v20, 2, s85 op_sel:[1,0,0,0]
s_waitcnt lgkmcnt(8)
v_or_b32 v52, v32, v33
v_mfma_f32_32x32x16_f16 v[78:93], a[220:223], v[40:43], v[78:93]
ds_read_u16_d16_hi v39, v39
v_mad_u32_u16 v21, v21, 2, s85 op_sel:[1,0,0,0]
v_mad_u32_u16 v22, v22, 2, s85 op_sel:[1,0,0,0]
v_mad_u32_u16 v23, v23, 2, s85 op_sel:[1,0,0,0]
ds_read_u16 v8, v8
v_mfma_f32_32x32x16_bf16 v[208:223], a[204:207], a[36:39], v[208:223]
ds_read_b128 a[204:207], v1 offset:9216
buffer_store_dwordx4 v[200:203], v6, s[8:11], s81 offen offset:128 sc1 nt
ds_read_u16_d16_hi v9, v9
v_mfma_f32_32x32x16_f16 v[94:109], a[224:227], v[40:43], v[94:109]
ds_read_u16 v10, v10
s_waitcnt lgkmcnt(9)
v_or_b32 v53, v34, v35
buffer_load_dwordx4 a[172:175], v5, s[4:7], s76 offen offset:16
v_mfma_f32_32x32x16_bf16 v[208:223], a[208:211], a[40:43], v[208:223]
ds_read_b128 a[208:211], v1 offset:10240
ds_read_u16_d16_hi v11, v11
ds_read_u16 v12, v12
ds_read_u16_d16_hi v13, v13
ds_read_u16 v14, v14
ds_read_u16_d16_hi v15, v15
v_mfma_f32_32x32x16_f16 v[62:77], a[228:231], v[44:47], v[62:77]
ds_read_u16 v16, v16
v_mfma_f32_32x32x16_f16 v[78:93], a[232:235], v[44:47], v[78:93]
s_waitcnt lgkmcnt(12)
v_or_b32 v54, v36, v37
ds_read_u16_d16_hi v17, v17
ds_read_u16 v18, v18
v_mfma_f32_32x32x16_bf16 v[208:223], a[212:215], a[44:47], v[208:223]
ds_read_u16_d16_hi v19, v19
s_nop 3
v_mfma_f32_32x32x16_f16 v[94:109], a[236:239], v[44:47], v[94:109]
s_waitcnt lgkmcnt(12)
v_or_b32 v55, v38, v39
ds_read_u16 v20, v20
v_mfma_f32_32x32x16_f16 v[110:125], a[216:219], v[232:235], v[110:125]
ds_read_b128 a[216:219], v3 offset:15104
s_nop 0
v_mul_f32 v56, s60, v216
v_mul_f32 v57, s60, v217
v_mul_f32 v58, s60, v218
v_mul_f32 v59, s60, v219
v_mfma_f32_32x32x16_bf16 v[24:39], a[192:195], a[0:3], 0
global_load_dword a255, v[158:159], off
s_waitcnt lgkmcnt(11)
v_or_b32 v40, v8, v9
v_mul_f32 v60, s60, v220
v_mfma_f32_32x32x16_f16 v[126:141], a[220:223], v[232:235], v[126:141]
buffer_store_dwordx4 v[204:207], v6, s[8:11], s81 offen offset:3200 sc1 nt
ds_read_b128 a[212:215], v1 offset:11264
v_mfma_f32_32x32x16_bf16 v[24:39], a[196:199], a[4:7], v[24:39]
v_mul_f32 v61, s60, v221
s_waitcnt lgkmcnt(9)
v_or_b32 v41, v10, v11
v_mul_f32 v7, s60, v222
v_mul_f32 v0, s60, v223
v_mad_u32_u16 v56, v56, 2, s85 op_sel:[1,0,0,0]
v_mfma_f32_32x32x16_f16 v[142:157], a[224:227], v[232:235], v[142:157]
ds_read_b128 a[220:223], v3 offset:16128
ds_read_b128 a[224:227], v3 offset:17152
v_mad_u32_u16 v57, v57, 2, s85 op_sel:[1,0,0,0]
v_mad_u32_u16 v58, v58, 2, s85 op_sel:[1,0,0,0]
v_mad_u32_u16 v59, v59, 2, s85 op_sel:[1,0,0,0]
v_mfma_f32_32x32x16_bf16 v[24:39], a[200:203], a[8:11], v[24:39]
ds_read_u16_d16_hi v21, v21
v_or_b32 v42, v12, v13
v_mad_u32_u16 v60, v60, 2, s85 op_sel:[1,0,0,0]
v_mad_u32_u16 v61, v61, 2, s85 op_sel:[1,0,0,0]
v_mad_u32_u16 v7, v7, 2, s85 op_sel:[1,0,0,0]
v_mad_u32_u16 v0, v0, 2, s85 op_sel:[1,0,0,0]
v_mfma_f32_32x32x16_f16 v[110:125], a[228:231], v[236:239], v[110:125]
ds_read_b128 a[228:231], v3 offset:18176
v_cvt_pk_f16_f32 v224, v208, v209
v_cvt_pk_f16_f32 v225, v210, v211
v_pk_fma_f16 v240, v224, v224, s84
s_waitcnt lgkmcnt(9)
v_or_b32 v43, v14, v15
v_mfma_f32_32x32x16_bf16 v[24:39], a[204:207], a[12:15], v[24:39]
ds_read_u16 v22, v22
v_cvt_pk_f16_f32 v226, v212, v213
v_pk_fma_f16 v241, v225, v225, s84
v_pk_mul_f16 v240, v224, v240
v_cvt_pk_f16_f32 v227, v214, v215
v_exp_f16 v248, v240
v_mfma_f32_32x32x16_f16 v[126:141], a[232:235], v[236:239], v[126:141]
ds_read_b128 a[232:235], v3 offset:19200
ds_read_u16_d16_hi v23, v23
v_or_b32 v44, v16, v17
v_pk_fma_f16 v242, v226, v226, s84
v_pk_mul_f16 v241, v225, v241
v_pk_fma_f16 v243, v227, v227, s84
v_mfma_f32_32x32x16_bf16 v[24:39], a[208:211], a[16:19], v[24:39]
ds_read_u16 v56, v56
v_pk_mul_f16 v242, v226, v242
v_pk_mul_f16 v243, v227, v243
v_exp_f16 v249, v241
s_waitcnt lgkmcnt(8)
v_or_b32 v45, v18, v19
v_mfma_f32_32x32x16_f16 v[142:157], a[236:239], v[236:239], v[142:157]
ds_read_b128 a[236:239], v3 offset:20224
v_exp_f16 v250, v242
v_exp_f16_sdwa v248, v240 dst_sel:WORD_1 dst_unused:UNUSED_PRESERVE src0_sel:WORD_1
v_exp_f16 v251, v243
s_waitcnt vmcnt(9)
v_smfmac_f32_32x32x32_bf16 v[142:157], a[250:253], a[176:183], v4
ds_read_u16_d16_hi v57, v57
v_exp_f16_sdwa v249, v241 dst_sel:WORD_1 dst_unused:UNUSED_PRESERVE src0_sel:WORD_1
v_exp_f16_sdwa v250, v242 dst_sel:WORD_1 dst_unused:UNUSED_PRESERVE src0_sel:WORD_1
v_mfma_f32_32x32x16_bf16 v[24:39], a[212:215], a[20:23], v[24:39]
ds_read_u16 v58, v58
ds_read_u16_d16_hi v59, v59
ds_read_u16 v60, v60
ds_read_u16_d16_hi v61, v61
v_exp_f16_sdwa v251, v243 dst_sel:WORD_1 dst_unused:UNUSED_PRESERVE src0_sel:WORD_1
v_mfma_f32_32x32x16_f16 v[62:77], a[216:219], v[48:51], v[62:77]
ds_read_u16 v7, v7
buffer_load_dwordx4 a[176:179], v5, s[4:7], s77 offen offset:0
ds_read_u16_d16_hi v0, v0
s_waitcnt lgkmcnt(10)
v_or_b32 v46, v20, v21
v_mfma_f32_32x32x16_bf16 v[208:223], a[192:195], a[24:27], 0
v_mad_u32_u16 v24, v24, 2, s85 op_sel:[1,0,0,0]
v_mad_u32_u16 v25, v25, 2, s85 op_sel:[1,0,0,0]
v_mad_u32_u16 v26, v26, 2, s85 op_sel:[1,0,0,0]
v_mad_u32_u16 v27, v27, 2, s85 op_sel:[1,0,0,0]
v_mad_u32_u16 v28, v28, 2, s85 op_sel:[1,0,0,0]
v_mfma_f32_32x32x16_f16 v[78:93], a[220:223], v[48:51], v[78:93]
ds_read_b128 a[192:195], v1 offset:12288
ds_read_u16 v24, v24
v_mad_u32_u16 v29, v29, 2, s85 op_sel:[1,0,0,0]
v_mad_u32_u16 v30, v30, 2, s85 op_sel:[1,0,0,0]
s_waitcnt lgkmcnt(9)
v_or_b32 v47, v22, v23
v_mfma_f32_32x32x16_bf16 v[208:223], a[196:199], a[28:31], v[208:223]
ds_read_b128 a[196:199], v1 offset:13312
v_mad_u32_u16 v31, v31, 2, s85 op_sel:[1,0,0,0]
v_mad_u32_u16 v32, v32, 2, s85 op_sel:[1,0,0,0]
v_mad_u32_u16 v33, v33, 2, s85 op_sel:[1,0,0,0]
v_mad_u32_u16 v34, v34, 2, s85 op_sel:[1,0,0,0]
v_mfma_f32_32x32x16_f16 v[94:109], a[224:227], v[48:51], v[94:109]
ds_read_u16_d16_hi v25, v25
ds_read_u16 v26, v26
v_pk_add_f16 v240, v248, 1.0 op_sel_hi:[1,0]
v_mad_u32_u16 v35, v35, 2, s85 op_sel:[1,0,0,0]
v_mad_u32_u16 v36, v36, 2, s85 op_sel:[1,0,0,0]
v_rcp_f16 v248, v240
v_mfma_f32_32x32x16_bf16 v[208:223], a[200:203], a[32:35], v[208:223]
ds_read_b128 a[200:203], v1 offset:14336
buffer_load_dwordx4 a[180:183], v5, s[4:7], s77 offen offset:16
ds_read_u16_d16_hi v27, v27
v_pk_add_f16 v241, v249, 1.0 op_sel_hi:[1,0]
v_mfma_f32_32x32x16_f16 v[62:77], a[228:231], v[52:55], v[62:77]
v_mad_u32_u16 v37, v37, 2, s85 op_sel:[1,0,0,0]
v_pk_add_f16 v242, v250, 1.0 op_sel_hi:[1,0]
v_mad_u32_u16 v38, v38, 2, s85 op_sel:[1,0,0,0]
v_mad_u32_u16 v39, v39, 2, s85 op_sel:[1,0,0,0]
v_pk_add_f16 v243, v251, 1.0 op_sel_hi:[1,0]
s_waitcnt lgkmcnt(9)
v_or_b32 v228, v56, v57
v_mfma_f32_32x32x16_bf16 v[208:223], a[204:207], a[36:39], v[208:223]
ds_read_b128 a[204:207], v1 offset:15360
ds_read_u16 v28, v28
v_or_b32 v229, v58, v59
v_rcp_f16 v249, v241
v_cvt_pk_bf16_f32 v160, v62, v63
v_mfma_f32_32x32x16_f16 v[78:93], a[232:235], v[52:55], v[78:93]
ds_read_u16_d16_hi v29, v29
v_cvt_pk_bf16_f32 v161, v64, v65
v_or_b32 v230, v60, v61
v_cvt_pk_bf16_f32 v162, v66, v67
v_rcp_f16 v250, v242
v_mfma_f32_32x32x16_bf16 v[208:223], a[208:211], a[40:43], v[208:223]
ds_read_b128 a[208:211], v1 offset:16384
v_cvt_pk_bf16_f32 v163, v68, v69
v_rcp_f16_sdwa v248, v240 dst_sel:WORD_1 dst_unused:UNUSED_PRESERVE src0_sel:WORD_1
v_cvt_pk_bf16_f32 v164, v70, v71
s_waitcnt lgkmcnt(8)
v_or_b32 v231, v7, v0
v_mfma_f32_32x32x16_f16 v[94:109], a[236:239], v[52:55], v[94:109]
ds_read_u16 v30, v30
ds_read_u16_d16_hi v31, v31
v_cvt_pk_bf16_f32 v165, v72, v73
v_rcp_f16 v251, v243
v_cvt_pk_bf16_f32 v166, v74, v75
v_mfma_f32_32x32x16_bf16 v[208:223], a[212:215], a[44:47], v[208:223]
ds_read_b128 a[212:215], v1 offset:17408
v_cvt_pk_bf16_f32 v167, v76, v77
v_rcp_f16_sdwa v249, v241 dst_sel:WORD_1 dst_unused:UNUSED_PRESERVE src0_sel:WORD_1
v_permlane16_swap_b32 v160, v164
v_mfma_f32_32x32x16_f16 v[110:125], a[216:219], a[96:99], v[110:125]
ds_read_b128 a[216:219], v2 offset:6144
ds_read_u16 v32, v32
s_waitcnt lgkmcnt(10)
v_or_b32 v48, v24, v25
v_permlane16_swap_b32 v161, v165
v_mfma_f32_32x32x16_bf16 v[8:23], a[192:195], a[0:3], 0
ds_read_b128 a[192:195], v1 offset:18432
v_permlane16_swap_b32 v162, v166
v_mul_f32 v56, s60, v216
v_permlane16_swap_b32 v163, v167
v_mfma_f32_32x32x16_f16 v[126:141], a[220:223], a[96:99], v[126:141]
ds_read_b128 a[220:223], v2 offset:7168
v_cvt_pk_bf16_f32 v168, v78, v79
s_waitcnt lgkmcnt(9)
v_or_b32 v49, v26, v27
v_cvt_pk_bf16_f32 v169, v80, v81
v_mul_f32 v57, s60, v217
v_mfma_f32_32x32x16_bf16 v[8:23], a[196:199], a[4:7], v[8:23]
ds_read_b128 a[196:199], v1 offset:19456
ds_read_u16_d16_hi v33, v33
v_cvt_pk_bf16_f32 v170, v82, v83
v_mul_f32 v58, s60, v218
v_mul_f32 v59, s60, v219
v_cvt_pk_bf16_f32 v171, v84, v85
v_mfma_f32_32x32x16_f16 v[142:157], a[224:227], a[96:99], v[142:157]
ds_read_b128 a[224:227], v2 offset:8192
v_cvt_pk_bf16_f32 v172, v86, v87
v_mul_f32 v60, s60, v220
s_waitcnt lgkmcnt(9)
v_or_b32 v50, v28, v29
v_cvt_pk_bf16_f32 v173, v88, v89
v_mfma_f32_32x32x16_bf16 v[8:23], a[200:203], a[8:11], v[8:23]
ds_read_b128 a[200:203], v1 offset:20480
ds_read_u16 v34, v34
v_cvt_pk_bf16_f32 v174, v90, v91
v_mul_f32 v61, s60, v221
v_cvt_pk_bf16_f32 v175, v92, v93
v_mul_f32 v7, s60, v222
v_mfma_f32_32x32x16_f16 v[110:125], a[228:231], a[100:103], v[110:125]
ds_read_b128 a[228:231], v2 offset:9216
v_permlane16_swap_b32 v168, v172
v_mul_f32 v0, s60, v223
v_permlane16_swap_b32 v169, v173
v_mfma_f32_32x32x16_bf16 v[8:23], a[204:207], a[12:15], v[8:23]
ds_read_b128 a[204:207], v1 offset:21504
s_waitcnt lgkmcnt(9)
v_or_b32 v51, v30, v31
v_permlane16_swap_b32 v170, v174
v_mad_u32_u16 v56, v56, 2, s85 op_sel:[1,0,0,0]
v_mfma_f32_32x32x16_f16 v[126:141], a[232:235], a[100:103], v[126:141]
ds_read_b128 a[232:235], v2 offset:10240
ds_read_u16_d16_hi v35, v35
v_permlane16_swap_b32 v171, v175
v_mad_u32_u16 v57, v57, 2, s85 op_sel:[1,0,0,0]
v_cvt_pk_bf16_f32 v176, v94, v95
v_mfma_f32_32x32x16_bf16 v[8:23], a[208:211], a[16:19], v[8:23]
ds_read_b128 a[208:211], v1 offset:22528
ds_read_u16 v36, v36
v_cvt_pk_bf16_f32 v177, v96, v97
v_mad_u32_u16 v58, v58, 2, s85 op_sel:[1,0,0,0]
v_rcp_f16_sdwa v250, v242 dst_sel:WORD_1 dst_unused:UNUSED_PRESERVE src0_sel:WORD_1
v_mfma_f32_32x32x16_f16 v[142:157], a[236:239], a[100:103], v[142:157]
ds_read_b128 a[236:239], v2 offset:11264
ds_read_u16_d16_hi v37, v37
v_cvt_pk_bf16_f32 v178, v98, v99
v_mad_u32_u16 v59, v59, 2, s85 op_sel:[1,0,0,0]
v_cvt_pk_bf16_f32 v179, v100, v101
v_mad_u32_u16 v60, v60, 2, s85 op_sel:[1,0,0,0]
v_mfma_f32_32x32x16_bf16 v[8:23], a[212:215], a[20:23], v[8:23]
ds_read_b128 a[212:215], v1 offset:23552
s_waitcnt lgkmcnt(9)
v_or_b32 v52, v32, v33
v_cvt_pk_bf16_f32 v180, v102, v103
v_pk_mul_f16 v224, v224, v248
v_cvt_pk_bf16_f32 v181, v104, v105
v_mfma_f32_32x32x16_bf16 v[62:77], a[240:243], a[246:249], 0
ds_read_u16 v38, v38
ds_read_u16_d16_hi v39, v39
v_cvt_pk_bf16_f32 v182, v106, v107
v_mad_u32_u16 v61, v61, 2, s85 op_sel:[1,0,0,0]
v_cvt_pk_bf16_f32 v183, v108, v109
v_rcp_f16_sdwa v251, v243 dst_sel:WORD_1 dst_unused:UNUSED_PRESERVE src0_sel:WORD_1
v_mfma_f32_32x32x16_bf16 v[78:93], a[242:245], a[246:249], 0
ds_read_u16 v56, v56
ds_read_u16_d16_hi v57, v57
buffer_store_dwordx4 v[160:163], v6, s[8:11], s78 offen offset:0 sc1 nt
ds_read_u16 v58, v58
v_mfma_f32_32x32x16_bf16 v[94:109], a[244:247], a[246:249], 0
ds_read_u16_d16_hi v59, v59
v_permlane16_swap_b32 v176, v180
v_mad_u32_u16 v7, v7, 2, s85 op_sel:[1,0,0,0]
s_waitcnt lgkmcnt(8)
v_or_b32 v53, v34, v35
v_mfma_f32_32x32x16_f16 v[62:77], a[216:219], v[40:43], v[62:77]
ds_read_u16 v60, v60
ds_read_u16_d16_hi v61, v61
v_permlane16_swap_b32 v177, v181
v_mad_u32_u16 v0, v0, 2, s85 op_sel:[1,0,0,0]
v_permlane16_swap_b32 v178, v182
v_mfma_f32_32x32x16_f16 v[78:93], a[220:223], v[40:43], v[78:93]
ds_read_u16 v7, v7
v_permlane16_swap_b32 v179, v183
v_cvt_pk_f16_f32 v232, v208, v209
v_cvt_pk_bf16_f32 v184, v110, v111
v_cvt_pk_f16_f32 v233, v210, v211
v_mfma_f32_32x32x16_f16 v[94:109], a[224:227], v[40:43], v[94:109]
ds_read_u16_d16_hi v0, v0
s_waitcnt lgkmcnt(9)
v_or_b32 v54, v36, v37
v_cvt_pk_bf16_f32 v185, v112, v113
v_pk_mul_f16 v225, v225, v249
v_cvt_pk_bf16_f32 v186, v114, v115
v_mfma_f32_32x32x16_f16 v[62:77], a[228:231], v[44:47], v[62:77]
v_cvt_pk_bf16_f32 v187, v116, v117
v_pk_fma_f16 v244, v232, v232, s84
v_cvt_pk_bf16_f32 v188, v118, v119
v_cvt_pk_f16_f32 v234, v212, v213
v_cvt_pk_bf16_f32 v189, v120, v121
v_pk_fma_f16 v245, v233, v233, s84
v_mfma_f32_32x32x16_f16 v[78:93], a[232:235], v[44:47], v[78:93]
v_cvt_pk_bf16_f32 v190, v122, v123
s_waitcnt lgkmcnt(6)
v_or_b32 v55, v38, v39
v_cvt_pk_bf16_f32 v191, v124, v125
v_pk_mul_f16 v244, v232, v244
v_permlane16_swap_b32 v184, v188
v_mfma_f32_32x32x16_bf16 v[24:39], a[192:195], a[0:3], 0
v_permlane16_swap_b32 v185, v189
v_cvt_pk_f16_f32 v235, v214, v215
v_permlane16_swap_b32 v186, v190
v_pk_mul_f16 v226, v226, v250
v_mfma_f32_32x32x16_f16 v[94:109], a[236:239], v[44:47], v[94:109]
v_permlane16_swap_b32 v187, v191
v_pk_fma_f16 v246, v234, v234, s84
v_cvt_pk_bf16_f32 v192, v126, v127
v_pk_mul_f16 v245, v233, v245
v_exp_f16 v248, v244
v_mfma_f32_32x32x16_bf16 v[24:39], a[196:199], a[4:7], v[24:39]
v_cvt_pk_bf16_f32 v193, v128, v129
v_pk_fma_f16 v247, v235, v235, s84
v_cvt_pk_bf16_f32 v194, v130, v131
v_pk_mul_f16 v246, v234, v246
v_cvt_pk_bf16_f32 v195, v132, v133
v_pk_mul_f16 v247, v235, v247
v_mfma_f32_32x32x16_bf16 v[110:125], a[240:243], a[246:249], 0
v_cvt_pk_bf16_f32 v196, v134, v135
v_pk_mul_f16 v227, v227, v251
v_cvt_pk_bf16_f32 v197, v136, v137
v_mad_u32_u16 v8, v8, 2, s85 op_sel:[1,0,0,0]
v_exp_f16 v249, v245
v_mfma_f32_32x32x16_bf16 v[24:39], a[200:203], a[8:11], v[24:39]
ds_read_u16 v8, v8
v_cvt_pk_bf16_f32 v198, v138, v139
v_mad_u32_u16 v9, v9, 2, s85 op_sel:[1,0,0,0]
v_cvt_pk_bf16_f32 v199, v140, v141
v_mad_u32_u16 v10, v10, 2, s85 op_sel:[1,0,0,0]
v_permlane16_swap_b32 v192, v196
v_mfma_f32_32x32x16_bf16 v[126:141], a[242:245], a[246:249], 0
ds_read_u16_d16_hi v9, v9
ds_read_u16 v10, v10
s_add_u32 s101, s3, 16384
buffer_load_dwordx4 a[120:123], v1, s[12:15], s101 offen offset:0
v_mfma_f32_32x32x16_bf16 v[24:39], a[204:207], a[12:15], v[24:39]
v_permlane16_swap_b32 v193, v197
v_mad_u32_u16 v11, v11, 2, s85 op_sel:[1,0,0,0]
v_permlane16_swap_b32 v194, v198
v_mad_u32_u16 v12, v12, 2, s85 op_sel:[1,0,0,0]
v_mfma_f32_32x32x16_bf16 v[24:39], a[208:211], a[16:19], v[24:39]
ds_read_u16_d16_hi v11, v11
ds_read_u16 v12, v12
v_permlane16_swap_b32 v195, v199
v_mad_u32_u16 v13, v13, 2, s85 op_sel:[1,0,0,0]
v_cvt_pk_bf16_f32 v200, v142, v143
v_mfma_f32_32x32x16_bf16 v[24:39], a[212:215], a[20:23], v[24:39]
ds_read_u16_d16_hi v13, v13
v_cvt_pk_bf16_f32 v201, v144, v145
v_mad_u32_u16 v14, v14, 2, s85 op_sel:[1,0,0,0]
v_cvt_pk_bf16_f32 v202, v146, v147
v_mad_u32_u16 v15, v15, 2, s85 op_sel:[1,0,0,0]
v_exp_f16 v250, v246
v_mfma_f32_32x32x16_bf16 v[208:223], a[192:195], a[24:27], 0
ds_read_b128 a[192:195], v1 offset:24576
ds_read_u16 v14, v14
ds_read_u16_d16_hi v15, v15
s_waitcnt lgkmcnt(5)
v_or_b32 v40, v8, v9
v_cvt_pk_bf16_f32 v203, v148, v149
v_mfma_f32_32x32x16_bf16 v[208:223], a[196:199], a[28:31], v[208:223]
ds_read_b128 a[196:199], v1 offset:25600
v_cvt_pk_bf16_f32 v204, v150, v151
v_mad_u32_u16 v16, v16, 2, s85 op_sel:[1,0,0,0]
v_cvt_pk_bf16_f32 v205, v152, v153
v_mad_u32_u16 v17, v17, 2, s85 op_sel:[1,0,0,0]
v_cvt_pk_bf16_f32 v206, v154, v155
v_mfma_f32_32x32x16_bf16 v[208:223], a[200:203], a[32:35], v[208:223]
ds_read_b128 a[200:203], v1 offset:26624
ds_read_u16 v16, v16
ds_read_u16_d16_hi v17, v17
buffer_load_dwordx4 a[124:127], v1, s[12:15], s101 offen offset:1024
v_mfma_f32_32x32x16_bf16 v[208:223], a[204:207], a[36:39], v[208:223]
ds_read_b128 a[204:207], v1 offset:27648
v_or_b32 v41, v10, v11
v_cvt_pk_bf16_f32 v207, v156, v157
v_mad_u32_u16 v18, v18, 2, s85 op_sel:[1,0,0,0]
v_permlane16_swap_b32 v200, v204
v_mfma_f32_32x32x16_bf16 v[142:157], a[244:247], a[246:249], 0
ds_read_u16 v18, v18
s_waitcnt lgkmcnt(6)
v_or_b32 v42, v12, v13
v_permlane16_swap_b32 v201, v205
v_exp_f16_sdwa v248, v244 dst_sel:WORD_1 dst_unused:UNUSED_PRESERVE src0_sel:WORD_1
v_mfma_f32_32x32x16_bf16 v[208:223], a[208:211], a[40:43], v[208:223]
ds_read_b128 a[208:211], v1 offset:28672
v_permlane16_swap_b32 v202, v206
v_pk_add_f16 v244, v248, 1.0 op_sel_hi:[1,0]
v_permlane16_swap_b32 v203, v207
v_mfma_f32_32x32x16_f16 v[110:125], a[216:219], v[224:227], v[110:125]
ds_read_b128 a[216:219], v2 offset:12288
v_or_b32 v43, v14, v15
v_mad_u32_u16 v19, v19, 2, s85 op_sel:[1,0,0,0]
v_mad_u32_u16 v20, v20, 2, s85 op_sel:[1,0,0,0]
v_exp_f16 v251, v247
v_mfma_f32_32x32x16_bf16 v[208:223], a[212:215], a[44:47], v[208:223]
ds_read_b128 a[212:215], v1 offset:29696
ds_read_u16_d16_hi v19, v19
ds_read_u16 v20, v20
v_exp_f16_sdwa v249, v245 dst_sel:WORD_1 dst_unused:UNUSED_PRESERVE src0_sel:WORD_1
v_exp_f16_sdwa v250, v246 dst_sel:WORD_1 dst_unused:UNUSED_PRESERVE src0_sel:WORD_1
v_mfma_f32_32x32x16_f16 v[126:141], a[220:223], v[224:227], v[126:141]
ds_read_b128 a[220:223], v2 offset:13312
v_pk_add_f16 v245, v249, 1.0 op_sel_hi:[1,0]
s_waitcnt lgkmcnt(5)
v_or_b32 v44, v16, v17
v_mad_u32_u16 v21, v21, 2, s85 op_sel:[1,0,0,0]
v_pk_add_f16 v246, v250, 1.0 op_sel_hi:[1,0]
v_mfma_f32_32x32x16_f16 v[142:157], a[224:227], v[224:227], v[142:157]
ds_read_b128 a[224:227], v2 offset:14336
ds_read_u16_d16_hi v21, v21
v_mad_u32_u16 v22, v22, 2, s85 op_sel:[1,0,0,0]
v_mad_u32_u16 v23, v23, 2, s85 op_sel:[1,0,0,0]
v_exp_f16_sdwa v251, v247 dst_sel:WORD_1 dst_unused:UNUSED_PRESERVE src0_sel:WORD_1
v_mfma_f32_32x32x16_f16 v[110:125], a[228:231], v[228:231], v[110:125]
ds_read_b128 a[228:231], v2 offset:15360
ds_read_u16 v22, v22
ds_read_u16_d16_hi v23, v23
v_pk_add_f16 v247, v251, 1.0 op_sel_hi:[1,0]
v_or_b32 v236, v56, v57
v_or_b32 v237, v58, v59
v_mfma_f32_32x32x16_f16 v[126:141], a[232:235], v[228:231], v[126:141]
ds_read_b128 a[232:235], v2 offset:16384
v_or_b32 v238, v60, v61
v_or_b32 v239, v7, v0
v_rcp_f16 v248, v244
v_rcp_f16 v249, v245
v_mfma_f32_32x32x16_f16 v[142:157], a[236:239], v[228:231], v[142:157]
ds_read_b128 a[236:239], v2 offset:17408
s_waitcnt lgkmcnt(6)
v_or_b32 v45, v18, v19
v_rcp_f16 v250, v246
v_rcp_f16_sdwa v248, v244 dst_sel:WORD_1 dst_unused:UNUSED_PRESERVE src0_sel:WORD_1
v_mfma_f32_32x32x16_f16 v[62:77], a[216:219], v[48:51], v[62:77]
v_pk_mul_f16 v232, v232, v248
v_rcp_f16 v251, v247
v_rcp_f16_sdwa v249, v245 dst_sel:WORD_1 dst_unused:UNUSED_PRESERVE src0_sel:WORD_1
v_rcp_f16_sdwa v250, v246 dst_sel:WORD_1 dst_unused:UNUSED_PRESERVE src0_sel:WORD_1
v_mfma_f32_32x32x16_f16 v[78:93], a[220:223], v[48:51], v[78:93]
v_pk_mul_f16 v233, v233, v249
v_pk_mul_f16 v234, v234, v250
s_waitcnt lgkmcnt(3)
v_or_b32 v46, v20, v21
v_rcp_f16_sdwa v251, v247 dst_sel:WORD_1 dst_unused:UNUSED_PRESERVE src0_sel:WORD_1
v_mfma_f32_32x32x16_f16 v[94:109], a[224:227], v[48:51], v[94:109]
v_pk_mul_f16 v235, v235, v251
v_mad_u32_u16 v24, v24, 2, s85 op_sel:[1,0,0,0]
v_mad_u32_u16 v25, v25, 2, s85 op_sel:[1,0,0,0]
v_mad_u32_u16 v26, v26, 2, s85 op_sel:[1,0,0,0]
v_mad_u32_u16 v27, v27, 2, s85 op_sel:[1,0,0,0]
v_mad_u32_u16 v28, v28, 2, s85 op_sel:[1,0,0,0]
v_mfma_f32_32x32x16_f16 v[62:77], a[228:231], v[52:55], v[62:77]
ds_read_u16 v24, v24
ds_read_u16_d16_hi v25, v25
ds_read_u16 v26, v26
ds_read_u16_d16_hi v27, v27
s_waitcnt lgkmcnt(4)
v_or_b32 v47, v22, v23
v_mfma_f32_32x32x16_bf16 v[8:23], a[192:195], a[0:3], 0
ds_read_u16 v28, v28
v_mad_u32_u16 v29, v29, 2, s85 op_sel:[1,0,0,0]
v_mad_u32_u16 v30, v30, 2, s85 op_sel:[1,0,0,0]
v_mad_u32_u16 v31, v31, 2, s85 op_sel:[1,0,0,0]
v_mad_u32_u16 v32, v32, 2, s85 op_sel:[1,0,0,0]
v_mfma_f32_32x32x16_f16 v[78:93], a[232:235], v[52:55], v[78:93]
ds_read_u16_d16_hi v29, v29
ds_read_u16 v30, v30
ds_read_u16_d16_hi v31, v31
ds_read_u16 v32, v32
v_mad_u32_u16 v33, v33, 2, s85 op_sel:[1,0,0,0]
v_mad_u32_u16 v34, v34, 2, s85 op_sel:[1,0,0,0]
v_mfma_f32_32x32x16_bf16 v[8:23], a[196:199], a[4:7], v[8:23]
ds_read_u16_d16_hi v33, v33
ds_read_u16 v34, v34
v_mad_u32_u16 v35, v35, 2, s85 op_sel:[1,0,0,0]
v_mad_u32_u16 v36, v36, 2, s85 op_sel:[1,0,0,0]
v_mad_u32_u16 v37, v37, 2, s85 op_sel:[1,0,0,0]
v_mad_u32_u16 v38, v38, 2, s85 op_sel:[1,0,0,0]
v_mfma_f32_32x32x16_f16 v[94:109], a[236:239], v[52:55], v[94:109]
ds_read_u16_d16_hi v35, v35
v_mad_u32_u16 v39, v39, 2, s85 op_sel:[1,0,0,0]
v_mul_f32 v56, s60, v216
v_mul_f32 v57, s60, v217
v_mul_f32 v58, s60, v218
v_mul_f32 v59, s60, v219
v_mfma_f32_32x32x16_bf16 v[8:23], a[200:203], a[8:11], v[8:23]
ds_read_u16 v36, v36
ds_read_u16_d16_hi v37, v37
s_waitcnt lgkmcnt(10)
v_or_b32 v48, v24, v25
v_mul_f32 v60, s60, v220
v_mul_f32 v61, s60, v221
s_waitcnt vmcnt(7)
v_smfmac_f32_32x32x32_bf16 v[62:77], a[250:253], a[168:175], v4
ds_read_u16 v38, v38
v_mul_f32 v7, s60, v222
v_mul_f32 v0, s60, v223
v_or_b32 v49, v26, v27
v_mad_u32_u16 v56, v56, 2, s85 op_sel:[1,0,0,0]
v_mfma_f32_32x32x16_bf16 v[8:23], a[204:207], a[12:15], v[8:23]
ds_read_u16_d16_hi v39, v39
buffer_load_dwordx4 a[168:171], v5, s[4:7], s76 offen offset:64
ds_read_u16 v56, v56
v_mad_u32_u16 v57, v57, 2, s85 op_sel:[1,0,0,0]
v_mfma_f32_32x32x16_f16 v[110:125], a[216:219], v[232:235], v[110:125]
v_mad_u32_u16 v58, v58, 2, s85 op_sel:[1,0,0,0]
s_waitcnt lgkmcnt(9)
v_or_b32 v50, v28, v29
v_mad_u32_u16 v59, v59, 2, s85 op_sel:[1,0,0,0]
v_mad_u32_u16 v60, v60, 2, s85 op_sel:[1,0,0,0]
v_mad_u32_u16 v61, v61, 2, s85 op_sel:[1,0,0,0]
v_mfma_f32_32x32x16_bf16 v[8:23], a[208:211], a[16:19], v[8:23]
ds_read_b128 a[216:219], v2 offset:18432
ds_read_u16_d16_hi v57, v57
v_mad_u32_u16 v7, v7, 2, s85 op_sel:[1,0,0,0]
v_mad_u32_u16 v0, v0, 2, s85 op_sel:[1,0,0,0]
v_cvt_pk_f16_f32 v224, v208, v209
v_cvt_pk_f16_f32 v225, v210, v211
v_mfma_f32_32x32x16_f16 v[126:141], a[220:223], v[232:235], v[126:141]
ds_read_b128 a[220:223], v2 offset:19456
v_or_b32 v51, v30, v31
v_pk_fma_f16 v240, v224, v224, s84
v_cvt_pk_f16_f32 v226, v212, v213
v_pk_fma_f16 v241, v225, v225, s84
v_pk_mul_f16 v240, v224, v240
v_mfma_f32_32x32x16_bf16 v[8:23], a[212:215], a[20:23], v[8:23]
ds_read_u16 v58, v58
v_cvt_pk_f16_f32 v227, v214, v215
v_pk_fma_f16 v242, v226, v226, s84
s_waitcnt lgkmcnt(9)
v_or_b32 v52, v32, v33
v_pk_mul_f16 v241, v225, v241
v_mfma_f32_32x32x16_f16 v[142:157], a[224:227], v[232:235], v[142:157]
ds_read_b128 a[224:227], v2 offset:20480
buffer_store_dwordx4 v[164:167], v6, s[8:11], s78 offen offset:3072 sc1 nt
ds_read_u16_d16_hi v59, v59
v_mfma_f32_32x32x16_bf16 v[208:223], a[192:195], a[24:27], 0
ds_read_b128 a[192:195], v1 offset:30720
v_or_b32 v53, v34, v35
v_pk_fma_f16 v243, v227, v227, s84
v_pk_mul_f16 v242, v226, v242
v_pk_mul_f16 v243, v227, v243
v_mad_u32_u16 v8, v8, 2, s85 op_sel:[1,0,0,0]
v_mfma_f32_32x32x16_f16 v[110:125], a[228:231], v[236:239], v[110:125]
ds_read_b128 a[228:231], v2 offset:21504
v_mad_u32_u16 v9, v9, 2, s85 op_sel:[1,0,0,0]
v_mad_u32_u16 v10, v10, 2, s85 op_sel:[1,0,0,0]
v_exp_f16 v248, v240
s_waitcnt lgkmcnt(9)
v_or_b32 v54, v36, v37
v_mfma_f32_32x32x16_bf16 v[208:223], a[196:199], a[28:31], v[208:223]
ds_read_b128 a[196:199], v1 offset:31744
v_mad_u32_u16 v11, v11, 2, s85 op_sel:[1,0,0,0]
v_mad_u32_u16 v12, v12, 2, s85 op_sel:[1,0,0,0]
v_mad_u32_u16 v13, v13, 2, s85 op_sel:[1,0,0,0]
v_mad_u32_u16 v14, v14, 2, s85 op_sel:[1,0,0,0]
v_mad_u32_u16 v15, v15, 2, s85 op_sel:[1,0,0,0]
v_mfma_f32_32x32x16_f16 v[126:141], a[232:235], v[236:239], v[126:141]
ds_read_b128 a[232:235], v2 offset:22528
ds_read_u16 v60, v60
v_or_b32 v55, v38, v39
v_mad_u32_u16 v16, v16, 2, s85 op_sel:[1,0,0,0]
v_mad_u32_u16 v17, v17, 2, s85 op_sel:[1,0,0,0]
v_mad_u32_u16 v18, v18, 2, s85 op_sel:[1,0,0,0]
v_mfma_f32_32x32x16_bf16 v[208:223], a[200:203], a[32:35], v[208:223]
ds_read_b128 a[200:203], v1 offset:32768
buffer_load_dwordx4 a[172:175], v5, s[4:7], s76 offen offset:80
ds_read_u16_d16_hi v61, v61
v_exp_f16 v249, v241
v_mfma_f32_32x32x16_f16 v[142:157], a[236:239], v[236:239], v[142:157]
v_exp_f16 v250, v242
v_exp_f16_sdwa v248, v240 dst_sel:WORD_1 dst_unused:UNUSED_PRESERVE src0_sel:WORD_1
v_exp_f16 v251, v243
v_mfma_f32_32x32x16_bf16 v[208:223], a[204:207], a[36:39], v[208:223]
ds_read_b128 a[204:207], v1 offset:33792
ds_read_b128 a[236:239], v2 offset:23552
v_pk_add_f16 v240, v248, 1.0 op_sel_hi:[1,0]
v_mad_u32_u16 v19, v19, 2, s85 op_sel:[1,0,0,0]
v_mad_u32_u16 v20, v20, 2, s85 op_sel:[1,0,0,0]
v_exp_f16_sdwa v249, v241 dst_sel:WORD_1 dst_unused:UNUSED_PRESERVE src0_sel:WORD_1
s_waitcnt lgkmcnt(7)
v_mfma_f32_32x32x16_f16 v[62:77], a[216:219], v[40:43], v[62:77]
ds_read_u16 v7, v7
ds_read_u16_d16_hi v0, v0
v_pk_add_f16 v241, v249, 1.0 op_sel_hi:[1,0]
v_mad_u32_u16 v21, v21, 2, s85 op_sel:[1,0,0,0]
v_exp_f16_sdwa v250, v242 dst_sel:WORD_1 dst_unused:UNUSED_PRESERVE src0_sel:WORD_1
v_mfma_f32_32x32x16_bf16 v[208:223], a[208:211], a[40:43], v[208:223]
ds_read_b128 a[208:211], v1 offset:34816
ds_read_u16 v8, v8
v_pk_add_f16 v242, v250, 1.0 op_sel_hi:[1,0]
v_exp_f16_sdwa v251, v243 dst_sel:WORD_1 dst_unused:UNUSED_PRESERVE src0_sel:WORD_1
v_mad_u32_u16 v22, v22, 2, s85 op_sel:[1,0,0,0]
v_mfma_f32_32x32x16_f16 v[78:93], a[220:223], v[40:43], v[78:93]
ds_read_u16_d16_hi v9, v9
ds_read_u16 v10, v10
v_mad_u32_u16 v23, v23, 2, s85 op_sel:[1,0,0,0]
v_pk_add_f16 v243, v251, 1.0 op_sel_hi:[1,0]
v_or_b32 v228, v56, v57
v_or_b32 v229, v58, v59
v_mfma_f32_32x32x16_bf16 v[208:223], a[212:215], a[44:47], v[208:223]
ds_read_b128 a[212:215], v1 offset:35840
v_rcp_f16 v248, v240
v_rcp_f16 v249, v241
v_rcp_f16 v250, v242
v_mfma_f32_32x32x16_f16 v[94:109], a[224:227], v[40:43], v[94:109]
ds_read_u16_d16_hi v11, v11
ds_read_u16 v12, v12
v_rcp_f16_sdwa v248, v240 dst_sel:WORD_1 dst_unused:UNUSED_PRESERVE src0_sel:WORD_1
s_waitcnt lgkmcnt(8)
v_or_b32 v230, v60, v61
v_mfma_f32_32x32x16_bf16 v[24:39], a[192:195], a[0:3], 0
ds_read_b128 a[192:195], v1 offset:36864
ds_read_u16_d16_hi v13, v13
v_rcp_f16 v251, v243
v_rcp_f16_sdwa v249, v241 dst_sel:WORD_1 dst_unused:UNUSED_PRESERVE src0_sel:WORD_1
v_mfma_f32_32x32x16_f16 v[62:77], a[228:231], v[44:47], v[62:77]
ds_read_u16 v14, v14
v_rcp_f16_sdwa v250, v242 dst_sel:WORD_1 dst_unused:UNUSED_PRESERVE src0_sel:WORD_1
v_rcp_f16_sdwa v251, v243 dst_sel:WORD_1 dst_unused:UNUSED_PRESERVE src0_sel:WORD_1
ds_read_u16_d16_hi v15, v15
v_mfma_f32_32x32x16_bf16 v[24:39], a[196:199], a[4:7], v[24:39]
ds_read_b128 a[196:199], v1 offset:37888
s_waitcnt lgkmcnt(10)
v_or_b32 v231, v7, v0
v_mul_f32 v56, s60, v216
v_mul_f32 v57, s60, v217
v_mul_f32 v58, s60, v218
v_mfma_f32_32x32x16_f16 v[78:93], a[232:235], v[44:47], v[78:93]
ds_read_u16 v16, v16
v_mul_f32 v59, s60, v219
v_mul_f32 v60, s60, v220
v_mul_f32 v61, s60, v221
v_mul_f32 v7, s60, v222
v_mul_f32 v0, s60, v223
v_mfma_f32_32x32x16_bf16 v[24:39], a[200:203], a[8:11], v[24:39]
ds_read_b128 a[200:203], v1 offset:38912
ds_read_u16_d16_hi v17, v17
s_waitcnt lgkmcnt(10)
v_or_b32 v40, v8, v9
v_mad_u32_u16 v56, v56, 2, s85 op_sel:[1,0,0,0]
v_mad_u32_u16 v57, v57, 2, s85 op_sel:[1,0,0,0]
v_mfma_f32_32x32x16_f16 v[94:109], a[236:239], v[44:47], v[94:109]
ds_read_u16 v18, v18
v_mad_u32_u16 v58, v58, 2, s85 op_sel:[1,0,0,0]
v_mad_u32_u16 v59, v59, 2, s85 op_sel:[1,0,0,0]
v_mad_u32_u16 v60, v60, 2, s85 op_sel:[1,0,0,0]
v_pk_mul_f16 v224, v224, v248
v_mad_u32_u16 v61, v61, 2, s85 op_sel:[1,0,0,0]
v_mfma_f32_32x32x16_bf16 v[24:39], a[204:207], a[12:15], v[24:39]
ds_read_b128 a[204:207], v1 offset:39936
v_mad_u32_u16 v7, v7, 2, s85 op_sel:[1,0,0,0]
s_waitcnt lgkmcnt(9)
v_or_b32 v41, v10, v11
v_mad_u32_u16 v0, v0, 2, s85 op_sel:[1,0,0,0]
v_cvt_pk_f16_f32 v232, v208, v209
v_mfma_f32_32x32x16_f16 v[110:125], a[216:219], a[104:107], v[110:125]
ds_read_b128 a[216:219], v2 offset:24576
v_cvt_pk_f16_f32 v233, v210, v211
v_pk_mul_f16 v225, v225, v249
v_pk_fma_f16 v244, v232, v232, s84
v_cvt_pk_f16_f32 v234, v212, v213
v_pk_fma_f16 v245, v233, v233, s84
v_mfma_f32_32x32x16_bf16 v[24:39], a[208:211], a[16:19], v[24:39]
ds_read_b128 a[208:211], v1 offset:40960
ds_read_u16_d16_hi v19, v19
buffer_store_dwordx4 v[168:171], v6, s[8:11], s78 offen offset:64 sc1 nt
ds_read_u16 v20, v20
v_mfma_f32_32x32x16_f16 v[126:141], a[220:223], a[104:107], v[126:141]
ds_read_b128 a[220:223], v2 offset:25600
s_waitcnt lgkmcnt(10)
v_or_b32 v42, v12, v13
v_pk_mul_f16 v244, v232, v244
v_cvt_pk_f16_f32 v235, v214, v215
v_or_b32 v43, v14, v15
v_mfma_f32_32x32x16_bf16 v[24:39], a[212:215], a[20:23], v[24:39]
ds_read_b128 a[212:215], v1 offset:41984
v_pk_mul_f16 v226, v226, v250
v_pk_fma_f16 v246, v234, v234, s84
v_pk_mul_f16 v245, v233, v245
v_exp_f16 v248, v244
v_mfma_f32_32x32x16_f16 v[142:157], a[224:227], a[104:107], v[142:157]
ds_read_b128 a[224:227], v2 offset:26624
ds_read_u16_d16_hi v21, v21
v_pk_fma_f16 v247, v235, v235, s84
v_pk_mul_f16 v246, v234, v246
v_pk_mul_f16 v247, v235, v247
v_pk_mul_f16 v227, v227, v251
v_mfma_f32_32x32x16_f16 v[110:125], a[228:231], a[108:111], v[110:125]
ds_read_b128 a[228:231], v2 offset:34560
v_mad_u32_u16 v24, v24, 2, s85 op_sel:[1,0,0,0]
s_waitcnt lgkmcnt(8)
v_or_b32 v44, v16, v17
v_mad_u32_u16 v25, v25, 2, s85 op_sel:[1,0,0,0]
v_mad_u32_u16 v26, v26, 2, s85 op_sel:[1,0,0,0]
v_mfma_f32_32x32x16_f16 v[126:141], a[232:235], a[108:111], v[126:141]
ds_read_b128 a[232:235], v2 offset:35584
v_mad_u32_u16 v27, v27, 2, s85 op_sel:[1,0,0,0]
v_mad_u32_u16 v28, v28, 2, s85 op_sel:[1,0,0,0]
v_mad_u32_u16 v29, v29, 2, s85 op_sel:[1,0,0,0]
v_mad_u32_u16 v30, v30, 2, s85 op_sel:[1,0,0,0]
v_exp_f16 v249, v245
v_mfma_f32_32x32x16_f16 v[142:157], a[236:239], a[108:111], v[142:157]
ds_read_b128 a[236:239], v2 offset:36608
ds_read_u16 v22, v22
ds_read_u16_d16_hi v23, v23
v_mad_u32_u16 v31, v31, 2, s85 op_sel:[1,0,0,0]
v_mad_u32_u16 v32, v32, 2, s85 op_sel:[1,0,0,0]
v_mad_u32_u16 v33, v33, 2, s85 op_sel:[1,0,0,0]
s_waitcnt vmcnt(7)
v_smfmac_f32_32x32x32_bf16 v[110:125], a[250:253], a[176:183], v4
ds_read_u16 v56, v56
s_waitcnt lgkmcnt(8)
v_or_b32 v45, v18, v19
v_mad_u32_u16 v34, v34, 2, s85 op_sel:[1,0,0,0]
v_exp_f16 v250, v246
v_mfma_f32_32x32x16_f16 v[62:77], a[216:219], v[48:51], v[62:77]
ds_read_u16_d16_hi v57, v57
ds_read_u16 v58, v58
buffer_load_dwordx4 a[176:179], v5, s[4:7], s77 offen offset:64
ds_read_u16_d16_hi v59, v59
v_mfma_f32_32x32x16_f16 v[78:93], a[220:223], v[48:51], v[78:93]
v_exp_f16_sdwa v248, v244 dst_sel:WORD_1 dst_unused:UNUSED_PRESERVE src0_sel:WORD_1
v_exp_f16 v251, v247
v_pk_add_f16 v244, v248, 1.0 op_sel_hi:[1,0]
v_mad_u32_u16 v35, v35, 2, s85 op_sel:[1,0,0,0]
s_waitcnt lgkmcnt(7)
v_mfma_f32_32x32x16_f16 v[94:109], a[224:227], v[48:51], v[94:109]
ds_read_u16 v60, v60
ds_read_u16_d16_hi v61, v61
ds_read_u16 v7, v7
v_or_b32 v46, v20, v21
v_mad_u32_u16 v36, v36, 2, s85 op_sel:[1,0,0,0]
v_exp_f16_sdwa v249, v245 dst_sel:WORD_1 dst_unused:UNUSED_PRESERVE src0_sel:WORD_1
v_mfma_f32_32x32x16_f16 v[62:77], a[228:231], v[52:55], v[62:77]
ds_read_u16_d16_hi v0, v0
ds_read_u16 v24, v24
v_pk_add_f16 v245, v249, 1.0 op_sel_hi:[1,0]
v_mad_u32_u16 v37, v37, 2, s85 op_sel:[1,0,0,0]
v_exp_f16_sdwa v250, v246 dst_sel:WORD_1 dst_unused:UNUSED_PRESERVE src0_sel:WORD_1
v_mfma_f32_32x32x16_f16 v[78:93], a[232:235], v[52:55], v[78:93]
ds_read_u16_d16_hi v25, v25
v_pk_add_f16 v246, v250, 1.0 op_sel_hi:[1,0]
v_mad_u32_u16 v38, v38, 2, s85 op_sel:[1,0,0,0]
v_mad_u32_u16 v39, v39, 2, s85 op_sel:[1,0,0,0]
v_exp_f16_sdwa v251, v247 dst_sel:WORD_1 dst_unused:UNUSED_PRESERVE src0_sel:WORD_1
s_waitcnt lgkmcnt(9)
v_mfma_f32_32x32x16_f16 v[94:109], a[236:239], v[52:55], v[94:109]
ds_read_u16 v26, v26
buffer_load_dwordx4 a[180:183], v5, s[4:7], s77 offen offset:80
ds_read_u16_d16_hi v27, v27
v_or_b32 v47, v22, v23
v_mfma_f32_32x32x16_bf16 v[8:23], a[192:195], a[0:3], 0
v_pk_add_f16 v247, v251, 1.0 op_sel_hi:[1,0]
v_rcp_f16 v248, v244
v_rcp_f16 v249, v245
v_rcp_f16 v250, v246
v_mfma_f32_32x32x16_f16 v[110:125], a[216:219], v[224:227], v[110:125]
ds_read_b128 a[216:219], v2 offset:37632
ds_read_u16 v28, v28
s_waitcnt lgkmcnt(10)
v_or_b32 v236, v56, v57
v_rcp_f16_sdwa v248, v244 dst_sel:WORD_1 dst_unused:UNUSED_PRESERVE src0_sel:WORD_1
v_mfma_f32_32x32x16_bf16 v[8:23], a[196:199], a[4:7], v[8:23]
ds_read_u16_d16_hi v29, v29
v_rcp_f16 v251, v247
v_or_b32 v237, v58, v59
v_rcp_f16_sdwa v249, v245 dst_sel:WORD_1 dst_unused:UNUSED_PRESERVE src0_sel:WORD_1
v_mfma_f32_32x32x16_f16 v[126:141], a[220:223], v[224:227], v[126:141]
ds_read_b128 a[220:223], v2 offset:38656
v_rcp_f16_sdwa v250, v246 dst_sel:WORD_1 dst_unused:UNUSED_PRESERVE src0_sel:WORD_1
v_rcp_f16_sdwa v251, v247 dst_sel:WORD_1 dst_unused:UNUSED_PRESERVE src0_sel:WORD_1
ds_read_u16 v30, v30
v_mfma_f32_32x32x16_bf16 v[8:23], a[200:203], a[8:11], v[8:23]
ds_read_u16_d16_hi v31, v31
s_add_u32 s101, s3, 22528
buffer_load_dwordx4 a[128:131], v1, s[12:15], s101 offen offset:0
s_waitcnt lgkmcnt(9)
v_or_b32 v238, v60, v61
v_mfma_f32_32x32x16_f16 v[142:157], a[224:227], v[224:227], v[142:157]
ds_read_b128 a[224:227], v2 offset:39680
buffer_load_dwordx4 a[132:135], v1, s[12:15], s101 offen offset:1024
v_or_b32 v239, v7, v0
v_pk_mul_f16 v232, v232, v248
v_mfma_f32_32x32x16_bf16 v[8:23], a[204:207], a[12:15], v[8:23]
ds_read_u16 v32, v32
v_pk_mul_f16 v233, v233, v249
v_pk_mul_f16 v234, v234, v250
v_pk_mul_f16 v235, v235, v251
ds_read_u16_d16_hi v33, v33
v_mfma_f32_32x32x16_f16 v[110:125], a[228:231], v[228:231], v[110:125]
ds_read_b128 a[228:231], v2 offset:40704
s_waitcnt lgkmcnt(10)
v_or_b32 v48, v24, v25
buffer_store_dwordx4 v[172:175], v6, s[8:11], s78 offen offset:3136 sc1 nt
v_mfma_f32_32x32x16_bf16 v[8:23], a[208:211], a[16:19], v[8:23]
ds_read_u16 v34, v34
ds_read_u16_d16_hi v35, v35
v_or_b32 v49, v26, v27
ds_read_u16 v36, v36
v_mfma_f32_32x32x16_f16 v[126:141], a[232:235], v[228:231], v[126:141]
ds_read_b128 a[232:235], v2 offset:41728
ds_read_u16_d16_hi v37, v37
ds_read_u16 v38, v38
ds_read_u16_d16_hi v39, v39
v_mfma_f32_32x32x16_f16 v[142:157], a[236:239], v[228:231], v[142:157]
ds_read_b128 a[236:239], v2 offset:42752
s_waitcnt lgkmcnt(13)
v_or_b32 v50, v28, v29
v_mfma_f32_32x32x16_f16 v[62:77], a[216:219], v[40:43], v[62:77]
v_mfma_f32_32x32x16_f16 v[78:93], a[220:223], v[40:43], v[78:93]
s_waitcnt lgkmcnt(10)
v_or_b32 v51, v30, v31
v_mfma_f32_32x32x16_bf16 v[8:23], a[212:215], a[20:23], v[8:23]
s_nop 5
v_mfma_f32_32x32x16_bf16 v[208:223], a[192:195], a[24:27], 0
ds_read_b128 a[192:195], v1 offset:43008
s_waitcnt lgkmcnt(8)
v_or_b32 v52, v32, v33
v_mfma_f32_32x32x16_f16 v[94:109], a[224:227], v[40:43], v[94:109]
s_nop 0
v_mad_u32_u16 v8, v8, 2, s85 op_sel:[1,0,0,0]
v_mad_u32_u16 v9, v9, 2, s85 op_sel:[1,0,0,0]
v_mad_u32_u16 v10, v10, 2, s85 op_sel:[1,0,0,0]
v_mad_u32_u16 v11, v11, 2, s85 op_sel:[1,0,0,0]
v_mad_u32_u16 v12, v12, 2, s85 op_sel:[1,0,0,0]
v_mfma_f32_32x32x16_bf16 v[208:223], a[196:199], a[28:31], v[208:223]
ds_read_b128 a[196:199], v1 offset:44032
ds_read_u16 v8, v8
ds_read_u16_d16_hi v9, v9
ds_read_u16 v10, v10
v_mad_u32_u16 v13, v13, 2, s85 op_sel:[1,0,0,0]
s_waitcnt lgkmcnt(9)
v_or_b32 v53, v34, v35
v_mfma_f32_32x32x16_f16 v[62:77], a[228:231], v[44:47], v[62:77]
ds_read_u16_d16_hi v11, v11
v_mad_u32_u16 v14, v14, 2, s85 op_sel:[1,0,0,0]
v_mad_u32_u16 v15, v15, 2, s85 op_sel:[1,0,0,0]
v_mad_u32_u16 v16, v16, 2, s85 op_sel:[1,0,0,0]
v_mad_u32_u16 v17, v17, 2, s85 op_sel:[1,0,0,0]
v_mad_u32_u16 v18, v18, 2, s85 op_sel:[1,0,0,0]
v_mfma_f32_32x32x16_bf16 v[208:223], a[200:203], a[32:35], v[208:223]
ds_read_b128 a[200:203], v1 offset:45056
ds_read_u16 v12, v12
v_mad_u32_u16 v19, v19, 2, s85 op_sel:[1,0,0,0]
v_mad_u32_u16 v20, v20, 2, s85 op_sel:[1,0,0,0]
v_mad_u32_u16 v21, v21, 2, s85 op_sel:[1,0,0,0]
v_mfma_f32_32x32x16_f16 v[78:93], a[232:235], v[44:47], v[78:93]
ds_read_u16_d16_hi v13, v13
s_waitcnt lgkmcnt(9)
v_or_b32 v54, v36, v37
v_mad_u32_u16 v22, v22, 2, s85 op_sel:[1,0,0,0]
v_mad_u32_u16 v23, v23, 2, s85 op_sel:[1,0,0,0]
ds_read_u16 v14, v14
v_mfma_f32_32x32x16_bf16 v[208:223], a[204:207], a[36:39], v[208:223]
ds_read_u16_d16_hi v15, v15
v_or_b32 v55, v38, v39
ds_read_u16 v16, v16
ds_read_u16_d16_hi v17, v17
v_mfma_f32_32x32x16_f16 v[94:109], a[236:239], v[44:47], v[94:109]
ds_read_u16 v18, v18
ds_read_u16_d16_hi v19, v19
ds_read_u16 v20, v20
ds_read_u16_d16_hi v21, v21
v_mfma_f32_32x32x16_bf16 v[208:223], a[208:211], a[40:43], v[208:223]
ds_read_u16 v22, v22
v_mfma_f32_32x32x16_f16 v[110:125], a[216:219], v[232:235], v[110:125]
ds_read_b128 a[216:219], v2 offset:43776
s_waitcnt lgkmcnt(13)
v_or_b32 v40, v8, v9
v_mfma_f32_32x32x16_f16 v[126:141], a[220:223], v[232:235], v[126:141]
ds_read_b128 a[220:223], v2 offset:44800
buffer_store_dwordx4 v[176:179], v6, s[8:11], s78 offen offset:128 sc1 nt
v_mfma_f32_32x32x16_bf16 v[208:223], a[212:215], a[44:47], v[208:223]
v_or_b32 v41, v10, v11
ds_read_u16_d16_hi v23, v23
ds_read_b128 a[204:207], v1 offset:46080
v_mfma_f32_32x32x16_f16 v[142:157], a[224:227], v[232:235], v[142:157]
ds_read_b128 a[224:227], v2 offset:45824
ds_read_b128 a[208:211], v1 offset:47104
v_mfma_f32_32x32x16_f16 v[110:125], a[228:231], v[236:239], v[110:125]
s_waitcnt lgkmcnt(13)
v_or_b32 v42, v12, v13
ds_read_b128 a[228:231], v2 offset:46848
v_mfma_f32_32x32x16_f16 v[126:141], a[232:235], v[236:239], v[126:141]
s_nop 0
v_mul_f32 v56, s60, v216
v_or_b32 v43, v14, v15
v_mul_f32 v57, s60, v217
v_mul_f32 v58, s60, v218
v_mul_f32 v59, s60, v219
v_mfma_f32_32x32x16_bf16 v[24:39], a[192:195], a[0:3], 0
v_mul_f32 v60, s60, v220
v_mul_f32 v61, s60, v221
v_mul_f32 v7, s60, v222
v_mul_f32 v0, s60, v223
v_mad_u32_u16 v56, v56, 2, s85 op_sel:[1,0,0,0]
v_mad_u32_u16 v57, v57, 2, s85 op_sel:[1,0,0,0]
v_mfma_f32_32x32x16_f16 v[142:157], a[236:239], v[236:239], v[142:157]
s_waitcnt lgkmcnt(10)
v_or_b32 v44, v16, v17
v_mad_u32_u16 v58, v58, 2, s85 op_sel:[1,0,0,0]
v_mad_u32_u16 v59, v59, 2, s85 op_sel:[1,0,0,0]
v_mad_u32_u16 v60, v60, 2, s85 op_sel:[1,0,0,0]
v_mad_u32_u16 v61, v61, 2, s85 op_sel:[1,0,0,0]
v_mfma_f32_32x32x16_bf16 v[24:39], a[196:199], a[4:7], v[24:39]
ds_read_b128 a[212:215], v1 offset:48128
v_mad_u32_u16 v7, v7, 2, s85 op_sel:[1,0,0,0]
v_mad_u32_u16 v0, v0, 2, s85 op_sel:[1,0,0,0]
v_cvt_pk_f16_f32 v224, v208, v209
v_or_b32 v45, v18, v19
v_cvt_pk_f16_f32 v225, v210, v211
v_mfma_f32_32x32x16_bf16 v[24:39], a[200:203], a[8:11], v[24:39]
ds_read_b128 a[232:235], v2 offset:47872
v_pk_fma_f16 v240, v224, v224, s84
v_cvt_pk_f16_f32 v226, v212, v213
v_pk_fma_f16 v241, v225, v225, s84
v_pk_mul_f16 v240, v224, v240
v_cvt_pk_f16_f32 v227, v214, v215
v_pk_fma_f16 v242, v226, v226, s84
v_exp_f16 v248, v240
s_waitcnt lgkmcnt(7)
v_or_b32 v46, v20, v21
v_pk_mul_f16 v241, v225, v241
v_pk_fma_f16 v243, v227, v227, s84
v_pk_mul_f16 v242, v226, v242
v_exp_f16 v249, v241
v_pk_mul_f16 v243, v227, v243
v_exp_f16 v250, v242
v_mfma_f32_32x32x16_f16 v[62:77], a[216:219], v[48:51], v[62:77]
ds_read_b128 a[236:239], v2 offset:48896
ds_read_u16 v56, v56
ds_read_u16_d16_hi v57, v57
ds_read_u16 v58, v58
v_exp_f16_sdwa v248, v240 dst_sel:WORD_1 dst_unused:UNUSED_PRESERVE src0_sel:WORD_1
v_mfma_f32_32x32x16_f16 v[78:93], a[220:223], v[48:51], v[78:93]
ds_read_u16_d16_hi v59, v59
s_waitcnt lgkmcnt(8)
v_or_b32 v47, v22, v23
v_exp_f16 v251, v243
v_exp_f16_sdwa v249, v241 dst_sel:WORD_1 dst_unused:UNUSED_PRESERVE src0_sel:WORD_1
v_mfma_f32_32x32x16_bf16 v[24:39], a[204:207], a[12:15], v[24:39]
ds_read_u16 v60, v60
ds_read_u16_d16_hi v61, v61
ds_read_u16 v7, v7
buffer_store_dwordx4 v[180:183], v6, s[8:11], s78 offen offset:3200 sc1 nt
v_mfma_f32_32x32x16_f16 v[94:109], a[224:227], v[48:51], v[94:109]
ds_read_u16_d16_hi v0, v0
v_exp_f16_sdwa v250, v242 dst_sel:WORD_1 dst_unused:UNUSED_PRESERVE src0_sel:WORD_1
v_exp_f16_sdwa v251, v243 dst_sel:WORD_1 dst_unused:UNUSED_PRESERVE src0_sel:WORD_1
s_waitcnt lgkmcnt(7)
v_mfma_f32_32x32x16_f16 v[62:77], a[228:231], v[52:55], v[62:77]
v_mfma_f32_32x32x16_f16 v[78:93], a[232:235], v[52:55], v[78:93]
v_mfma_f32_32x32x16_f16 v[94:109], a[236:239], v[52:55], v[94:109]
v_mfma_f32_32x32x16_bf16 v[24:39], a[208:211], a[16:19], v[24:39]
v_mfma_f32_32x32x16_bf16 v[24:39], a[212:215], a[20:23], v[24:39]
s_nop 5
v_mfma_f32_32x32x16_bf16 v[208:223], a[192:195], a[24:27], 0
ds_read_b128 a[192:195], v1 offset:49152
s_nop 3
v_mad_u32_u16 v24, v24, 2, s85 op_sel:[1,0,0,0]
s_waitcnt vmcnt(8)
v_smfmac_f32_32x32x32_bf16 v[78:93], a[250:253], a[168:175], v4
ds_read_u16 v24, v24
v_mad_u32_u16 v25, v25, 2, s85 op_sel:[1,0,0,0]
v_mad_u32_u16 v26, v26, 2, s85 op_sel:[1,0,0,0]
v_mad_u32_u16 v27, v27, 2, s85 op_sel:[1,0,0,0]
v_mad_u32_u16 v28, v28, 2, s85 op_sel:[1,0,0,0]
v_mfma_f32_32x32x16_bf16 v[208:223], a[196:199], a[28:31], v[208:223]
ds_read_b128 a[196:199], v1 offset:50176
ds_read_u16_d16_hi v25, v25
ds_read_u16 v26, v26
ds_read_u16_d16_hi v27, v27
v_mad_u32_u16 v29, v29, 2, s85 op_sel:[1,0,0,0]
v_mad_u32_u16 v30, v30, 2, s85 op_sel:[1,0,0,0]
v_mfma_f32_32x32x16_f16 v[110:125], a[216:219], a[112:115], v[110:125]
ds_read_b128 a[216:219], v2 offset:49920
ds_read_u16 v28, v28
ds_read_u16_d16_hi v29, v29
ds_read_u16 v30, v30
v_mad_u32_u16 v31, v31, 2, s85 op_sel:[1,0,0,0]
v_mad_u32_u16 v32, v32, 2, s85 op_sel:[1,0,0,0]
v_mfma_f32_32x32x16_bf16 v[208:223], a[200:203], a[32:35], v[208:223]
ds_read_b128 a[200:203], v1 offset:51200
ds_read_u16_d16_hi v31, v31
ds_read_u16 v32, v32
buffer_store_dwordx4 v[184:187], v6, s[8:11], s79 offen offset:0 sc1 nt
v_mfma_f32_32x32x16_f16 v[126:141], a[220:223], a[112:115], v[126:141]
ds_read_b128 a[220:223], v2 offset:50944
v_mad_u32_u16 v33, v33, 2, s85 op_sel:[1,0,0,0]
v_mad_u32_u16 v34, v34, 2, s85 op_sel:[1,0,0,0]
v_pk_add_f16 v240, v248, 1.0 op_sel_hi:[1,0]
v_mad_u32_u16 v35, v35, 2, s85 op_sel:[1,0,0,0]
v_mad_u32_u16 v36, v36, 2, s85 op_sel:[1,0,0,0]
v_mfma_f32_32x32x16_bf16 v[208:223], a[204:207], a[36:39], v[208:223]
ds_read_b128 a[204:207], v1 offset:52224
v_pk_add_f16 v241, v249, 1.0 op_sel_hi:[1,0]
s_waitcnt lgkmcnt(9)
v_or_b32 v48, v24, v25
v_mad_u32_u16 v37, v37, 2, s85 op_sel:[1,0,0,0]
v_pk_add_f16 v242, v250, 1.0 op_sel_hi:[1,0]
v_mfma_f32_32x32x16_f16 v[142:157], a[224:227], a[112:115], v[142:157]
ds_read_b128 a[224:227], v2 offset:51968
ds_read_u16_d16_hi v33, v33
v_mad_u32_u16 v38, v38, 2, s85 op_sel:[1,0,0,0]
v_mad_u32_u16 v39, v39, 2, s85 op_sel:[1,0,0,0]
v_pk_add_f16 v243, v251, 1.0 op_sel_hi:[1,0]
v_or_b32 v228, v56, v57
v_mfma_f32_32x32x16_bf16 v[208:223], a[208:211], a[40:43], v[208:223]
ds_read_b128 a[208:211], v1 offset:53248
v_or_b32 v49, v26, v27
v_or_b32 v229, v58, v59
v_or_b32 v230, v60, v61
v_or_b32 v231, v7, v0
v_rcp_f16 v248, v240
v_mfma_f32_32x32x16_f16 v[110:125], a[228:231], a[116:119], v[110:125]
ds_read_b128 a[228:231], v2 offset:52992
ds_read_u16 v34, v34
buffer_load_dwordx4 a[168:171], v5, s[4:7], s76 offen offset:128
v_rcp_f16 v249, v241
v_mfma_f32_32x32x16_bf16 v[208:223], a[212:215], a[44:47], v[208:223]
ds_read_b128 a[212:215], v1 offset:54272
s_waitcnt lgkmcnt(9)
v_or_b32 v50, v28, v29
v_rcp_f16 v250, v242
v_rcp_f16_sdwa v248, v240 dst_sel:WORD_1 dst_unused:UNUSED_PRESERVE src0_sel:WORD_1
v_mfma_f32_32x32x16_f16 v[126:141], a[232:235], a[116:119], v[126:141]
ds_read_b128 a[232:235], v2 offset:54016
ds_read_u16_d16_hi v35, v35
v_rcp_f16 v251, v243
v_rcp_f16_sdwa v249, v241 dst_sel:WORD_1 dst_unused:UNUSED_PRESERVE src0_sel:WORD_1
v_mfma_f32_32x32x16_bf16 v[8:23], a[192:195], a[0:3], 0
ds_read_b128 a[192:195], v1 offset:55296
v_or_b32 v51, v30, v31
v_mul_f32 v56, s60, v216
v_mul_f32 v57, s60, v217
v_mul_f32 v58, s60, v218
v_mul_f32 v59, s60, v219
v_mfma_f32_32x32x16_f16 v[142:157], a[236:239], a[116:119], v[142:157]
ds_read_b128 a[236:239], v2 offset:55040
v_mul_f32 v60, s60, v220
v_mul_f32 v61, s60, v221
v_mul_f32 v7, s60, v222
v_mul_f32 v0, s60, v223
v_mad_u32_u16 v56, v56, 2, s85 op_sel:[1,0,0,0]
v_mfma_f32_32x32x16_bf16 v[8:23], a[196:199], a[4:7], v[8:23]
ds_read_b128 a[196:199], v1 offset:56320
ds_read_u16 v36, v36
ds_read_u16_d16_hi v37, v37
buffer_load_dwordx4 a[172:175], v5, s[4:7], s76 offen offset:144
v_mfma_f32_32x32x16_f16 v[62:77], a[216:219], v[40:43], v[62:77]
s_waitcnt lgkmcnt(8)
v_or_b32 v52, v32, v33
v_mad_u32_u16 v57, v57, 2, s85 op_sel:[1,0,0,0]
v_mad_u32_u16 v58, v58, 2, s85 op_sel:[1,0,0,0]
v_mad_u32_u16 v59, v59, 2, s85 op_sel:[1,0,0,0]
v_mad_u32_u16 v60, v60, 2, s85 op_sel:[1,0,0,0]
v_mfma_f32_32x32x16_bf16 v[8:23], a[200:203], a[8:11], v[8:23]
ds_read_b128 a[200:203], v1 offset:57344
ds_read_u16 v38, v38
ds_read_u16_d16_hi v39, v39
v_pk_mul_f16 v224, v224, v248
v_rcp_f16_sdwa v250, v242 dst_sel:WORD_1 dst_unused:UNUSED_PRESERVE src0_sel:WORD_1
v_mfma_f32_32x32x16_f16 v[78:93], a[220:223], v[40:43], v[78:93]
ds_read_u16 v56, v56
v_mad_u32_u16 v61, v61, 2, s85 op_sel:[1,0,0,0]
v_mad_u32_u16 v7, v7, 2, s85 op_sel:[1,0,0,0]
v_mad_u32_u16 v0, v0, 2, s85 op_sel:[1,0,0,0]
v_cvt_pk_f16_f32 v232, v208, v209
v_cvt_pk_f16_f32 v233, v210, v211
v_mfma_f32_32x32x16_bf16 v[8:23], a[204:207], a[12:15], v[8:23]
ds_read_b128 a[204:207], v1 offset:58368
ds_read_u16_d16_hi v57, v57
v_pk_mul_f16 v225, v225, v249
v_rcp_f16_sdwa v251, v243 dst_sel:WORD_1 dst_unused:UNUSED_PRESERVE src0_sel:WORD_1
s_waitcnt lgkmcnt(8)
v_or_b32 v53, v34, v35
v_mfma_f32_32x32x16_f16 v[94:109], a[224:227], v[40:43], v[94:109]
ds_read_u16 v58, v58
ds_read_u16_d16_hi v59, v59
v_pk_fma_f16 v244, v232, v232, s84
v_cvt_pk_f16_f32 v234, v212, v213
v_pk_fma_f16 v245, v233, v233, s84
v_pk_mul_f16 v244, v232, v244
v_mfma_f32_32x32x16_bf16 v[8:23], a[208:211], a[16:19], v[8:23]
ds_read_b128 a[208:211], v1 offset:59392
ds_read_u16 v60, v60
v_cvt_pk_f16_f32 v235, v214, v215
v_pk_mul_f16 v226, v226, v250
v_pk_fma_f16 v246, v234, v234, s84
v_pk_mul_f16 v245, v233, v245
v_mfma_f32_32x32x16_f16 v[62:77], a[228:231], v[44:47], v[62:77]
ds_read_u16_d16_hi v61, v61
v_pk_fma_f16 v247, v235, v235, s84
v_pk_mul_f16 v246, v234, v246
v_exp_f16 v248, v244
s_waitcnt lgkmcnt(9)
v_or_b32 v54, v36, v37
v_mfma_f32_32x32x16_bf16 v[8:23], a[212:215], a[20:23], v[8:23]
ds_read_b128 a[212:215], v1 offset:60416
ds_read_u16 v7, v7
v_pk_mul_f16 v247, v235, v247
v_pk_mul_f16 v227, v227, v251
v_exp_f16 v249, v245
v_mfma_f32_32x32x16_f16 v[78:93], a[232:235], v[44:47], v[78:93]
ds_read_u16_d16_hi v0, v0
v_exp_f16 v250, v246
v_exp_f16_sdwa v248, v244 dst_sel:WORD_1 dst_unused:UNUSED_PRESERVE src0_sel:WORD_1
s_waitcnt lgkmcnt(9)
v_or_b32 v55, v38, v39
v_mfma_f32_32x32x16_bf16 v[24:39], a[192:195], a[0:3], 0
v_mad_u32_u16 v8, v8, 2, s85 op_sel:[1,0,0,0]
v_mad_u32_u16 v9, v9, 2, s85 op_sel:[1,0,0,0]
v_mad_u32_u16 v10, v10, 2, s85 op_sel:[1,0,0,0]
v_mad_u32_u16 v11, v11, 2, s85 op_sel:[1,0,0,0]
v_exp_f16 v251, v247
v_mfma_f32_32x32x16_f16 v[94:109], a[236:239], v[44:47], v[94:109]
ds_read_u16 v8, v8
ds_read_u16_d16_hi v9, v9
ds_read_u16 v10, v10
v_mad_u32_u16 v12, v12, 2, s85 op_sel:[1,0,0,0]
v_mad_u32_u16 v13, v13, 2, s85 op_sel:[1,0,0,0]
v_mad_u32_u16 v14, v14, 2, s85 op_sel:[1,0,0,0]
v_mfma_f32_32x32x16_bf16 v[24:39], a[196:199], a[4:7], v[24:39]
ds_read_u16_d16_hi v11, v11
v_mad_u32_u16 v15, v15, 2, s85 op_sel:[1,0,0,0]
v_mad_u32_u16 v16, v16, 2, s85 op_sel:[1,0,0,0]
v_exp_f16_sdwa v249, v245 dst_sel:WORD_1 dst_unused:UNUSED_PRESERVE src0_sel:WORD_1
v_mad_u32_u16 v17, v17, 2, s85 op_sel:[1,0,0,0]
v_mfma_f32_32x32x16_f16 v[110:125], a[216:219], v[224:227], v[110:125]
ds_read_b128 a[216:219], v2 offset:56064
v_mad_u32_u16 v18, v18, 2, s85 op_sel:[1,0,0,0]
v_pk_add_f16 v244, v248, 1.0 op_sel_hi:[1,0]
v_mad_u32_u16 v19, v19, 2, s85 op_sel:[1,0,0,0]
v_mad_u32_u16 v20, v20, 2, s85 op_sel:[1,0,0,0]
v_exp_f16_sdwa v250, v246 dst_sel:WORD_1 dst_unused:UNUSED_PRESERVE src0_sel:WORD_1
v_mfma_f32_32x32x16_bf16 v[24:39], a[200:203], a[8:11], v[24:39]
ds_read_u16 v12, v12
ds_read_u16_d16_hi v13, v13
buffer_store_dwordx4 v[188:191], v6, s[8:11], s79 offen offset:3072 sc1 nt
ds_read_u16 v14, v14
v_mfma_f32_32x32x16_f16 v[126:141], a[220:223], v[224:227], v[126:141]
v_pk_add_f16 v245, v249, 1.0 op_sel_hi:[1,0]
v_mad_u32_u16 v21, v21, 2, s85 op_sel:[1,0,0,0]
v_pk_add_f16 v246, v250, 1.0 op_sel_hi:[1,0]
v_mad_u32_u16 v22, v22, 2, s85 op_sel:[1,0,0,0]
v_mad_u32_u16 v23, v23, 2, s85 op_sel:[1,0,0,0]
v_exp_f16_sdwa v251, v247 dst_sel:WORD_1 dst_unused:UNUSED_PRESERVE src0_sel:WORD_1
v_mfma_f32_32x32x16_bf16 v[24:39], a[204:207], a[12:15], v[24:39]
ds_read_b128 a[220:223], v2 offset:57088
ds_read_u16_d16_hi v15, v15
v_pk_add_f16 v247, v251, 1.0 op_sel_hi:[1,0]
s_waitcnt lgkmcnt(9)
v_or_b32 v236, v56, v57
v_or_b32 v237, v58, v59
v_mfma_f32_32x32x16_f16 v[142:157], a[224:227], v[224:227], v[142:157]
ds_read_b128 a[224:227], v2 offset:58112
v_or_b32 v238, v60, v61
v_or_b32 v239, v7, v0
v_rcp_f16 v248, v244
v_rcp_f16 v249, v245
v_mfma_f32_32x32x16_bf16 v[24:39], a[208:211], a[16:19], v[24:39]
ds_read_u16 v16, v16
ds_read_u16_d16_hi v17, v17
v_rcp_f16 v250, v246
v_rcp_f16_sdwa v248, v244 dst_sel:WORD_1 dst_unused:UNUSED_PRESERVE src0_sel:WORD_1
v_mfma_f32_32x32x16_f16 v[110:125], a[228:231], v[228:231], v[110:125]
ds_read_b128 a[228:231], v2 offset:59136
s_waitcnt lgkmcnt(9)
v_or_b32 v40, v8, v9
v_pk_mul_f16 v232, v232, v248
v_rcp_f16 v251, v247
v_mfma_f32_32x32x16_bf16 v[24:39], a[212:215], a[20:23], v[24:39]
ds_read_u16 v18, v18
v_rcp_f16_sdwa v249, v245 dst_sel:WORD_1 dst_unused:UNUSED_PRESERVE src0_sel:WORD_1
v_or_b32 v41, v10, v11
v_pk_mul_f16 v233, v233, v249
v_rcp_f16_sdwa v250, v246 dst_sel:WORD_1 dst_unused:UNUSED_PRESERVE src0_sel:WORD_1
v_mfma_f32_32x32x16_f16 v[126:141], a[232:235], v[228:231], v[126:141]
ds_read_b128 a[232:235], v2 offset:60160
ds_read_u16_d16_hi v19, v19
v_pk_mul_f16 v234, v234, v250
v_rcp_f16_sdwa v251, v247 dst_sel:WORD_1 dst_unused:UNUSED_PRESERVE src0_sel:WORD_1
v_mfma_f32_32x32x16_f16 v[142:157], a[236:239], v[228:231], v[142:157]
ds_read_b128 a[236:239], v2 offset:61184
v_pk_mul_f16 v235, v235, v251
v_mad_u32_u16 v24, v24, 2, s85 op_sel:[1,0,0,0]
v_mad_u32_u16 v25, v25, 2, s85 op_sel:[1,0,0,0]
s_waitcnt lgkmcnt(9)
v_or_b32 v42, v12, v13
v_mfma_f32_32x32x16_bf16 v[208:223], a[192:195], a[24:27], 0
ds_read_b128 a[192:195], v1 offset:61440
v_mad_u32_u16 v26, v26, 2, s85 op_sel:[1,0,0,0]
v_mad_u32_u16 v27, v27, 2, s85 op_sel:[1,0,0,0]
v_mad_u32_u16 v28, v28, 2, s85 op_sel:[1,0,0,0]
v_mad_u32_u16 v29, v29, 2, s85 op_sel:[1,0,0,0]
s_waitcnt vmcnt(9)
v_smfmac_f32_32x32x32_bf16 v[126:141], a[250:253], a[176:183], v4
ds_read_u16 v20, v20
v_mad_u32_u16 v30, v30, 2, s85 op_sel:[1,0,0,0]
v_mad_u32_u16 v31, v31, 2, s85 op_sel:[1,0,0,0]
s_waitcnt lgkmcnt(8)
v_or_b32 v43, v14, v15
v_mfma_f32_32x32x16_bf16 v[208:223], a[196:199], a[28:31], v[208:223]
ds_read_b128 a[196:199], v1 offset:62464
ds_read_u16_d16_hi v21, v21
ds_read_u16 v22, v22
buffer_load_dwordx4 a[176:179], v5, s[4:7], s77 offen offset:128
v_mfma_f32_32x32x16_f16 v[62:77], a[216:219], v[48:51], v[62:77]
ds_read_u16_d16_hi v23, v23
v_mad_u32_u16 v32, v32, 2, s85 op_sel:[1,0,0,0]
v_mad_u32_u16 v33, v33, 2, s85 op_sel:[1,0,0,0]
v_mad_u32_u16 v34, v34, 2, s85 op_sel:[1,0,0,0]
v_mad_u32_u16 v35, v35, 2, s85 op_sel:[1,0,0,0]
v_mad_u32_u16 v36, v36, 2, s85 op_sel:[1,0,0,0]
v_mfma_f32_32x32x16_bf16 v[208:223], a[200:203], a[32:35], v[208:223]
ds_read_b128 a[200:203], v1 offset:63488
s_waitcnt lgkmcnt(9)
v_or_b32 v44, v16, v17
v_mad_u32_u16 v37, v37, 2, s85 op_sel:[1,0,0,0]
v_mad_u32_u16 v38, v38, 2, s85 op_sel:[1,0,0,0]
v_mad_u32_u16 v39, v39, 2, s85 op_sel:[1,0,0,0]
v_mfma_f32_32x32x16_f16 v[78:93], a[220:223], v[48:51], v[78:93]
ds_read_u16 v24, v24
ds_read_u16_d16_hi v25, v25
buffer_load_dwordx4 a[180:183], v5, s[4:7], s77 offen offset:144
ds_read_u16 v26, v26
v_mfma_f32_32x32x16_bf16 v[208:223], a[204:207], a[36:39], v[208:223]
ds_read_u16_d16_hi v27, v27
ds_read_u16 v28, v28
ds_read_u16_d16_hi v29, v29
s_waitcnt lgkmcnt(11)
v_or_b32 v45, v18, v19
v_mfma_f32_32x32x16_f16 v[94:109], a[224:227], v[48:51], v[94:109]
ds_read_u16 v30, v30
ds_read_u16_d16_hi v31, v31
ds_read_u16 v32, v32
v_mfma_f32_32x32x16_f16 v[62:77], a[228:231], v[52:55], v[62:77]
ds_read_u16_d16_hi v33, v33
v_mfma_f32_32x32x16_f16 v[78:93], a[232:235], v[52:55], v[78:93]
ds_read_u16 v34, v34
s_waitcnt lgkmcnt(12)
v_or_b32 v46, v20, v21
v_mfma_f32_32x32x16_f16 v[94:109], a[236:239], v[52:55], v[94:109]
ds_read_u16_d16_hi v35, v35
ds_read_u16 v36, v36
v_mfma_f32_32x32x16_f16 v[110:125], a[216:219], v[232:235], v[110:125]
v_or_b32 v47, v22, v23
ds_read_b128 a[216:219], v2 offset:62208
v_mfma_f32_32x32x16_bf16 v[208:223], a[208:211], a[40:43], v[208:223]
ds_read_u16_d16_hi v37, v37
buffer_store_dwordx4 v[192:195], v6, s[8:11], s79 offen offset:64 sc1 nt
v_mfma_f32_32x32x16_f16 v[126:141], a[220:223], v[232:235], v[126:141]
s_waitcnt lgkmcnt(11)
v_or_b32 v48, v24, v25
ds_read_b128 a[220:223], v2 offset:63232
ds_read_u16 v38, v38
v_mfma_f32_32x32x16_bf16 v[208:223], a[212:215], a[44:47], v[208:223]
ds_read_u16_d16_hi v39, v39
ds_read_b128 a[204:207], v1 offset:64512
v_mfma_f32_32x32x16_f16 v[142:157], a[224:227], v[232:235], v[142:157]
v_or_b32 v49, v26, v27
ds_read_b128 a[224:227], v2 offset:64256
v_mfma_f32_32x32x16_f16 v[110:125], a[228:231], v[236:239], v[110:125]
ds_read_b128 a[228:231], v2 offset:65280
s_waitcnt lgkmcnt(13)
v_or_b32 v50, v28, v29
v_mfma_f32_32x32x16_bf16 v[8:23], a[192:195], a[0:3], 0
ds_read_b128 a[208:211], v2 offset:0
s_nop 0
v_mul_f32 v56, s60, v216
v_mul_f32 v57, s60, v217
v_mul_f32 v58, s60, v218
v_mfma_f32_32x32x16_f16 v[126:141], a[232:235], v[236:239], v[126:141]
v_or_b32 v51, v30, v31
v_mul_f32 v59, s60, v219
v_mul_f32 v60, s60, v220
v_mul_f32 v61, s60, v221
v_mul_f32 v7, s60, v222
v_mul_f32 v0, s60, v223
v_mfma_f32_32x32x16_bf16 v[8:23], a[196:199], a[4:7], v[8:23]
v_mad_u32_u16 v56, v56, 2, s85 op_sel:[1,0,0,0]
v_mad_u32_u16 v57, v57, 2, s85 op_sel:[1,0,0,0]
v_mad_u32_u16 v58, v58, 2, s85 op_sel:[1,0,0,0]
v_mad_u32_u16 v59, v59, 2, s85 op_sel:[1,0,0,0]
v_mad_u32_u16 v60, v60, 2, s85 op_sel:[1,0,0,0]
s_waitcnt lgkmcnt(10)
v_or_b32 v52, v32, v33
v_mfma_f32_32x32x16_f16 v[142:157], a[236:239], v[236:239], v[142:157]
v_mad_u32_u16 v61, v61, 2, s85 op_sel:[1,0,0,0]
v_mad_u32_u16 v7, v7, 2, s85 op_sel:[1,0,0,0]
v_mad_u32_u16 v0, v0, 2, s85 op_sel:[1,0,0,0]
v_cvt_pk_f16_f32 v224, v208, v209
v_cvt_pk_f16_f32 v225, v210, v211
v_pk_fma_f16 v240, v224, v224, s84
v_mfma_f32_32x32x16_bf16 v[8:23], a[200:203], a[8:11], v[8:23]
ds_read_b128 a[212:215], v2 offset:1024
v_or_b32 v53, v34, v35
v_cvt_pk_f16_f32 v226, v212, v213
v_pk_fma_f16 v241, v225, v225, s84
v_pk_mul_f16 v240, v224, v240
v_cvt_pk_f16_f32 v227, v214, v215
v_pk_fma_f16 v242, v226, v226, s84
v_pk_mul_f16 v241, v225, v241
v_exp_f16 v248, v240
v_pk_fma_f16 v243, v227, v227, s84
v_pk_mul_f16 v242, v226, v242
s_waitcnt lgkmcnt(7)
v_mfma_f32_32x32x16_f16 v[62:77], a[216:219], v[40:43], v[62:77]
ds_read_b128 a[232:235], v3 offset:768
ds_read_b128 a[236:239], v3 offset:1792
ds_read_u16 v56, v56
v_pk_mul_f16 v243, v227, v243
v_or_b32 v54, v36, v37
v_exp_f16 v249, v241
v_exp_f16 v250, v242
v_mfma_f32_32x32x16_f16 v[78:93], a[220:223], v[40:43], v[78:93]
ds_read_u16_d16_hi v57, v57
ds_read_u16 v58, v58
v_exp_f16_sdwa v248, v240 dst_sel:WORD_1 dst_unused:UNUSED_PRESERVE src0_sel:WORD_1
v_exp_f16 v251, v243
v_exp_f16_sdwa v249, v241 dst_sel:WORD_1 dst_unused:UNUSED_PRESERVE src0_sel:WORD_1
v_exp_f16_sdwa v250, v242 dst_sel:WORD_1 dst_unused:UNUSED_PRESERVE src0_sel:WORD_1
s_waitcnt lgkmcnt(7)
v_or_b32 v55, v38, v39
v_exp_f16_sdwa v251, v243 dst_sel:WORD_1 dst_unused:UNUSED_PRESERVE src0_sel:WORD_1
v_mfma_f32_32x32x16_bf16 v[8:23], a[204:207], a[12:15], v[8:23]
ds_read_u16_d16_hi v59, v59
ds_read_u16 v60, v60
ds_read_u16_d16_hi v61, v61
ds_read_u16 v7, v7
ds_read_u16_d16_hi v0, v0
v_mfma_f32_32x32x16_f16 v[94:109], a[224:227], v[40:43], v[94:109]
v_mfma_f32_32x32x16_f16 v[62:77], a[228:231], v[44:47], v[62:77]
s_waitcnt lgkmcnt(6)
v_mfma_f32_32x32x16_f16 v[78:93], a[232:235], v[44:47], v[78:93]
v_mfma_f32_32x32x16_f16 v[94:109], a[236:239], v[44:47], v[94:109]
v_mfma_f32_32x32x16_bf16 v[8:23], a[208:211], a[16:19], v[8:23]
v_mfma_f32_32x32x16_bf16 v[8:23], a[212:215], a[20:23], v[8:23]
s_nop 5
v_mfma_f32_32x32x16_f16 v[110:125], a[216:219], a[120:123], v[110:125]
ds_read_b128 a[216:219], v3 offset:2816
s_nop 3
v_mad_u32_u16 v8, v8, 2, s85 op_sel:[1,0,0,0]
v_mfma_f32_32x32x16_bf16 v[208:223], a[192:195], a[24:27], 0
ds_read_b128 a[192:195], v2 offset:2048
ds_read_u16 v8, v8
v_mad_u32_u16 v9, v9, 2, s85 op_sel:[1,0,0,0]
v_mad_u32_u16 v10, v10, 2, s85 op_sel:[1,0,0,0]
v_mad_u32_u16 v11, v11, 2, s85 op_sel:[1,0,0,0]
v_mad_u32_u16 v12, v12, 2, s85 op_sel:[1,0,0,0]
v_mfma_f32_32x32x16_f16 v[126:141], a[220:223], a[120:123], v[126:141]
ds_read_b128 a[220:223], v3 offset:3840
ds_read_u16_d16_hi v9, v9
ds_read_u16 v10, v10
ds_read_u16_d16_hi v11, v11
v_mad_u32_u16 v13, v13, 2, s85 op_sel:[1,0,0,0]
v_mad_u32_u16 v14, v14, 2, s85 op_sel:[1,0,0,0]
v_mfma_f32_32x32x16_bf16 v[208:223], a[196:199], a[28:31], v[208:223]
ds_read_b128 a[196:199], v2 offset:3072
ds_read_u16 v12, v12
ds_read_u16_d16_hi v13, v13
ds_read_u16 v14, v14
v_mad_u32_u16 v15, v15, 2, s85 op_sel:[1,0,0,0]
v_mad_u32_u16 v16, v16, 2, s85 op_sel:[1,0,0,0]
v_mfma_f32_32x32x16_f16 v[142:157], a[224:227], a[120:123], v[142:157]
ds_read_b128 a[224:227], v3 offset:4864
ds_read_u16_d16_hi v15, v15
buffer_store_dwordx4 v[196:199], v6, s[8:11], s79 offen offset:3136 sc1 nt
ds_read_u16 v16, v16
v_mfma_f32_32x32x16_bf16 v[208:223], a[200:203], a[32:35], v[208:223]
v_mad_u32_u16 v17, v17, 2, s85 op_sel:[1,0,0,0]
v_mad_u32_u16 v18, v18, 2, s85 op_sel:[1,0,0,0]
v_pk_add_f16 v240, v248, 1.0 op_sel_hi:[1,0]
v_mad_u32_u16 v19, v19, 2, s85 op_sel:[1,0,0,0]
v_mad_u32_u16 v20, v20, 2, s85 op_sel:[1,0,0,0]
v_pk_add_f16 v241, v249, 1.0 op_sel_hi:[1,0]
v_mfma_f32_32x32x16_f16 v[110:125], a[228:231], a[124:127], v[110:125]
ds_read_b128 a[200:203], v2 offset:4096
ds_read_b128 a[228:231], v3 offset:5888
v_mad_u32_u16 v21, v21, 2, s85 op_sel:[1,0,0,0]
s_waitcnt lgkmcnt(9)
v_or_b32 v40, v8, v9
v_pk_add_f16 v242, v250, 1.0 op_sel_hi:[1,0]
v_mfma_f32_32x32x16_bf16 v[208:223], a[204:207], a[36:39], v[208:223]
ds_read_b128 a[204:207], v2 offset:5120
v_mad_u32_u16 v22, v22, 2, s85 op_sel:[1,0,0,0]
v_mad_u32_u16 v23, v23, 2, s85 op_sel:[1,0,0,0]
v_pk_add_f16 v243, v251, 1.0 op_sel_hi:[1,0]
v_or_b32 v228, v56, v57
v_or_b32 v229, v58, v59
v_mfma_f32_32x32x16_f16 v[126:141], a[232:235], a[124:127], v[126:141]
ds_read_b128 a[232:235], v3 offset:6912
v_or_b32 v41, v10, v11
v_or_b32 v230, v60, v61
v_or_b32 v231, v7, v0
v_rcp_f16 v248, v240
v_mfma_f32_32x32x16_bf16 v[208:223], a[208:211], a[40:43], v[208:223]
ds_read_b128 a[208:211], v3 offset:26368
ds_read_u16_d16_hi v17, v17
v_rcp_f16 v249, v241
v_rcp_f16 v250, v242
v_mfma_f32_32x32x16_f16 v[142:157], a[236:239], a[124:127], v[142:157]
ds_read_b128 a[236:239], v3 offset:7936
v_rcp_f16_sdwa v248, v240 dst_sel:WORD_1 dst_unused:UNUSED_PRESERVE src0_sel:WORD_1
s_waitcnt lgkmcnt(9)
v_or_b32 v42, v12, v13
v_rcp_f16 v251, v243
v_mfma_f32_32x32x16_bf16 v[208:223], a[212:215], a[44:47], v[208:223]
ds_read_b128 a[212:215], v3 offset:27392
ds_read_u16 v18, v18
v_rcp_f16_sdwa v249, v241 dst_sel:WORD_1 dst_unused:UNUSED_PRESERVE src0_sel:WORD_1
v_rcp_f16_sdwa v250, v242 dst_sel:WORD_1 dst_unused:UNUSED_PRESERVE src0_sel:WORD_1
v_mfma_f32_32x32x16_f16 v[62:77], a[216:219], v[48:51], v[62:77]
ds_read_u16_d16_hi v19, v19
v_rcp_f16_sdwa v251, v243 dst_sel:WORD_1 dst_unused:UNUSED_PRESERVE src0_sel:WORD_1
s_waitcnt lgkmcnt(8)
v_or_b32 v43, v14, v15
ds_read_u16 v20, v20
v_mfma_f32_32x32x16_bf16 v[24:39], a[192:195], a[0:3], 0
ds_read_u16_d16_hi v21, v21
v_mul_f32 v56, s60, v216
v_mul_f32 v57, s60, v217
v_mul_f32 v58, s60, v218
v_mul_f32 v59, s60, v219
v_mul_f32 v60, s60, v220
v_mfma_f32_32x32x16_f16 v[78:93], a[220:223], v[48:51], v[78:93]
ds_read_u16 v22, v22
ds_read_u16_d16_hi v23, v23
v_mul_f32 v61, s60, v221
v_mul_f32 v7, s60, v222
v_mul_f32 v0, s60, v223
v_mad_u32_u16 v56, v56, 2, s85 op_sel:[1,0,0,0]
v_mfma_f32_32x32x16_bf16 v[24:39], a[196:199], a[4:7], v[24:39]
ds_read_u16 v56, v56
v_mad_u32_u16 v57, v57, 2, s85 op_sel:[1,0,0,0]
v_mad_u32_u16 v58, v58, 2, s85 op_sel:[1,0,0,0]
v_mad_u32_u16 v59, v59, 2, s85 op_sel:[1,0,0,0]
v_mad_u32_u16 v60, v60, 2, s85 op_sel:[1,0,0,0]
v_mfma_f32_32x32x16_f16 v[94:109], a[224:227], v[48:51], v[94:109]
ds_read_u16_d16_hi v57, v57
ds_read_u16 v58, v58
s_waitcnt lgkmcnt(8)
v_or_b32 v44, v16, v17
v_pk_mul_f16 v224, v224, v248
v_mad_u32_u16 v61, v61, 2, s85 op_sel:[1,0,0,0]
v_mfma_f32_32x32x16_bf16 v[24:39], a[200:203], a[8:11], v[24:39]
ds_read_u16_d16_hi v59, v59
ds_read_u16 v60, v60
v_mad_u32_u16 v7, v7, 2, s85 op_sel:[1,0,0,0]
v_mad_u32_u16 v0, v0, 2, s85 op_sel:[1,0,0,0]
v_cvt_pk_f16_f32 v232, v208, v209
v_mfma_f32_32x32x16_f16 v[62:77], a[228:231], v[52:55], v[62:77]
ds_read_u16_d16_hi v61, v61
v_cvt_pk_f16_f32 v233, v210, v211
v_pk_mul_f16 v225, v225, v249
v_pk_fma_f16 v244, v232, v232, s84
v_cvt_pk_f16_f32 v234, v212, v213
v_pk_fma_f16 v245, v233, v233, s84
v_mfma_f32_32x32x16_bf16 v[24:39], a[204:207], a[12:15], v[24:39]
ds_read_u16 v7, v7
ds_read_u16_d16_hi v0, v0
s_waitcnt lgkmcnt(10)
v_or_b32 v45, v18, v19
v_pk_mul_f16 v244, v232, v244
v_cvt_pk_f16_f32 v235, v214, v215
v_mfma_f32_32x32x16_f16 v[78:93], a[232:235], v[52:55], v[78:93]
v_pk_mul_f16 v226, v226, v250
v_pk_fma_f16 v246, v234, v234, s84
v_pk_mul_f16 v245, v233, v245
v_pk_fma_f16 v247, v235, v235, s84
v_or_b32 v46, v20, v21
v_exp_f16 v248, v244
v_mfma_f32_32x32x16_bf16 v[24:39], a[208:211], a[16:19], v[24:39]
v_pk_mul_f16 v246, v234, v246
v_pk_mul_f16 v247, v235, v247
v_pk_mul_f16 v227, v227, v251
v_exp_f16 v249, v245
v_exp_f16 v250, v246
v_mfma_f32_32x32x16_f16 v[94:109], a[236:239], v[52:55], v[94:109]
s_waitcnt lgkmcnt(6)
v_or_b32 v47, v22, v23
v_exp_f16_sdwa v248, v244 dst_sel:WORD_1 dst_unused:UNUSED_PRESERVE src0_sel:WORD_1
v_exp_f16 v251, v247
v_mfma_f32_32x32x16_bf16 v[24:39], a[212:215], a[20:23], v[24:39]
v_exp_f16_sdwa v249, v245 dst_sel:WORD_1 dst_unused:UNUSED_PRESERVE src0_sel:WORD_1
v_exp_f16_sdwa v250, v246 dst_sel:WORD_1 dst_unused:UNUSED_PRESERVE src0_sel:WORD_1
v_exp_f16_sdwa v251, v247 dst_sel:WORD_1 dst_unused:UNUSED_PRESERVE src0_sel:WORD_1
s_waitcnt vmcnt(5)
v_smfmac_f32_32x32x32_bf16 v[94:109], a[250:253], a[168:175], v4
s_nop 4
v_mfma_f32_32x32x16_f16 v[110:125], a[216:219], v[224:227], v[110:125]
ds_read_b128 a[216:219], v3 offset:8960
v_mad_u32_u16 v24, v24, 2, s85 op_sel:[1,0,0,0]
v_mad_u32_u16 v25, v25, 2, s85 op_sel:[1,0,0,0]
v_mad_u32_u16 v26, v26, 2, s85 op_sel:[1,0,0,0]
v_mad_u32_u16 v27, v27, 2, s85 op_sel:[1,0,0,0]
v_mfma_f32_32x32x16_f16 v[126:141], a[220:223], v[224:227], v[126:141]
ds_read_b128 a[220:223], v3 offset:9984
ds_read_u16 v24, v24
ds_read_u16_d16_hi v25, v25
ds_read_u16 v26, v26
v_mad_u32_u16 v28, v28, 2, s85 op_sel:[1,0,0,0]
v_mad_u32_u16 v29, v29, 2, s85 op_sel:[1,0,0,0]
v_mfma_f32_32x32x16_f16 v[142:157], a[224:227], v[224:227], v[142:157]
ds_read_b128 a[224:227], v3 offset:11008
ds_read_u16_d16_hi v27, v27
ds_read_u16 v28, v28
ds_read_u16_d16_hi v29, v29
v_mad_u32_u16 v30, v30, 2, s85 op_sel:[1,0,0,0]
v_mad_u32_u16 v31, v31, 2, s85 op_sel:[1,0,0,0]
v_mfma_f32_32x32x16_f16 v[110:125], a[228:231], v[228:231], v[110:125]
ds_read_b128 a[228:231], v3 offset:12032
ds_read_u16 v30, v30
buffer_store_dwordx4 v[200:203], v6, s[8:11], s79 offen offset:128 sc1 nt
ds_read_u16_d16_hi v31, v31
v_mfma_f32_32x32x16_f16 v[126:141], a[232:235], v[228:231], v[126:141]
ds_read_b128 a[232:235], v3 offset:13056
v_mad_u32_u16 v32, v32, 2, s85 op_sel:[1,0,0,0]
v_mad_u32_u16 v33, v33, 2, s85 op_sel:[1,0,0,0]
v_mad_u32_u16 v34, v34, 2, s85 op_sel:[1,0,0,0]
v_pk_add_f16 v244, v248, 1.0 op_sel_hi:[1,0]
v_mad_u32_u16 v35, v35, 2, s85 op_sel:[1,0,0,0]
v_mfma_f32_32x32x16_f16 v[142:157], a[236:239], v[228:231], v[142:157]
ds_read_b128 a[236:239], v3 offset:14080
v_mad_u32_u16 v36, v36, 2, s85 op_sel:[1,0,0,0]
v_pk_add_f16 v245, v249, 1.0 op_sel_hi:[1,0]
v_mad_u32_u16 v37, v37, 2, s85 op_sel:[1,0,0,0]
v_rcp_f16 v248, v244
s_waitcnt lgkmcnt(8)
v_mfma_f32_32x32x16_f16 v[62:77], a[216:219], v[40:43], v[62:77]
ds_read_u16 v32, v32
ds_read_u16_d16_hi v33, v33
v_or_b32 v48, v24, v25
v_pk_add_f16 v246, v250, 1.0 op_sel_hi:[1,0]
v_mad_u32_u16 v38, v38, 2, s85 op_sel:[1,0,0,0]
v_mad_u32_u16 v39, v39, 2, s85 op_sel:[1,0,0,0]
v_mfma_f32_32x32x16_f16 v[78:93], a[220:223], v[40:43], v[78:93]
ds_read_u16 v34, v34
v_pk_add_f16 v247, v251, 1.0 op_sel_hi:[1,0]
v_or_b32 v236, v56, v57
v_or_b32 v237, v58, v59
v_or_b32 v238, v60, v61
v_or_b32 v239, v7, v0
v_mfma_f32_32x32x16_f16 v[94:109], a[224:227], v[40:43], v[94:109]
ds_read_u16_d16_hi v35, v35
s_waitcnt lgkmcnt(9)
v_or_b32 v49, v26, v27
v_rcp_f16 v249, v245
v_rcp_f16 v250, v246
v_rcp_f16_sdwa v248, v244 dst_sel:WORD_1 dst_unused:UNUSED_PRESERVE src0_sel:WORD_1
v_rcp_f16 v251, v247
v_pk_mul_f16 v232, v232, v248
v_rcp_f16_sdwa v249, v245 dst_sel:WORD_1 dst_unused:UNUSED_PRESERVE src0_sel:WORD_1
v_or_b32 v50, v28, v29
v_pk_mul_f16 v233, v233, v249
v_rcp_f16_sdwa v250, v246 dst_sel:WORD_1 dst_unused:UNUSED_PRESERVE src0_sel:WORD_1
s_waitcnt lgkmcnt(6)
v_mfma_f32_32x32x16_f16 v[62:77], a[228:231], v[44:47], v[62:77]
ds_read_u16 v36, v36
ds_read_u16_d16_hi v37, v37
ds_read_u16 v38, v38
ds_read_u16_d16_hi v39, v39
v_pk_mul_f16 v234, v234, v250
v_rcp_f16_sdwa v251, v247 dst_sel:WORD_1 dst_unused:UNUSED_PRESERVE src0_sel:WORD_1
s_nop 0
v_pk_mul_f16 v235, v235, v251
v_or_b32 v51, v30, v31
s_waitcnt lgkmcnt(7)
v_mfma_f32_32x32x16_f16 v[78:93], a[232:235], v[44:47], v[78:93]
v_mfma_f32_32x32x16_f16 v[94:109], a[236:239], v[44:47], v[94:109]
v_mfma_f32_32x32x16_f16 v[110:125], a[216:219], v[232:235], v[110:125]
ds_read_b128 a[216:219], v3 offset:15104
s_waitcnt lgkmcnt(5)
v_or_b32 v52, v32, v33
v_mfma_f32_32x32x16_f16 v[126:141], a[220:223], v[232:235], v[126:141]
ds_read_b128 a[220:223], v3 offset:16128
buffer_store_dwordx4 v[204:207], v6, s[8:11], s79 offen offset:3200 sc1 nt
v_mfma_f32_32x32x16_f16 v[142:157], a[224:227], v[232:235], v[142:157]
ds_read_b128 a[224:227], v3 offset:17152
v_or_b32 v53, v34, v35
v_mfma_f32_32x32x16_f16 v[110:125], a[228:231], v[236:239], v[110:125]
ds_read_b128 a[228:231], v3 offset:18176
s_waitcnt lgkmcnt(3)
v_or_b32 v54, v36, v37
v_mfma_f32_32x32x16_f16 v[126:141], a[232:235], v[236:239], v[126:141]
ds_read_b128 a[232:235], v3 offset:19200
v_or_b32 v55, v38, v39
v_mfma_f32_32x32x16_f16 v[142:157], a[236:239], v[236:239], v[142:157]
ds_read_b128 a[236:239], v3 offset:20224
s_waitcnt vmcnt(4)
v_smfmac_f32_32x32x32_bf16 v[142:157], a[250:253], a[176:183], v4
v_mfma_f32_32x32x16_f16 v[62:77], a[216:219], v[48:51], v[62:77]
s_waitcnt lgkmcnt(0)
v_mfma_f32_32x32x16_f16 v[78:93], a[220:223], v[48:51], v[78:93]
v_mfma_f32_32x32x16_f16 v[94:109], a[224:227], v[48:51], v[94:109]
v_mfma_f32_32x32x16_f16 v[62:77], a[228:231], v[52:55], v[62:77]
s_nop 5
v_mfma_f32_32x32x16_f16 v[78:93], a[232:235], v[52:55], v[78:93]
s_nop 4
v_cvt_pk_bf16_f32 v160, v62, v63
v_mfma_f32_32x32x16_f16 v[94:109], a[236:239], v[52:55], v[94:109]
v_cvt_pk_bf16_f32 v161, v64, v65
v_cvt_pk_bf16_f32 v162, v66, v67
v_cvt_pk_bf16_f32 v163, v68, v69
v_cvt_pk_bf16_f32 v164, v70, v71
v_cvt_pk_bf16_f32 v165, v72, v73
v_mfma_f32_32x32x16_f16 v[110:125], a[216:219], a[128:131], v[110:125]
v_cvt_pk_bf16_f32 v166, v74, v75
v_cvt_pk_bf16_f32 v167, v76, v77
v_permlane16_swap_b32 v160, v164
v_permlane16_swap_b32 v161, v165
v_mfma_f32_32x32x16_f16 v[126:141], a[220:223], a[128:131], v[126:141]
v_permlane16_swap_b32 v162, v166
v_permlane16_swap_b32 v163, v167
v_cvt_pk_bf16_f32 v168, v78, v79
v_cvt_pk_bf16_f32 v169, v80, v81
v_mfma_f32_32x32x16_f16 v[142:157], a[224:227], a[128:131], v[142:157]
buffer_store_dwordx4 v[160:163], v6, s[8:11], s76 offen offset:0 sc1 nt
v_mfma_f32_32x32x16_f16 v[110:125], a[228:231], a[132:135], v[110:125]
v_cvt_pk_bf16_f32 v170, v82, v83
v_cvt_pk_bf16_f32 v171, v84, v85
v_cvt_pk_bf16_f32 v172, v86, v87
v_cvt_pk_bf16_f32 v173, v88, v89
v_cvt_pk_bf16_f32 v174, v90, v91
v_mfma_f32_32x32x16_f16 v[126:141], a[232:235], a[132:135], v[126:141]
v_cvt_pk_bf16_f32 v175, v92, v93
v_permlane16_swap_b32 v168, v172
v_permlane16_swap_b32 v169, v173
v_permlane16_swap_b32 v170, v174
v_mfma_f32_32x32x16_f16 v[142:157], a[236:239], a[132:135], v[142:157]
v_permlane16_swap_b32 v171, v175
v_cvt_pk_bf16_f32 v176, v94, v95
v_cvt_pk_bf16_f32 v177, v96, v97
v_cvt_pk_bf16_f32 v178, v98, v99
v_cvt_pk_bf16_f32 v179, v100, v101
v_cvt_pk_bf16_f32 v180, v102, v103
v_cvt_pk_bf16_f32 v181, v104, v105
v_cvt_pk_bf16_f32 v182, v106, v107
v_cvt_pk_bf16_f32 v183, v108, v109
v_permlane16_swap_b32 v176, v180
v_permlane16_swap_b32 v177, v181
v_permlane16_swap_b32 v178, v182
v_permlane16_swap_b32 v179, v183
v_cvt_pk_bf16_f32 v184, v110, v111
v_cvt_pk_bf16_f32 v185, v112, v113
v_cvt_pk_bf16_f32 v186, v114, v115
v_cvt_pk_bf16_f32 v187, v116, v117
v_cvt_pk_bf16_f32 v188, v118, v119
v_cvt_pk_bf16_f32 v189, v120, v121
v_cvt_pk_bf16_f32 v190, v122, v123
v_cvt_pk_bf16_f32 v191, v124, v125
v_permlane16_swap_b32 v184, v188
v_permlane16_swap_b32 v185, v189
v_permlane16_swap_b32 v186, v190
v_permlane16_swap_b32 v187, v191
v_cvt_pk_bf16_f32 v192, v126, v127
v_cvt_pk_bf16_f32 v193, v128, v129
v_cvt_pk_bf16_f32 v194, v130, v131
v_cvt_pk_bf16_f32 v195, v132, v133
v_cvt_pk_bf16_f32 v196, v134, v135
v_cvt_pk_bf16_f32 v197, v136, v137
v_cvt_pk_bf16_f32 v198, v138, v139
v_cvt_pk_bf16_f32 v199, v140, v141
v_permlane16_swap_b32 v192, v196
v_permlane16_swap_b32 v193, v197
v_permlane16_swap_b32 v194, v198
v_permlane16_swap_b32 v195, v199
v_cvt_pk_bf16_f32 v200, v142, v143
v_cvt_pk_bf16_f32 v201, v144, v145
v_cvt_pk_bf16_f32 v202, v146, v147
v_cvt_pk_bf16_f32 v203, v148, v149
v_cvt_pk_bf16_f32 v204, v150, v151
v_cvt_pk_bf16_f32 v205, v152, v153
v_cvt_pk_bf16_f32 v206, v154, v155
v_cvt_pk_bf16_f32 v207, v156, v157
v_permlane16_swap_b32 v200, v204
v_permlane16_swap_b32 v201, v205
v_permlane16_swap_b32 v202, v206
v_permlane16_swap_b32 v203, v207
buffer_store_dwordx4 v[164:167], v6, s[8:11], s76 offen offset:3072 sc1 nt
buffer_store_dwordx4 v[168:171], v6, s[8:11], s76 offen offset:64 sc1 nt
buffer_store_dwordx4 v[172:175], v6, s[8:11], s76 offen offset:3136 sc1 nt
buffer_store_dwordx4 v[176:179], v6, s[8:11], s76 offen offset:128 sc1 nt
buffer_store_dwordx4 v[180:183], v6, s[8:11], s76 offen offset:3200 sc1 nt
buffer_store_dwordx4 v[184:187], v6, s[8:11], s77 offen offset:0 sc1 nt
buffer_store_dwordx4 v[188:191], v6, s[8:11], s77 offen offset:3072 sc1 nt
buffer_store_dwordx4 v[192:195], v6, s[8:11], s77 offen offset:64 sc1 nt
buffer_store_dwordx4 v[196:199], v6, s[8:11], s77 offen offset:3136 sc1 nt
buffer_store_dwordx4 v[200:203], v6, s[8:11], s77 offen offset:128 sc1 nt
buffer_store_dwordx4 v[204:207], v6, s[8:11], s77 offen offset:3200 sc1 nt
L_last:
s_endpgm
L_exit:
s_endpgm
L_redo:
v_lshlrev_b32 v46, 17, v0
v_or_b32 v46, 0x8000, v46
v_mov_b32 v48, 0x409d30fc
v_lshlrev_b32 v60, 2, v0
v_add_u32 v61, 159488, v60
v_add_u32 v60, 93952, v60
v_add_u32 v50, 0, v46
v_add_u32 v51, 0x10000, v46
v_pk_mul_f32 v[50:51], v[50:51], s[86:87] op_sel:[0,1] op_sel_hi:[1,1] neg_lo:[1,0] neg_hi:[1,0]
v_pk_fma_f32 v[52:53], v[50:51], v[50:51], v[48:49] op_sel_hi:[1,1,0]
v_add_u32 v54, 0x2000000, v46
v_pk_mul_f32 v[52:53], v[50:51], v[52:53]
v_add_u32 v55, 0x2010000, v46
v_exp_f32 v52, v52
v_pk_mul_f32 v[54:55], v[54:55], s[86:87] op_sel:[0,1] op_sel_hi:[1,1] neg_lo:[1,0] neg_hi:[1,0]
v_exp_f32 v53, v53
v_pk_fma_f32 v[56:57], v[54:55], v[54:55], v[48:49] op_sel_hi:[1,1,0]
v_pk_add_f32 v[52:53], v[52:53], 1.0 op_sel_hi:[1,0]
v_pk_mul_f32 v[56:57], v[54:55], v[56:57]
v_rcp_f32 v52, v52
v_exp_f32 v56, v56
v_rcp_f32 v53, v53
v_exp_f32 v57, v57
v_pk_mul_f32 v[50:51], v[50:51], v[52:53]
v_pk_add_f32 v[56:57], v[56:57], 1.0 op_sel_hi:[1,0]
v_pk_mul_f32 v[50:51], v[50:51], v[50:51]
v_rcp_f32 v56, v56
v_cvt_pk_bf16_f32 v58, v50, v51
v_rcp_f32 v57, v57
s_nop 0
v_pk_mul_f32 v[54:55], v[54:55], v[56:57]
v_pk_mul_f32 v[54:55], v[54:55], v[54:55]
v_cvt_pk_bf16_f32 v59, v54, v55
ds_write_b32 v60, v58 offset:0
ds_write_b32 v60, v59 offset:1024
v_add_u32 v50, 0x4000000, v46
v_add_u32 v51, 0x4010000, v46
v_pk_mul_f32 v[50:51], v[50:51], s[86:87] op_sel:[0,1] op_sel_hi:[1,1] neg_lo:[1,0] neg_hi:[1,0]
v_pk_fma_f32 v[52:53], v[50:51], v[50:51], v[48:49] op_sel_hi:[1,1,0]
v_add_u32 v54, 0x6000000, v46
v_pk_mul_f32 v[52:53], v[50:51], v[52:53]
v_add_u32 v55, 0x6010000, v46
v_exp_f32 v52, v52
v_pk_mul_f32 v[54:55], v[54:55], s[86:87] op_sel:[0,1] op_sel_hi:[1,1] neg_lo:[1,0] neg_hi:[1,0]
v_exp_f32 v53, v53
v_pk_fma_f32 v[56:57], v[54:55], v[54:55], v[48:49] op_sel_hi:[1,1,0]
v_pk_add_f32 v[52:53], v[52:53], 1.0 op_sel_hi:[1,0]
v_pk_mul_f32 v[56:57], v[54:55], v[56:57]
v_rcp_f32 v52, v52
v_exp_f32 v56, v56
v_rcp_f32 v53, v53
v_exp_f32 v57, v57
v_pk_mul_f32 v[50:51], v[50:51], v[52:53]
v_pk_add_f32 v[56:57], v[56:57], 1.0 op_sel_hi:[1,0]
v_pk_mul_f32 v[50:51], v[50:51], v[50:51]
v_rcp_f32 v56, v56
v_cvt_pk_bf16_f32 v58, v50, v51
v_rcp_f32 v57, v57
s_nop 0
v_pk_mul_f32 v[54:55], v[54:55], v[56:57]
v_pk_mul_f32 v[54:55], v[54:55], v[54:55]
v_cvt_pk_bf16_f32 v59, v54, v55
ds_write_b32 v60, v58 offset:2048
ds_write_b32 v60, v59 offset:3072
v_add_u32 v50, 0x8000000, v46
v_add_u32 v51, 0x8010000, v46
v_pk_mul_f32 v[50:51], v[50:51], s[86:87] op_sel:[0,1] op_sel_hi:[1,1] neg_lo:[1,0] neg_hi:[1,0]
v_pk_fma_f32 v[52:53], v[50:51], v[50:51], v[48:49] op_sel_hi:[1,1,0]
v_add_u32 v54, 0xa000000, v46
v_pk_mul_f32 v[52:53], v[50:51], v[52:53]
v_add_u32 v55, 0xa010000, v46
v_exp_f32 v52, v52
v_pk_mul_f32 v[54:55], v[54:55], s[86:87] op_sel:[0,1] op_sel_hi:[1,1] neg_lo:[1,0] neg_hi:[1,0]
v_exp_f32 v53, v53
v_pk_fma_f32 v[56:57], v[54:55], v[54:55], v[48:49] op_sel_hi:[1,1,0]
v_pk_add_f32 v[52:53], v[52:53], 1.0 op_sel_hi:[1,0]
v_pk_mul_f32 v[56:57], v[54:55], v[56:57]
v_rcp_f32 v52, v52
v_exp_f32 v56, v56
v_rcp_f32 v53, v53
v_exp_f32 v57, v57
v_pk_mul_f32 v[50:51], v[50:51], v[52:53]
v_pk_add_f32 v[56:57], v[56:57], 1.0 op_sel_hi:[1,0]
v_pk_mul_f32 v[50:51], v[50:51], v[50:51]
v_rcp_f32 v56, v56
v_cvt_pk_bf16_f32 v58, v50, v51
v_rcp_f32 v57, v57
s_nop 0
v_pk_mul_f32 v[54:55], v[54:55], v[56:57]
v_pk_mul_f32 v[54:55], v[54:55], v[54:55]
v_cvt_pk_bf16_f32 v59, v54, v55
ds_write_b32 v60, v58 offset:4096
ds_write_b32 v60, v59 offset:5120
v_add_u32 v50, 0, v46
v_add_u32 v51, 0x10000, v46
v_pk_mul_f32 v[50:51], v[50:51], s[86:87] op_sel:[0,1] op_sel_hi:[1,1]
v_pk_fma_f32 v[52:53], v[50:51], v[50:51], v[48:49] op_sel_hi:[1,1,0]
v_add_u32 v54, 0x2000000, v46
v_pk_mul_f32 v[52:53], v[50:51], v[52:53]
v_add_u32 v55, 0x2010000, v46
v_exp_f32 v52, v52
v_pk_mul_f32 v[54:55], v[54:55], s[86:87] op_sel:[0,1] op_sel_hi:[1,1]
v_exp_f32 v53, v53
v_pk_fma_f32 v[56:57], v[54:55], v[54:55], v[48:49] op_sel_hi:[1,1,0]
v_pk_add_f32 v[52:53], v[52:53], 1.0 op_sel_hi:[1,0]
v_pk_mul_f32 v[56:57], v[54:55], v[56:57]
v_rcp_f32 v52, v52
v_exp_f32 v56, v56
v_rcp_f32 v53, v53
v_exp_f32 v57, v57
v_pk_mul_f32 v[50:51], v[50:51], v[52:53]
v_pk_add_f32 v[56:57], v[56:57], 1.0 op_sel_hi:[1,0]
v_pk_mul_f32 v[50:51], v[50:51], v[50:51]
v_rcp_f32 v56, v56
v_cvt_pk_bf16_f32 v58, v50, v51
v_rcp_f32 v57, v57
s_nop 0
v_pk_mul_f32 v[54:55], v[54:55], v[56:57]
v_pk_mul_f32 v[54:55], v[54:55], v[54:55]
v_cvt_pk_bf16_f32 v59, v54, v55
ds_write_b32 v61, v58 offset:0
ds_write_b32 v61, v59 offset:1024
v_add_u32 v50, 0x4000000, v46
v_add_u32 v51, 0x4010000, v46
v_pk_mul_f32 v[50:51], v[50:51], s[86:87] op_sel:[0,1] op_sel_hi:[1,1]
v_pk_fma_f32 v[52:53], v[50:51], v[50:51], v[48:49] op_sel_hi:[1,1,0]
v_add_u32 v54, 0x6000000, v46
v_pk_mul_f32 v[52:53], v[50:51], v[52:53]
v_add_u32 v55, 0x6010000, v46
v_exp_f32 v52, v52
v_pk_mul_f32 v[54:55], v[54:55], s[86:87] op_sel:[0,1] op_sel_hi:[1,1]
v_exp_f32 v53, v53
v_pk_fma_f32 v[56:57], v[54:55], v[54:55], v[48:49] op_sel_hi:[1,1,0]
v_pk_add_f32 v[52:53], v[52:53], 1.0 op_sel_hi:[1,0]
v_pk_mul_f32 v[56:57], v[54:55], v[56:57]
v_rcp_f32 v52, v52
v_exp_f32 v56, v56
v_rcp_f32 v53, v53
v_exp_f32 v57, v57
v_pk_mul_f32 v[50:51], v[50:51], v[52:53]
v_pk_add_f32 v[56:57], v[56:57], 1.0 op_sel_hi:[1,0]
v_pk_mul_f32 v[50:51], v[50:51], v[50:51]
v_rcp_f32 v56, v56
v_cvt_pk_bf16_f32 v58, v50, v51
v_rcp_f32 v57, v57
s_nop 0
v_pk_mul_f32 v[54:55], v[54:55], v[56:57]
v_pk_mul_f32 v[54:55], v[54:55], v[54:55]
v_cvt_pk_bf16_f32 v59, v54, v55
ds_write_b32 v61, v58 offset:2048
ds_write_b32 v61, v59 offset:3072
v_add_u32 v50, 0x8000000, v46
v_add_u32 v51, 0x8010000, v46
v_pk_mul_f32 v[50:51], v[50:51], s[86:87] op_sel:[0,1] op_sel_hi:[1,1]
v_pk_fma_f32 v[52:53], v[50:51], v[50:51], v[48:49] op_sel_hi:[1,1,0]
v_pk_mul_f32 v[52:53], v[50:51], v[52:53]
v_exp_f32 v52, v52
v_exp_f32 v53, v53
s_nop 0
v_pk_add_f32 v[52:53], v[52:53], 1.0 op_sel_hi:[1,0]
v_rcp_f32 v52, v52
v_rcp_f32 v53, v53
s_nop 0
v_pk_mul_f32 v[50:51], v[50:51], v[52:53]
v_pk_mul_f32 v[50:51], v[50:51], v[50:51]
v_cvt_pk_bf16_f32 v58, v50, v51
ds_write_b32 v61, v58 offset:4096
s_lshl_b32 s65, s88, 23
s_sub_u32 s65, 0x3f800000, s65
v_accvgpr_read_b32 v50, a0
v_and_b32 v51, 0xffff0000, v50
v_lshlrev_b32 v50, 16, v50
v_mul_f32 v50, s65, v50
v_mul_f32 v51, s65, v51
v_cvt_pk_bf16_f32 v50, v50, v51
v_accvgpr_write_b32 a0, v50
v_accvgpr_read_b32 v50, a1
v_and_b32 v51, 0xffff0000, v50
v_lshlrev_b32 v50, 16, v50
v_mul_f32 v50, s65, v50
v_mul_f32 v51, s65, v51
v_cvt_pk_bf16_f32 v50, v50, v51
v_accvgpr_write_b32 a1, v50
v_accvgpr_read_b32 v50, a2
v_and_b32 v51, 0xffff0000, v50
v_lshlrev_b32 v50, 16, v50
v_mul_f32 v50, s65, v50
v_mul_f32 v51, s65, v51
v_cvt_pk_bf16_f32 v50, v50, v51
v_accvgpr_write_b32 a2, v50
v_accvgpr_read_b32 v50, a3
v_and_b32 v51, 0xffff0000, v50
v_lshlrev_b32 v50, 16, v50
v_mul_f32 v50, s65, v50
v_mul_f32 v51, s65, v51
v_cvt_pk_bf16_f32 v50, v50, v51
v_accvgpr_write_b32 a3, v50
v_accvgpr_read_b32 v50, a4
v_and_b32 v51, 0xffff0000, v50
v_lshlrev_b32 v50, 16, v50
v_mul_f32 v50, s65, v50
v_mul_f32 v51, s65, v51
v_cvt_pk_bf16_f32 v50, v50, v51
v_accvgpr_write_b32 a4, v50
v_accvgpr_read_b32 v50, a5
v_and_b32 v51, 0xffff0000, v50
v_lshlrev_b32 v50, 16, v50
v_mul_f32 v50, s65, v50
v_mul_f32 v51, s65, v51
v_cvt_pk_bf16_f32 v50, v50, v51
v_accvgpr_write_b32 a5, v50
v_accvgpr_read_b32 v50, a6
v_and_b32 v51, 0xffff0000, v50
v_lshlrev_b32 v50, 16, v50
v_mul_f32 v50, s65, v50
v_mul_f32 v51, s65, v51
v_cvt_pk_bf16_f32 v50, v50, v51
v_accvgpr_write_b32 a6, v50
v_accvgpr_read_b32 v50, a7
v_and_b32 v51, 0xffff0000, v50
v_lshlrev_b32 v50, 16, v50
v_mul_f32 v50, s65, v50
v_mul_f32 v51, s65, v51
v_cvt_pk_bf16_f32 v50, v50, v51
v_accvgpr_write_b32 a7, v50
v_accvgpr_read_b32 v50, a8
v_and_b32 v51, 0xffff0000, v50
v_lshlrev_b32 v50, 16, v50
v_mul_f32 v50, s65, v50
v_mul_f32 v51, s65, v51
v_cvt_pk_bf16_f32 v50, v50, v51
v_accvgpr_write_b32 a8, v50
v_accvgpr_read_b32 v50, a9
v_and_b32 v51, 0xffff0000, v50
v_lshlrev_b32 v50, 16, v50
v_mul_f32 v50, s65, v50
v_mul_f32 v51, s65, v51
v_cvt_pk_bf16_f32 v50, v50, v51
v_accvgpr_write_b32 a9, v50
v_accvgpr_read_b32 v50, a10
v_and_b32 v51, 0xffff0000, v50
v_lshlrev_b32 v50, 16, v50
v_mul_f32 v50, s65, v50
v_mul_f32 v51, s65, v51
v_cvt_pk_bf16_f32 v50, v50, v51
v_accvgpr_write_b32 a10, v50
v_accvgpr_read_b32 v50, a11
v_and_b32 v51, 0xffff0000, v50
v_lshlrev_b32 v50, 16, v50
v_mul_f32 v50, s65, v50
v_mul_f32 v51, s65, v51
v_cvt_pk_bf16_f32 v50, v50, v51
v_accvgpr_write_b32 a11, v50
v_accvgpr_read_b32 v50, a12
v_and_b32 v51, 0xffff0000, v50
v_lshlrev_b32 v50, 16, v50
v_mul_f32 v50, s65, v50
v_mul_f32 v51, s65, v51
v_cvt_pk_bf16_f32 v50, v50, v51
v_accvgpr_write_b32 a12, v50
v_accvgpr_read_b32 v50, a13
v_and_b32 v51, 0xffff0000, v50
v_lshlrev_b32 v50, 16, v50
v_mul_f32 v50, s65, v50
v_mul_f32 v51, s65, v51
v_cvt_pk_bf16_f32 v50, v50, v51
v_accvgpr_write_b32 a13, v50
v_accvgpr_read_b32 v50, a14
v_and_b32 v51, 0xffff0000, v50
v_lshlrev_b32 v50, 16, v50
v_mul_f32 v50, s65, v50
v_mul_f32 v51, s65, v51
v_cvt_pk_bf16_f32 v50, v50, v51
v_accvgpr_write_b32 a14, v50
v_accvgpr_read_b32 v50, a15
v_and_b32 v51, 0xffff0000, v50
v_lshlrev_b32 v50, 16, v50
v_mul_f32 v50, s65, v50
v_mul_f32 v51, s65, v51
v_cvt_pk_bf16_f32 v50, v50, v51
v_accvgpr_write_b32 a15, v50
v_accvgpr_read_b32 v50, a16
v_and_b32 v51, 0xffff0000, v50
v_lshlrev_b32 v50, 16, v50
v_mul_f32 v50, s65, v50
v_mul_f32 v51, s65, v51
v_cvt_pk_bf16_f32 v50, v50, v51
v_accvgpr_write_b32 a16, v50
v_accvgpr_read_b32 v50, a17
v_and_b32 v51, 0xffff0000, v50
v_lshlrev_b32 v50, 16, v50
v_mul_f32 v50, s65, v50
v_mul_f32 v51, s65, v51
v_cvt_pk_bf16_f32 v50, v50, v51
v_accvgpr_write_b32 a17, v50
v_accvgpr_read_b32 v50, a18
v_and_b32 v51, 0xffff0000, v50
v_lshlrev_b32 v50, 16, v50
v_mul_f32 v50, s65, v50
v_mul_f32 v51, s65, v51
v_cvt_pk_bf16_f32 v50, v50, v51
v_accvgpr_write_b32 a18, v50
v_accvgpr_read_b32 v50, a19
v_and_b32 v51, 0xffff0000, v50
v_lshlrev_b32 v50, 16, v50
v_mul_f32 v50, s65, v50
v_mul_f32 v51, s65, v51
v_cvt_pk_bf16_f32 v50, v50, v51
v_accvgpr_write_b32 a19, v50
v_accvgpr_read_b32 v50, a20
v_and_b32 v51, 0xffff0000, v50
v_lshlrev_b32 v50, 16, v50
v_mul_f32 v50, s65, v50
v_mul_f32 v51, s65, v51
v_cvt_pk_bf16_f32 v50, v50, v51
v_accvgpr_write_b32 a20, v50
v_accvgpr_read_b32 v50, a21
v_and_b32 v51, 0xffff0000, v50
v_lshlrev_b32 v50, 16, v50
v_mul_f32 v50, s65, v50
v_mul_f32 v51, s65, v51
v_cvt_pk_bf16_f32 v50, v50, v51
v_accvgpr_write_b32 a21, v50
v_accvgpr_read_b32 v50, a22
v_and_b32 v51, 0xffff0000, v50
v_lshlrev_b32 v50, 16, v50
v_mul_f32 v50, s65, v50
v_mul_f32 v51, s65, v51
v_cvt_pk_bf16_f32 v50, v50, v51
v_accvgpr_write_b32 a22, v50
v_accvgpr_read_b32 v50, a23
v_and_b32 v51, 0xffff0000, v50
v_lshlrev_b32 v50, 16, v50
v_mul_f32 v50, s65, v50
v_mul_f32 v51, s65, v51
v_cvt_pk_bf16_f32 v50, v50, v51
v_accvgpr_write_b32 a23, v50
s_waitcnt lgkmcnt(0)
s_barrier
s_branch L_back
L_spin3:
ds_read_b32 v156, v155
s_waitcnt lgkmcnt(0)
v_cmp_gt_u32 vcc, 3, v156
s_nop 1
s_cbranch_vccnz L_spin3
s_branch L_ok3
L_spin4:
ds_read_b32 v156, v155
s_waitcnt lgkmcnt(0)
v_cmp_gt_u32 vcc, 4, v156
s_nop 1
s_cbranch_vccnz L_spin4
s_branch L_ok4
L_spin5:
ds_read_b32 v156, v155
s_waitcnt lgkmcnt(0)
v_cmp_gt_u32 vcc, 5, v156
s_nop 1
s_cbranch_vccnz L_spin5
s_branch L_ok5
L_spin6:
ds_read_b32 v156, v155
s_waitcnt lgkmcnt(0)
v_cmp_gt_u32 vcc, 6, v156
s_nop 1
s_cbranch_vccnz L_spin6
s_branch L_ok6
L_spin7:
ds_read_b32 v156, v155
s_waitcnt lgkmcnt(0)
v_cmp_gt_u32 vcc, 7, v156
s_nop 1
s_cbranch_vccnz L_spin7
s_branch L_ok7
L_spin8:
ds_read_b32 v156, v155
s_waitcnt lgkmcnt(0)
v_cmp_gt_u32 vcc, 8, v156
s_nop 1
s_cbranch_vccnz L_spin8
s_branch L_ok8
L_spin9:
ds_read_b32 v156, v155
s_waitcnt lgkmcnt(0)
v_cmp_gt_u32 vcc, 9, v156
s_nop 1
s_cbranch_vccnz L_spin9
s_branch L_ok9
L_spin10:
ds_read_b32 v156, v155
s_waitcnt lgkmcnt(0)
v_cmp_gt_u32 vcc, 10, v156
s_nop 1
s_cbranch_vccnz L_spin10
s_branch L_ok10
L_spin11:
ds_read_b32 v156, v155
s_waitcnt lgkmcnt(0)
v_cmp_gt_u32 vcc, 11, v156
s_nop 1
s_cbranch_vccnz L_spin11
s_branch L_ok11
L_spin12:
ds_read_b32 v156, v155
s_waitcnt lgkmcnt(0)
v_cmp_gt_u32 vcc, 12, v156
s_nop 1
s_cbranch_vccnz L_spin12
s_branch L_ok12
.section .rodata,"a"
.p2align 6
.amdhsa_kernel standalone__modern_conv_block_slak__vision_kernel
  .amdhsa_next_free_vgpr 512
  .amdhsa_next_free_sgpr 102
  .amdhsa_accum_offset 256
  .amdhsa_group_segment_fixed_size 0
  .amdhsa_kernarg_size 72
  .amdhsa_user_sgpr_count 2
  .amdhsa_user_sgpr_kernarg_segment_ptr 1
  .amdhsa_system_sgpr_workgroup_id_x 1
  .amdhsa_float_denorm_mode_32 3
.end_amdhsa_kernel
```
